```python
import torch

def _softmax(x, axis=-1):
    return torch.softmax(x, dim=axis)
def _gelu(x):
    return torch.nn.functional.gelu(x, approximate="tanh")
def _silu(x):
    return torch.nn.functional.silu(x)
def _sigmoid(x):
    return torch.sigmoid(x)
def _layernorm(x, axis=-1, eps=1e-5):
    m = x.mean(dim=axis, keepdim=True)
    v = x.var(dim=axis, keepdim=True, unbiased=False)
    return (x - m) / torch.sqrt(v + eps)
def _scatter_add(tgt, idx, src, axis=0):
    return tgt.clone().index_add_(axis, idx, src)
def _segment_sum(src, seg, n):
    out = torch.zeros((n,) + src.shape[1:], dtype=src.dtype)
    return out.index_add_(0, seg, src)
def _pad(x, pw):
    flat = tuple(v for pair in reversed(pw) for v in pair)
    return torch.nn.functional.pad(x, flat)

kernel_name = 'parallel_sum__linear_kernel_hedgehog__glu_gated_glu__prompt'

def setup_inputs():

    _w = (lambda a: (lambda t: t.to(torch.bfloat16) if t.is_floating_point() else t)(torch.as_tensor(a)))
    def _A_setup():
        B, S, D, H = 1, 2048, 1024, 32
        Dh = D // H
        return {
            "x": _w((lambda *s: torch.randn(*s, dtype=torch.bfloat16) * 0.05)(B, S, D)),
            "wqkv": _w((lambda *s: torch.randn(*s, dtype=torch.bfloat16) * 0.4)(D, 3 * D)),
            "w_phi": _w((lambda *s: torch.randn(*s, dtype=torch.bfloat16) * 0.4)(H, Dh, Dh) * (Dh ** -0.5)),
            "wo": _w((lambda *s: torch.randn(*s, dtype=torch.bfloat16) * 0.1)(D, D)),
        }
    _A_in = _A_setup()

    def _B_setup():
        B, S, D, F = 1, 2048, 1024, 3584
        return {
            "x": _w((lambda *s: torch.randn(*s, dtype=torch.bfloat16) * 0.05)(B, S, D)),
            "w_gate": _w((lambda *s: torch.randn(*s, dtype=torch.bfloat16) * 0.05)(D, F)),
            "w_up": _w((lambda *s: torch.randn(*s, dtype=torch.bfloat16) * 0.05)(D, F)),
            "w_down": _w((lambda *s: torch.randn(*s, dtype=torch.bfloat16) * 0.05)(F, D)),
        }
    _B_in = _B_setup()

    return {
        "A_x": _A_in["x"],
        "A_wqkv": _A_in["wqkv"],
        "A_w_phi": _A_in["w_phi"],
        "A_wo": _A_in["wo"],
        "B_x": _B_in["x"],
        "B_w_gate": _B_in["w_gate"],
        "B_w_up": _B_in["w_up"],
        "B_w_down": _B_in["w_down"],
    }

def reference(A_x, A_wqkv, A_w_phi, A_wo, B_x, B_w_gate, B_w_up, B_w_down):
    def _A_ref(x, wqkv, w_phi, wo):
        B, S, D = x.shape
        H = 32; Dh = D // H
        qkv = (lambda x, *d: x.permute(*d))((x @ wqkv).reshape(B, S, 3, H, Dh), 2, 0, 3, 1, 4)
        q, k, v = qkv[0], qkv[1], qkv[2]
        pq = torch.einsum("bhsd,hdf->bhsf", q, w_phi)
        pk = torch.einsum("bhsd,hdf->bhsf", k, w_phi)
        phi_q = torch.concatenate([_softmax(pq, axis=-1), _softmax(-pq, axis=-1)], axis=-1)
        phi_k = torch.concatenate([_softmax(pk, axis=-1), _softmax(-pk, axis=-1)], axis=-1)
        kv = torch.einsum("bhsf,bhsd->bhfd", phi_k, v)
        z  = torch.einsum("bhsf->bhf", phi_k)
        num = torch.einsum("bhqf,bhfd->bhqd", phi_q, kv)
        den = torch.einsum("bhqf,bhf->bhq", phi_q, z)[..., None] + 1e-6
        o = num / den
        return (lambda x, *d: x.permute(*d))(o, 0, 2, 1, 3).reshape(B, S, D) @ wo

    def _B_ref(x, w_gate, w_up, w_down):
        g = torch.einsum("bsd,df->bsf", x, w_gate)
        u = torch.einsum("bsd,df->bsf", x, w_up)
        h = _sigmoid(g) * u
        return torch.einsum("bsf,fd->bsd", h, w_down)

    x = A_x
    xn = _layernorm(x, axis=-1)
    return x + _A_ref(xn, A_wqkv, A_w_phi, A_wo) + _B_ref(xn, B_w_gate, B_w_up, B_w_down)
```

```asm
; @launch kernel=fused_kernel grid=(256,1,1) block=(512,1,1) lds=163840
.amdgcn_target "amdgcn-amd-amdhsa--gfx950"
.text
.globl fused_kernel
.p2align 8
.type fused_kernel,@function
fused_kernel:
  s_cmp_ge_u32 s2, 256
  s_cbranch_scc1 L_done
  s_getpc_b64 s[20:21]
L_pc_ref0:
  s_sub_u32 s20, s20, L_pc_ref0 - fused_kernel
  s_subb_u32 s21, s21, 0
  s_and_b32 s21, s21, 0xffff
  s_mov_b32 s22, L_done - fused_kernel
  s_mov_b32 s23, 0x00020000
  v_subrev_u32 v13, 448, v0
  v_cmp_gt_u32 vcc, 24, v13
  v_lshlrev_b32 v13, 7, v13
  s_lshr_b32 s51, s2, 3
  s_mul_i32 s51, s51, 3072
  s_and_saveexec_b64 s[52:53], vcc
  s_cbranch_execz L_pc_skip
  buffer_load_dword v1, v13, s[20:23], s51 offen
L_pc_skip:
  s_mov_b64 exec, -1
  s_load_dwordx8 s[36:43], s[0:1], 0
  s_load_dwordx4 s[44:47], s[0:1], 40
  s_load_dwordx4 s[96:99], s[0:1], 72
  s_load_dwordx2 s[100:101], s[0:1], 56
  s_load_dwordx2 s[48:49], s[0:1], 64
  v_lshrrev_b32 v11, 6, v0
  v_and_b32 v10, 63, v0
  v_readfirstlane_b32 s3, v11
  s_lshl_b32 s50, s2, 3
  v_add_u32 v60, s50, v11
  v_lshlrev_b32 v61, 11, v60
  v_lshl_add_u32 v61, v10, 4, v61
  v_lshlrev_b32 v9, 4, v10
  s_and_b32 s4, s3, 3
  s_lshr_b32 s5, s3, 2
  s_and_b32 s50, s2, 7
  s_lshr_b32 s51, s2, 3
  s_and_b32 s6, s51, 3
  s_lshl_b32 s50, s50, 2
  s_add_u32 s6, s6, s50
  s_lshr_b32 s7, s51, 2
  s_lshl_b32 s50, s7, 8
  s_lshl_b32 s55, s5, 6
  s_add_u32 s50, s50, s55
  s_lshl_b32 s55, s4, 2
  s_add_u32 s50, s50, s55
  s_add_u32 s50, s50, 0
  v_bfe_u32 v11, v10, 3, 1
  v_lshrrev_b32 v12, 4, v10
  v_lshl_add_u32 v11, v12, 4, v11
  v_add_u32 v11, s50, v11
  v_lshlrev_b32 v11, 11, v11
  v_and_b32 v13, 7, v10
  v_lshl_add_u32 v1, v13, 4, v11
  s_mul_i32 s24, s3, 2080
  s_lshl_b32 s50, s3, 6
  v_add_u32 v13, s50, v10
  v_mul_u32_u24 v14, 4682, v13
  v_lshrrev_b32 v14, 16, v14
  v_mul_u32_u24 v15, 14, v14
  v_sub_u32 v15, v13, v15
  v_mul_u32_u24 v14, 7168, v14
  v_lshl_add_u32 v14, v15, 4, v14
  s_mul_i32 s50, s6, 224
  v_add_u32 v2, s50, v14
  v_mov_b32 v3, v2
  v_lshrrev_b32 v15, 2, v10
  v_mul_u32_u24 v15, 6144, v15
  v_lshrrev_b32 v16, 3, v10
  v_and_b32 v16, 2, v16
  v_and_b32 v17, 3, v10
  v_xor_b32 v16, v16, v17
  v_lshl_add_u32 v15, v16, 4, v15
  s_lshr_b32 s50, s3, 1
  s_lshl_b32 s50, s50, 11
  s_and_b32 s51, s3, 1
  s_mul_i32 s51, s51, 98304
  s_add_u32 s50, s50, s51
  s_lshl_b32 s51, s6, 6
  s_add_u32 s50, s50, s51
  v_add_u32 v4, s50, v15
  s_lshl_b32 s35, s3, 10
  s_add_u32 s33, s35, 6144
  s_add_u32 s34, s35, 13312
  s_mov_b32 s27, 0
  s_mov_b32 s30, 229376
  s_mov_b32 s28, 0
  s_mov_b32 s31, 229376
  s_mov_b32 s29, 0
  s_mov_b32 s32, 196608
  s_waitcnt lgkmcnt(0)
  s_mov_b32 s8, s36
  s_and_b32 s9, s37, 0xffff
  s_mov_b32 s10, 4194304
  s_mov_b32 s11, 0x00020000
  s_mov_b32 s12, s44
  s_and_b32 s13, s45, 0xffff
  s_mov_b32 s14, 7340032
  s_mov_b32 s15, 0x00020000
  s_mov_b32 s16, s46
  s_and_b32 s17, s47, 0xffff
  s_mov_b32 s18, 7340032
  s_mov_b32 s19, 0x00020000
  s_mov_b32 s20, s38
  s_and_b32 s21, s39, 0xffff
  s_mov_b32 s22, 6291456
  s_mov_b32 s23, 0x00020000
  s_cmp_eq_u32 s3, 7
  s_cbranch_scc1 L_pro7
  s_cmp_eq_u32 s3, 6
  s_cbranch_scc1 L_pro6
  s_mov_b32 s50, 0
  s_add_u32 m0, s24, 0
  s_nop 0
  buffer_load_dwordx4 v1, s[8:11], s50 offen lds
  s_mov_b32 s50, 4096
  s_add_u32 m0, s24, 1040
  s_nop 0
  buffer_load_dwordx4 v1, s[8:11], s50 offen lds
  s_mov_b32 s50, 262144
  s_add_u32 m0, s24, 16640
  s_nop 0
  buffer_load_dwordx4 v1, s[8:11], s50 offen lds
  s_mov_b32 s50, 266240
  s_add_u32 m0, s24, 17680
  s_nop 0
  buffer_load_dwordx4 v1, s[8:11], s50 offen lds
  s_add_u32 m0, s33, 66560
  s_nop 0
  buffer_load_dwordx4 v2, s[12:15], s27 offen lds
  s_add_u32 s27, s27, s30
  s_add_u32 m0, s34, 66560
  s_nop 0
  buffer_load_dwordx4 v3, s[16:19], s28 offen lds
  s_add_u32 s28, s28, s31
  s_add_u32 m0, s35, 66560
  s_nop 0
  buffer_load_dwordx4 v4, s[20:23], s29 offen lds
  s_add_u32 s29, s29, s32
  s_add_u32 m0, s33, 87040
  s_nop 0
  buffer_load_dwordx4 v2, s[12:15], s27 offen lds
  s_add_u32 s27, s27, s30
  s_add_u32 m0, s34, 87040
  s_nop 0
  buffer_load_dwordx4 v3, s[16:19], s28 offen lds
  s_add_u32 s28, s28, s31
  s_add_u32 m0, s35, 87040
  s_nop 0
  buffer_load_dwordx4 v4, s[20:23], s29 offen lds
  s_add_u32 s29, s29, s32
  s_branch L_pro_common
L_pro6:
  s_mov_b32 s50, 0
  s_add_u32 m0, s24, 0
  s_nop 0
  buffer_load_dwordx4 v1, s[8:11], s50 offen lds
  s_mov_b32 s50, 4096
  s_add_u32 m0, s24, 1040
  s_nop 0
  buffer_load_dwordx4 v1, s[8:11], s50 offen lds
  s_mov_b32 s50, 8192
  s_add_u32 m0, s24, 2080
  s_nop 0
  buffer_load_dwordx4 v1, s[8:11], s50 offen lds
  s_mov_b32 s50, 12288
  s_add_u32 m0, s24, 3120
  s_nop 0
  buffer_load_dwordx4 v1, s[8:11], s50 offen lds
  s_mov_b32 s50, 262144
  s_add_u32 m0, s24, 16640
  s_nop 0
  buffer_load_dwordx4 v1, s[8:11], s50 offen lds
  s_mov_b32 s50, 266240
  s_add_u32 m0, s24, 17680
  s_nop 0
  buffer_load_dwordx4 v1, s[8:11], s50 offen lds
  s_mov_b32 s50, 270336
  s_add_u32 m0, s24, 18720
  s_nop 0
  buffer_load_dwordx4 v1, s[8:11], s50 offen lds
  s_mov_b32 s50, 274432
  s_add_u32 m0, s24, 19760
  s_nop 0
  buffer_load_dwordx4 v1, s[8:11], s50 offen lds
  s_add_u32 m0, s33, 66560
  s_nop 0
  buffer_load_dwordx4 v2, s[12:15], s27 offen lds
  s_add_u32 s27, s27, s30
  s_add_u32 m0, s34, 66560
  s_nop 0
  buffer_load_dwordx4 v3, s[16:19], s28 offen lds
  s_add_u32 s28, s28, s31
  s_add_u32 m0, s33, 87040
  s_nop 0
  buffer_load_dwordx4 v2, s[12:15], s27 offen lds
  s_add_u32 s27, s27, s30
  s_add_u32 m0, s34, 87040
  s_nop 0
  buffer_load_dwordx4 v3, s[16:19], s28 offen lds
  s_add_u32 s28, s28, s31
  s_branch L_pro_common
L_pro7:
  buffer_load_dwordx4 v[80:83], v61, s[8:11], 0 offen
  buffer_load_dwordx4 v[84:87], v61, s[8:11], 0 offen offset:1024
  v_min_u32 v13, 13, v10
  s_mul_i32 s50, s2, 14
  v_add_u32 v13, s50, v13
  v_lshlrev_b32 v2, 7, v13
  v_mov_b32 v3, v2
  v_min_u32 v13, 11, v10
  s_mul_i32 s50, s2, 12
  v_add_u32 v13, s50, v13
  v_lshlrev_b32 v4, 7, v13
  s_mov_b32 s27, 1146880
  s_mov_b32 s30, 458752
  s_mov_b32 s28, 1146880
  s_mov_b32 s31, 458752
  s_mov_b32 s29, 983040
  s_mov_b32 s32, 393216
L_pro_common:
  s_mov_b32 s64, s98
  s_and_b32 s65, s99, 0xffff
  s_mov_b32 s66, 268435456
  s_mov_b32 s67, 0x00020000
  s_mov_b32 s56, s96
  s_and_b32 s57, s97, 0xffff
  s_mov_b32 s58, 256
  s_mov_b32 s59, 0x00020000
  s_mov_b32 s68, s40
  s_and_b32 s69, s41, 0xffff
  s_mov_b32 s70, 65536
  s_mov_b32 s71, 0x00020000
  s_mov_b32 s72, 3216550459
  s_mov_b32 s73, 1069066811
  s_mov_b32 s78, 0x3f803f80
  s_mov_b32 s79, 0xffff0000
  v_and_b32 v16, 15, v10
  v_lshrrev_b32 v17, 2, v16
  v_lshl_add_u32 v17, v12, 2, v17
  v_and_b32 v18, 3, v16
  v_lshlrev_b32 v18, 3, v18
  v_mul_u32_u24 v19, 224, v17
  v_add_u32 v19, v19, v18
  v_add_u32 v6, 66560, v19
  v_lshl_add_u32 v19, v17, 6, v18
  v_and_b32 v20, 1, v12
  v_lshl_add_u32 v19, v20, 5, v19
  v_add_u32 v7, 66560, v19
  v_xor_b32 v8, 32, v7
  v_add_u32 v93, 40960, v6
  v_add_u32 v94, 40960, v7
  v_add_u32 v95, 40960, v8
  v_lshrrev_b32 v19, 1, v16
  s_lshl_b32 s50, s4, 3
  v_add_u32 v19, s50, v19
  v_mul_u32_u24 v19, 1040, v19
  v_and_b32 v20, 1, v16
  v_lshl_add_u32 v19, v20, 7, v19
  v_lshl_add_u32 v5, v12, 3, v19
  s_mov_b32 s25, 256
  s_mov_b32 s26, 256
  v_mov_b32 v96, 0
  v_mov_b32 v97, 0
  v_mov_b32 v98, 0
  v_mov_b32 v99, 0
  v_mov_b32 v100, 0
  v_mov_b32 v101, 0
  v_mov_b32 v102, 0
  v_mov_b32 v103, 0
  v_mov_b32 v104, 0
  v_mov_b32 v105, 0
  v_mov_b32 v106, 0
  v_mov_b32 v107, 0
  v_mov_b32 v108, 0
  v_mov_b32 v109, 0
  v_mov_b32 v110, 0
  v_mov_b32 v111, 0
  v_mov_b32 v112, 0
  v_mov_b32 v113, 0
  v_mov_b32 v114, 0
  v_mov_b32 v115, 0
  v_mov_b32 v116, 0
  v_mov_b32 v117, 0
  v_mov_b32 v118, 0
  v_mov_b32 v119, 0
  v_mov_b32 v120, 0
  v_mov_b32 v121, 0
  v_mov_b32 v122, 0
  v_mov_b32 v123, 0
  v_mov_b32 v124, 0
  v_mov_b32 v125, 0
  v_mov_b32 v126, 0
  v_mov_b32 v127, 0
  v_mov_b32 v128, 0
  v_mov_b32 v129, 0
  v_mov_b32 v130, 0
  v_mov_b32 v131, 0
  v_mov_b32 v132, 0
  v_mov_b32 v133, 0
  v_mov_b32 v134, 0
  v_mov_b32 v135, 0
  v_mov_b32 v136, 0
  v_mov_b32 v137, 0
  v_mov_b32 v138, 0
  v_mov_b32 v139, 0
  v_mov_b32 v140, 0
  v_mov_b32 v141, 0
  v_mov_b32 v142, 0
  v_mov_b32 v143, 0
  v_mov_b32 v144, 0
  v_mov_b32 v145, 0
  v_mov_b32 v146, 0
  v_mov_b32 v147, 0
  v_mov_b32 v148, 0
  v_mov_b32 v149, 0
  v_mov_b32 v150, 0
  v_mov_b32 v151, 0
  v_mov_b32 v152, 0
  v_mov_b32 v153, 0
  v_mov_b32 v154, 0
  v_mov_b32 v155, 0
  v_mov_b32 v156, 0
  v_mov_b32 v157, 0
  v_mov_b32 v158, 0
  v_mov_b32 v159, 0
  v_mov_b32 v160, 0
  v_mov_b32 v161, 0
  v_mov_b32 v162, 0
  v_mov_b32 v163, 0
  v_mov_b32 v164, 0
  v_mov_b32 v165, 0
  v_mov_b32 v166, 0
  v_mov_b32 v167, 0
  v_mov_b32 v168, 0
  v_mov_b32 v169, 0
  v_mov_b32 v170, 0
  v_mov_b32 v171, 0
  v_mov_b32 v172, 0
  v_mov_b32 v173, 0
  v_mov_b32 v174, 0
  v_mov_b32 v175, 0
  v_mov_b32 v176, 0
  v_mov_b32 v177, 0
  v_mov_b32 v178, 0
  v_mov_b32 v179, 0
  v_mov_b32 v180, 0
  v_mov_b32 v181, 0
  v_mov_b32 v182, 0
  v_mov_b32 v183, 0
  v_mov_b32 v184, 0
  v_mov_b32 v185, 0
  v_mov_b32 v186, 0
  v_mov_b32 v187, 0
  v_mov_b32 v188, 0
  v_mov_b32 v189, 0
  v_mov_b32 v190, 0
  v_mov_b32 v191, 0
  v_mov_b32 v192, 0
  v_mov_b32 v193, 0
  v_mov_b32 v194, 0
  v_mov_b32 v195, 0
  v_mov_b32 v196, 0
  v_mov_b32 v197, 0
  v_mov_b32 v198, 0
  v_mov_b32 v199, 0
  v_mov_b32 v200, 0
  v_mov_b32 v201, 0
  v_mov_b32 v202, 0
  v_mov_b32 v203, 0
  v_mov_b32 v204, 0
  v_mov_b32 v205, 0
  v_mov_b32 v206, 0
  v_mov_b32 v207, 0
  v_mov_b32 v208, 0
  v_mov_b32 v209, 0
  v_mov_b32 v210, 0
  v_mov_b32 v211, 0
  v_mov_b32 v212, 0
  v_mov_b32 v213, 0
  v_mov_b32 v214, 0
  v_mov_b32 v215, 0
  v_mov_b32 v216, 0
  v_mov_b32 v217, 0
  v_mov_b32 v218, 0
  v_mov_b32 v219, 0
  v_mov_b32 v220, 0
  v_mov_b32 v221, 0
  v_mov_b32 v222, 0
  v_mov_b32 v223, 0
  v_mov_b32 v224, 0
  v_mov_b32 v225, 0
  v_mov_b32 v226, 0
  v_mov_b32 v227, 0
  v_mov_b32 v228, 0
  v_mov_b32 v229, 0
  v_mov_b32 v230, 0
  v_mov_b32 v231, 0
  v_mov_b32 v232, 0
  v_mov_b32 v233, 0
  v_mov_b32 v234, 0
  v_mov_b32 v235, 0
  v_mov_b32 v236, 0
  v_mov_b32 v237, 0
  v_mov_b32 v238, 0
  v_mov_b32 v239, 0
  v_mov_b32 v240, 0
  v_mov_b32 v241, 0
  v_mov_b32 v242, 0
  v_mov_b32 v243, 0
  v_mov_b32 v244, 0
  v_mov_b32 v245, 0
  v_mov_b32 v246, 0
  v_mov_b32 v247, 0
  v_mov_b32 v248, 0
  v_mov_b32 v249, 0
  v_mov_b32 v250, 0
  v_mov_b32 v251, 0
  v_mov_b32 v252, 0
  v_mov_b32 v253, 0
  v_mov_b32 v254, 0
  v_mov_b32 v255, 0
  v_mov_b32 v90, 0
  v_mov_b32 v91, 0
  v_mov_b32 v92, 0
  v_mov_b32 v76, 0
  v_mov_b32 v77, 0
  v_mov_b32 v78, 0
  v_mov_b32 v79, 0
  v_mov_b32 v0, 0
  s_lshl_b32 s50, s7, 11
  s_lshl_b32 s55, s3, 7
  s_add_u32 s50, s50, s55
  s_lshl_b32 s55, s6, 2
  s_add_u32 s50, s50, s55
  s_add_u32 s50, s50, 50331648
  v_mov_b32 v40, s50
  s_add_u32 s50, s50, 1024
  v_writelane_b32 v40, s50, 1
  s_lshl_b32 s50, s6, 8
  s_lshl_b32 s55, s7, 5
  s_add_u32 s50, s50, s55
  s_lshl_b32 s55, s3, 2
  s_add_u32 s50, s50, s55
  s_add_u32 s50, s50, 50348032
  v_writelane_b32 v40, s50, 2
  s_lshl_b32 s50, s7, 9
  s_lshl_b32 s55, s4, 7
  s_add_u32 s50, s50, s55
  s_lshl_b32 s55, s6, 2
  s_add_u32 s50, s50, s55
  s_add_u32 s50, s50, 50356224
  s_and_b32 s51, s2, 7
  s_lshr_b32 s52, s2, 3
  s_and_b32 s76, s51, 1
  s_lshr_b32 s77, s51, 1
  s_lshl_b32 s77, s77, 2
  s_and_b32 s51, s52, 3
  s_add_u32 s77, s77, s51
  s_lshr_b32 s75, s52, 2
  s_lshl_b32 s74, s77, 3
  s_add_u32 s74, s74, s75
  s_lshl_b32 s51, s74, 7
  s_lshl_b32 s55, s4, 2
  s_add_u32 s51, s51, s55
  s_add_u32 s51, s51, 50360320
  s_cmp_eq_u32 s5, 0
  s_cselect_b32 s50, s50, s51
  v_writelane_b32 v40, s50, 3
  s_cselect_b32 s52, 31, 23
  s_cmp_eq_u32 s76, 1
  s_cselect_b32 s52, 31, s52
  s_lshl_b32 s50, s6, 8
  s_lshl_b32 s55, s7, 5
  s_add_u32 s50, s50, s55
  s_lshl_b32 s55, s3, 2
  s_add_u32 s50, s50, s55
  s_add_u32 s50, s50, 50376704
  v_writelane_b32 v40, s50, 4
  s_sub_u32 s61, 8, s7
  s_cmp_eq_u32 s3, 7
  s_cbranch_scc1 L_pro_b7
  s_waitcnt vmcnt(0)
  s_barrier
  s_cmp_eq_u32 s3, 6
  s_cbranch_scc1 L_pro_g6
  s_add_u32 m0, s33, 107520
  s_nop 0
  buffer_load_dwordx4 v2, s[12:15], s27 offen lds
  s_add_u32 s27, s27, s30
  s_add_u32 m0, s34, 107520
  s_nop 0
  buffer_load_dwordx4 v3, s[16:19], s28 offen lds
  s_add_u32 s28, s28, s31
  s_add_u32 m0, s35, 107520
  s_nop 0
  buffer_load_dwordx4 v4, s[20:23], s29 offen lds
  s_add_u32 s29, s29, s32
  s_mov_b32 s50, 128
  s_add_u32 m0, s24, 33280
  s_nop 0
  buffer_load_dwordx4 v1, s[8:11], s50 offen lds
  s_mov_b32 s50, 4224
  s_add_u32 m0, s24, 34320
  s_nop 0
  buffer_load_dwordx4 v1, s[8:11], s50 offen lds
  s_mov_b32 s50, 262272
  s_add_u32 m0, s24, 49920
  s_nop 0
  buffer_load_dwordx4 v1, s[8:11], s50 offen lds
  s_mov_b32 s50, 266368
  s_add_u32 m0, s24, 50960
  s_nop 0
  buffer_load_dwordx4 v1, s[8:11], s50 offen lds
  buffer_load_dwordx4 v[80:83], v61, s[8:11], 0 offen
  buffer_load_dwordx4 v[84:87], v61, s[8:11], 0 offen offset:1024
  s_branch L_pro_c2
L_pro_g6:
  s_add_u32 m0, s33, 107520
  s_nop 0
  buffer_load_dwordx4 v2, s[12:15], s27 offen lds
  s_add_u32 s27, s27, s30
  s_add_u32 m0, s34, 107520
  s_nop 0
  buffer_load_dwordx4 v3, s[16:19], s28 offen lds
  s_add_u32 s28, s28, s31
  s_mov_b32 s50, 128
  s_add_u32 m0, s24, 33280
  s_nop 0
  buffer_load_dwordx4 v1, s[8:11], s50 offen lds
  s_mov_b32 s50, 4224
  s_add_u32 m0, s24, 34320
  s_nop 0
  buffer_load_dwordx4 v1, s[8:11], s50 offen lds
  s_mov_b32 s50, 8320
  s_add_u32 m0, s24, 35360
  s_nop 0
  buffer_load_dwordx4 v1, s[8:11], s50 offen lds
  s_mov_b32 s50, 12416
  s_add_u32 m0, s24, 36400
  s_nop 0
  buffer_load_dwordx4 v1, s[8:11], s50 offen lds
  s_mov_b32 s50, 262272
  s_add_u32 m0, s24, 49920
  s_nop 0
  buffer_load_dwordx4 v1, s[8:11], s50 offen lds
  s_mov_b32 s50, 266368
  s_add_u32 m0, s24, 50960
  s_nop 0
  buffer_load_dwordx4 v1, s[8:11], s50 offen lds
  s_mov_b32 s50, 270464
  s_add_u32 m0, s24, 52000
  s_nop 0
  buffer_load_dwordx4 v1, s[8:11], s50 offen lds
  s_mov_b32 s50, 274560
  s_add_u32 m0, s24, 53040
  s_nop 0
  buffer_load_dwordx4 v1, s[8:11], s50 offen lds
  buffer_load_dwordx4 v[80:83], v61, s[8:11], 0 offen
  buffer_load_dwordx4 v[84:87], v61, s[8:11], 0 offen offset:1024
  s_branch L_pro_c2
L_pro_b7:
  s_barrier
L_pro_c2:
  s_mov_b32 exec_lo, s52
  s_mov_b32 exec_hi, 0
  buffer_store_dword v0, v40, s[64:67], 0 offen sc1
  s_mov_b64 exec, -1
  ds_read_b64 v[12:13], v5 offset:0
  ds_read_b64 v[14:15], v5 offset:32
  ds_read_b64 v[16:17], v5 offset:256
  ds_read_b64 v[18:19], v5 offset:288
  ds_read_b64 v[20:21], v5 offset:512
  ds_read_b64 v[22:23], v5 offset:544
  ds_read_b64 v[24:25], v5 offset:768
  ds_read_b64 v[26:27], v5 offset:800
  ds_read_b64 v[28:29], v5 offset:64
  ds_read_b64 v[30:31], v5 offset:96
  ds_read_b64 v[32:33], v5 offset:320
  ds_read_b64 v[34:35], v5 offset:352
  ds_read_b64 v[36:37], v5 offset:576
  ds_read_b64 v[38:39], v5 offset:608
  ds_read_b64 v[40:41], v5 offset:832
  ds_read_b64 v[42:43], v5 offset:864
  s_cmp_eq_u32 s5, 1
  s_cbranch_scc1 L_pro_w1
  ds_read_b64_tr_b16 v[60:61], v7 offset:0
  ds_read_b64_tr_b16 v[62:63], v7 offset:1024
  ds_read_b64_tr_b16 v[64:65], v8 offset:0
  ds_read_b64_tr_b16 v[66:67], v8 offset:1024
  ds_read_b64_tr_b16 v[68:69], v6 offset:6144
  ds_read_b64_tr_b16 v[70:71], v6 offset:9728
  ds_read_b64_tr_b16 v[72:73], v6 offset:13312
  ds_read_b64_tr_b16 v[74:75], v6 offset:16896
  s_waitcnt lgkmcnt(8)
  s_barrier
  s_waitcnt lgkmcnt(0)
  s_mov_b32 s60, 8
  s_cmp_eq_u32 s4, 1
  s_cbranch_scc1 L_loop1
  s_cmp_eq_u32 s4, 2
  s_cbranch_scc1 L_loop2
  s_cmp_eq_u32 s4, 3
  s_cbranch_scc1 L_loop3
L_loop0:
  s_cmp_eq_u32 s60, s61
  s_cbranch_scc1 L_loopc0
L_loopp0:
  v_mfma_f32_16x16x32_bf16 v[96:99], v[60:63], v[12:15], v[96:99]
  ds_read_b64_tr_b16 v[76:77], v6 offset:6176
  v_mfma_f32_16x16x32_bf16 v[100:103], v[60:63], v[16:19], v[100:103]
  ds_read_b64_tr_b16 v[78:79], v6 offset:9760
  s_cmp_eq_u32 s60, 6
  s_cbranch_scc0 L_nx_1
  s_call_b64 s[74:75], L_x_drain_0
L_nx_1:
  v_mfma_f32_16x16x32_bf16 v[104:107], v[60:63], v[20:23], v[104:107]
  s_add_u32 m0, s33, 128000
  ds_read_b64_tr_b16 v[72:73], v6 offset:13312
  v_mfma_f32_16x16x32_bf16 v[108:111], v[60:63], v[24:27], v[108:111]
  buffer_load_dwordx4 v2, s[12:15], s27 offen lds
  s_add_u32 s27, s27, s30
  ds_read_b64_tr_b16 v[74:75], v6 offset:16896
  v_mfma_f32_16x16x32_bf16 v[124:127], v[64:67], v[24:27], v[124:127]
  v_mfma_f32_16x16x32_bf16 v[120:123], v[64:67], v[20:23], v[120:123]
  v_mfma_f32_16x16x32_bf16 v[116:119], v[64:67], v[16:19], v[116:119]
  s_add_u32 m0, s34, 128000
  v_mfma_f32_16x16x32_bf16 v[112:115], v[64:67], v[12:15], v[112:115]
  buffer_load_dwordx4 v3, s[16:19], s28 offen lds
  s_add_u32 s28, s28, s31
  v_mfma_f32_16x16x32_bf16 v[128:131], v[68:71], v[12:15], v[128:131]
  ds_read_b64_tr_b16 v[64:65], v6 offset:6208
  v_mfma_f32_16x16x32_bf16 v[132:135], v[68:71], v[16:19], v[132:135]
  ds_read_b64_tr_b16 v[66:67], v6 offset:9792
  v_mfma_f32_16x16x32_bf16 v[136:139], v[68:71], v[20:23], v[136:139]
  s_add_u32 m0, s35, 128000
  ds_read_b64_tr_b16 v[60:61], v6 offset:13344
  v_mfma_f32_16x16x32_bf16 v[140:143], v[68:71], v[24:27], v[140:143]
  buffer_load_dwordx4 v4, s[20:23], s29 offen lds
  s_add_u32 s29, s29, s32
  ds_read_b64_tr_b16 v[62:63], v6 offset:16928
  s_waitcnt lgkmcnt(4)
  v_mfma_f32_16x16x32_bf16 v[156:159], v[72:75], v[24:27], v[156:159]
  ds_read_b64_tr_b16 v[68:69], v6 offset:13376
  v_mfma_f32_16x16x32_bf16 v[152:155], v[72:75], v[20:23], v[152:155]
  ds_read_b64_tr_b16 v[70:71], v6 offset:16960
  v_mfma_f32_16x16x32_bf16 v[148:151], v[72:75], v[16:19], v[148:151]
  s_add_u32 s50, s26, 0
  s_add_u32 m0, s24, 0
  v_mfma_f32_16x16x32_bf16 v[144:147], v[72:75], v[12:15], v[144:147]
  buffer_load_dwordx4 v1, s[8:11], s50 offen lds
  v_mfma_f32_16x16x32_bf16 v[160:163], v[76:79], v[12:15], v[160:163]
  ds_read_b64_tr_b16 v[72:73], v6 offset:6240
  v_mfma_f32_16x16x32_bf16 v[164:167], v[76:79], v[16:19], v[164:167]
  ds_read_b64_tr_b16 v[74:75], v6 offset:9824
  v_mfma_f32_16x16x32_bf16 v[168:171], v[76:79], v[20:23], v[168:171]
  s_add_u32 s50, s26, 4096
  s_add_u32 m0, s24, 1040
  v_mfma_f32_16x16x32_bf16 v[172:175], v[76:79], v[24:27], v[172:175]
  buffer_load_dwordx4 v1, s[8:11], s50 offen lds
  s_waitcnt lgkmcnt(4)
  v_mfma_f32_16x16x32_bf16 v[188:191], v[60:63], v[24:27], v[188:191]
  v_mfma_f32_16x16x32_bf16 v[184:187], v[60:63], v[20:23], v[184:187]
  v_mfma_f32_16x16x32_bf16 v[180:183], v[60:63], v[16:19], v[180:183]
  v_mfma_f32_16x16x32_bf16 v[176:179], v[60:63], v[12:15], v[176:179]
  v_mfma_f32_16x16x32_bf16 v[192:195], v[64:67], v[12:15], v[192:195]
  ds_read_b64_tr_b16 v[60:61], v7 offset:20480
  v_mfma_f32_16x16x32_bf16 v[196:199], v[64:67], v[16:19], v[196:199]
  ds_read_b64_tr_b16 v[62:63], v7 offset:21504
  v_mfma_f32_16x16x32_bf16 v[200:203], v[64:67], v[20:23], v[200:203]
  ds_read_b64_tr_b16 v[76:77], v6 offset:13408
  v_mfma_f32_16x16x32_bf16 v[204:207], v[64:67], v[24:27], v[204:207]
  ds_read_b64_tr_b16 v[78:79], v6 offset:16992
  s_waitcnt lgkmcnt(6)
  v_mfma_f32_16x16x32_bf16 v[220:223], v[68:71], v[24:27], v[220:223]
  ds_read_b64_tr_b16 v[64:65], v8 offset:20480
  v_mfma_f32_16x16x32_bf16 v[216:219], v[68:71], v[20:23], v[216:219]
  ds_read_b64_tr_b16 v[66:67], v8 offset:21504
  v_mfma_f32_16x16x32_bf16 v[212:215], v[68:71], v[16:19], v[212:215]
  v_mfma_f32_16x16x32_bf16 v[208:211], v[68:71], v[12:15], v[208:211]
  s_waitcnt lgkmcnt(6)
  v_mfma_f32_16x16x32_bf16 v[224:227], v[72:75], v[12:15], v[224:227]
  ds_read_b64_tr_b16 v[68:69], v6 offset:26624
  v_mfma_f32_16x16x32_bf16 v[228:231], v[72:75], v[16:19], v[228:231]
  ds_read_b64_tr_b16 v[70:71], v6 offset:30208
  v_mfma_f32_16x16x32_bf16 v[232:235], v[72:75], v[20:23], v[232:235]
  v_mfma_f32_16x16x32_bf16 v[236:239], v[72:75], v[24:27], v[236:239]
  s_cmp_eq_u32 s60, 2
  s_cbranch_scc0 L_nx_2
  s_call_b64 s[74:75], L_x_poll_0
L_nx_2:
  s_waitcnt lgkmcnt(4)
  v_mfma_f32_16x16x32_bf16 v[252:255], v[76:79], v[24:27], v[252:255]
  v_mfma_f32_16x16x32_bf16 v[248:251], v[76:79], v[20:23], v[248:251]
  v_mfma_f32_16x16x32_bf16 v[244:247], v[76:79], v[16:19], v[244:247]
  v_mfma_f32_16x16x32_bf16 v[240:243], v[76:79], v[12:15], v[240:243]
  s_waitcnt vmcnt(5)
  s_barrier
  v_mfma_f32_16x16x32_bf16 v[96:99], v[60:63], v[28:31], v[96:99]
  ds_read_b64_tr_b16 v[76:77], v6 offset:26656
  v_mfma_f32_16x16x32_bf16 v[100:103], v[60:63], v[32:35], v[100:103]
  ds_read_b64_tr_b16 v[78:79], v6 offset:30240
  v_mfma_f32_16x16x32_bf16 v[104:107], v[60:63], v[36:39], v[104:107]
  s_add_u32 m0, s33, 66560
  ds_read_b64_tr_b16 v[72:73], v6 offset:33792
  ds_read_b64 v[12:13], v5 offset:33280
  v_mfma_f32_16x16x32_bf16 v[108:111], v[60:63], v[40:43], v[108:111]
  buffer_load_dwordx4 v2, s[12:15], s27 offen lds
  s_add_u32 s27, s27, s30
  ds_read_b64_tr_b16 v[74:75], v6 offset:37376
  ds_read_b64 v[14:15], v5 offset:33312
  s_waitcnt lgkmcnt(8)
  v_mfma_f32_16x16x32_bf16 v[124:127], v[64:67], v[40:43], v[124:127]
  v_mfma_f32_16x16x32_bf16 v[120:123], v[64:67], v[36:39], v[120:123]
  v_mfma_f32_16x16x32_bf16 v[116:119], v[64:67], v[32:35], v[116:119]
  s_add_u32 m0, s34, 66560
  ds_read_b64 v[16:17], v5 offset:33536
  v_mfma_f32_16x16x32_bf16 v[112:115], v[64:67], v[28:31], v[112:115]
  buffer_load_dwordx4 v3, s[16:19], s28 offen lds
  s_add_u32 s28, s28, s31
  ds_read_b64 v[18:19], v5 offset:33568
  s_waitcnt lgkmcnt(8)
  v_mfma_f32_16x16x32_bf16 v[128:131], v[68:71], v[28:31], v[128:131]
  ds_read_b64_tr_b16 v[64:65], v6 offset:26688
  v_mfma_f32_16x16x32_bf16 v[132:135], v[68:71], v[32:35], v[132:135]
  ds_read_b64_tr_b16 v[66:67], v6 offset:30272
  v_mfma_f32_16x16x32_bf16 v[136:139], v[68:71], v[36:39], v[136:139]
  s_add_u32 m0, s35, 66560
  ds_read_b64_tr_b16 v[60:61], v6 offset:33824
  ds_read_b64 v[20:21], v5 offset:33792
  v_mfma_f32_16x16x32_bf16 v[140:143], v[68:71], v[40:43], v[140:143]
  buffer_load_dwordx4 v4, s[20:23], s29 offen lds
  s_add_u32 s29, s29, s32
  ds_read_b64_tr_b16 v[62:63], v6 offset:37408
  ds_read_b64 v[22:23], v5 offset:33824
  s_waitcnt lgkmcnt(9)
  v_mfma_f32_16x16x32_bf16 v[156:159], v[72:75], v[40:43], v[156:159]
  ds_read_b64_tr_b16 v[68:69], v6 offset:33856
  v_mfma_f32_16x16x32_bf16 v[152:155], v[72:75], v[36:39], v[152:155]
  ds_read_b64_tr_b16 v[70:71], v6 offset:37440
  v_mfma_f32_16x16x32_bf16 v[148:151], v[72:75], v[32:35], v[148:151]
  s_add_u32 s50, s26, 262144
  s_add_u32 m0, s24, 16640
  ds_read_b64 v[24:25], v5 offset:34048
  v_mfma_f32_16x16x32_bf16 v[144:147], v[72:75], v[28:31], v[144:147]
  buffer_load_dwordx4 v1, s[8:11], s50 offen lds
  ds_read_b64 v[26:27], v5 offset:34080
  v_mfma_f32_16x16x32_bf16 v[160:163], v[76:79], v[28:31], v[160:163]
  ds_read_b64_tr_b16 v[72:73], v6 offset:26720
  v_mfma_f32_16x16x32_bf16 v[164:167], v[76:79], v[32:35], v[164:167]
  ds_read_b64_tr_b16 v[74:75], v6 offset:30304
  v_mfma_f32_16x16x32_bf16 v[168:171], v[76:79], v[36:39], v[168:171]
  s_add_u32 s50, s26, 266240
  s_add_u32 m0, s24, 17680
  ds_read_b64 v[44:45], v5 offset:33344
  v_mfma_f32_16x16x32_bf16 v[172:175], v[76:79], v[40:43], v[172:175]
  buffer_load_dwordx4 v1, s[8:11], s50 offen lds
  ds_read_b64 v[46:47], v5 offset:33376
  s_waitcnt lgkmcnt(9)
  v_mfma_f32_16x16x32_bf16 v[188:191], v[60:63], v[40:43], v[188:191]
  v_mfma_f32_16x16x32_bf16 v[184:187], v[60:63], v[36:39], v[184:187]
  v_mfma_f32_16x16x32_bf16 v[180:183], v[60:63], v[32:35], v[180:183]
  v_mfma_f32_16x16x32_bf16 v[176:179], v[60:63], v[28:31], v[176:179]
  v_mfma_f32_16x16x32_bf16 v[192:195], v[64:67], v[28:31], v[192:195]
  ds_read_b64_tr_b16 v[60:61], v94 offset:0
  v_mfma_f32_16x16x32_bf16 v[196:199], v[64:67], v[32:35], v[196:199]
  ds_read_b64_tr_b16 v[62:63], v94 offset:1024
  v_mfma_f32_16x16x32_bf16 v[200:203], v[64:67], v[36:39], v[200:203]
  ds_read_b64_tr_b16 v[76:77], v6 offset:33888
  ds_read_b64 v[48:49], v5 offset:33600
  v_mfma_f32_16x16x32_bf16 v[204:207], v[64:67], v[40:43], v[204:207]
  ds_read_b64_tr_b16 v[78:79], v6 offset:37472
  ds_read_b64 v[50:51], v5 offset:33632
  s_waitcnt lgkmcnt(12)
  v_mfma_f32_16x16x32_bf16 v[220:223], v[68:71], v[40:43], v[220:223]
  ds_read_b64_tr_b16 v[64:65], v95 offset:0
  v_mfma_f32_16x16x32_bf16 v[216:219], v[68:71], v[36:39], v[216:219]
  ds_read_b64_tr_b16 v[66:67], v95 offset:1024
  v_mfma_f32_16x16x32_bf16 v[212:215], v[68:71], v[32:35], v[212:215]
  ds_read_b64 v[52:53], v5 offset:33856
  v_mfma_f32_16x16x32_bf16 v[208:211], v[68:71], v[28:31], v[208:211]
  ds_read_b64 v[54:55], v5 offset:33888
  s_waitcnt lgkmcnt(12)
  v_mfma_f32_16x16x32_bf16 v[224:227], v[72:75], v[28:31], v[224:227]
  ds_read_b64_tr_b16 v[68:69], v93 offset:6144
  v_mfma_f32_16x16x32_bf16 v[228:231], v[72:75], v[32:35], v[228:231]
  ds_read_b64_tr_b16 v[70:71], v93 offset:9728
  v_mfma_f32_16x16x32_bf16 v[232:235], v[72:75], v[36:39], v[232:235]
  ds_read_b64 v[56:57], v5 offset:34112
  v_mfma_f32_16x16x32_bf16 v[236:239], v[72:75], v[40:43], v[236:239]
  ds_read_b64 v[58:59], v5 offset:34144
  s_waitcnt lgkmcnt(9)
  v_mfma_f32_16x16x32_bf16 v[252:255], v[76:79], v[40:43], v[252:255]
  v_mfma_f32_16x16x32_bf16 v[248:251], v[76:79], v[36:39], v[248:251]
  v_mfma_f32_16x16x32_bf16 v[244:247], v[76:79], v[32:35], v[244:247]
  s_add_u32 s25, s25, 128
  s_cmp_ge_u32 s25, 2048
  s_cselect_b32 s26, 0x10000000, s25
  v_mfma_f32_16x16x32_bf16 v[240:243], v[76:79], v[28:31], v[240:243]
  s_waitcnt vmcnt(5) lgkmcnt(0)
  s_barrier
  v_mfma_f32_16x16x32_bf16 v[96:99], v[60:63], v[12:15], v[96:99]
  ds_read_b64_tr_b16 v[76:77], v93 offset:6176
  v_mfma_f32_16x16x32_bf16 v[100:103], v[60:63], v[16:19], v[100:103]
  ds_read_b64_tr_b16 v[78:79], v93 offset:9760
  s_cmp_eq_u32 s60, 2
  s_cbranch_scc0 L_nx_3
  s_call_b64 s[74:75], L_x_stat_0
L_nx_3:
  s_cmp_eq_u32 s60, 8
  s_cbranch_scc0 L_nx_4
  s_call_b64 s[74:75], L_x_rows_0
L_nx_4:
  v_mfma_f32_16x16x32_bf16 v[104:107], v[60:63], v[20:23], v[104:107]
  s_add_u32 m0, s33, 87040
  ds_read_b64_tr_b16 v[72:73], v93 offset:13312
  v_mfma_f32_16x16x32_bf16 v[108:111], v[60:63], v[24:27], v[108:111]
  buffer_load_dwordx4 v2, s[12:15], s27 offen lds
  s_add_u32 s27, s27, s30
  ds_read_b64_tr_b16 v[74:75], v93 offset:16896
  v_mfma_f32_16x16x32_bf16 v[124:127], v[64:67], v[24:27], v[124:127]
  v_mfma_f32_16x16x32_bf16 v[120:123], v[64:67], v[20:23], v[120:123]
  v_mfma_f32_16x16x32_bf16 v[116:119], v[64:67], v[16:19], v[116:119]
  s_add_u32 m0, s34, 87040
  v_mfma_f32_16x16x32_bf16 v[112:115], v[64:67], v[12:15], v[112:115]
  buffer_load_dwordx4 v3, s[16:19], s28 offen lds
  s_add_u32 s28, s28, s31
  v_mfma_f32_16x16x32_bf16 v[128:131], v[68:71], v[12:15], v[128:131]
  ds_read_b64_tr_b16 v[64:65], v93 offset:6208
  v_mfma_f32_16x16x32_bf16 v[132:135], v[68:71], v[16:19], v[132:135]
  ds_read_b64_tr_b16 v[66:67], v93 offset:9792
  v_mfma_f32_16x16x32_bf16 v[136:139], v[68:71], v[20:23], v[136:139]
  s_add_u32 m0, s35, 87040
  ds_read_b64_tr_b16 v[60:61], v93 offset:13344
  v_mfma_f32_16x16x32_bf16 v[140:143], v[68:71], v[24:27], v[140:143]
  buffer_load_dwordx4 v4, s[20:23], s29 offen lds
  s_add_u32 s29, s29, s32
  ds_read_b64_tr_b16 v[62:63], v93 offset:16928
  s_waitcnt lgkmcnt(4)
  v_mfma_f32_16x16x32_bf16 v[156:159], v[72:75], v[24:27], v[156:159]
  ds_read_b64_tr_b16 v[68:69], v93 offset:13376
  v_mfma_f32_16x16x32_bf16 v[152:155], v[72:75], v[20:23], v[152:155]
  ds_read_b64_tr_b16 v[70:71], v93 offset:16960
  v_mfma_f32_16x16x32_bf16 v[148:151], v[72:75], v[16:19], v[148:151]
  s_add_u32 s50, s26, 0
  s_add_u32 m0, s24, 33280
  v_mfma_f32_16x16x32_bf16 v[144:147], v[72:75], v[12:15], v[144:147]
  buffer_load_dwordx4 v1, s[8:11], s50 offen lds
  v_mfma_f32_16x16x32_bf16 v[160:163], v[76:79], v[12:15], v[160:163]
  ds_read_b64_tr_b16 v[72:73], v93 offset:6240
  v_mfma_f32_16x16x32_bf16 v[164:167], v[76:79], v[16:19], v[164:167]
  ds_read_b64_tr_b16 v[74:75], v93 offset:9824
  v_mfma_f32_16x16x32_bf16 v[168:171], v[76:79], v[20:23], v[168:171]
  s_add_u32 s50, s26, 4096
  s_add_u32 m0, s24, 34320
  v_mfma_f32_16x16x32_bf16 v[172:175], v[76:79], v[24:27], v[172:175]
  buffer_load_dwordx4 v1, s[8:11], s50 offen lds
  s_waitcnt lgkmcnt(4)
  v_mfma_f32_16x16x32_bf16 v[188:191], v[60:63], v[24:27], v[188:191]
  v_mfma_f32_16x16x32_bf16 v[184:187], v[60:63], v[20:23], v[184:187]
  v_mfma_f32_16x16x32_bf16 v[180:183], v[60:63], v[16:19], v[180:183]
  v_mfma_f32_16x16x32_bf16 v[176:179], v[60:63], v[12:15], v[176:179]
  v_mfma_f32_16x16x32_bf16 v[192:195], v[64:67], v[12:15], v[192:195]
  ds_read_b64_tr_b16 v[60:61], v94 offset:20480
  v_mfma_f32_16x16x32_bf16 v[196:199], v[64:67], v[16:19], v[196:199]
  ds_read_b64_tr_b16 v[62:63], v94 offset:21504
  v_mfma_f32_16x16x32_bf16 v[200:203], v[64:67], v[20:23], v[200:203]
  ds_read_b64_tr_b16 v[76:77], v93 offset:13408
  v_mfma_f32_16x16x32_bf16 v[204:207], v[64:67], v[24:27], v[204:207]
  ds_read_b64_tr_b16 v[78:79], v93 offset:16992
  s_waitcnt lgkmcnt(6)
  v_mfma_f32_16x16x32_bf16 v[220:223], v[68:71], v[24:27], v[220:223]
  ds_read_b64_tr_b16 v[64:65], v95 offset:20480
  v_mfma_f32_16x16x32_bf16 v[216:219], v[68:71], v[20:23], v[216:219]
  ds_read_b64_tr_b16 v[66:67], v95 offset:21504
  v_mfma_f32_16x16x32_bf16 v[212:215], v[68:71], v[16:19], v[212:215]
  v_mfma_f32_16x16x32_bf16 v[208:211], v[68:71], v[12:15], v[208:211]
  s_waitcnt lgkmcnt(6)
  v_mfma_f32_16x16x32_bf16 v[224:227], v[72:75], v[12:15], v[224:227]
  ds_read_b64_tr_b16 v[68:69], v93 offset:26624
  v_mfma_f32_16x16x32_bf16 v[228:231], v[72:75], v[16:19], v[228:231]
  ds_read_b64_tr_b16 v[70:71], v93 offset:30208
  v_mfma_f32_16x16x32_bf16 v[232:235], v[72:75], v[20:23], v[232:235]
  v_mfma_f32_16x16x32_bf16 v[236:239], v[72:75], v[24:27], v[236:239]
  s_waitcnt lgkmcnt(4)
  v_mfma_f32_16x16x32_bf16 v[252:255], v[76:79], v[24:27], v[252:255]
  v_mfma_f32_16x16x32_bf16 v[248:251], v[76:79], v[20:23], v[248:251]
  v_mfma_f32_16x16x32_bf16 v[244:247], v[76:79], v[16:19], v[244:247]
  v_mfma_f32_16x16x32_bf16 v[240:243], v[76:79], v[12:15], v[240:243]
  s_waitcnt vmcnt(5)
  s_barrier
  v_mfma_f32_16x16x32_bf16 v[96:99], v[60:63], v[44:47], v[96:99]
  ds_read_b64_tr_b16 v[76:77], v93 offset:26656
  v_mfma_f32_16x16x32_bf16 v[100:103], v[60:63], v[48:51], v[100:103]
  ds_read_b64_tr_b16 v[78:79], v93 offset:30240
  v_mfma_f32_16x16x32_bf16 v[104:107], v[60:63], v[52:55], v[104:107]
  s_add_u32 m0, s33, 107520
  ds_read_b64_tr_b16 v[72:73], v93 offset:33792
  ds_read_b64 v[12:13], v5 offset:0
  v_mfma_f32_16x16x32_bf16 v[108:111], v[60:63], v[56:59], v[108:111]
  buffer_load_dwordx4 v2, s[12:15], s27 offen lds
  s_add_u32 s27, s27, s30
  ds_read_b64_tr_b16 v[74:75], v93 offset:37376
  ds_read_b64 v[14:15], v5 offset:32
  s_waitcnt lgkmcnt(8)
  v_mfma_f32_16x16x32_bf16 v[124:127], v[64:67], v[56:59], v[124:127]
  v_mfma_f32_16x16x32_bf16 v[120:123], v[64:67], v[52:55], v[120:123]
  v_mfma_f32_16x16x32_bf16 v[116:119], v[64:67], v[48:51], v[116:119]
  s_add_u32 m0, s34, 107520
  ds_read_b64 v[16:17], v5 offset:256
  v_mfma_f32_16x16x32_bf16 v[112:115], v[64:67], v[44:47], v[112:115]
  buffer_load_dwordx4 v3, s[16:19], s28 offen lds
  s_add_u32 s28, s28, s31
  ds_read_b64 v[18:19], v5 offset:288
  s_waitcnt lgkmcnt(8)
  v_mfma_f32_16x16x32_bf16 v[128:131], v[68:71], v[44:47], v[128:131]
  ds_read_b64_tr_b16 v[64:65], v93 offset:26688
  v_mfma_f32_16x16x32_bf16 v[132:135], v[68:71], v[48:51], v[132:135]
  ds_read_b64_tr_b16 v[66:67], v93 offset:30272
  v_mfma_f32_16x16x32_bf16 v[136:139], v[68:71], v[52:55], v[136:139]
  s_add_u32 m0, s35, 107520
  ds_read_b64_tr_b16 v[60:61], v93 offset:33824
  ds_read_b64 v[20:21], v5 offset:512
  v_mfma_f32_16x16x32_bf16 v[140:143], v[68:71], v[56:59], v[140:143]
  buffer_load_dwordx4 v4, s[20:23], s29 offen lds
  s_add_u32 s29, s29, s32
  ds_read_b64_tr_b16 v[62:63], v93 offset:37408
  ds_read_b64 v[22:23], v5 offset:544
  s_waitcnt lgkmcnt(9)
  v_mfma_f32_16x16x32_bf16 v[156:159], v[72:75], v[56:59], v[156:159]
  ds_read_b64_tr_b16 v[68:69], v93 offset:33856
  v_mfma_f32_16x16x32_bf16 v[152:155], v[72:75], v[52:55], v[152:155]
  ds_read_b64_tr_b16 v[70:71], v93 offset:37440
  v_mfma_f32_16x16x32_bf16 v[148:151], v[72:75], v[48:51], v[148:151]
  s_add_u32 s50, s26, 262144
  s_add_u32 m0, s24, 49920
  ds_read_b64 v[24:25], v5 offset:768
  v_mfma_f32_16x16x32_bf16 v[144:147], v[72:75], v[44:47], v[144:147]
  buffer_load_dwordx4 v1, s[8:11], s50 offen lds
  ds_read_b64 v[26:27], v5 offset:800
  v_mfma_f32_16x16x32_bf16 v[160:163], v[76:79], v[44:47], v[160:163]
  ds_read_b64_tr_b16 v[72:73], v93 offset:26720
  v_mfma_f32_16x16x32_bf16 v[164:167], v[76:79], v[48:51], v[164:167]
  ds_read_b64_tr_b16 v[74:75], v93 offset:30304
  v_mfma_f32_16x16x32_bf16 v[168:171], v[76:79], v[52:55], v[168:171]
  s_add_u32 s50, s26, 266240
  s_add_u32 m0, s24, 50960
  ds_read_b64 v[28:29], v5 offset:64
  v_mfma_f32_16x16x32_bf16 v[172:175], v[76:79], v[56:59], v[172:175]
  buffer_load_dwordx4 v1, s[8:11], s50 offen lds
  ds_read_b64 v[30:31], v5 offset:96
  s_waitcnt lgkmcnt(9)
  v_mfma_f32_16x16x32_bf16 v[188:191], v[60:63], v[56:59], v[188:191]
  v_mfma_f32_16x16x32_bf16 v[184:187], v[60:63], v[52:55], v[184:187]
  v_mfma_f32_16x16x32_bf16 v[180:183], v[60:63], v[48:51], v[180:183]
  v_mfma_f32_16x16x32_bf16 v[176:179], v[60:63], v[44:47], v[176:179]
  v_mfma_f32_16x16x32_bf16 v[192:195], v[64:67], v[44:47], v[192:195]
  ds_read_b64_tr_b16 v[60:61], v7 offset:0
  v_mfma_f32_16x16x32_bf16 v[196:199], v[64:67], v[48:51], v[196:199]
  ds_read_b64_tr_b16 v[62:63], v7 offset:1024
  v_mfma_f32_16x16x32_bf16 v[200:203], v[64:67], v[52:55], v[200:203]
  ds_read_b64_tr_b16 v[76:77], v93 offset:33888
  ds_read_b64 v[32:33], v5 offset:320
  v_mfma_f32_16x16x32_bf16 v[204:207], v[64:67], v[56:59], v[204:207]
  ds_read_b64_tr_b16 v[78:79], v93 offset:37472
  ds_read_b64 v[34:35], v5 offset:352
  s_waitcnt lgkmcnt(12)
  v_mfma_f32_16x16x32_bf16 v[220:223], v[68:71], v[56:59], v[220:223]
  ds_read_b64_tr_b16 v[64:65], v8 offset:0
  v_mfma_f32_16x16x32_bf16 v[216:219], v[68:71], v[52:55], v[216:219]
  ds_read_b64_tr_b16 v[66:67], v8 offset:1024
  v_mfma_f32_16x16x32_bf16 v[212:215], v[68:71], v[48:51], v[212:215]
  ds_read_b64 v[36:37], v5 offset:576
  v_mfma_f32_16x16x32_bf16 v[208:211], v[68:71], v[44:47], v[208:211]
  ds_read_b64 v[38:39], v5 offset:608
  s_waitcnt lgkmcnt(12)
  v_mfma_f32_16x16x32_bf16 v[224:227], v[72:75], v[44:47], v[224:227]
  ds_read_b64_tr_b16 v[68:69], v6 offset:6144
  v_mfma_f32_16x16x32_bf16 v[228:231], v[72:75], v[48:51], v[228:231]
  ds_read_b64_tr_b16 v[70:71], v6 offset:9728
  v_mfma_f32_16x16x32_bf16 v[232:235], v[72:75], v[52:55], v[232:235]
  ds_read_b64 v[40:41], v5 offset:832
  v_mfma_f32_16x16x32_bf16 v[236:239], v[72:75], v[56:59], v[236:239]
  ds_read_b64 v[42:43], v5 offset:864
  s_waitcnt lgkmcnt(9)
  v_mfma_f32_16x16x32_bf16 v[252:255], v[76:79], v[56:59], v[252:255]
  v_mfma_f32_16x16x32_bf16 v[248:251], v[76:79], v[52:55], v[248:251]
  v_mfma_f32_16x16x32_bf16 v[244:247], v[76:79], v[48:51], v[244:247]
  s_add_u32 s25, s25, 128
  s_cmp_ge_u32 s25, 2048
  s_cselect_b32 s26, 0x10000000, s25
  v_mfma_f32_16x16x32_bf16 v[240:243], v[76:79], v[44:47], v[240:243]
  s_waitcnt vmcnt(5) lgkmcnt(0)
  s_barrier
  s_sub_u32 s60, s60, 1
  s_cmp_gt_u32 s60, 2
  s_cbranch_scc1 L_loop0
L_loopc0:
  v_mfma_f32_16x16x32_bf16 v[96:99], v[60:63], v[12:15], v[96:99]
  ds_read_b64_tr_b16 v[76:77], v6 offset:6176
  v_lshlrev_b32 v10, 16, v60
  v_and_b32 v11, s79, v60
  v_mfma_f32_16x16x32_bf16 v[100:103], v[60:63], v[16:19], v[100:103]
  ds_read_b64_tr_b16 v[78:79], v6 offset:9760
  v_add_f32 v90, v90, v10
  v_add_f32 v90, v90, v11
  s_cmp_eq_u32 s60, 6
  s_cbranch_scc0 L_nx_5
  s_call_b64 s[74:75], L_x_drain_0
L_nx_5:
  v_mfma_f32_16x16x32_bf16 v[104:107], v[60:63], v[20:23], v[104:107]
  s_add_u32 m0, s33, 128000
  v_lshlrev_b32 v10, 16, v61
  v_and_b32 v11, s79, v61
  ds_read_b64_tr_b16 v[72:73], v6 offset:13312
  v_mfma_f32_16x16x32_bf16 v[108:111], v[60:63], v[24:27], v[108:111]
  buffer_load_dwordx4 v2, s[12:15], s27 offen lds
  s_add_u32 s27, s27, s30
  v_add_f32 v90, v90, v10
  v_add_f32 v90, v90, v11
  ds_read_b64_tr_b16 v[74:75], v6 offset:16896
  v_mfma_f32_16x16x32_bf16 v[124:127], v[64:67], v[24:27], v[124:127]
  v_lshlrev_b32 v10, 16, v62
  v_and_b32 v11, s79, v62
  v_mfma_f32_16x16x32_bf16 v[120:123], v[64:67], v[20:23], v[120:123]
  v_add_f32 v90, v90, v10
  v_add_f32 v90, v90, v11
  v_mfma_f32_16x16x32_bf16 v[116:119], v[64:67], v[16:19], v[116:119]
  s_add_u32 m0, s34, 128000
  v_lshlrev_b32 v10, 16, v63
  v_and_b32 v11, s79, v63
  v_mfma_f32_16x16x32_bf16 v[112:115], v[64:67], v[12:15], v[112:115]
  buffer_load_dwordx4 v3, s[16:19], s28 offen lds
  s_add_u32 s28, s28, s31
  v_add_f32 v90, v90, v10
  v_add_f32 v90, v90, v11
  v_mfma_f32_16x16x32_bf16 v[128:131], v[68:71], v[12:15], v[128:131]
  ds_read_b64_tr_b16 v[64:65], v6 offset:6208
  v_mfma_f32_16x16x32_bf16 v[132:135], v[68:71], v[16:19], v[132:135]
  ds_read_b64_tr_b16 v[66:67], v6 offset:9792
  v_mfma_f32_16x16x32_bf16 v[136:139], v[68:71], v[20:23], v[136:139]
  s_add_u32 m0, s35, 128000
  ds_read_b64_tr_b16 v[60:61], v6 offset:13344
  v_mfma_f32_16x16x32_bf16 v[140:143], v[68:71], v[24:27], v[140:143]
  buffer_load_dwordx4 v4, s[20:23], s29 offen lds
  s_add_u32 s29, s29, s32
  ds_read_b64_tr_b16 v[62:63], v6 offset:16928
  s_waitcnt lgkmcnt(4)
  v_mfma_f32_16x16x32_bf16 v[156:159], v[72:75], v[24:27], v[156:159]
  ds_read_b64_tr_b16 v[68:69], v6 offset:13376
  v_mfma_f32_16x16x32_bf16 v[152:155], v[72:75], v[20:23], v[152:155]
  ds_read_b64_tr_b16 v[70:71], v6 offset:16960
  v_mfma_f32_16x16x32_bf16 v[148:151], v[72:75], v[16:19], v[148:151]
  s_add_u32 s50, s26, 0
  s_add_u32 m0, s24, 0
  v_mfma_f32_16x16x32_bf16 v[144:147], v[72:75], v[12:15], v[144:147]
  buffer_load_dwordx4 v1, s[8:11], s50 offen lds
  v_mfma_f32_16x16x32_bf16 v[160:163], v[76:79], v[12:15], v[160:163]
  ds_read_b64_tr_b16 v[72:73], v6 offset:6240
  v_lshlrev_b32 v10, 16, v76
  v_and_b32 v11, s79, v76
  v_mfma_f32_16x16x32_bf16 v[164:167], v[76:79], v[16:19], v[164:167]
  ds_read_b64_tr_b16 v[74:75], v6 offset:9824
  v_add_f32 v91, v91, v10
  v_add_f32 v91, v91, v11
  v_mfma_f32_16x16x32_bf16 v[168:171], v[76:79], v[20:23], v[168:171]
  s_add_u32 s50, s26, 4096
  s_add_u32 m0, s24, 1040
  v_lshlrev_b32 v10, 16, v77
  v_and_b32 v11, s79, v77
  v_mfma_f32_16x16x32_bf16 v[172:175], v[76:79], v[24:27], v[172:175]
  buffer_load_dwordx4 v1, s[8:11], s50 offen lds
  v_add_f32 v91, v91, v10
  v_add_f32 v91, v91, v11
  s_waitcnt lgkmcnt(4)
  v_mfma_f32_16x16x32_bf16 v[188:191], v[60:63], v[24:27], v[188:191]
  v_lshlrev_b32 v10, 16, v78
  v_and_b32 v11, s79, v78
  v_mfma_f32_16x16x32_bf16 v[184:187], v[60:63], v[20:23], v[184:187]
  v_add_f32 v91, v91, v10
  v_add_f32 v91, v91, v11
  v_mfma_f32_16x16x32_bf16 v[180:183], v[60:63], v[16:19], v[180:183]
  v_lshlrev_b32 v10, 16, v79
  v_and_b32 v11, s79, v79
  v_mfma_f32_16x16x32_bf16 v[176:179], v[60:63], v[12:15], v[176:179]
  v_add_f32 v91, v91, v10
  v_add_f32 v91, v91, v11
  v_mfma_f32_16x16x32_bf16 v[192:195], v[64:67], v[12:15], v[192:195]
  ds_read_b64_tr_b16 v[60:61], v7 offset:20480
  v_mfma_f32_16x16x32_bf16 v[196:199], v[64:67], v[16:19], v[196:199]
  ds_read_b64_tr_b16 v[62:63], v7 offset:21504
  v_mfma_f32_16x16x32_bf16 v[200:203], v[64:67], v[20:23], v[200:203]
  ds_read_b64_tr_b16 v[76:77], v6 offset:13408
  v_mfma_f32_16x16x32_bf16 v[204:207], v[64:67], v[24:27], v[204:207]
  ds_read_b64_tr_b16 v[78:79], v6 offset:16992
  s_waitcnt lgkmcnt(6)
  v_mfma_f32_16x16x32_bf16 v[220:223], v[68:71], v[24:27], v[220:223]
  ds_read_b64_tr_b16 v[64:65], v8 offset:20480
  v_mfma_f32_16x16x32_bf16 v[216:219], v[68:71], v[20:23], v[216:219]
  ds_read_b64_tr_b16 v[66:67], v8 offset:21504
  v_mfma_f32_16x16x32_bf16 v[212:215], v[68:71], v[16:19], v[212:215]
  v_mfma_f32_16x16x32_bf16 v[208:211], v[68:71], v[12:15], v[208:211]
  s_waitcnt lgkmcnt(6)
  v_mfma_f32_16x16x32_bf16 v[224:227], v[72:75], v[12:15], v[224:227]
  ds_read_b64_tr_b16 v[68:69], v6 offset:26624
  v_lshlrev_b32 v10, 16, v72
  v_and_b32 v11, s79, v72
  v_mfma_f32_16x16x32_bf16 v[228:231], v[72:75], v[16:19], v[228:231]
  ds_read_b64_tr_b16 v[70:71], v6 offset:30208
  v_add_f32 v92, v92, v10
  v_add_f32 v92, v92, v11
  v_mfma_f32_16x16x32_bf16 v[232:235], v[72:75], v[20:23], v[232:235]
  v_lshlrev_b32 v10, 16, v73
  v_and_b32 v11, s79, v73
  v_mfma_f32_16x16x32_bf16 v[236:239], v[72:75], v[24:27], v[236:239]
  v_add_f32 v92, v92, v10
  v_add_f32 v92, v92, v11
  s_cmp_eq_u32 s60, 2
  s_cbranch_scc0 L_nx_6
  s_call_b64 s[74:75], L_x_poll_0
L_nx_6:
  s_waitcnt lgkmcnt(4)
  v_mfma_f32_16x16x32_bf16 v[252:255], v[76:79], v[24:27], v[252:255]
  v_lshlrev_b32 v10, 16, v74
  v_and_b32 v11, s79, v74
  v_mfma_f32_16x16x32_bf16 v[248:251], v[76:79], v[20:23], v[248:251]
  v_add_f32 v92, v92, v10
  v_add_f32 v92, v92, v11
  v_mfma_f32_16x16x32_bf16 v[244:247], v[76:79], v[16:19], v[244:247]
  v_lshlrev_b32 v10, 16, v75
  v_and_b32 v11, s79, v75
  v_mfma_f32_16x16x32_bf16 v[240:243], v[76:79], v[12:15], v[240:243]
  v_add_f32 v92, v92, v10
  v_add_f32 v92, v92, v11
  s_waitcnt vmcnt(5)
  s_barrier
  v_mfma_f32_16x16x32_bf16 v[96:99], v[60:63], v[28:31], v[96:99]
  ds_read_b64_tr_b16 v[76:77], v6 offset:26656
  v_lshlrev_b32 v10, 16, v60
  v_and_b32 v11, s79, v60
  v_mfma_f32_16x16x32_bf16 v[100:103], v[60:63], v[32:35], v[100:103]
  ds_read_b64_tr_b16 v[78:79], v6 offset:30240
  v_add_f32 v90, v90, v10
  v_add_f32 v90, v90, v11
  v_mfma_f32_16x16x32_bf16 v[104:107], v[60:63], v[36:39], v[104:107]
  s_add_u32 m0, s33, 66560
  ds_read_b64_tr_b16 v[72:73], v6 offset:33792
  ds_read_b64 v[12:13], v5 offset:33280
  v_lshlrev_b32 v10, 16, v61
  v_and_b32 v11, s79, v61
  v_mfma_f32_16x16x32_bf16 v[108:111], v[60:63], v[40:43], v[108:111]
  buffer_load_dwordx4 v2, s[12:15], s27 offen lds
  s_add_u32 s27, s27, s30
  ds_read_b64_tr_b16 v[74:75], v6 offset:37376
  ds_read_b64 v[14:15], v5 offset:33312
  v_add_f32 v90, v90, v10
  v_add_f32 v90, v90, v11
  s_waitcnt lgkmcnt(8)
  v_mfma_f32_16x16x32_bf16 v[124:127], v[64:67], v[40:43], v[124:127]
  v_lshlrev_b32 v10, 16, v62
  v_and_b32 v11, s79, v62
  v_mfma_f32_16x16x32_bf16 v[120:123], v[64:67], v[36:39], v[120:123]
  v_add_f32 v90, v90, v10
  v_add_f32 v90, v90, v11
  v_mfma_f32_16x16x32_bf16 v[116:119], v[64:67], v[32:35], v[116:119]
  s_add_u32 m0, s34, 66560
  ds_read_b64 v[16:17], v5 offset:33536
  v_lshlrev_b32 v10, 16, v63
  v_and_b32 v11, s79, v63
  v_mfma_f32_16x16x32_bf16 v[112:115], v[64:67], v[28:31], v[112:115]
  buffer_load_dwordx4 v3, s[16:19], s28 offen lds
  s_add_u32 s28, s28, s31
  ds_read_b64 v[18:19], v5 offset:33568
  v_add_f32 v90, v90, v10
  v_add_f32 v90, v90, v11
  s_waitcnt lgkmcnt(8)
  v_mfma_f32_16x16x32_bf16 v[128:131], v[68:71], v[28:31], v[128:131]
  ds_read_b64_tr_b16 v[64:65], v6 offset:26688
  v_mfma_f32_16x16x32_bf16 v[132:135], v[68:71], v[32:35], v[132:135]
  ds_read_b64_tr_b16 v[66:67], v6 offset:30272
  v_mfma_f32_16x16x32_bf16 v[136:139], v[68:71], v[36:39], v[136:139]
  s_add_u32 m0, s35, 66560
  ds_read_b64_tr_b16 v[60:61], v6 offset:33824
  ds_read_b64 v[20:21], v5 offset:33792
  v_mfma_f32_16x16x32_bf16 v[140:143], v[68:71], v[40:43], v[140:143]
  buffer_load_dwordx4 v4, s[20:23], s29 offen lds
  s_add_u32 s29, s29, s32
  ds_read_b64_tr_b16 v[62:63], v6 offset:37408
  ds_read_b64 v[22:23], v5 offset:33824
  s_waitcnt lgkmcnt(9)
  v_mfma_f32_16x16x32_bf16 v[156:159], v[72:75], v[40:43], v[156:159]
  ds_read_b64_tr_b16 v[68:69], v6 offset:33856
  v_mfma_f32_16x16x32_bf16 v[152:155], v[72:75], v[36:39], v[152:155]
  ds_read_b64_tr_b16 v[70:71], v6 offset:37440
  v_mfma_f32_16x16x32_bf16 v[148:151], v[72:75], v[32:35], v[148:151]
  s_add_u32 s50, s26, 262144
  s_add_u32 m0, s24, 16640
  ds_read_b64 v[24:25], v5 offset:34048
  v_mfma_f32_16x16x32_bf16 v[144:147], v[72:75], v[28:31], v[144:147]
  buffer_load_dwordx4 v1, s[8:11], s50 offen lds
  ds_read_b64 v[26:27], v5 offset:34080
  v_mfma_f32_16x16x32_bf16 v[160:163], v[76:79], v[28:31], v[160:163]
  ds_read_b64_tr_b16 v[72:73], v6 offset:26720
  v_lshlrev_b32 v10, 16, v76
  v_and_b32 v11, s79, v76
  v_mfma_f32_16x16x32_bf16 v[164:167], v[76:79], v[32:35], v[164:167]
  ds_read_b64_tr_b16 v[74:75], v6 offset:30304
  v_add_f32 v91, v91, v10
  v_add_f32 v91, v91, v11
  v_mfma_f32_16x16x32_bf16 v[168:171], v[76:79], v[36:39], v[168:171]
  s_add_u32 s50, s26, 266240
  s_add_u32 m0, s24, 17680
  ds_read_b64 v[44:45], v5 offset:33344
  v_lshlrev_b32 v10, 16, v77
  v_and_b32 v11, s79, v77
  v_mfma_f32_16x16x32_bf16 v[172:175], v[76:79], v[40:43], v[172:175]
  buffer_load_dwordx4 v1, s[8:11], s50 offen lds
  ds_read_b64 v[46:47], v5 offset:33376
  v_add_f32 v91, v91, v10
  v_add_f32 v91, v91, v11
  s_waitcnt lgkmcnt(9)
  v_mfma_f32_16x16x32_bf16 v[188:191], v[60:63], v[40:43], v[188:191]
  v_lshlrev_b32 v10, 16, v78
  v_and_b32 v11, s79, v78
  v_mfma_f32_16x16x32_bf16 v[184:187], v[60:63], v[36:39], v[184:187]
  v_add_f32 v91, v91, v10
  v_add_f32 v91, v91, v11
  v_mfma_f32_16x16x32_bf16 v[180:183], v[60:63], v[32:35], v[180:183]
  v_lshlrev_b32 v10, 16, v79
  v_and_b32 v11, s79, v79
  v_mfma_f32_16x16x32_bf16 v[176:179], v[60:63], v[28:31], v[176:179]
  v_add_f32 v91, v91, v10
  v_add_f32 v91, v91, v11
  v_mfma_f32_16x16x32_bf16 v[192:195], v[64:67], v[28:31], v[192:195]
  ds_read_b64_tr_b16 v[60:61], v94 offset:0
  v_mfma_f32_16x16x32_bf16 v[196:199], v[64:67], v[32:35], v[196:199]
  ds_read_b64_tr_b16 v[62:63], v94 offset:1024
  v_mfma_f32_16x16x32_bf16 v[200:203], v[64:67], v[36:39], v[200:203]
  ds_read_b64_tr_b16 v[76:77], v6 offset:33888
  ds_read_b64 v[48:49], v5 offset:33600
  v_mfma_f32_16x16x32_bf16 v[204:207], v[64:67], v[40:43], v[204:207]
  ds_read_b64_tr_b16 v[78:79], v6 offset:37472
  ds_read_b64 v[50:51], v5 offset:33632
  s_waitcnt lgkmcnt(12)
  v_mfma_f32_16x16x32_bf16 v[220:223], v[68:71], v[40:43], v[220:223]
  ds_read_b64_tr_b16 v[64:65], v95 offset:0
  v_mfma_f32_16x16x32_bf16 v[216:219], v[68:71], v[36:39], v[216:219]
  ds_read_b64_tr_b16 v[66:67], v95 offset:1024
  v_mfma_f32_16x16x32_bf16 v[212:215], v[68:71], v[32:35], v[212:215]
  ds_read_b64 v[52:53], v5 offset:33856
  v_mfma_f32_16x16x32_bf16 v[208:211], v[68:71], v[28:31], v[208:211]
  ds_read_b64 v[54:55], v5 offset:33888
  s_waitcnt lgkmcnt(12)
  v_mfma_f32_16x16x32_bf16 v[224:227], v[72:75], v[28:31], v[224:227]
  ds_read_b64_tr_b16 v[68:69], v93 offset:6144
  v_lshlrev_b32 v10, 16, v72
  v_and_b32 v11, s79, v72
  v_mfma_f32_16x16x32_bf16 v[228:231], v[72:75], v[32:35], v[228:231]
  ds_read_b64_tr_b16 v[70:71], v93 offset:9728
  v_add_f32 v92, v92, v10
  v_add_f32 v92, v92, v11
  v_mfma_f32_16x16x32_bf16 v[232:235], v[72:75], v[36:39], v[232:235]
  ds_read_b64 v[56:57], v5 offset:34112
  v_lshlrev_b32 v10, 16, v73
  v_and_b32 v11, s79, v73
  v_mfma_f32_16x16x32_bf16 v[236:239], v[72:75], v[40:43], v[236:239]
  ds_read_b64 v[58:59], v5 offset:34144
  v_add_f32 v92, v92, v10
  v_add_f32 v92, v92, v11
  s_waitcnt lgkmcnt(9)
  v_mfma_f32_16x16x32_bf16 v[252:255], v[76:79], v[40:43], v[252:255]
  v_lshlrev_b32 v10, 16, v74
  v_and_b32 v11, s79, v74
  v_mfma_f32_16x16x32_bf16 v[248:251], v[76:79], v[36:39], v[248:251]
  v_add_f32 v92, v92, v10
  v_add_f32 v92, v92, v11
  v_mfma_f32_16x16x32_bf16 v[244:247], v[76:79], v[32:35], v[244:247]
  s_add_u32 s25, s25, 128
  s_cmp_ge_u32 s25, 2048
  s_cselect_b32 s26, 0x10000000, s25
  v_lshlrev_b32 v10, 16, v75
  v_and_b32 v11, s79, v75
  v_mfma_f32_16x16x32_bf16 v[240:243], v[76:79], v[28:31], v[240:243]
  v_add_f32 v92, v92, v10
  v_add_f32 v92, v92, v11
  s_waitcnt vmcnt(5) lgkmcnt(0)
  s_barrier
  v_mfma_f32_16x16x32_bf16 v[96:99], v[60:63], v[12:15], v[96:99]
  ds_read_b64_tr_b16 v[76:77], v93 offset:6176
  v_lshlrev_b32 v10, 16, v60
  v_and_b32 v11, s79, v60
  v_mfma_f32_16x16x32_bf16 v[100:103], v[60:63], v[16:19], v[100:103]
  ds_read_b64_tr_b16 v[78:79], v93 offset:9760
  v_add_f32 v90, v90, v10
  v_add_f32 v90, v90, v11
  s_cmp_eq_u32 s60, 2
  s_cbranch_scc0 L_nx_7
  s_call_b64 s[74:75], L_x_stat_0
L_nx_7:
  s_cmp_eq_u32 s60, 8
  s_cbranch_scc0 L_nx_8
  s_call_b64 s[74:75], L_x_rows_0
L_nx_8:
  v_mfma_f32_16x16x32_bf16 v[104:107], v[60:63], v[20:23], v[104:107]
  s_add_u32 m0, s33, 87040
  ds_read_b64_tr_b16 v[72:73], v93 offset:13312
  v_lshlrev_b32 v10, 16, v61
  v_and_b32 v11, s79, v61
  v_mfma_f32_16x16x32_bf16 v[108:111], v[60:63], v[24:27], v[108:111]
  buffer_load_dwordx4 v2, s[12:15], s27 offen lds
  s_add_u32 s27, s27, s30
  ds_read_b64_tr_b16 v[74:75], v93 offset:16896
  v_add_f32 v90, v90, v10
  v_add_f32 v90, v90, v11
  v_mfma_f32_16x16x32_bf16 v[124:127], v[64:67], v[24:27], v[124:127]
  v_lshlrev_b32 v10, 16, v62
  v_and_b32 v11, s79, v62
  v_mfma_f32_16x16x32_bf16 v[120:123], v[64:67], v[20:23], v[120:123]
  v_add_f32 v90, v90, v10
  v_add_f32 v90, v90, v11
  v_mfma_f32_16x16x32_bf16 v[116:119], v[64:67], v[16:19], v[116:119]
  s_add_u32 m0, s34, 87040
  v_lshlrev_b32 v10, 16, v63
  v_and_b32 v11, s79, v63
  v_mfma_f32_16x16x32_bf16 v[112:115], v[64:67], v[12:15], v[112:115]
  buffer_load_dwordx4 v3, s[16:19], s28 offen lds
  s_add_u32 s28, s28, s31
  v_add_f32 v90, v90, v10
  v_add_f32 v90, v90, v11
  v_mfma_f32_16x16x32_bf16 v[128:131], v[68:71], v[12:15], v[128:131]
  ds_read_b64_tr_b16 v[64:65], v93 offset:6208
  v_mfma_f32_16x16x32_bf16 v[132:135], v[68:71], v[16:19], v[132:135]
  ds_read_b64_tr_b16 v[66:67], v93 offset:9792
  v_mfma_f32_16x16x32_bf16 v[136:139], v[68:71], v[20:23], v[136:139]
  s_add_u32 m0, s35, 87040
  ds_read_b64_tr_b16 v[60:61], v93 offset:13344
  v_mfma_f32_16x16x32_bf16 v[140:143], v[68:71], v[24:27], v[140:143]
  buffer_load_dwordx4 v4, s[20:23], s29 offen lds
  s_add_u32 s29, s29, s32
  ds_read_b64_tr_b16 v[62:63], v93 offset:16928
  s_waitcnt lgkmcnt(4)
  v_mfma_f32_16x16x32_bf16 v[156:159], v[72:75], v[24:27], v[156:159]
  ds_read_b64_tr_b16 v[68:69], v93 offset:13376
  v_mfma_f32_16x16x32_bf16 v[152:155], v[72:75], v[20:23], v[152:155]
  ds_read_b64_tr_b16 v[70:71], v93 offset:16960
  v_mfma_f32_16x16x32_bf16 v[148:151], v[72:75], v[16:19], v[148:151]
  s_add_u32 s50, s26, 0
  s_add_u32 m0, s24, 33280
  v_mfma_f32_16x16x32_bf16 v[144:147], v[72:75], v[12:15], v[144:147]
  buffer_load_dwordx4 v1, s[8:11], s50 offen lds
  v_mfma_f32_16x16x32_bf16 v[160:163], v[76:79], v[12:15], v[160:163]
  ds_read_b64_tr_b16 v[72:73], v93 offset:6240
  v_lshlrev_b32 v10, 16, v76
  v_and_b32 v11, s79, v76
  v_mfma_f32_16x16x32_bf16 v[164:167], v[76:79], v[16:19], v[164:167]
  ds_read_b64_tr_b16 v[74:75], v93 offset:9824
  v_add_f32 v91, v91, v10
  v_add_f32 v91, v91, v11
  v_mfma_f32_16x16x32_bf16 v[168:171], v[76:79], v[20:23], v[168:171]
  s_add_u32 s50, s26, 4096
  s_add_u32 m0, s24, 34320
  v_lshlrev_b32 v10, 16, v77
  v_and_b32 v11, s79, v77
  v_mfma_f32_16x16x32_bf16 v[172:175], v[76:79], v[24:27], v[172:175]
  buffer_load_dwordx4 v1, s[8:11], s50 offen lds
  v_add_f32 v91, v91, v10
  v_add_f32 v91, v91, v11
  s_waitcnt lgkmcnt(4)
  v_mfma_f32_16x16x32_bf16 v[188:191], v[60:63], v[24:27], v[188:191]
  v_lshlrev_b32 v10, 16, v78
  v_and_b32 v11, s79, v78
  v_mfma_f32_16x16x32_bf16 v[184:187], v[60:63], v[20:23], v[184:187]
  v_add_f32 v91, v91, v10
  v_add_f32 v91, v91, v11
  v_mfma_f32_16x16x32_bf16 v[180:183], v[60:63], v[16:19], v[180:183]
  v_lshlrev_b32 v10, 16, v79
  v_and_b32 v11, s79, v79
  v_mfma_f32_16x16x32_bf16 v[176:179], v[60:63], v[12:15], v[176:179]
  v_add_f32 v91, v91, v10
  v_add_f32 v91, v91, v11
  v_mfma_f32_16x16x32_bf16 v[192:195], v[64:67], v[12:15], v[192:195]
  ds_read_b64_tr_b16 v[60:61], v94 offset:20480
  v_mfma_f32_16x16x32_bf16 v[196:199], v[64:67], v[16:19], v[196:199]
  ds_read_b64_tr_b16 v[62:63], v94 offset:21504
  v_mfma_f32_16x16x32_bf16 v[200:203], v[64:67], v[20:23], v[200:203]
  ds_read_b64_tr_b16 v[76:77], v93 offset:13408
  v_mfma_f32_16x16x32_bf16 v[204:207], v[64:67], v[24:27], v[204:207]
  ds_read_b64_tr_b16 v[78:79], v93 offset:16992
  s_waitcnt lgkmcnt(6)
  v_mfma_f32_16x16x32_bf16 v[220:223], v[68:71], v[24:27], v[220:223]
  ds_read_b64_tr_b16 v[64:65], v95 offset:20480
  v_mfma_f32_16x16x32_bf16 v[216:219], v[68:71], v[20:23], v[216:219]
  ds_read_b64_tr_b16 v[66:67], v95 offset:21504
  v_mfma_f32_16x16x32_bf16 v[212:215], v[68:71], v[16:19], v[212:215]
  v_mfma_f32_16x16x32_bf16 v[208:211], v[68:71], v[12:15], v[208:211]
  s_waitcnt lgkmcnt(6)
  v_mfma_f32_16x16x32_bf16 v[224:227], v[72:75], v[12:15], v[224:227]
  ds_read_b64_tr_b16 v[68:69], v93 offset:26624
  v_lshlrev_b32 v10, 16, v72
  v_and_b32 v11, s79, v72
  v_mfma_f32_16x16x32_bf16 v[228:231], v[72:75], v[16:19], v[228:231]
  ds_read_b64_tr_b16 v[70:71], v93 offset:30208
  v_add_f32 v92, v92, v10
  v_add_f32 v92, v92, v11
  v_mfma_f32_16x16x32_bf16 v[232:235], v[72:75], v[20:23], v[232:235]
  v_lshlrev_b32 v10, 16, v73
  v_and_b32 v11, s79, v73
  v_mfma_f32_16x16x32_bf16 v[236:239], v[72:75], v[24:27], v[236:239]
  v_add_f32 v92, v92, v10
  v_add_f32 v92, v92, v11
  s_waitcnt lgkmcnt(4)
  v_mfma_f32_16x16x32_bf16 v[252:255], v[76:79], v[24:27], v[252:255]
  v_lshlrev_b32 v10, 16, v74
  v_and_b32 v11, s79, v74
  v_mfma_f32_16x16x32_bf16 v[248:251], v[76:79], v[20:23], v[248:251]
  v_add_f32 v92, v92, v10
  v_add_f32 v92, v92, v11
  v_mfma_f32_16x16x32_bf16 v[244:247], v[76:79], v[16:19], v[244:247]
  v_lshlrev_b32 v10, 16, v75
  v_and_b32 v11, s79, v75
  v_mfma_f32_16x16x32_bf16 v[240:243], v[76:79], v[12:15], v[240:243]
  v_add_f32 v92, v92, v10
  v_add_f32 v92, v92, v11
  s_waitcnt vmcnt(5)
  s_barrier
  v_mfma_f32_16x16x32_bf16 v[96:99], v[60:63], v[44:47], v[96:99]
  ds_read_b64_tr_b16 v[76:77], v93 offset:26656
  v_lshlrev_b32 v10, 16, v60
  v_and_b32 v11, s79, v60
  v_mfma_f32_16x16x32_bf16 v[100:103], v[60:63], v[48:51], v[100:103]
  ds_read_b64_tr_b16 v[78:79], v93 offset:30240
  v_add_f32 v90, v90, v10
  v_add_f32 v90, v90, v11
  v_mfma_f32_16x16x32_bf16 v[104:107], v[60:63], v[52:55], v[104:107]
  s_add_u32 m0, s33, 107520
  ds_read_b64_tr_b16 v[72:73], v93 offset:33792
  ds_read_b64 v[12:13], v5 offset:0
  v_lshlrev_b32 v10, 16, v61
  v_and_b32 v11, s79, v61
  v_mfma_f32_16x16x32_bf16 v[108:111], v[60:63], v[56:59], v[108:111]
  buffer_load_dwordx4 v2, s[12:15], s27 offen lds
  s_add_u32 s27, s27, s30
  ds_read_b64_tr_b16 v[74:75], v93 offset:37376
  ds_read_b64 v[14:15], v5 offset:32
  v_add_f32 v90, v90, v10
  v_add_f32 v90, v90, v11
  s_waitcnt lgkmcnt(8)
  v_mfma_f32_16x16x32_bf16 v[124:127], v[64:67], v[56:59], v[124:127]
  v_lshlrev_b32 v10, 16, v62
  v_and_b32 v11, s79, v62
  v_mfma_f32_16x16x32_bf16 v[120:123], v[64:67], v[52:55], v[120:123]
  v_add_f32 v90, v90, v10
  v_add_f32 v90, v90, v11
  v_mfma_f32_16x16x32_bf16 v[116:119], v[64:67], v[48:51], v[116:119]
  s_add_u32 m0, s34, 107520
  ds_read_b64 v[16:17], v5 offset:256
  v_lshlrev_b32 v10, 16, v63
  v_and_b32 v11, s79, v63
  v_mfma_f32_16x16x32_bf16 v[112:115], v[64:67], v[44:47], v[112:115]
  buffer_load_dwordx4 v3, s[16:19], s28 offen lds
  s_add_u32 s28, s28, s31
  ds_read_b64 v[18:19], v5 offset:288
  v_add_f32 v90, v90, v10
  v_add_f32 v90, v90, v11
  s_waitcnt lgkmcnt(8)
  v_mfma_f32_16x16x32_bf16 v[128:131], v[68:71], v[44:47], v[128:131]
  ds_read_b64_tr_b16 v[64:65], v93 offset:26688
  v_mfma_f32_16x16x32_bf16 v[132:135], v[68:71], v[48:51], v[132:135]
  ds_read_b64_tr_b16 v[66:67], v93 offset:30272
  v_mfma_f32_16x16x32_bf16 v[136:139], v[68:71], v[52:55], v[136:139]
  s_add_u32 m0, s35, 107520
  ds_read_b64_tr_b16 v[60:61], v93 offset:33824
  ds_read_b64 v[20:21], v5 offset:512
  v_mfma_f32_16x16x32_bf16 v[140:143], v[68:71], v[56:59], v[140:143]
  buffer_load_dwordx4 v4, s[20:23], s29 offen lds
  s_add_u32 s29, s29, s32
  ds_read_b64_tr_b16 v[62:63], v93 offset:37408
  ds_read_b64 v[22:23], v5 offset:544
  s_waitcnt lgkmcnt(9)
  v_mfma_f32_16x16x32_bf16 v[156:159], v[72:75], v[56:59], v[156:159]
  ds_read_b64_tr_b16 v[68:69], v93 offset:33856
  v_mfma_f32_16x16x32_bf16 v[152:155], v[72:75], v[52:55], v[152:155]
  ds_read_b64_tr_b16 v[70:71], v93 offset:37440
  v_mfma_f32_16x16x32_bf16 v[148:151], v[72:75], v[48:51], v[148:151]
  s_add_u32 s50, s26, 262144
  s_add_u32 m0, s24, 49920
  ds_read_b64 v[24:25], v5 offset:768
  v_mfma_f32_16x16x32_bf16 v[144:147], v[72:75], v[44:47], v[144:147]
  buffer_load_dwordx4 v1, s[8:11], s50 offen lds
  ds_read_b64 v[26:27], v5 offset:800
  v_mfma_f32_16x16x32_bf16 v[160:163], v[76:79], v[44:47], v[160:163]
  ds_read_b64_tr_b16 v[72:73], v93 offset:26720
  v_lshlrev_b32 v10, 16, v76
  v_and_b32 v11, s79, v76
  v_mfma_f32_16x16x32_bf16 v[164:167], v[76:79], v[48:51], v[164:167]
  ds_read_b64_tr_b16 v[74:75], v93 offset:30304
  v_add_f32 v91, v91, v10
  v_add_f32 v91, v91, v11
  v_mfma_f32_16x16x32_bf16 v[168:171], v[76:79], v[52:55], v[168:171]
  s_add_u32 s50, s26, 266240
  s_add_u32 m0, s24, 50960
  ds_read_b64 v[28:29], v5 offset:64
  v_lshlrev_b32 v10, 16, v77
  v_and_b32 v11, s79, v77
  v_mfma_f32_16x16x32_bf16 v[172:175], v[76:79], v[56:59], v[172:175]
  buffer_load_dwordx4 v1, s[8:11], s50 offen lds
  ds_read_b64 v[30:31], v5 offset:96
  v_add_f32 v91, v91, v10
  v_add_f32 v91, v91, v11
  s_waitcnt lgkmcnt(9)
  v_mfma_f32_16x16x32_bf16 v[188:191], v[60:63], v[56:59], v[188:191]
  v_lshlrev_b32 v10, 16, v78
  v_and_b32 v11, s79, v78
  v_mfma_f32_16x16x32_bf16 v[184:187], v[60:63], v[52:55], v[184:187]
  v_add_f32 v91, v91, v10
  v_add_f32 v91, v91, v11
  v_mfma_f32_16x16x32_bf16 v[180:183], v[60:63], v[48:51], v[180:183]
  v_lshlrev_b32 v10, 16, v79
  v_and_b32 v11, s79, v79
  v_mfma_f32_16x16x32_bf16 v[176:179], v[60:63], v[44:47], v[176:179]
  v_add_f32 v91, v91, v10
  v_add_f32 v91, v91, v11
  v_mfma_f32_16x16x32_bf16 v[192:195], v[64:67], v[44:47], v[192:195]
  ds_read_b64_tr_b16 v[60:61], v7 offset:0
  v_mfma_f32_16x16x32_bf16 v[196:199], v[64:67], v[48:51], v[196:199]
  ds_read_b64_tr_b16 v[62:63], v7 offset:1024
  v_mfma_f32_16x16x32_bf16 v[200:203], v[64:67], v[52:55], v[200:203]
  ds_read_b64_tr_b16 v[76:77], v93 offset:33888
  ds_read_b64 v[32:33], v5 offset:320
  v_mfma_f32_16x16x32_bf16 v[204:207], v[64:67], v[56:59], v[204:207]
  ds_read_b64_tr_b16 v[78:79], v93 offset:37472
  ds_read_b64 v[34:35], v5 offset:352
  s_waitcnt lgkmcnt(12)
  v_mfma_f32_16x16x32_bf16 v[220:223], v[68:71], v[56:59], v[220:223]
  ds_read_b64_tr_b16 v[64:65], v8 offset:0
  v_mfma_f32_16x16x32_bf16 v[216:219], v[68:71], v[52:55], v[216:219]
  ds_read_b64_tr_b16 v[66:67], v8 offset:1024
  v_mfma_f32_16x16x32_bf16 v[212:215], v[68:71], v[48:51], v[212:215]
  ds_read_b64 v[36:37], v5 offset:576
  v_mfma_f32_16x16x32_bf16 v[208:211], v[68:71], v[44:47], v[208:211]
  ds_read_b64 v[38:39], v5 offset:608
  s_waitcnt lgkmcnt(12)
  v_mfma_f32_16x16x32_bf16 v[224:227], v[72:75], v[44:47], v[224:227]
  ds_read_b64_tr_b16 v[68:69], v6 offset:6144
  v_lshlrev_b32 v10, 16, v72
  v_and_b32 v11, s79, v72
  v_mfma_f32_16x16x32_bf16 v[228:231], v[72:75], v[48:51], v[228:231]
  ds_read_b64_tr_b16 v[70:71], v6 offset:9728
  v_add_f32 v92, v92, v10
  v_add_f32 v92, v92, v11
  v_mfma_f32_16x16x32_bf16 v[232:235], v[72:75], v[52:55], v[232:235]
  ds_read_b64 v[40:41], v5 offset:832
  v_lshlrev_b32 v10, 16, v73
  v_and_b32 v11, s79, v73
  v_mfma_f32_16x16x32_bf16 v[236:239], v[72:75], v[56:59], v[236:239]
  ds_read_b64 v[42:43], v5 offset:864
  v_add_f32 v92, v92, v10
  v_add_f32 v92, v92, v11
  s_waitcnt lgkmcnt(9)
  v_mfma_f32_16x16x32_bf16 v[252:255], v[76:79], v[56:59], v[252:255]
  v_lshlrev_b32 v10, 16, v74
  v_and_b32 v11, s79, v74
  v_mfma_f32_16x16x32_bf16 v[248:251], v[76:79], v[52:55], v[248:251]
  v_add_f32 v92, v92, v10
  v_add_f32 v92, v92, v11
  v_mfma_f32_16x16x32_bf16 v[244:247], v[76:79], v[48:51], v[244:247]
  s_add_u32 s25, s25, 128
  s_cmp_ge_u32 s25, 2048
  s_cselect_b32 s26, 0x10000000, s25
  v_lshlrev_b32 v10, 16, v75
  v_and_b32 v11, s79, v75
  v_mfma_f32_16x16x32_bf16 v[240:243], v[76:79], v[44:47], v[240:243]
  v_add_f32 v92, v92, v10
  v_add_f32 v92, v92, v11
  s_waitcnt vmcnt(5) lgkmcnt(0)
  s_barrier
  s_sub_u32 s60, s60, 1
  s_cmp_lt_u32 s60, 2
  s_cbranch_scc1 L_loopt0
  s_call_b64 s[74:75], L_x_cpub_0
  s_cmp_gt_u32 s60, 2
  s_cbranch_scc1 L_loopp0
L_loopt0:
  s_cmp_lg_u32 s60, 0
  s_cbranch_scc1 L_loopc0
  s_branch L_epi0
L_x_drain_0:
  s_waitcnt vmcnt(0)
  s_setpc_b64 s[74:75]
L_x_rows_0:
  s_waitcnt vmcnt(0)
  v_lshlrev_b32 v10, 16, v80
  v_and_b32 v11, s79, v80
  v_mov_b32 v88, v10
  v_mov_b32 v89, v11
  v_lshlrev_b32 v10, 16, v81
  v_and_b32 v11, s79, v81
  v_add_f32 v88, v88, v10
  v_add_f32 v89, v89, v11
  v_lshlrev_b32 v10, 16, v82
  v_and_b32 v11, s79, v82
  v_add_f32 v88, v88, v10
  v_add_f32 v89, v89, v11
  v_lshlrev_b32 v10, 16, v83
  v_and_b32 v11, s79, v83
  v_add_f32 v88, v88, v10
  v_add_f32 v89, v89, v11
  v_lshlrev_b32 v10, 16, v84
  v_and_b32 v11, s79, v84
  v_add_f32 v88, v88, v10
  v_add_f32 v89, v89, v11
  v_lshlrev_b32 v10, 16, v85
  v_and_b32 v11, s79, v85
  v_add_f32 v88, v88, v10
  v_add_f32 v89, v89, v11
  v_lshlrev_b32 v10, 16, v86
  v_and_b32 v11, s79, v86
  v_add_f32 v88, v88, v10
  v_add_f32 v89, v89, v11
  v_lshlrev_b32 v10, 16, v87
  v_and_b32 v11, s79, v87
  v_add_f32 v88, v88, v10
  v_add_f32 v89, v89, v11
  v_add_f32 v88, v88, v89
  s_nop 1
  v_add_f32_dpp v88, v88, v88 quad_perm:[1,0,3,2] row_mask:0xf bank_mask:0xf
  s_nop 1
  v_add_f32_dpp v88, v88, v88 quad_perm:[2,3,0,1] row_mask:0xf bank_mask:0xf
  s_nop 1
  v_add_f32_dpp v88, v88, v88 row_half_mirror row_mask:0xf bank_mask:0xf
  s_nop 1
  v_add_f32_dpp v88, v88, v88 row_mirror row_mask:0xf bank_mask:0xf
  v_mov_b32 v10, v88
  s_nop 1
  v_permlane16_swap_b32 v88, v10
  s_nop 0
  v_add_f32 v88, v88, v10
  v_mov_b32 v10, v88
  s_nop 1
  v_permlane32_swap_b32 v88, v10
  s_nop 0
  v_add_f32 v88, v88, v10
  v_mul_f32 v88, 0xba800000, v88
  v_lshlrev_b32 v10, 16, v80
  v_and_b32 v11, s79, v80
  v_add_f32 v10, v10, v88
  v_add_f32 v11, v11, v88
  v_mul_f32 v89, v10, v10
  v_fmac_f32 v89, v11, v11
  v_lshlrev_b32 v10, 16, v81
  v_and_b32 v11, s79, v81
  v_add_f32 v10, v10, v88
  v_add_f32 v11, v11, v88
  v_fmac_f32 v89, v10, v10
  v_fmac_f32 v89, v11, v11
  v_lshlrev_b32 v10, 16, v82
  v_and_b32 v11, s79, v82
  v_add_f32 v10, v10, v88
  v_add_f32 v11, v11, v88
  v_fmac_f32 v89, v10, v10
  v_fmac_f32 v89, v11, v11
  v_lshlrev_b32 v10, 16, v83
  v_and_b32 v11, s79, v83
  v_add_f32 v10, v10, v88
  v_add_f32 v11, v11, v88
  v_fmac_f32 v89, v10, v10
  v_fmac_f32 v89, v11, v11
  v_lshlrev_b32 v10, 16, v84
  v_and_b32 v11, s79, v84
  v_add_f32 v10, v10, v88
  v_add_f32 v11, v11, v88
  v_fmac_f32 v89, v10, v10
  v_fmac_f32 v89, v11, v11
  v_lshlrev_b32 v10, 16, v85
  v_and_b32 v11, s79, v85
  v_add_f32 v10, v10, v88
  v_add_f32 v11, v11, v88
  v_fmac_f32 v89, v10, v10
  v_fmac_f32 v89, v11, v11
  v_lshlrev_b32 v10, 16, v86
  v_and_b32 v11, s79, v86
  v_add_f32 v10, v10, v88
  v_add_f32 v11, v11, v88
  v_fmac_f32 v89, v10, v10
  v_fmac_f32 v89, v11, v11
  v_lshlrev_b32 v10, 16, v87
  v_and_b32 v11, s79, v87
  v_add_f32 v10, v10, v88
  v_add_f32 v11, v11, v88
  v_fmac_f32 v89, v10, v10
  v_fmac_f32 v89, v11, v11
  s_nop 1
  v_add_f32_dpp v89, v89, v89 quad_perm:[1,0,3,2] row_mask:0xf bank_mask:0xf
  s_nop 1
  v_add_f32_dpp v89, v89, v89 quad_perm:[2,3,0,1] row_mask:0xf bank_mask:0xf
  s_nop 1
  v_add_f32_dpp v89, v89, v89 row_half_mirror row_mask:0xf bank_mask:0xf
  s_nop 1
  v_add_f32_dpp v89, v89, v89 row_mirror row_mask:0xf bank_mask:0xf
  v_mov_b32 v10, v89
  s_nop 1
  v_permlane16_swap_b32 v89, v10
  s_nop 0
  v_add_f32 v89, v89, v10
  v_mov_b32 v10, v89
  s_nop 1
  v_permlane32_swap_b32 v89, v10
  s_nop 0
  v_add_f32 v89, v89, v10
  v_mul_f32 v89, 0x3a800000, v89
  v_cvt_pk_bf16_f32 v10, v88, v89
  v_lshlrev_b32 v80, 16, v10
  v_and_b32 v89, s79, v10
  v_add_f32 v89, 0x3727c5ac, v89
  v_cvt_pk_bf16_f32 v89, v89, v89
  v_lshlrev_b32 v89, 16, v89
  v_sqrt_f32 v89, v89
  s_lshl_b32 s51, s2, 6
  v_cvt_pk_bf16_f32 v89, v89, v89
  s_add_u32 s51, s51, 51380224
  v_lshlrev_b32 v81, 16, v89
  s_mov_b64 exec, 1
  buffer_store_dwordx2 v[80:81], v0, s[64:67], s51 offen sc1
  s_mov_b64 exec, -1
  s_setpc_b64 s[74:75]
L_x_poll_0:
  v_and_b32 v89, 0x70, v9
  v_lshlrev_b32 v89, 1, v89
  buffer_load_dword v88, v89, s[56:59], 0 offen sc1
  s_setpc_b64 s[74:75]
L_x_stat_0:
  s_waitcnt vmcnt(0)
  v_cmp_ne_u32 vcc, 32, v88
  s_nop 4
  s_cbranch_vccz L_x_stat_0_go
  s_sleep 2
  v_and_b32 v89, 0x70, v9
  v_lshlrev_b32 v89, 1, v89
  buffer_load_dword v88, v89, s[56:59], 0 offen sc1
  s_branch L_x_stat_0
L_x_stat_0_go:
  s_lshl_b32 s51, s6, 8
  s_lshl_b32 s55, s7, 5
  s_add_u32 s51, s51, s55
  s_lshl_b32 s55, s3, 2
  s_add_u32 s51, s51, s55
  s_add_u32 s51, s51, 50376704
  v_mov_b32 v88, 1
  s_mov_b64 exec, 1
  buffer_store_dword v88, v0, s[64:67], s51 offen sc1
  s_mov_b64 exec, -1
  v_and_b32 v88, 0xf0, v9
  v_lshrrev_b32 v88, 1, v88
  s_lshl_b32 s51, s7, 11
  s_add_u32 s51, s51, 51380224
  buffer_load_dwordx2 v[80:81], v88, s[64:67], s51 offen offset:0 sc1
  buffer_load_dwordx2 v[82:83], v88, s[64:67], s51 offen offset:128 sc1
  buffer_load_dwordx2 v[84:85], v88, s[64:67], s51 offen offset:256 sc1
  buffer_load_dwordx2 v[86:87], v88, s[64:67], s51 offen offset:384 sc1
  s_setpc_b64 s[74:75]
L_x_cpub_0:
  v_mov_b32 v10, v90
  v_mov_b32 v11, v91
  v_mov_b32 v88, v92
  s_nop 1
  v_permlane16_swap_b32 v90, v10
  v_permlane16_swap_b32 v91, v11
  v_permlane16_swap_b32 v92, v88
  v_add_f32 v90, v90, v10
  v_add_f32 v91, v91, v11
  v_add_f32 v92, v92, v88
  v_mov_b32 v10, v90
  v_mov_b32 v11, v91
  v_mov_b32 v88, v92
  s_nop 1
  v_permlane32_swap_b32 v90, v10
  v_permlane32_swap_b32 v91, v11
  v_permlane32_swap_b32 v92, v88
  v_add_f32 v90, v90, v10
  v_add_f32 v91, v91, v11
  v_add_f32 v92, v92, v88
  v_and_b32 v89, 0xf0, v9
  v_lshrrev_b32 v89, 2, v89
  s_mul_i32 s51, s6, 7680
  s_mul_i32 s52, s7, 1280
  s_add_u32 s51, s51, s52
  s_add_u32 s51, s51, 52428800
  s_mov_b64 exec, 0xffff
  buffer_store_dword v90, v89, s[64:67], s51 offen offset:0 sc1
  buffer_store_dword v91, v89, s[64:67], s51 offen offset:256 sc1
  buffer_store_dword v92, v89, s[64:67], s51 offen offset:512 sc1
  s_mov_b64 exec, -1
  s_nop 1
  v_mov_b32 v90, 0
  v_mov_b32 v91, 0
  v_mov_b32 v92, 0
  s_setpc_b64 s[74:75]
L_loop1:
  s_cmp_eq_u32 s60, s61
  s_cbranch_scc1 L_loopc1
L_loopp1:
  v_mfma_f32_16x16x32_bf16 v[96:99], v[60:63], v[12:15], v[96:99]
  v_mfma_f32_16x16x32_bf16 v[100:103], v[60:63], v[16:19], v[100:103]
  s_cmp_eq_u32 s60, 6
  s_cbranch_scc0 L_nx_9
  s_call_b64 s[74:75], L_x_drain_1
L_nx_9:
  v_mfma_f32_16x16x32_bf16 v[104:107], v[60:63], v[20:23], v[104:107]
  s_add_u32 m0, s33, 128000
  v_mfma_f32_16x16x32_bf16 v[108:111], v[60:63], v[24:27], v[108:111]
  buffer_load_dwordx4 v2, s[12:15], s27 offen lds
  s_add_u32 s27, s27, s30
  v_mfma_f32_16x16x32_bf16 v[124:127], v[64:67], v[24:27], v[124:127]
  ds_read_b64_tr_b16 v[60:61], v6 offset:13344
  v_mfma_f32_16x16x32_bf16 v[120:123], v[64:67], v[20:23], v[120:123]
  ds_read_b64_tr_b16 v[62:63], v6 offset:16928
  v_mfma_f32_16x16x32_bf16 v[116:119], v[64:67], v[16:19], v[116:119]
  s_add_u32 m0, s34, 128000
  ds_read_b64_tr_b16 v[76:77], v6 offset:6176
  v_mfma_f32_16x16x32_bf16 v[112:115], v[64:67], v[12:15], v[112:115]
  buffer_load_dwordx4 v3, s[16:19], s28 offen lds
  s_add_u32 s28, s28, s31
  ds_read_b64_tr_b16 v[78:79], v6 offset:9760
  v_mfma_f32_16x16x32_bf16 v[128:131], v[68:71], v[12:15], v[128:131]
  v_mfma_f32_16x16x32_bf16 v[132:135], v[68:71], v[16:19], v[132:135]
  v_mfma_f32_16x16x32_bf16 v[136:139], v[68:71], v[20:23], v[136:139]
  s_add_u32 m0, s35, 128000
  v_mfma_f32_16x16x32_bf16 v[140:143], v[68:71], v[24:27], v[140:143]
  buffer_load_dwordx4 v4, s[20:23], s29 offen lds
  s_add_u32 s29, s29, s32
  s_waitcnt lgkmcnt(4)
  v_mfma_f32_16x16x32_bf16 v[156:159], v[72:75], v[24:27], v[156:159]
  ds_read_b64_tr_b16 v[68:69], v6 offset:13376
  v_mfma_f32_16x16x32_bf16 v[152:155], v[72:75], v[20:23], v[152:155]
  ds_read_b64_tr_b16 v[70:71], v6 offset:16960
  v_mfma_f32_16x16x32_bf16 v[148:151], v[72:75], v[16:19], v[148:151]
  s_add_u32 s50, s26, 0
  s_add_u32 m0, s24, 0
  ds_read_b64_tr_b16 v[64:65], v6 offset:6208
  v_mfma_f32_16x16x32_bf16 v[144:147], v[72:75], v[12:15], v[144:147]
  buffer_load_dwordx4 v1, s[8:11], s50 offen lds
  ds_read_b64_tr_b16 v[66:67], v6 offset:9792
  s_waitcnt lgkmcnt(4)
  v_mfma_f32_16x16x32_bf16 v[160:163], v[76:79], v[12:15], v[160:163]
  ds_read_b64_tr_b16 v[72:73], v6 offset:6240
  v_mfma_f32_16x16x32_bf16 v[164:167], v[76:79], v[16:19], v[164:167]
  ds_read_b64_tr_b16 v[74:75], v6 offset:9824
  v_mfma_f32_16x16x32_bf16 v[168:171], v[76:79], v[20:23], v[168:171]
  s_add_u32 s50, s26, 4096
  s_add_u32 m0, s24, 1040
  v_mfma_f32_16x16x32_bf16 v[172:175], v[76:79], v[24:27], v[172:175]
  buffer_load_dwordx4 v1, s[8:11], s50 offen lds
  v_mfma_f32_16x16x32_bf16 v[188:191], v[60:63], v[24:27], v[188:191]
  ds_read_b64_tr_b16 v[76:77], v6 offset:13408
  v_mfma_f32_16x16x32_bf16 v[184:187], v[60:63], v[20:23], v[184:187]
  ds_read_b64_tr_b16 v[78:79], v6 offset:16992
  v_mfma_f32_16x16x32_bf16 v[180:183], v[60:63], v[16:19], v[180:183]
  v_mfma_f32_16x16x32_bf16 v[176:179], v[60:63], v[12:15], v[176:179]
  s_waitcnt lgkmcnt(4)
  v_mfma_f32_16x16x32_bf16 v[192:195], v[64:67], v[12:15], v[192:195]
  v_mfma_f32_16x16x32_bf16 v[196:199], v[64:67], v[16:19], v[196:199]
  v_mfma_f32_16x16x32_bf16 v[200:203], v[64:67], v[20:23], v[200:203]
  v_mfma_f32_16x16x32_bf16 v[204:207], v[64:67], v[24:27], v[204:207]
  v_mfma_f32_16x16x32_bf16 v[220:223], v[68:71], v[24:27], v[220:223]
  ds_read_b64_tr_b16 v[64:65], v8 offset:20480
  v_mfma_f32_16x16x32_bf16 v[216:219], v[68:71], v[20:23], v[216:219]
  ds_read_b64_tr_b16 v[66:67], v8 offset:21504
  v_mfma_f32_16x16x32_bf16 v[212:215], v[68:71], v[16:19], v[212:215]
  ds_read_b64_tr_b16 v[60:61], v7 offset:20480
  v_mfma_f32_16x16x32_bf16 v[208:211], v[68:71], v[12:15], v[208:211]
  ds_read_b64_tr_b16 v[62:63], v7 offset:21504
  s_waitcnt lgkmcnt(6)
  v_mfma_f32_16x16x32_bf16 v[224:227], v[72:75], v[12:15], v[224:227]
  ds_read_b64_tr_b16 v[68:69], v6 offset:26624
  v_mfma_f32_16x16x32_bf16 v[228:231], v[72:75], v[16:19], v[228:231]
  ds_read_b64_tr_b16 v[70:71], v6 offset:30208
  v_mfma_f32_16x16x32_bf16 v[232:235], v[72:75], v[20:23], v[232:235]
  v_mfma_f32_16x16x32_bf16 v[236:239], v[72:75], v[24:27], v[236:239]
  s_cmp_eq_u32 s60, 2
  s_cbranch_scc0 L_nx_10
  s_call_b64 s[74:75], L_x_poll_1
L_nx_10:
  s_waitcnt lgkmcnt(6)
  v_mfma_f32_16x16x32_bf16 v[252:255], v[76:79], v[24:27], v[252:255]
  ds_read_b64_tr_b16 v[72:73], v6 offset:33792
  v_mfma_f32_16x16x32_bf16 v[248:251], v[76:79], v[20:23], v[248:251]
  ds_read_b64_tr_b16 v[74:75], v6 offset:37376
  v_mfma_f32_16x16x32_bf16 v[244:247], v[76:79], v[16:19], v[244:247]
  v_mfma_f32_16x16x32_bf16 v[240:243], v[76:79], v[12:15], v[240:243]
  s_waitcnt vmcnt(5)
  s_barrier
  s_waitcnt lgkmcnt(4)
  v_mfma_f32_16x16x32_bf16 v[96:99], v[60:63], v[28:31], v[96:99]
  v_mfma_f32_16x16x32_bf16 v[100:103], v[60:63], v[32:35], v[100:103]
  v_mfma_f32_16x16x32_bf16 v[104:107], v[60:63], v[36:39], v[104:107]
  s_add_u32 m0, s33, 66560
  ds_read_b64 v[12:13], v5 offset:33280
  v_mfma_f32_16x16x32_bf16 v[108:111], v[60:63], v[40:43], v[108:111]
  buffer_load_dwordx4 v2, s[12:15], s27 offen lds
  s_add_u32 s27, s27, s30
  ds_read_b64 v[14:15], v5 offset:33312
  v_mfma_f32_16x16x32_bf16 v[124:127], v[64:67], v[40:43], v[124:127]
  ds_read_b64_tr_b16 v[60:61], v6 offset:33824
  v_mfma_f32_16x16x32_bf16 v[120:123], v[64:67], v[36:39], v[120:123]
  ds_read_b64_tr_b16 v[62:63], v6 offset:37408
  v_mfma_f32_16x16x32_bf16 v[116:119], v[64:67], v[32:35], v[116:119]
  s_add_u32 m0, s34, 66560
  ds_read_b64_tr_b16 v[76:77], v6 offset:26656
  ds_read_b64 v[16:17], v5 offset:33536
  v_mfma_f32_16x16x32_bf16 v[112:115], v[64:67], v[28:31], v[112:115]
  buffer_load_dwordx4 v3, s[16:19], s28 offen lds
  s_add_u32 s28, s28, s31
  ds_read_b64_tr_b16 v[78:79], v6 offset:30240
  ds_read_b64 v[18:19], v5 offset:33568
  s_waitcnt lgkmcnt(10)
  v_mfma_f32_16x16x32_bf16 v[128:131], v[68:71], v[28:31], v[128:131]
  v_mfma_f32_16x16x32_bf16 v[132:135], v[68:71], v[32:35], v[132:135]
  v_mfma_f32_16x16x32_bf16 v[136:139], v[68:71], v[36:39], v[136:139]
  s_add_u32 m0, s35, 66560
  ds_read_b64 v[20:21], v5 offset:33792
  v_mfma_f32_16x16x32_bf16 v[140:143], v[68:71], v[40:43], v[140:143]
  buffer_load_dwordx4 v4, s[20:23], s29 offen lds
  s_add_u32 s29, s29, s32
  ds_read_b64 v[22:23], v5 offset:33824
  s_waitcnt lgkmcnt(10)
  v_mfma_f32_16x16x32_bf16 v[156:159], v[72:75], v[40:43], v[156:159]
  ds_read_b64_tr_b16 v[68:69], v6 offset:33856
  v_mfma_f32_16x16x32_bf16 v[152:155], v[72:75], v[36:39], v[152:155]
  ds_read_b64_tr_b16 v[70:71], v6 offset:37440
  v_mfma_f32_16x16x32_bf16 v[148:151], v[72:75], v[32:35], v[148:151]
  s_add_u32 s50, s26, 262144
  s_add_u32 m0, s24, 16640
  ds_read_b64_tr_b16 v[64:65], v6 offset:26688
  ds_read_b64 v[24:25], v5 offset:34048
  v_mfma_f32_16x16x32_bf16 v[144:147], v[72:75], v[28:31], v[144:147]
  buffer_load_dwordx4 v1, s[8:11], s50 offen lds
  ds_read_b64_tr_b16 v[66:67], v6 offset:30272
  ds_read_b64 v[26:27], v5 offset:34080
  s_waitcnt lgkmcnt(9)
  v_mfma_f32_16x16x32_bf16 v[160:163], v[76:79], v[28:31], v[160:163]
  ds_read_b64_tr_b16 v[72:73], v6 offset:26720
  v_mfma_f32_16x16x32_bf16 v[164:167], v[76:79], v[32:35], v[164:167]
  ds_read_b64_tr_b16 v[74:75], v6 offset:30304
  v_mfma_f32_16x16x32_bf16 v[168:171], v[76:79], v[36:39], v[168:171]
  s_add_u32 s50, s26, 266240
  s_add_u32 m0, s24, 17680
  ds_read_b64 v[44:45], v5 offset:33344
  v_mfma_f32_16x16x32_bf16 v[172:175], v[76:79], v[40:43], v[172:175]
  buffer_load_dwordx4 v1, s[8:11], s50 offen lds
  ds_read_b64 v[46:47], v5 offset:33376
  v_mfma_f32_16x16x32_bf16 v[188:191], v[60:63], v[40:43], v[188:191]
  ds_read_b64_tr_b16 v[76:77], v6 offset:33888
  v_mfma_f32_16x16x32_bf16 v[184:187], v[60:63], v[36:39], v[184:187]
  ds_read_b64_tr_b16 v[78:79], v6 offset:37472
  v_mfma_f32_16x16x32_bf16 v[180:183], v[60:63], v[32:35], v[180:183]
  v_mfma_f32_16x16x32_bf16 v[176:179], v[60:63], v[28:31], v[176:179]
  s_waitcnt lgkmcnt(7)
  v_mfma_f32_16x16x32_bf16 v[192:195], v[64:67], v[28:31], v[192:195]
  v_mfma_f32_16x16x32_bf16 v[196:199], v[64:67], v[32:35], v[196:199]
  v_mfma_f32_16x16x32_bf16 v[200:203], v[64:67], v[36:39], v[200:203]
  ds_read_b64 v[48:49], v5 offset:33600
  v_mfma_f32_16x16x32_bf16 v[204:207], v[64:67], v[40:43], v[204:207]
  ds_read_b64 v[50:51], v5 offset:33632
  v_mfma_f32_16x16x32_bf16 v[220:223], v[68:71], v[40:43], v[220:223]
  ds_read_b64_tr_b16 v[64:65], v95 offset:0
  v_mfma_f32_16x16x32_bf16 v[216:219], v[68:71], v[36:39], v[216:219]
  ds_read_b64_tr_b16 v[66:67], v95 offset:1024
  v_mfma_f32_16x16x32_bf16 v[212:215], v[68:71], v[32:35], v[212:215]
  ds_read_b64_tr_b16 v[60:61], v94 offset:0
  ds_read_b64 v[52:53], v5 offset:33856
  v_mfma_f32_16x16x32_bf16 v[208:211], v[68:71], v[28:31], v[208:211]
  ds_read_b64_tr_b16 v[62:63], v94 offset:1024
  ds_read_b64 v[54:55], v5 offset:33888
  s_waitcnt lgkmcnt(12)
  v_mfma_f32_16x16x32_bf16 v[224:227], v[72:75], v[28:31], v[224:227]
  ds_read_b64_tr_b16 v[68:69], v93 offset:6144
  v_mfma_f32_16x16x32_bf16 v[228:231], v[72:75], v[32:35], v[228:231]
  ds_read_b64_tr_b16 v[70:71], v93 offset:9728
  v_mfma_f32_16x16x32_bf16 v[232:235], v[72:75], v[36:39], v[232:235]
  ds_read_b64 v[56:57], v5 offset:34112
  v_mfma_f32_16x16x32_bf16 v[236:239], v[72:75], v[40:43], v[236:239]
  ds_read_b64 v[58:59], v5 offset:34144
  s_waitcnt lgkmcnt(12)
  v_mfma_f32_16x16x32_bf16 v[252:255], v[76:79], v[40:43], v[252:255]
  ds_read_b64_tr_b16 v[72:73], v93 offset:13312
  v_mfma_f32_16x16x32_bf16 v[248:251], v[76:79], v[36:39], v[248:251]
  ds_read_b64_tr_b16 v[74:75], v93 offset:16896
  v_mfma_f32_16x16x32_bf16 v[244:247], v[76:79], v[32:35], v[244:247]
  s_add_u32 s25, s25, 128
  s_cmp_ge_u32 s25, 2048
  s_cselect_b32 s26, 0x10000000, s25
  v_mfma_f32_16x16x32_bf16 v[240:243], v[76:79], v[28:31], v[240:243]
  s_waitcnt vmcnt(5) lgkmcnt(2)
  s_barrier
  v_mfma_f32_16x16x32_bf16 v[96:99], v[60:63], v[12:15], v[96:99]
  v_mfma_f32_16x16x32_bf16 v[100:103], v[60:63], v[16:19], v[100:103]
  s_cmp_eq_u32 s60, 2
  s_cbranch_scc0 L_nx_11
  s_call_b64 s[74:75], L_x_stat_1
L_nx_11:
  s_cmp_eq_u32 s60, 8
  s_cbranch_scc0 L_nx_12
  s_call_b64 s[74:75], L_x_rows_1
L_nx_12:
  v_mfma_f32_16x16x32_bf16 v[104:107], v[60:63], v[20:23], v[104:107]
  s_add_u32 m0, s33, 87040
  v_mfma_f32_16x16x32_bf16 v[108:111], v[60:63], v[24:27], v[108:111]
  buffer_load_dwordx4 v2, s[12:15], s27 offen lds
  s_add_u32 s27, s27, s30
  v_mfma_f32_16x16x32_bf16 v[124:127], v[64:67], v[24:27], v[124:127]
  ds_read_b64_tr_b16 v[60:61], v93 offset:13344
  v_mfma_f32_16x16x32_bf16 v[120:123], v[64:67], v[20:23], v[120:123]
  ds_read_b64_tr_b16 v[62:63], v93 offset:16928
  v_mfma_f32_16x16x32_bf16 v[116:119], v[64:67], v[16:19], v[116:119]
  s_add_u32 m0, s34, 87040
  ds_read_b64_tr_b16 v[76:77], v93 offset:6176
  v_mfma_f32_16x16x32_bf16 v[112:115], v[64:67], v[12:15], v[112:115]
  buffer_load_dwordx4 v3, s[16:19], s28 offen lds
  s_add_u32 s28, s28, s31
  ds_read_b64_tr_b16 v[78:79], v93 offset:9760
  v_mfma_f32_16x16x32_bf16 v[128:131], v[68:71], v[12:15], v[128:131]
  v_mfma_f32_16x16x32_bf16 v[132:135], v[68:71], v[16:19], v[132:135]
  v_mfma_f32_16x16x32_bf16 v[136:139], v[68:71], v[20:23], v[136:139]
  s_add_u32 m0, s35, 87040
  v_mfma_f32_16x16x32_bf16 v[140:143], v[68:71], v[24:27], v[140:143]
  buffer_load_dwordx4 v4, s[20:23], s29 offen lds
  s_add_u32 s29, s29, s32
  s_waitcnt lgkmcnt(4)
  v_mfma_f32_16x16x32_bf16 v[156:159], v[72:75], v[24:27], v[156:159]
  ds_read_b64_tr_b16 v[68:69], v93 offset:13376
  v_mfma_f32_16x16x32_bf16 v[152:155], v[72:75], v[20:23], v[152:155]
  ds_read_b64_tr_b16 v[70:71], v93 offset:16960
  v_mfma_f32_16x16x32_bf16 v[148:151], v[72:75], v[16:19], v[148:151]
  s_add_u32 s50, s26, 0
  s_add_u32 m0, s24, 33280
  ds_read_b64_tr_b16 v[64:65], v93 offset:6208
  v_mfma_f32_16x16x32_bf16 v[144:147], v[72:75], v[12:15], v[144:147]
  buffer_load_dwordx4 v1, s[8:11], s50 offen lds
  ds_read_b64_tr_b16 v[66:67], v93 offset:9792
  s_waitcnt lgkmcnt(4)
  v_mfma_f32_16x16x32_bf16 v[160:163], v[76:79], v[12:15], v[160:163]
  ds_read_b64_tr_b16 v[72:73], v93 offset:6240
  v_mfma_f32_16x16x32_bf16 v[164:167], v[76:79], v[16:19], v[164:167]
  ds_read_b64_tr_b16 v[74:75], v93 offset:9824
  v_mfma_f32_16x16x32_bf16 v[168:171], v[76:79], v[20:23], v[168:171]
  s_add_u32 s50, s26, 4096
  s_add_u32 m0, s24, 34320
  v_mfma_f32_16x16x32_bf16 v[172:175], v[76:79], v[24:27], v[172:175]
  buffer_load_dwordx4 v1, s[8:11], s50 offen lds
  v_mfma_f32_16x16x32_bf16 v[188:191], v[60:63], v[24:27], v[188:191]
  ds_read_b64_tr_b16 v[76:77], v93 offset:13408
  v_mfma_f32_16x16x32_bf16 v[184:187], v[60:63], v[20:23], v[184:187]
  ds_read_b64_tr_b16 v[78:79], v93 offset:16992
  v_mfma_f32_16x16x32_bf16 v[180:183], v[60:63], v[16:19], v[180:183]
  v_mfma_f32_16x16x32_bf16 v[176:179], v[60:63], v[12:15], v[176:179]
  s_waitcnt lgkmcnt(4)
  v_mfma_f32_16x16x32_bf16 v[192:195], v[64:67], v[12:15], v[192:195]
  v_mfma_f32_16x16x32_bf16 v[196:199], v[64:67], v[16:19], v[196:199]
  v_mfma_f32_16x16x32_bf16 v[200:203], v[64:67], v[20:23], v[200:203]
  v_mfma_f32_16x16x32_bf16 v[204:207], v[64:67], v[24:27], v[204:207]
  v_mfma_f32_16x16x32_bf16 v[220:223], v[68:71], v[24:27], v[220:223]
  ds_read_b64_tr_b16 v[64:65], v95 offset:20480
  v_mfma_f32_16x16x32_bf16 v[216:219], v[68:71], v[20:23], v[216:219]
  ds_read_b64_tr_b16 v[66:67], v95 offset:21504
  v_mfma_f32_16x16x32_bf16 v[212:215], v[68:71], v[16:19], v[212:215]
  ds_read_b64_tr_b16 v[60:61], v94 offset:20480
  v_mfma_f32_16x16x32_bf16 v[208:211], v[68:71], v[12:15], v[208:211]
  ds_read_b64_tr_b16 v[62:63], v94 offset:21504
  s_waitcnt lgkmcnt(6)
  v_mfma_f32_16x16x32_bf16 v[224:227], v[72:75], v[12:15], v[224:227]
  ds_read_b64_tr_b16 v[68:69], v93 offset:26624
  v_mfma_f32_16x16x32_bf16 v[228:231], v[72:75], v[16:19], v[228:231]
  ds_read_b64_tr_b16 v[70:71], v93 offset:30208
  v_mfma_f32_16x16x32_bf16 v[232:235], v[72:75], v[20:23], v[232:235]
  v_mfma_f32_16x16x32_bf16 v[236:239], v[72:75], v[24:27], v[236:239]
  s_waitcnt lgkmcnt(6)
  v_mfma_f32_16x16x32_bf16 v[252:255], v[76:79], v[24:27], v[252:255]
  ds_read_b64_tr_b16 v[72:73], v93 offset:33792
  v_mfma_f32_16x16x32_bf16 v[248:251], v[76:79], v[20:23], v[248:251]
  ds_read_b64_tr_b16 v[74:75], v93 offset:37376
  v_mfma_f32_16x16x32_bf16 v[244:247], v[76:79], v[16:19], v[244:247]
  v_mfma_f32_16x16x32_bf16 v[240:243], v[76:79], v[12:15], v[240:243]
  s_waitcnt vmcnt(5)
  s_barrier
  s_waitcnt lgkmcnt(4)
  v_mfma_f32_16x16x32_bf16 v[96:99], v[60:63], v[44:47], v[96:99]
  v_mfma_f32_16x16x32_bf16 v[100:103], v[60:63], v[48:51], v[100:103]
  v_mfma_f32_16x16x32_bf16 v[104:107], v[60:63], v[52:55], v[104:107]
  s_add_u32 m0, s33, 107520
  ds_read_b64 v[12:13], v5 offset:0
  v_mfma_f32_16x16x32_bf16 v[108:111], v[60:63], v[56:59], v[108:111]
  buffer_load_dwordx4 v2, s[12:15], s27 offen lds
  s_add_u32 s27, s27, s30
  ds_read_b64 v[14:15], v5 offset:32
  v_mfma_f32_16x16x32_bf16 v[124:127], v[64:67], v[56:59], v[124:127]
  ds_read_b64_tr_b16 v[60:61], v93 offset:33824
  v_mfma_f32_16x16x32_bf16 v[120:123], v[64:67], v[52:55], v[120:123]
  ds_read_b64_tr_b16 v[62:63], v93 offset:37408
  v_mfma_f32_16x16x32_bf16 v[116:119], v[64:67], v[48:51], v[116:119]
  s_add_u32 m0, s34, 107520
  ds_read_b64_tr_b16 v[76:77], v93 offset:26656
  ds_read_b64 v[16:17], v5 offset:256
  v_mfma_f32_16x16x32_bf16 v[112:115], v[64:67], v[44:47], v[112:115]
  buffer_load_dwordx4 v3, s[16:19], s28 offen lds
  s_add_u32 s28, s28, s31
  ds_read_b64_tr_b16 v[78:79], v93 offset:30240
  ds_read_b64 v[18:19], v5 offset:288
  s_waitcnt lgkmcnt(10)
  v_mfma_f32_16x16x32_bf16 v[128:131], v[68:71], v[44:47], v[128:131]
  v_mfma_f32_16x16x32_bf16 v[132:135], v[68:71], v[48:51], v[132:135]
  v_mfma_f32_16x16x32_bf16 v[136:139], v[68:71], v[52:55], v[136:139]
  s_add_u32 m0, s35, 107520
  ds_read_b64 v[20:21], v5 offset:512
  v_mfma_f32_16x16x32_bf16 v[140:143], v[68:71], v[56:59], v[140:143]
  buffer_load_dwordx4 v4, s[20:23], s29 offen lds
  s_add_u32 s29, s29, s32
  ds_read_b64 v[22:23], v5 offset:544
  s_waitcnt lgkmcnt(10)
  v_mfma_f32_16x16x32_bf16 v[156:159], v[72:75], v[56:59], v[156:159]
  ds_read_b64_tr_b16 v[68:69], v93 offset:33856
  v_mfma_f32_16x16x32_bf16 v[152:155], v[72:75], v[52:55], v[152:155]
  ds_read_b64_tr_b16 v[70:71], v93 offset:37440
  v_mfma_f32_16x16x32_bf16 v[148:151], v[72:75], v[48:51], v[148:151]
  s_add_u32 s50, s26, 262144
  s_add_u32 m0, s24, 49920
  ds_read_b64_tr_b16 v[64:65], v93 offset:26688
  ds_read_b64 v[24:25], v5 offset:768
  v_mfma_f32_16x16x32_bf16 v[144:147], v[72:75], v[44:47], v[144:147]
  buffer_load_dwordx4 v1, s[8:11], s50 offen lds
  ds_read_b64_tr_b16 v[66:67], v93 offset:30272
  ds_read_b64 v[26:27], v5 offset:800
  s_waitcnt lgkmcnt(9)
  v_mfma_f32_16x16x32_bf16 v[160:163], v[76:79], v[44:47], v[160:163]
  ds_read_b64_tr_b16 v[72:73], v93 offset:26720
  v_mfma_f32_16x16x32_bf16 v[164:167], v[76:79], v[48:51], v[164:167]
  ds_read_b64_tr_b16 v[74:75], v93 offset:30304
  v_mfma_f32_16x16x32_bf16 v[168:171], v[76:79], v[52:55], v[168:171]
  s_add_u32 s50, s26, 266240
  s_add_u32 m0, s24, 50960
  ds_read_b64 v[28:29], v5 offset:64
  v_mfma_f32_16x16x32_bf16 v[172:175], v[76:79], v[56:59], v[172:175]
  buffer_load_dwordx4 v1, s[8:11], s50 offen lds
  ds_read_b64 v[30:31], v5 offset:96
  v_mfma_f32_16x16x32_bf16 v[188:191], v[60:63], v[56:59], v[188:191]
  ds_read_b64_tr_b16 v[76:77], v93 offset:33888
  v_mfma_f32_16x16x32_bf16 v[184:187], v[60:63], v[52:55], v[184:187]
  ds_read_b64_tr_b16 v[78:79], v93 offset:37472
  v_mfma_f32_16x16x32_bf16 v[180:183], v[60:63], v[48:51], v[180:183]
  v_mfma_f32_16x16x32_bf16 v[176:179], v[60:63], v[44:47], v[176:179]
  s_waitcnt lgkmcnt(7)
  v_mfma_f32_16x16x32_bf16 v[192:195], v[64:67], v[44:47], v[192:195]
  v_mfma_f32_16x16x32_bf16 v[196:199], v[64:67], v[48:51], v[196:199]
  v_mfma_f32_16x16x32_bf16 v[200:203], v[64:67], v[52:55], v[200:203]
  ds_read_b64 v[32:33], v5 offset:320
  v_mfma_f32_16x16x32_bf16 v[204:207], v[64:67], v[56:59], v[204:207]
  ds_read_b64 v[34:35], v5 offset:352
  v_mfma_f32_16x16x32_bf16 v[220:223], v[68:71], v[56:59], v[220:223]
  ds_read_b64_tr_b16 v[64:65], v8 offset:0
  v_mfma_f32_16x16x32_bf16 v[216:219], v[68:71], v[52:55], v[216:219]
  ds_read_b64_tr_b16 v[66:67], v8 offset:1024
  v_mfma_f32_16x16x32_bf16 v[212:215], v[68:71], v[48:51], v[212:215]
  ds_read_b64_tr_b16 v[60:61], v7 offset:0
  ds_read_b64 v[36:37], v5 offset:576
  v_mfma_f32_16x16x32_bf16 v[208:211], v[68:71], v[44:47], v[208:211]
  ds_read_b64_tr_b16 v[62:63], v7 offset:1024
  ds_read_b64 v[38:39], v5 offset:608
  s_waitcnt lgkmcnt(12)
  v_mfma_f32_16x16x32_bf16 v[224:227], v[72:75], v[44:47], v[224:227]
  ds_read_b64_tr_b16 v[68:69], v6 offset:6144
  v_mfma_f32_16x16x32_bf16 v[228:231], v[72:75], v[48:51], v[228:231]
  ds_read_b64_tr_b16 v[70:71], v6 offset:9728
  v_mfma_f32_16x16x32_bf16 v[232:235], v[72:75], v[52:55], v[232:235]
  ds_read_b64 v[40:41], v5 offset:832
  v_mfma_f32_16x16x32_bf16 v[236:239], v[72:75], v[56:59], v[236:239]
  ds_read_b64 v[42:43], v5 offset:864
  s_waitcnt lgkmcnt(12)
  v_mfma_f32_16x16x32_bf16 v[252:255], v[76:79], v[56:59], v[252:255]
  ds_read_b64_tr_b16 v[72:73], v6 offset:13312
  v_mfma_f32_16x16x32_bf16 v[248:251], v[76:79], v[52:55], v[248:251]
  ds_read_b64_tr_b16 v[74:75], v6 offset:16896
  v_mfma_f32_16x16x32_bf16 v[244:247], v[76:79], v[48:51], v[244:247]
  s_add_u32 s25, s25, 128
  s_cmp_ge_u32 s25, 2048
  s_cselect_b32 s26, 0x10000000, s25
  v_mfma_f32_16x16x32_bf16 v[240:243], v[76:79], v[44:47], v[240:243]
  s_waitcnt vmcnt(5) lgkmcnt(2)
  s_barrier
  s_sub_u32 s60, s60, 1
  s_cmp_gt_u32 s60, 2
  s_cbranch_scc1 L_loop1
L_loopc1:
  v_mfma_f32_16x16x32_bf16 v[96:99], v[60:63], v[12:15], v[96:99]
  v_mfma_f32_16x16x32_bf16 v[100:103], v[60:63], v[16:19], v[100:103]
  s_cmp_eq_u32 s60, 6
  s_cbranch_scc0 L_nx_13
  s_call_b64 s[74:75], L_x_drain_1
L_nx_13:
  v_mfma_f32_16x16x32_bf16 v[104:107], v[60:63], v[20:23], v[104:107]
  s_add_u32 m0, s33, 128000
  v_mfma_f32_16x16x32_bf16 v[108:111], v[60:63], v[24:27], v[108:111]
  buffer_load_dwordx4 v2, s[12:15], s27 offen lds
  s_add_u32 s27, s27, s30
  v_mfma_f32_16x16x32_bf16 v[124:127], v[64:67], v[24:27], v[124:127]
  ds_read_b64_tr_b16 v[60:61], v6 offset:13344
  v_lshlrev_b32 v10, 16, v64
  v_and_b32 v11, s79, v64
  v_mfma_f32_16x16x32_bf16 v[120:123], v[64:67], v[20:23], v[120:123]
  ds_read_b64_tr_b16 v[62:63], v6 offset:16928
  v_add_f32 v90, v90, v10
  v_add_f32 v90, v90, v11
  v_mfma_f32_16x16x32_bf16 v[116:119], v[64:67], v[16:19], v[116:119]
  s_add_u32 m0, s34, 128000
  ds_read_b64_tr_b16 v[76:77], v6 offset:6176
  v_lshlrev_b32 v10, 16, v65
  v_and_b32 v11, s79, v65
  v_mfma_f32_16x16x32_bf16 v[112:115], v[64:67], v[12:15], v[112:115]
  buffer_load_dwordx4 v3, s[16:19], s28 offen lds
  s_add_u32 s28, s28, s31
  ds_read_b64_tr_b16 v[78:79], v6 offset:9760
  v_add_f32 v90, v90, v10
  v_add_f32 v90, v90, v11
  v_mfma_f32_16x16x32_bf16 v[128:131], v[68:71], v[12:15], v[128:131]
  v_lshlrev_b32 v10, 16, v66
  v_and_b32 v11, s79, v66
  v_mfma_f32_16x16x32_bf16 v[132:135], v[68:71], v[16:19], v[132:135]
  v_add_f32 v90, v90, v10
  v_add_f32 v90, v90, v11
  v_mfma_f32_16x16x32_bf16 v[136:139], v[68:71], v[20:23], v[136:139]
  s_add_u32 m0, s35, 128000
  v_lshlrev_b32 v10, 16, v67
  v_and_b32 v11, s79, v67
  v_mfma_f32_16x16x32_bf16 v[140:143], v[68:71], v[24:27], v[140:143]
  buffer_load_dwordx4 v4, s[20:23], s29 offen lds
  s_add_u32 s29, s29, s32
  v_add_f32 v90, v90, v10
  v_add_f32 v90, v90, v11
  s_waitcnt lgkmcnt(4)
  v_mfma_f32_16x16x32_bf16 v[156:159], v[72:75], v[24:27], v[156:159]
  ds_read_b64_tr_b16 v[68:69], v6 offset:13376
  v_mfma_f32_16x16x32_bf16 v[152:155], v[72:75], v[20:23], v[152:155]
  ds_read_b64_tr_b16 v[70:71], v6 offset:16960
  v_mfma_f32_16x16x32_bf16 v[148:151], v[72:75], v[16:19], v[148:151]
  s_add_u32 s50, s26, 0
  s_add_u32 m0, s24, 0
  ds_read_b64_tr_b16 v[64:65], v6 offset:6208
  v_mfma_f32_16x16x32_bf16 v[144:147], v[72:75], v[12:15], v[144:147]
  buffer_load_dwordx4 v1, s[8:11], s50 offen lds
  ds_read_b64_tr_b16 v[66:67], v6 offset:9792
  s_waitcnt lgkmcnt(4)
  v_mfma_f32_16x16x32_bf16 v[160:163], v[76:79], v[12:15], v[160:163]
  ds_read_b64_tr_b16 v[72:73], v6 offset:6240
  v_mfma_f32_16x16x32_bf16 v[164:167], v[76:79], v[16:19], v[164:167]
  ds_read_b64_tr_b16 v[74:75], v6 offset:9824
  v_mfma_f32_16x16x32_bf16 v[168:171], v[76:79], v[20:23], v[168:171]
  s_add_u32 s50, s26, 4096
  s_add_u32 m0, s24, 1040
  v_mfma_f32_16x16x32_bf16 v[172:175], v[76:79], v[24:27], v[172:175]
  buffer_load_dwordx4 v1, s[8:11], s50 offen lds
  v_mfma_f32_16x16x32_bf16 v[188:191], v[60:63], v[24:27], v[188:191]
  ds_read_b64_tr_b16 v[76:77], v6 offset:13408
  v_lshlrev_b32 v10, 16, v60
  v_and_b32 v11, s79, v60
  v_mfma_f32_16x16x32_bf16 v[184:187], v[60:63], v[20:23], v[184:187]
  ds_read_b64_tr_b16 v[78:79], v6 offset:16992
  v_add_f32 v91, v91, v10
  v_add_f32 v91, v91, v11
  v_mfma_f32_16x16x32_bf16 v[180:183], v[60:63], v[16:19], v[180:183]
  v_lshlrev_b32 v10, 16, v61
  v_and_b32 v11, s79, v61
  v_mfma_f32_16x16x32_bf16 v[176:179], v[60:63], v[12:15], v[176:179]
  v_add_f32 v91, v91, v10
  v_add_f32 v91, v91, v11
  s_waitcnt lgkmcnt(4)
  v_mfma_f32_16x16x32_bf16 v[192:195], v[64:67], v[12:15], v[192:195]
  v_lshlrev_b32 v10, 16, v62
  v_and_b32 v11, s79, v62
  v_mfma_f32_16x16x32_bf16 v[196:199], v[64:67], v[16:19], v[196:199]
  v_add_f32 v91, v91, v10
  v_add_f32 v91, v91, v11
  v_mfma_f32_16x16x32_bf16 v[200:203], v[64:67], v[20:23], v[200:203]
  v_lshlrev_b32 v10, 16, v63
  v_and_b32 v11, s79, v63
  v_mfma_f32_16x16x32_bf16 v[204:207], v[64:67], v[24:27], v[204:207]
  v_add_f32 v91, v91, v10
  v_add_f32 v91, v91, v11
  v_mfma_f32_16x16x32_bf16 v[220:223], v[68:71], v[24:27], v[220:223]
  ds_read_b64_tr_b16 v[64:65], v8 offset:20480
  v_mfma_f32_16x16x32_bf16 v[216:219], v[68:71], v[20:23], v[216:219]
  ds_read_b64_tr_b16 v[66:67], v8 offset:21504
  v_mfma_f32_16x16x32_bf16 v[212:215], v[68:71], v[16:19], v[212:215]
  ds_read_b64_tr_b16 v[60:61], v7 offset:20480
  v_mfma_f32_16x16x32_bf16 v[208:211], v[68:71], v[12:15], v[208:211]
  ds_read_b64_tr_b16 v[62:63], v7 offset:21504
  s_waitcnt lgkmcnt(6)
  v_mfma_f32_16x16x32_bf16 v[224:227], v[72:75], v[12:15], v[224:227]
  ds_read_b64_tr_b16 v[68:69], v6 offset:26624
  v_mfma_f32_16x16x32_bf16 v[228:231], v[72:75], v[16:19], v[228:231]
  ds_read_b64_tr_b16 v[70:71], v6 offset:30208
  v_mfma_f32_16x16x32_bf16 v[232:235], v[72:75], v[20:23], v[232:235]
  v_mfma_f32_16x16x32_bf16 v[236:239], v[72:75], v[24:27], v[236:239]
  s_cmp_eq_u32 s60, 2
  s_cbranch_scc0 L_nx_14
  s_call_b64 s[74:75], L_x_poll_1
L_nx_14:
  s_waitcnt lgkmcnt(6)
  v_mfma_f32_16x16x32_bf16 v[252:255], v[76:79], v[24:27], v[252:255]
  ds_read_b64_tr_b16 v[72:73], v6 offset:33792
  v_lshlrev_b32 v10, 16, v76
  v_and_b32 v11, s79, v76
  v_add_f32 v92, v92, v10
  v_add_f32 v92, v92, v11
  v_mfma_f32_16x16x32_bf16 v[248:251], v[76:79], v[20:23], v[248:251]
  ds_read_b64_tr_b16 v[74:75], v6 offset:37376
  v_lshlrev_b32 v10, 16, v77
  v_and_b32 v11, s79, v77
  v_add_f32 v92, v92, v10
  v_add_f32 v92, v92, v11
  v_mfma_f32_16x16x32_bf16 v[244:247], v[76:79], v[16:19], v[244:247]
  v_lshlrev_b32 v10, 16, v78
  v_and_b32 v11, s79, v78
  v_add_f32 v92, v92, v10
  v_add_f32 v92, v92, v11
  v_mfma_f32_16x16x32_bf16 v[240:243], v[76:79], v[12:15], v[240:243]
  v_lshlrev_b32 v10, 16, v79
  v_and_b32 v11, s79, v79
  v_add_f32 v92, v92, v10
  v_add_f32 v92, v92, v11
  s_waitcnt vmcnt(5)
  s_barrier
  s_waitcnt lgkmcnt(4)
  v_mfma_f32_16x16x32_bf16 v[96:99], v[60:63], v[28:31], v[96:99]
  v_mfma_f32_16x16x32_bf16 v[100:103], v[60:63], v[32:35], v[100:103]
  v_mfma_f32_16x16x32_bf16 v[104:107], v[60:63], v[36:39], v[104:107]
  s_add_u32 m0, s33, 66560
  ds_read_b64 v[12:13], v5 offset:33280
  v_mfma_f32_16x16x32_bf16 v[108:111], v[60:63], v[40:43], v[108:111]
  buffer_load_dwordx4 v2, s[12:15], s27 offen lds
  s_add_u32 s27, s27, s30
  ds_read_b64 v[14:15], v5 offset:33312
  v_mfma_f32_16x16x32_bf16 v[124:127], v[64:67], v[40:43], v[124:127]
  ds_read_b64_tr_b16 v[60:61], v6 offset:33824
  v_lshlrev_b32 v10, 16, v64
  v_and_b32 v11, s79, v64
  v_mfma_f32_16x16x32_bf16 v[120:123], v[64:67], v[36:39], v[120:123]
  ds_read_b64_tr_b16 v[62:63], v6 offset:37408
  v_add_f32 v90, v90, v10
  v_add_f32 v90, v90, v11
  v_mfma_f32_16x16x32_bf16 v[116:119], v[64:67], v[32:35], v[116:119]
  s_add_u32 m0, s34, 66560
  ds_read_b64_tr_b16 v[76:77], v6 offset:26656
  ds_read_b64 v[16:17], v5 offset:33536
  v_lshlrev_b32 v10, 16, v65
  v_and_b32 v11, s79, v65
  v_mfma_f32_16x16x32_bf16 v[112:115], v[64:67], v[28:31], v[112:115]
  buffer_load_dwordx4 v3, s[16:19], s28 offen lds
  s_add_u32 s28, s28, s31
  ds_read_b64_tr_b16 v[78:79], v6 offset:30240
  ds_read_b64 v[18:19], v5 offset:33568
  v_add_f32 v90, v90, v10
  v_add_f32 v90, v90, v11
  s_waitcnt lgkmcnt(10)
  v_mfma_f32_16x16x32_bf16 v[128:131], v[68:71], v[28:31], v[128:131]
  v_lshlrev_b32 v10, 16, v66
  v_and_b32 v11, s79, v66
  v_mfma_f32_16x16x32_bf16 v[132:135], v[68:71], v[32:35], v[132:135]
  v_add_f32 v90, v90, v10
  v_add_f32 v90, v90, v11
  v_mfma_f32_16x16x32_bf16 v[136:139], v[68:71], v[36:39], v[136:139]
  s_add_u32 m0, s35, 66560
  ds_read_b64 v[20:21], v5 offset:33792
  v_lshlrev_b32 v10, 16, v67
  v_and_b32 v11, s79, v67
  v_mfma_f32_16x16x32_bf16 v[140:143], v[68:71], v[40:43], v[140:143]
  buffer_load_dwordx4 v4, s[20:23], s29 offen lds
  s_add_u32 s29, s29, s32
  ds_read_b64 v[22:23], v5 offset:33824
  v_add_f32 v90, v90, v10
  v_add_f32 v90, v90, v11
  s_waitcnt lgkmcnt(10)
  v_mfma_f32_16x16x32_bf16 v[156:159], v[72:75], v[40:43], v[156:159]
  ds_read_b64_tr_b16 v[68:69], v6 offset:33856
  v_mfma_f32_16x16x32_bf16 v[152:155], v[72:75], v[36:39], v[152:155]
  ds_read_b64_tr_b16 v[70:71], v6 offset:37440
  v_mfma_f32_16x16x32_bf16 v[148:151], v[72:75], v[32:35], v[148:151]
  s_add_u32 s50, s26, 262144
  s_add_u32 m0, s24, 16640
  ds_read_b64_tr_b16 v[64:65], v6 offset:26688
  ds_read_b64 v[24:25], v5 offset:34048
  v_mfma_f32_16x16x32_bf16 v[144:147], v[72:75], v[28:31], v[144:147]
  buffer_load_dwordx4 v1, s[8:11], s50 offen lds
  ds_read_b64_tr_b16 v[66:67], v6 offset:30272
  ds_read_b64 v[26:27], v5 offset:34080
  s_waitcnt lgkmcnt(9)
  v_mfma_f32_16x16x32_bf16 v[160:163], v[76:79], v[28:31], v[160:163]
  ds_read_b64_tr_b16 v[72:73], v6 offset:26720
  v_mfma_f32_16x16x32_bf16 v[164:167], v[76:79], v[32:35], v[164:167]
  ds_read_b64_tr_b16 v[74:75], v6 offset:30304
  v_mfma_f32_16x16x32_bf16 v[168:171], v[76:79], v[36:39], v[168:171]
  s_add_u32 s50, s26, 266240
  s_add_u32 m0, s24, 17680
  ds_read_b64 v[44:45], v5 offset:33344
  v_mfma_f32_16x16x32_bf16 v[172:175], v[76:79], v[40:43], v[172:175]
  buffer_load_dwordx4 v1, s[8:11], s50 offen lds
  ds_read_b64 v[46:47], v5 offset:33376
  v_mfma_f32_16x16x32_bf16 v[188:191], v[60:63], v[40:43], v[188:191]
  ds_read_b64_tr_b16 v[76:77], v6 offset:33888
  v_lshlrev_b32 v10, 16, v60
  v_and_b32 v11, s79, v60
  v_mfma_f32_16x16x32_bf16 v[184:187], v[60:63], v[36:39], v[184:187]
  ds_read_b64_tr_b16 v[78:79], v6 offset:37472
  v_add_f32 v91, v91, v10
  v_add_f32 v91, v91, v11
  v_mfma_f32_16x16x32_bf16 v[180:183], v[60:63], v[32:35], v[180:183]
  v_lshlrev_b32 v10, 16, v61
  v_and_b32 v11, s79, v61
  v_mfma_f32_16x16x32_bf16 v[176:179], v[60:63], v[28:31], v[176:179]
  v_add_f32 v91, v91, v10
  v_add_f32 v91, v91, v11
  s_waitcnt lgkmcnt(7)
  v_mfma_f32_16x16x32_bf16 v[192:195], v[64:67], v[28:31], v[192:195]
  v_lshlrev_b32 v10, 16, v62
  v_and_b32 v11, s79, v62
  v_mfma_f32_16x16x32_bf16 v[196:199], v[64:67], v[32:35], v[196:199]
  v_add_f32 v91, v91, v10
  v_add_f32 v91, v91, v11
  v_mfma_f32_16x16x32_bf16 v[200:203], v[64:67], v[36:39], v[200:203]
  ds_read_b64 v[48:49], v5 offset:33600
  v_lshlrev_b32 v10, 16, v63
  v_and_b32 v11, s79, v63
  v_mfma_f32_16x16x32_bf16 v[204:207], v[64:67], v[40:43], v[204:207]
  ds_read_b64 v[50:51], v5 offset:33632
  v_add_f32 v91, v91, v10
  v_add_f32 v91, v91, v11
  v_mfma_f32_16x16x32_bf16 v[220:223], v[68:71], v[40:43], v[220:223]
  ds_read_b64_tr_b16 v[64:65], v95 offset:0
  v_mfma_f32_16x16x32_bf16 v[216:219], v[68:71], v[36:39], v[216:219]
  ds_read_b64_tr_b16 v[66:67], v95 offset:1024
  v_mfma_f32_16x16x32_bf16 v[212:215], v[68:71], v[32:35], v[212:215]
  ds_read_b64_tr_b16 v[60:61], v94 offset:0
  ds_read_b64 v[52:53], v5 offset:33856
  v_mfma_f32_16x16x32_bf16 v[208:211], v[68:71], v[28:31], v[208:211]
  ds_read_b64_tr_b16 v[62:63], v94 offset:1024
  ds_read_b64 v[54:55], v5 offset:33888
  s_waitcnt lgkmcnt(12)
  v_mfma_f32_16x16x32_bf16 v[224:227], v[72:75], v[28:31], v[224:227]
  ds_read_b64_tr_b16 v[68:69], v93 offset:6144
  v_mfma_f32_16x16x32_bf16 v[228:231], v[72:75], v[32:35], v[228:231]
  ds_read_b64_tr_b16 v[70:71], v93 offset:9728
  v_mfma_f32_16x16x32_bf16 v[232:235], v[72:75], v[36:39], v[232:235]
  ds_read_b64 v[56:57], v5 offset:34112
  v_mfma_f32_16x16x32_bf16 v[236:239], v[72:75], v[40:43], v[236:239]
  ds_read_b64 v[58:59], v5 offset:34144
  s_waitcnt lgkmcnt(12)
  v_mfma_f32_16x16x32_bf16 v[252:255], v[76:79], v[40:43], v[252:255]
  ds_read_b64_tr_b16 v[72:73], v93 offset:13312
  v_lshlrev_b32 v10, 16, v76
  v_and_b32 v11, s79, v76
  v_add_f32 v92, v92, v10
  v_add_f32 v92, v92, v11
  v_mfma_f32_16x16x32_bf16 v[248:251], v[76:79], v[36:39], v[248:251]
  ds_read_b64_tr_b16 v[74:75], v93 offset:16896
  v_lshlrev_b32 v10, 16, v77
  v_and_b32 v11, s79, v77
  v_add_f32 v92, v92, v10
  v_add_f32 v92, v92, v11
  v_mfma_f32_16x16x32_bf16 v[244:247], v[76:79], v[32:35], v[244:247]
  s_add_u32 s25, s25, 128
  s_cmp_ge_u32 s25, 2048
  s_cselect_b32 s26, 0x10000000, s25
  v_lshlrev_b32 v10, 16, v78
  v_and_b32 v11, s79, v78
  v_add_f32 v92, v92, v10
  v_add_f32 v92, v92, v11
  v_mfma_f32_16x16x32_bf16 v[240:243], v[76:79], v[28:31], v[240:243]
  v_lshlrev_b32 v10, 16, v79
  v_and_b32 v11, s79, v79
  v_add_f32 v92, v92, v10
  v_add_f32 v92, v92, v11
  s_waitcnt vmcnt(5) lgkmcnt(2)
  s_barrier
  v_mfma_f32_16x16x32_bf16 v[96:99], v[60:63], v[12:15], v[96:99]
  v_mfma_f32_16x16x32_bf16 v[100:103], v[60:63], v[16:19], v[100:103]
  s_cmp_eq_u32 s60, 2
  s_cbranch_scc0 L_nx_15
  s_call_b64 s[74:75], L_x_stat_1
L_nx_15:
  s_cmp_eq_u32 s60, 8
  s_cbranch_scc0 L_nx_16
  s_call_b64 s[74:75], L_x_rows_1
L_nx_16:
  v_mfma_f32_16x16x32_bf16 v[104:107], v[60:63], v[20:23], v[104:107]
  s_add_u32 m0, s33, 87040
  v_mfma_f32_16x16x32_bf16 v[108:111], v[60:63], v[24:27], v[108:111]
  buffer_load_dwordx4 v2, s[12:15], s27 offen lds
  s_add_u32 s27, s27, s30
  v_mfma_f32_16x16x32_bf16 v[124:127], v[64:67], v[24:27], v[124:127]
  ds_read_b64_tr_b16 v[60:61], v93 offset:13344
  v_lshlrev_b32 v10, 16, v64
  v_and_b32 v11, s79, v64
  v_mfma_f32_16x16x32_bf16 v[120:123], v[64:67], v[20:23], v[120:123]
  ds_read_b64_tr_b16 v[62:63], v93 offset:16928
  v_add_f32 v90, v90, v10
  v_add_f32 v90, v90, v11
  v_mfma_f32_16x16x32_bf16 v[116:119], v[64:67], v[16:19], v[116:119]
  s_add_u32 m0, s34, 87040
  ds_read_b64_tr_b16 v[76:77], v93 offset:6176
  v_lshlrev_b32 v10, 16, v65
  v_and_b32 v11, s79, v65
  v_mfma_f32_16x16x32_bf16 v[112:115], v[64:67], v[12:15], v[112:115]
  buffer_load_dwordx4 v3, s[16:19], s28 offen lds
  s_add_u32 s28, s28, s31
  ds_read_b64_tr_b16 v[78:79], v93 offset:9760
  v_add_f32 v90, v90, v10
  v_add_f32 v90, v90, v11
  v_mfma_f32_16x16x32_bf16 v[128:131], v[68:71], v[12:15], v[128:131]
  v_lshlrev_b32 v10, 16, v66
  v_and_b32 v11, s79, v66
  v_mfma_f32_16x16x32_bf16 v[132:135], v[68:71], v[16:19], v[132:135]
  v_add_f32 v90, v90, v10
  v_add_f32 v90, v90, v11
  v_mfma_f32_16x16x32_bf16 v[136:139], v[68:71], v[20:23], v[136:139]
  s_add_u32 m0, s35, 87040
  v_lshlrev_b32 v10, 16, v67
  v_and_b32 v11, s79, v67
  v_mfma_f32_16x16x32_bf16 v[140:143], v[68:71], v[24:27], v[140:143]
  buffer_load_dwordx4 v4, s[20:23], s29 offen lds
  s_add_u32 s29, s29, s32
  v_add_f32 v90, v90, v10
  v_add_f32 v90, v90, v11
  s_waitcnt lgkmcnt(4)
  v_mfma_f32_16x16x32_bf16 v[156:159], v[72:75], v[24:27], v[156:159]
  ds_read_b64_tr_b16 v[68:69], v93 offset:13376
  v_mfma_f32_16x16x32_bf16 v[152:155], v[72:75], v[20:23], v[152:155]
  ds_read_b64_tr_b16 v[70:71], v93 offset:16960
  v_mfma_f32_16x16x32_bf16 v[148:151], v[72:75], v[16:19], v[148:151]
  s_add_u32 s50, s26, 0
  s_add_u32 m0, s24, 33280
  ds_read_b64_tr_b16 v[64:65], v93 offset:6208
  v_mfma_f32_16x16x32_bf16 v[144:147], v[72:75], v[12:15], v[144:147]
  buffer_load_dwordx4 v1, s[8:11], s50 offen lds
  ds_read_b64_tr_b16 v[66:67], v93 offset:9792
  s_waitcnt lgkmcnt(4)
  v_mfma_f32_16x16x32_bf16 v[160:163], v[76:79], v[12:15], v[160:163]
  ds_read_b64_tr_b16 v[72:73], v93 offset:6240
  v_mfma_f32_16x16x32_bf16 v[164:167], v[76:79], v[16:19], v[164:167]
  ds_read_b64_tr_b16 v[74:75], v93 offset:9824
  v_mfma_f32_16x16x32_bf16 v[168:171], v[76:79], v[20:23], v[168:171]
  s_add_u32 s50, s26, 4096
  s_add_u32 m0, s24, 34320
  v_mfma_f32_16x16x32_bf16 v[172:175], v[76:79], v[24:27], v[172:175]
  buffer_load_dwordx4 v1, s[8:11], s50 offen lds
  v_mfma_f32_16x16x32_bf16 v[188:191], v[60:63], v[24:27], v[188:191]
  ds_read_b64_tr_b16 v[76:77], v93 offset:13408
  v_lshlrev_b32 v10, 16, v60
  v_and_b32 v11, s79, v60
  v_mfma_f32_16x16x32_bf16 v[184:187], v[60:63], v[20:23], v[184:187]
  ds_read_b64_tr_b16 v[78:79], v93 offset:16992
  v_add_f32 v91, v91, v10
  v_add_f32 v91, v91, v11
  v_mfma_f32_16x16x32_bf16 v[180:183], v[60:63], v[16:19], v[180:183]
  v_lshlrev_b32 v10, 16, v61
  v_and_b32 v11, s79, v61
  v_mfma_f32_16x16x32_bf16 v[176:179], v[60:63], v[12:15], v[176:179]
  v_add_f32 v91, v91, v10
  v_add_f32 v91, v91, v11
  s_waitcnt lgkmcnt(4)
  v_mfma_f32_16x16x32_bf16 v[192:195], v[64:67], v[12:15], v[192:195]
  v_lshlrev_b32 v10, 16, v62
  v_and_b32 v11, s79, v62
  v_mfma_f32_16x16x32_bf16 v[196:199], v[64:67], v[16:19], v[196:199]
  v_add_f32 v91, v91, v10
  v_add_f32 v91, v91, v11
  v_mfma_f32_16x16x32_bf16 v[200:203], v[64:67], v[20:23], v[200:203]
  v_lshlrev_b32 v10, 16, v63
  v_and_b32 v11, s79, v63
  v_mfma_f32_16x16x32_bf16 v[204:207], v[64:67], v[24:27], v[204:207]
  v_add_f32 v91, v91, v10
  v_add_f32 v91, v91, v11
  v_mfma_f32_16x16x32_bf16 v[220:223], v[68:71], v[24:27], v[220:223]
  ds_read_b64_tr_b16 v[64:65], v95 offset:20480
  v_mfma_f32_16x16x32_bf16 v[216:219], v[68:71], v[20:23], v[216:219]
  ds_read_b64_tr_b16 v[66:67], v95 offset:21504
  v_mfma_f32_16x16x32_bf16 v[212:215], v[68:71], v[16:19], v[212:215]
  ds_read_b64_tr_b16 v[60:61], v94 offset:20480
  v_mfma_f32_16x16x32_bf16 v[208:211], v[68:71], v[12:15], v[208:211]
  ds_read_b64_tr_b16 v[62:63], v94 offset:21504
  s_waitcnt lgkmcnt(6)
  v_mfma_f32_16x16x32_bf16 v[224:227], v[72:75], v[12:15], v[224:227]
  ds_read_b64_tr_b16 v[68:69], v93 offset:26624
  v_mfma_f32_16x16x32_bf16 v[228:231], v[72:75], v[16:19], v[228:231]
  ds_read_b64_tr_b16 v[70:71], v93 offset:30208
  v_mfma_f32_16x16x32_bf16 v[232:235], v[72:75], v[20:23], v[232:235]
  v_mfma_f32_16x16x32_bf16 v[236:239], v[72:75], v[24:27], v[236:239]
  s_waitcnt lgkmcnt(6)
  v_mfma_f32_16x16x32_bf16 v[252:255], v[76:79], v[24:27], v[252:255]
  ds_read_b64_tr_b16 v[72:73], v93 offset:33792
  v_lshlrev_b32 v10, 16, v76
  v_and_b32 v11, s79, v76
  v_add_f32 v92, v92, v10
  v_add_f32 v92, v92, v11
  v_mfma_f32_16x16x32_bf16 v[248:251], v[76:79], v[20:23], v[248:251]
  ds_read_b64_tr_b16 v[74:75], v93 offset:37376
  v_lshlrev_b32 v10, 16, v77
  v_and_b32 v11, s79, v77
  v_add_f32 v92, v92, v10
  v_add_f32 v92, v92, v11
  v_mfma_f32_16x16x32_bf16 v[244:247], v[76:79], v[16:19], v[244:247]
  v_lshlrev_b32 v10, 16, v78
  v_and_b32 v11, s79, v78
  v_add_f32 v92, v92, v10
  v_add_f32 v92, v92, v11
  v_mfma_f32_16x16x32_bf16 v[240:243], v[76:79], v[12:15], v[240:243]
  v_lshlrev_b32 v10, 16, v79
  v_and_b32 v11, s79, v79
  v_add_f32 v92, v92, v10
  v_add_f32 v92, v92, v11
  s_waitcnt vmcnt(5)
  s_barrier
  s_waitcnt lgkmcnt(4)
  v_mfma_f32_16x16x32_bf16 v[96:99], v[60:63], v[44:47], v[96:99]
  v_mfma_f32_16x16x32_bf16 v[100:103], v[60:63], v[48:51], v[100:103]
  v_mfma_f32_16x16x32_bf16 v[104:107], v[60:63], v[52:55], v[104:107]
  s_add_u32 m0, s33, 107520
  ds_read_b64 v[12:13], v5 offset:0
  v_mfma_f32_16x16x32_bf16 v[108:111], v[60:63], v[56:59], v[108:111]
  buffer_load_dwordx4 v2, s[12:15], s27 offen lds
  s_add_u32 s27, s27, s30
  ds_read_b64 v[14:15], v5 offset:32
  v_mfma_f32_16x16x32_bf16 v[124:127], v[64:67], v[56:59], v[124:127]
  ds_read_b64_tr_b16 v[60:61], v93 offset:33824
  v_lshlrev_b32 v10, 16, v64
  v_and_b32 v11, s79, v64
  v_mfma_f32_16x16x32_bf16 v[120:123], v[64:67], v[52:55], v[120:123]
  ds_read_b64_tr_b16 v[62:63], v93 offset:37408
  v_add_f32 v90, v90, v10
  v_add_f32 v90, v90, v11
  v_mfma_f32_16x16x32_bf16 v[116:119], v[64:67], v[48:51], v[116:119]
  s_add_u32 m0, s34, 107520
  ds_read_b64_tr_b16 v[76:77], v93 offset:26656
  ds_read_b64 v[16:17], v5 offset:256
  v_lshlrev_b32 v10, 16, v65
  v_and_b32 v11, s79, v65
  v_mfma_f32_16x16x32_bf16 v[112:115], v[64:67], v[44:47], v[112:115]
  buffer_load_dwordx4 v3, s[16:19], s28 offen lds
  s_add_u32 s28, s28, s31
  ds_read_b64_tr_b16 v[78:79], v93 offset:30240
  ds_read_b64 v[18:19], v5 offset:288
  v_add_f32 v90, v90, v10
  v_add_f32 v90, v90, v11
  s_waitcnt lgkmcnt(10)
  v_mfma_f32_16x16x32_bf16 v[128:131], v[68:71], v[44:47], v[128:131]
  v_lshlrev_b32 v10, 16, v66
  v_and_b32 v11, s79, v66
  v_mfma_f32_16x16x32_bf16 v[132:135], v[68:71], v[48:51], v[132:135]
  v_add_f32 v90, v90, v10
  v_add_f32 v90, v90, v11
  v_mfma_f32_16x16x32_bf16 v[136:139], v[68:71], v[52:55], v[136:139]
  s_add_u32 m0, s35, 107520
  ds_read_b64 v[20:21], v5 offset:512
  v_lshlrev_b32 v10, 16, v67
  v_and_b32 v11, s79, v67
  v_mfma_f32_16x16x32_bf16 v[140:143], v[68:71], v[56:59], v[140:143]
  buffer_load_dwordx4 v4, s[20:23], s29 offen lds
  s_add_u32 s29, s29, s32
  ds_read_b64 v[22:23], v5 offset:544
  v_add_f32 v90, v90, v10
  v_add_f32 v90, v90, v11
  s_waitcnt lgkmcnt(10)
  v_mfma_f32_16x16x32_bf16 v[156:159], v[72:75], v[56:59], v[156:159]
  ds_read_b64_tr_b16 v[68:69], v93 offset:33856
  v_mfma_f32_16x16x32_bf16 v[152:155], v[72:75], v[52:55], v[152:155]
  ds_read_b64_tr_b16 v[70:71], v93 offset:37440
  v_mfma_f32_16x16x32_bf16 v[148:151], v[72:75], v[48:51], v[148:151]
  s_add_u32 s50, s26, 262144
  s_add_u32 m0, s24, 49920
  ds_read_b64_tr_b16 v[64:65], v93 offset:26688
  ds_read_b64 v[24:25], v5 offset:768
  v_mfma_f32_16x16x32_bf16 v[144:147], v[72:75], v[44:47], v[144:147]
  buffer_load_dwordx4 v1, s[8:11], s50 offen lds
  ds_read_b64_tr_b16 v[66:67], v93 offset:30272
  ds_read_b64 v[26:27], v5 offset:800
  s_waitcnt lgkmcnt(9)
  v_mfma_f32_16x16x32_bf16 v[160:163], v[76:79], v[44:47], v[160:163]
  ds_read_b64_tr_b16 v[72:73], v93 offset:26720
  v_mfma_f32_16x16x32_bf16 v[164:167], v[76:79], v[48:51], v[164:167]
  ds_read_b64_tr_b16 v[74:75], v93 offset:30304
  v_mfma_f32_16x16x32_bf16 v[168:171], v[76:79], v[52:55], v[168:171]
  s_add_u32 s50, s26, 266240
  s_add_u32 m0, s24, 50960
  ds_read_b64 v[28:29], v5 offset:64
  v_mfma_f32_16x16x32_bf16 v[172:175], v[76:79], v[56:59], v[172:175]
  buffer_load_dwordx4 v1, s[8:11], s50 offen lds
  ds_read_b64 v[30:31], v5 offset:96
  v_mfma_f32_16x16x32_bf16 v[188:191], v[60:63], v[56:59], v[188:191]
  ds_read_b64_tr_b16 v[76:77], v93 offset:33888
  v_lshlrev_b32 v10, 16, v60
  v_and_b32 v11, s79, v60
  v_mfma_f32_16x16x32_bf16 v[184:187], v[60:63], v[52:55], v[184:187]
  ds_read_b64_tr_b16 v[78:79], v93 offset:37472
  v_add_f32 v91, v91, v10
  v_add_f32 v91, v91, v11
  v_mfma_f32_16x16x32_bf16 v[180:183], v[60:63], v[48:51], v[180:183]
  v_lshlrev_b32 v10, 16, v61
  v_and_b32 v11, s79, v61
  v_mfma_f32_16x16x32_bf16 v[176:179], v[60:63], v[44:47], v[176:179]
  v_add_f32 v91, v91, v10
  v_add_f32 v91, v91, v11
  s_waitcnt lgkmcnt(7)
  v_mfma_f32_16x16x32_bf16 v[192:195], v[64:67], v[44:47], v[192:195]
  v_lshlrev_b32 v10, 16, v62
  v_and_b32 v11, s79, v62
  v_mfma_f32_16x16x32_bf16 v[196:199], v[64:67], v[48:51], v[196:199]
  v_add_f32 v91, v91, v10
  v_add_f32 v91, v91, v11
  v_mfma_f32_16x16x32_bf16 v[200:203], v[64:67], v[52:55], v[200:203]
  ds_read_b64 v[32:33], v5 offset:320
  v_lshlrev_b32 v10, 16, v63
  v_and_b32 v11, s79, v63
  v_mfma_f32_16x16x32_bf16 v[204:207], v[64:67], v[56:59], v[204:207]
  ds_read_b64 v[34:35], v5 offset:352
  v_add_f32 v91, v91, v10
  v_add_f32 v91, v91, v11
  v_mfma_f32_16x16x32_bf16 v[220:223], v[68:71], v[56:59], v[220:223]
  ds_read_b64_tr_b16 v[64:65], v8 offset:0
  v_mfma_f32_16x16x32_bf16 v[216:219], v[68:71], v[52:55], v[216:219]
  ds_read_b64_tr_b16 v[66:67], v8 offset:1024
  v_mfma_f32_16x16x32_bf16 v[212:215], v[68:71], v[48:51], v[212:215]
  ds_read_b64_tr_b16 v[60:61], v7 offset:0
  ds_read_b64 v[36:37], v5 offset:576
  v_mfma_f32_16x16x32_bf16 v[208:211], v[68:71], v[44:47], v[208:211]
  ds_read_b64_tr_b16 v[62:63], v7 offset:1024
  ds_read_b64 v[38:39], v5 offset:608
  s_waitcnt lgkmcnt(12)
  v_mfma_f32_16x16x32_bf16 v[224:227], v[72:75], v[44:47], v[224:227]
  ds_read_b64_tr_b16 v[68:69], v6 offset:6144
  v_mfma_f32_16x16x32_bf16 v[228:231], v[72:75], v[48:51], v[228:231]
  ds_read_b64_tr_b16 v[70:71], v6 offset:9728
  v_mfma_f32_16x16x32_bf16 v[232:235], v[72:75], v[52:55], v[232:235]
  ds_read_b64 v[40:41], v5 offset:832
  v_mfma_f32_16x16x32_bf16 v[236:239], v[72:75], v[56:59], v[236:239]
  ds_read_b64 v[42:43], v5 offset:864
  s_waitcnt lgkmcnt(12)
  v_mfma_f32_16x16x32_bf16 v[252:255], v[76:79], v[56:59], v[252:255]
  ds_read_b64_tr_b16 v[72:73], v6 offset:13312
  v_lshlrev_b32 v10, 16, v76
  v_and_b32 v11, s79, v76
  v_add_f32 v92, v92, v10
  v_add_f32 v92, v92, v11
  v_mfma_f32_16x16x32_bf16 v[248:251], v[76:79], v[52:55], v[248:251]
  ds_read_b64_tr_b16 v[74:75], v6 offset:16896
  v_lshlrev_b32 v10, 16, v77
  v_and_b32 v11, s79, v77
  v_add_f32 v92, v92, v10
  v_add_f32 v92, v92, v11
  v_mfma_f32_16x16x32_bf16 v[244:247], v[76:79], v[48:51], v[244:247]
  s_add_u32 s25, s25, 128
  s_cmp_ge_u32 s25, 2048
  s_cselect_b32 s26, 0x10000000, s25
  v_lshlrev_b32 v10, 16, v78
  v_and_b32 v11, s79, v78
  v_add_f32 v92, v92, v10
  v_add_f32 v92, v92, v11
  v_mfma_f32_16x16x32_bf16 v[240:243], v[76:79], v[44:47], v[240:243]
  v_lshlrev_b32 v10, 16, v79
  v_and_b32 v11, s79, v79
  v_add_f32 v92, v92, v10
  v_add_f32 v92, v92, v11
  s_waitcnt vmcnt(5) lgkmcnt(2)
  s_barrier
  s_sub_u32 s60, s60, 1
  s_cmp_lt_u32 s60, 2
  s_cbranch_scc1 L_loopt1
  s_call_b64 s[74:75], L_x_cpub_1
  s_cmp_gt_u32 s60, 2
  s_cbranch_scc1 L_loopp1
L_loopt1:
  s_cmp_lg_u32 s60, 0
  s_cbranch_scc1 L_loopc1
  s_branch L_epi0
L_x_drain_1:
  s_waitcnt vmcnt(0)
  s_setpc_b64 s[74:75]
L_x_rows_1:
  s_waitcnt vmcnt(0)
  v_lshlrev_b32 v10, 16, v80
  v_and_b32 v11, s79, v80
  v_mov_b32 v88, v10
  v_mov_b32 v89, v11
  v_lshlrev_b32 v10, 16, v81
  v_and_b32 v11, s79, v81
  v_add_f32 v88, v88, v10
  v_add_f32 v89, v89, v11
  v_lshlrev_b32 v10, 16, v82
  v_and_b32 v11, s79, v82
  v_add_f32 v88, v88, v10
  v_add_f32 v89, v89, v11
  v_lshlrev_b32 v10, 16, v83
  v_and_b32 v11, s79, v83
  v_add_f32 v88, v88, v10
  v_add_f32 v89, v89, v11
  v_lshlrev_b32 v10, 16, v84
  v_and_b32 v11, s79, v84
  v_add_f32 v88, v88, v10
  v_add_f32 v89, v89, v11
  v_lshlrev_b32 v10, 16, v85
  v_and_b32 v11, s79, v85
  v_add_f32 v88, v88, v10
  v_add_f32 v89, v89, v11
  v_lshlrev_b32 v10, 16, v86
  v_and_b32 v11, s79, v86
  v_add_f32 v88, v88, v10
  v_add_f32 v89, v89, v11
  v_lshlrev_b32 v10, 16, v87
  v_and_b32 v11, s79, v87
  v_add_f32 v88, v88, v10
  v_add_f32 v89, v89, v11
  v_add_f32 v88, v88, v89
  s_nop 1
  v_add_f32_dpp v88, v88, v88 quad_perm:[1,0,3,2] row_mask:0xf bank_mask:0xf
  s_nop 1
  v_add_f32_dpp v88, v88, v88 quad_perm:[2,3,0,1] row_mask:0xf bank_mask:0xf
  s_nop 1
  v_add_f32_dpp v88, v88, v88 row_half_mirror row_mask:0xf bank_mask:0xf
  s_nop 1
  v_add_f32_dpp v88, v88, v88 row_mirror row_mask:0xf bank_mask:0xf
  v_mov_b32 v10, v88
  s_nop 1
  v_permlane16_swap_b32 v88, v10
  s_nop 0
  v_add_f32 v88, v88, v10
  v_mov_b32 v10, v88
  s_nop 1
  v_permlane32_swap_b32 v88, v10
  s_nop 0
  v_add_f32 v88, v88, v10
  v_mul_f32 v88, 0xba800000, v88
  v_lshlrev_b32 v10, 16, v80
  v_and_b32 v11, s79, v80
  v_add_f32 v10, v10, v88
  v_add_f32 v11, v11, v88
  v_mul_f32 v89, v10, v10
  v_fmac_f32 v89, v11, v11
  v_lshlrev_b32 v10, 16, v81
  v_and_b32 v11, s79, v81
  v_add_f32 v10, v10, v88
  v_add_f32 v11, v11, v88
  v_fmac_f32 v89, v10, v10
  v_fmac_f32 v89, v11, v11
  v_lshlrev_b32 v10, 16, v82
  v_and_b32 v11, s79, v82
  v_add_f32 v10, v10, v88
  v_add_f32 v11, v11, v88
  v_fmac_f32 v89, v10, v10
  v_fmac_f32 v89, v11, v11
  v_lshlrev_b32 v10, 16, v83
  v_and_b32 v11, s79, v83
  v_add_f32 v10, v10, v88
  v_add_f32 v11, v11, v88
  v_fmac_f32 v89, v10, v10
  v_fmac_f32 v89, v11, v11
  v_lshlrev_b32 v10, 16, v84
  v_and_b32 v11, s79, v84
  v_add_f32 v10, v10, v88
  v_add_f32 v11, v11, v88
  v_fmac_f32 v89, v10, v10
  v_fmac_f32 v89, v11, v11
  v_lshlrev_b32 v10, 16, v85
  v_and_b32 v11, s79, v85
  v_add_f32 v10, v10, v88
  v_add_f32 v11, v11, v88
  v_fmac_f32 v89, v10, v10
  v_fmac_f32 v89, v11, v11
  v_lshlrev_b32 v10, 16, v86
  v_and_b32 v11, s79, v86
  v_add_f32 v10, v10, v88
  v_add_f32 v11, v11, v88
  v_fmac_f32 v89, v10, v10
  v_fmac_f32 v89, v11, v11
  v_lshlrev_b32 v10, 16, v87
  v_and_b32 v11, s79, v87
  v_add_f32 v10, v10, v88
  v_add_f32 v11, v11, v88
  v_fmac_f32 v89, v10, v10
  v_fmac_f32 v89, v11, v11
  s_nop 1
  v_add_f32_dpp v89, v89, v89 quad_perm:[1,0,3,2] row_mask:0xf bank_mask:0xf
  s_nop 1
  v_add_f32_dpp v89, v89, v89 quad_perm:[2,3,0,1] row_mask:0xf bank_mask:0xf
  s_nop 1
  v_add_f32_dpp v89, v89, v89 row_half_mirror row_mask:0xf bank_mask:0xf
  s_nop 1
  v_add_f32_dpp v89, v89, v89 row_mirror row_mask:0xf bank_mask:0xf
  v_mov_b32 v10, v89
  s_nop 1
  v_permlane16_swap_b32 v89, v10
  s_nop 0
  v_add_f32 v89, v89, v10
  v_mov_b32 v10, v89
  s_nop 1
  v_permlane32_swap_b32 v89, v10
  s_nop 0
  v_add_f32 v89, v89, v10
  v_mul_f32 v89, 0x3a800000, v89
  v_cvt_pk_bf16_f32 v10, v88, v89
  v_lshlrev_b32 v80, 16, v10
  v_and_b32 v89, s79, v10
  v_add_f32 v89, 0x3727c5ac, v89
  v_cvt_pk_bf16_f32 v89, v89, v89
  v_lshlrev_b32 v89, 16, v89
  v_sqrt_f32 v89, v89
  s_lshl_b32 s51, s2, 6
  v_cvt_pk_bf16_f32 v89, v89, v89
  s_add_u32 s51, s51, 51380232
  v_lshlrev_b32 v81, 16, v89
  s_mov_b64 exec, 1
  buffer_store_dwordx2 v[80:81], v0, s[64:67], s51 offen sc1
  s_mov_b64 exec, -1
  s_setpc_b64 s[74:75]
L_x_poll_1:
  v_and_b32 v89, 0x70, v9
  v_lshlrev_b32 v89, 1, v89
  buffer_load_dword v88, v89, s[56:59], 0 offen sc1
  s_setpc_b64 s[74:75]
L_x_stat_1:
  s_waitcnt vmcnt(0)
  v_cmp_ne_u32 vcc, 32, v88
  s_nop 4
  s_cbranch_vccz L_x_stat_1_go
  s_sleep 2
  v_and_b32 v89, 0x70, v9
  v_lshlrev_b32 v89, 1, v89
  buffer_load_dword v88, v89, s[56:59], 0 offen sc1
  s_branch L_x_stat_1
L_x_stat_1_go:
  s_lshl_b32 s51, s6, 8
  s_lshl_b32 s55, s7, 5
  s_add_u32 s51, s51, s55
  s_lshl_b32 s55, s3, 2
  s_add_u32 s51, s51, s55
  s_add_u32 s51, s51, 50376704
  v_mov_b32 v88, 1
  s_mov_b64 exec, 1
  buffer_store_dword v88, v0, s[64:67], s51 offen sc1
  s_mov_b64 exec, -1
  v_and_b32 v88, 0xf0, v9
  v_lshrrev_b32 v88, 1, v88
  s_lshl_b32 s51, s7, 11
  s_add_u32 s51, s51, 51380736
  buffer_load_dwordx2 v[80:81], v88, s[64:67], s51 offen offset:0 sc1
  buffer_load_dwordx2 v[82:83], v88, s[64:67], s51 offen offset:128 sc1
  buffer_load_dwordx2 v[84:85], v88, s[64:67], s51 offen offset:256 sc1
  buffer_load_dwordx2 v[86:87], v88, s[64:67], s51 offen offset:384 sc1
  s_setpc_b64 s[74:75]
L_x_cpub_1:
  v_mov_b32 v10, v90
  v_mov_b32 v11, v91
  v_mov_b32 v88, v92
  s_nop 1
  v_permlane16_swap_b32 v90, v10
  v_permlane16_swap_b32 v91, v11
  v_permlane16_swap_b32 v92, v88
  v_add_f32 v90, v90, v10
  v_add_f32 v91, v91, v11
  v_add_f32 v92, v92, v88
  v_mov_b32 v10, v90
  v_mov_b32 v11, v91
  v_mov_b32 v88, v92
  s_nop 1
  v_permlane32_swap_b32 v90, v10
  v_permlane32_swap_b32 v91, v11
  v_permlane32_swap_b32 v92, v88
  v_add_f32 v90, v90, v10
  v_add_f32 v91, v91, v11
  v_add_f32 v92, v92, v88
  v_and_b32 v89, 0xf0, v9
  v_lshrrev_b32 v89, 2, v89
  s_mul_i32 s51, s6, 7680
  s_mul_i32 s52, s7, 1280
  s_add_u32 s51, s51, s52
  s_add_u32 s51, s51, 52428864
  s_mov_b64 exec, 0xffff
  buffer_store_dword v90, v89, s[64:67], s51 offen offset:0 sc1
  buffer_store_dword v91, v89, s[64:67], s51 offen offset:256 sc1
  buffer_store_dword v92, v89, s[64:67], s51 offen offset:512 sc1
  s_mov_b64 exec, -1
  s_nop 1
  v_mov_b32 v90, 0
  v_mov_b32 v91, 0
  v_mov_b32 v92, 0
  s_setpc_b64 s[74:75]
L_loop2:
  s_cmp_eq_u32 s60, s61
  s_cbranch_scc1 L_loopc2
L_loopp2:
  v_mfma_f32_16x16x32_bf16 v[96:99], v[60:63], v[12:15], v[96:99]
  ds_read_b64_tr_b16 v[76:77], v6 offset:6176
  v_mfma_f32_16x16x32_bf16 v[100:103], v[60:63], v[16:19], v[100:103]
  ds_read_b64_tr_b16 v[78:79], v6 offset:9760
  s_cmp_eq_u32 s60, 6
  s_cbranch_scc0 L_nx_17
  s_call_b64 s[74:75], L_x_drain_2
L_nx_17:
  v_mfma_f32_16x16x32_bf16 v[104:107], v[60:63], v[20:23], v[104:107]
  s_add_u32 m0, s33, 128000
  v_mfma_f32_16x16x32_bf16 v[108:111], v[60:63], v[24:27], v[108:111]
  buffer_load_dwordx4 v2, s[12:15], s27 offen lds
  s_add_u32 s27, s27, s30
  v_mfma_f32_16x16x32_bf16 v[124:127], v[64:67], v[24:27], v[124:127]
  ds_read_b64_tr_b16 v[60:61], v6 offset:13344
  v_mfma_f32_16x16x32_bf16 v[120:123], v[64:67], v[20:23], v[120:123]
  ds_read_b64_tr_b16 v[62:63], v6 offset:16928
  v_mfma_f32_16x16x32_bf16 v[116:119], v[64:67], v[16:19], v[116:119]
  s_add_u32 m0, s34, 128000
  v_mfma_f32_16x16x32_bf16 v[112:115], v[64:67], v[12:15], v[112:115]
  buffer_load_dwordx4 v3, s[16:19], s28 offen lds
  s_add_u32 s28, s28, s31
  v_mfma_f32_16x16x32_bf16 v[128:131], v[68:71], v[12:15], v[128:131]
  ds_read_b64_tr_b16 v[64:65], v6 offset:6208
  v_mfma_f32_16x16x32_bf16 v[132:135], v[68:71], v[16:19], v[132:135]
  ds_read_b64_tr_b16 v[66:67], v6 offset:9792
  v_mfma_f32_16x16x32_bf16 v[136:139], v[68:71], v[20:23], v[136:139]
  s_add_u32 m0, s35, 128000
  v_mfma_f32_16x16x32_bf16 v[140:143], v[68:71], v[24:27], v[140:143]
  buffer_load_dwordx4 v4, s[20:23], s29 offen lds
  s_add_u32 s29, s29, s32
  s_waitcnt lgkmcnt(6)
  v_mfma_f32_16x16x32_bf16 v[156:159], v[72:75], v[24:27], v[156:159]
  v_mfma_f32_16x16x32_bf16 v[152:155], v[72:75], v[20:23], v[152:155]
  v_mfma_f32_16x16x32_bf16 v[148:151], v[72:75], v[16:19], v[148:151]
  s_add_u32 s50, s26, 0
  s_add_u32 m0, s24, 0
  v_mfma_f32_16x16x32_bf16 v[144:147], v[72:75], v[12:15], v[144:147]
  buffer_load_dwordx4 v1, s[8:11], s50 offen lds
  s_waitcnt lgkmcnt(4)
  v_mfma_f32_16x16x32_bf16 v[160:163], v[76:79], v[12:15], v[160:163]
  ds_read_b64_tr_b16 v[72:73], v6 offset:6240
  v_mfma_f32_16x16x32_bf16 v[164:167], v[76:79], v[16:19], v[164:167]
  ds_read_b64_tr_b16 v[74:75], v6 offset:9824
  v_mfma_f32_16x16x32_bf16 v[168:171], v[76:79], v[20:23], v[168:171]
  s_add_u32 s50, s26, 4096
  s_add_u32 m0, s24, 1040
  ds_read_b64_tr_b16 v[68:69], v6 offset:13376
  v_mfma_f32_16x16x32_bf16 v[172:175], v[76:79], v[24:27], v[172:175]
  buffer_load_dwordx4 v1, s[8:11], s50 offen lds
  ds_read_b64_tr_b16 v[70:71], v6 offset:16960
  s_waitcnt lgkmcnt(6)
  v_mfma_f32_16x16x32_bf16 v[188:191], v[60:63], v[24:27], v[188:191]
  ds_read_b64_tr_b16 v[76:77], v6 offset:13408
  v_mfma_f32_16x16x32_bf16 v[184:187], v[60:63], v[20:23], v[184:187]
  ds_read_b64_tr_b16 v[78:79], v6 offset:16992
  v_mfma_f32_16x16x32_bf16 v[180:183], v[60:63], v[16:19], v[180:183]
  v_mfma_f32_16x16x32_bf16 v[176:179], v[60:63], v[12:15], v[176:179]
  s_waitcnt lgkmcnt(6)
  v_mfma_f32_16x16x32_bf16 v[192:195], v[64:67], v[12:15], v[192:195]
  ds_read_b64_tr_b16 v[60:61], v7 offset:20480
  v_mfma_f32_16x16x32_bf16 v[196:199], v[64:67], v[16:19], v[196:199]
  ds_read_b64_tr_b16 v[62:63], v7 offset:21504
  v_mfma_f32_16x16x32_bf16 v[200:203], v[64:67], v[20:23], v[200:203]
  v_mfma_f32_16x16x32_bf16 v[204:207], v[64:67], v[24:27], v[204:207]
  s_waitcnt lgkmcnt(4)
  v_mfma_f32_16x16x32_bf16 v[220:223], v[68:71], v[24:27], v[220:223]
  v_mfma_f32_16x16x32_bf16 v[216:219], v[68:71], v[20:23], v[216:219]
  v_mfma_f32_16x16x32_bf16 v[212:215], v[68:71], v[16:19], v[212:215]
  v_mfma_f32_16x16x32_bf16 v[208:211], v[68:71], v[12:15], v[208:211]
  v_mfma_f32_16x16x32_bf16 v[224:227], v[72:75], v[12:15], v[224:227]
  ds_read_b64_tr_b16 v[68:69], v6 offset:26624
  v_mfma_f32_16x16x32_bf16 v[228:231], v[72:75], v[16:19], v[228:231]
  ds_read_b64_tr_b16 v[70:71], v6 offset:30208
  v_mfma_f32_16x16x32_bf16 v[232:235], v[72:75], v[20:23], v[232:235]
  ds_read_b64_tr_b16 v[64:65], v8 offset:20480
  v_mfma_f32_16x16x32_bf16 v[236:239], v[72:75], v[24:27], v[236:239]
  ds_read_b64_tr_b16 v[66:67], v8 offset:21504
  s_cmp_eq_u32 s60, 2
  s_cbranch_scc0 L_nx_18
  s_call_b64 s[74:75], L_x_poll_2
L_nx_18:
  s_waitcnt lgkmcnt(6)
  v_mfma_f32_16x16x32_bf16 v[252:255], v[76:79], v[24:27], v[252:255]
  ds_read_b64_tr_b16 v[72:73], v6 offset:33792
  v_mfma_f32_16x16x32_bf16 v[248:251], v[76:79], v[20:23], v[248:251]
  ds_read_b64_tr_b16 v[74:75], v6 offset:37376
  v_mfma_f32_16x16x32_bf16 v[244:247], v[76:79], v[16:19], v[244:247]
  v_mfma_f32_16x16x32_bf16 v[240:243], v[76:79], v[12:15], v[240:243]
  s_waitcnt vmcnt(5)
  s_barrier
  s_waitcnt lgkmcnt(6)
  v_mfma_f32_16x16x32_bf16 v[96:99], v[60:63], v[28:31], v[96:99]
  ds_read_b64_tr_b16 v[76:77], v6 offset:26656
  v_mfma_f32_16x16x32_bf16 v[100:103], v[60:63], v[32:35], v[100:103]
  ds_read_b64_tr_b16 v[78:79], v6 offset:30240
  v_mfma_f32_16x16x32_bf16 v[104:107], v[60:63], v[36:39], v[104:107]
  s_add_u32 m0, s33, 66560
  ds_read_b64 v[12:13], v5 offset:33280
  v_mfma_f32_16x16x32_bf16 v[108:111], v[60:63], v[40:43], v[108:111]
  buffer_load_dwordx4 v2, s[12:15], s27 offen lds
  s_add_u32 s27, s27, s30
  ds_read_b64 v[14:15], v5 offset:33312
  s_waitcnt lgkmcnt(6)
  v_mfma_f32_16x16x32_bf16 v[124:127], v[64:67], v[40:43], v[124:127]
  ds_read_b64_tr_b16 v[60:61], v6 offset:33824
  v_mfma_f32_16x16x32_bf16 v[120:123], v[64:67], v[36:39], v[120:123]
  ds_read_b64_tr_b16 v[62:63], v6 offset:37408
  v_mfma_f32_16x16x32_bf16 v[116:119], v[64:67], v[32:35], v[116:119]
  s_add_u32 m0, s34, 66560
  ds_read_b64 v[16:17], v5 offset:33536
  v_mfma_f32_16x16x32_bf16 v[112:115], v[64:67], v[28:31], v[112:115]
  buffer_load_dwordx4 v3, s[16:19], s28 offen lds
  s_add_u32 s28, s28, s31
  ds_read_b64 v[18:19], v5 offset:33568
  v_mfma_f32_16x16x32_bf16 v[128:131], v[68:71], v[28:31], v[128:131]
  ds_read_b64_tr_b16 v[64:65], v6 offset:26688
  v_mfma_f32_16x16x32_bf16 v[132:135], v[68:71], v[32:35], v[132:135]
  ds_read_b64_tr_b16 v[66:67], v6 offset:30272
  v_mfma_f32_16x16x32_bf16 v[136:139], v[68:71], v[36:39], v[136:139]
  s_add_u32 m0, s35, 66560
  ds_read_b64 v[20:21], v5 offset:33792
  v_mfma_f32_16x16x32_bf16 v[140:143], v[68:71], v[40:43], v[140:143]
  buffer_load_dwordx4 v4, s[20:23], s29 offen lds
  s_add_u32 s29, s29, s32
  ds_read_b64 v[22:23], v5 offset:33824
  s_waitcnt lgkmcnt(12)
  v_mfma_f32_16x16x32_bf16 v[156:159], v[72:75], v[40:43], v[156:159]
  v_mfma_f32_16x16x32_bf16 v[152:155], v[72:75], v[36:39], v[152:155]
  v_mfma_f32_16x16x32_bf16 v[148:151], v[72:75], v[32:35], v[148:151]
  s_add_u32 s50, s26, 262144
  s_add_u32 m0, s24, 16640
  ds_read_b64 v[24:25], v5 offset:34048
  v_mfma_f32_16x16x32_bf16 v[144:147], v[72:75], v[28:31], v[144:147]
  buffer_load_dwordx4 v1, s[8:11], s50 offen lds
  ds_read_b64 v[26:27], v5 offset:34080
  s_waitcnt lgkmcnt(12)
  v_mfma_f32_16x16x32_bf16 v[160:163], v[76:79], v[28:31], v[160:163]
  ds_read_b64_tr_b16 v[72:73], v6 offset:26720
  v_mfma_f32_16x16x32_bf16 v[164:167], v[76:79], v[32:35], v[164:167]
  ds_read_b64_tr_b16 v[74:75], v6 offset:30304
  v_mfma_f32_16x16x32_bf16 v[168:171], v[76:79], v[36:39], v[168:171]
  s_add_u32 s50, s26, 266240
  s_add_u32 m0, s24, 17680
  ds_read_b64_tr_b16 v[68:69], v6 offset:33856
  ds_read_b64 v[44:45], v5 offset:33344
  v_mfma_f32_16x16x32_bf16 v[172:175], v[76:79], v[40:43], v[172:175]
  buffer_load_dwordx4 v1, s[8:11], s50 offen lds
  ds_read_b64_tr_b16 v[70:71], v6 offset:37440
  ds_read_b64 v[46:47], v5 offset:33376
  s_waitcnt lgkmcnt(14)
  v_mfma_f32_16x16x32_bf16 v[188:191], v[60:63], v[40:43], v[188:191]
  ds_read_b64_tr_b16 v[76:77], v6 offset:33888
  v_mfma_f32_16x16x32_bf16 v[184:187], v[60:63], v[36:39], v[184:187]
  ds_read_b64_tr_b16 v[78:79], v6 offset:37472
  v_mfma_f32_16x16x32_bf16 v[180:183], v[60:63], v[32:35], v[180:183]
  v_mfma_f32_16x16x32_bf16 v[176:179], v[60:63], v[28:31], v[176:179]
  s_waitcnt lgkmcnt(12)
  v_mfma_f32_16x16x32_bf16 v[192:195], v[64:67], v[28:31], v[192:195]
  ds_read_b64_tr_b16 v[60:61], v94 offset:0
  v_mfma_f32_16x16x32_bf16 v[196:199], v[64:67], v[32:35], v[196:199]
  ds_read_b64_tr_b16 v[62:63], v94 offset:1024
  v_mfma_f32_16x16x32_bf16 v[200:203], v[64:67], v[36:39], v[200:203]
  ds_read_b64 v[48:49], v5 offset:33600
  v_mfma_f32_16x16x32_bf16 v[204:207], v[64:67], v[40:43], v[204:207]
  ds_read_b64 v[50:51], v5 offset:33632
  s_waitcnt lgkmcnt(7)
  v_mfma_f32_16x16x32_bf16 v[220:223], v[68:71], v[40:43], v[220:223]
  v_mfma_f32_16x16x32_bf16 v[216:219], v[68:71], v[36:39], v[216:219]
  v_mfma_f32_16x16x32_bf16 v[212:215], v[68:71], v[32:35], v[212:215]
  ds_read_b64 v[52:53], v5 offset:33856
  v_mfma_f32_16x16x32_bf16 v[208:211], v[68:71], v[28:31], v[208:211]
  ds_read_b64 v[54:55], v5 offset:33888
  v_mfma_f32_16x16x32_bf16 v[224:227], v[72:75], v[28:31], v[224:227]
  ds_read_b64_tr_b16 v[68:69], v93 offset:6144
  v_mfma_f32_16x16x32_bf16 v[228:231], v[72:75], v[32:35], v[228:231]
  ds_read_b64_tr_b16 v[70:71], v93 offset:9728
  v_mfma_f32_16x16x32_bf16 v[232:235], v[72:75], v[36:39], v[232:235]
  ds_read_b64_tr_b16 v[64:65], v95 offset:0
  ds_read_b64 v[56:57], v5 offset:34112
  v_mfma_f32_16x16x32_bf16 v[236:239], v[72:75], v[40:43], v[236:239]
  ds_read_b64_tr_b16 v[66:67], v95 offset:1024
  ds_read_b64 v[58:59], v5 offset:34144
  s_waitcnt lgkmcnt(12)
  v_mfma_f32_16x16x32_bf16 v[252:255], v[76:79], v[40:43], v[252:255]
  ds_read_b64_tr_b16 v[72:73], v93 offset:13312
  v_mfma_f32_16x16x32_bf16 v[248:251], v[76:79], v[36:39], v[248:251]
  ds_read_b64_tr_b16 v[74:75], v93 offset:16896
  v_mfma_f32_16x16x32_bf16 v[244:247], v[76:79], v[32:35], v[244:247]
  s_add_u32 s25, s25, 128
  s_cmp_ge_u32 s25, 2048
  s_cselect_b32 s26, 0x10000000, s25
  v_mfma_f32_16x16x32_bf16 v[240:243], v[76:79], v[28:31], v[240:243]
  s_waitcnt vmcnt(5) lgkmcnt(2)
  s_barrier
  v_mfma_f32_16x16x32_bf16 v[96:99], v[60:63], v[12:15], v[96:99]
  ds_read_b64_tr_b16 v[76:77], v93 offset:6176
  v_mfma_f32_16x16x32_bf16 v[100:103], v[60:63], v[16:19], v[100:103]
  ds_read_b64_tr_b16 v[78:79], v93 offset:9760
  s_cmp_eq_u32 s60, 2
  s_cbranch_scc0 L_nx_19
  s_call_b64 s[74:75], L_x_stat_2
L_nx_19:
  s_cmp_eq_u32 s60, 8
  s_cbranch_scc0 L_nx_20
  s_call_b64 s[74:75], L_x_rows_2
L_nx_20:
  v_mfma_f32_16x16x32_bf16 v[104:107], v[60:63], v[20:23], v[104:107]
  s_add_u32 m0, s33, 87040
  v_mfma_f32_16x16x32_bf16 v[108:111], v[60:63], v[24:27], v[108:111]
  buffer_load_dwordx4 v2, s[12:15], s27 offen lds
  s_add_u32 s27, s27, s30
  v_mfma_f32_16x16x32_bf16 v[124:127], v[64:67], v[24:27], v[124:127]
  ds_read_b64_tr_b16 v[60:61], v93 offset:13344
  v_mfma_f32_16x16x32_bf16 v[120:123], v[64:67], v[20:23], v[120:123]
  ds_read_b64_tr_b16 v[62:63], v93 offset:16928
  v_mfma_f32_16x16x32_bf16 v[116:119], v[64:67], v[16:19], v[116:119]
  s_add_u32 m0, s34, 87040
  v_mfma_f32_16x16x32_bf16 v[112:115], v[64:67], v[12:15], v[112:115]
  buffer_load_dwordx4 v3, s[16:19], s28 offen lds
  s_add_u32 s28, s28, s31
  v_mfma_f32_16x16x32_bf16 v[128:131], v[68:71], v[12:15], v[128:131]
  ds_read_b64_tr_b16 v[64:65], v93 offset:6208
  v_mfma_f32_16x16x32_bf16 v[132:135], v[68:71], v[16:19], v[132:135]
  ds_read_b64_tr_b16 v[66:67], v93 offset:9792
  v_mfma_f32_16x16x32_bf16 v[136:139], v[68:71], v[20:23], v[136:139]
  s_add_u32 m0, s35, 87040
  v_mfma_f32_16x16x32_bf16 v[140:143], v[68:71], v[24:27], v[140:143]
  buffer_load_dwordx4 v4, s[20:23], s29 offen lds
  s_add_u32 s29, s29, s32
  s_waitcnt lgkmcnt(6)
  v_mfma_f32_16x16x32_bf16 v[156:159], v[72:75], v[24:27], v[156:159]
  v_mfma_f32_16x16x32_bf16 v[152:155], v[72:75], v[20:23], v[152:155]
  v_mfma_f32_16x16x32_bf16 v[148:151], v[72:75], v[16:19], v[148:151]
  s_add_u32 s50, s26, 0
  s_add_u32 m0, s24, 33280
  v_mfma_f32_16x16x32_bf16 v[144:147], v[72:75], v[12:15], v[144:147]
  buffer_load_dwordx4 v1, s[8:11], s50 offen lds
  s_waitcnt lgkmcnt(4)
  v_mfma_f32_16x16x32_bf16 v[160:163], v[76:79], v[12:15], v[160:163]
  ds_read_b64_tr_b16 v[72:73], v93 offset:6240
  v_mfma_f32_16x16x32_bf16 v[164:167], v[76:79], v[16:19], v[164:167]
  ds_read_b64_tr_b16 v[74:75], v93 offset:9824
  v_mfma_f32_16x16x32_bf16 v[168:171], v[76:79], v[20:23], v[168:171]
  s_add_u32 s50, s26, 4096
  s_add_u32 m0, s24, 34320
  ds_read_b64_tr_b16 v[68:69], v93 offset:13376
  v_mfma_f32_16x16x32_bf16 v[172:175], v[76:79], v[24:27], v[172:175]
  buffer_load_dwordx4 v1, s[8:11], s50 offen lds
  ds_read_b64_tr_b16 v[70:71], v93 offset:16960
  s_waitcnt lgkmcnt(6)
  v_mfma_f32_16x16x32_bf16 v[188:191], v[60:63], v[24:27], v[188:191]
  ds_read_b64_tr_b16 v[76:77], v93 offset:13408
  v_mfma_f32_16x16x32_bf16 v[184:187], v[60:63], v[20:23], v[184:187]
  ds_read_b64_tr_b16 v[78:79], v93 offset:16992
  v_mfma_f32_16x16x32_bf16 v[180:183], v[60:63], v[16:19], v[180:183]
  v_mfma_f32_16x16x32_bf16 v[176:179], v[60:63], v[12:15], v[176:179]
  s_waitcnt lgkmcnt(6)
  v_mfma_f32_16x16x32_bf16 v[192:195], v[64:67], v[12:15], v[192:195]
  ds_read_b64_tr_b16 v[60:61], v94 offset:20480
  v_mfma_f32_16x16x32_bf16 v[196:199], v[64:67], v[16:19], v[196:199]
  ds_read_b64_tr_b16 v[62:63], v94 offset:21504
  v_mfma_f32_16x16x32_bf16 v[200:203], v[64:67], v[20:23], v[200:203]
  v_mfma_f32_16x16x32_bf16 v[204:207], v[64:67], v[24:27], v[204:207]
  s_waitcnt lgkmcnt(4)
  v_mfma_f32_16x16x32_bf16 v[220:223], v[68:71], v[24:27], v[220:223]
  v_mfma_f32_16x16x32_bf16 v[216:219], v[68:71], v[20:23], v[216:219]
  v_mfma_f32_16x16x32_bf16 v[212:215], v[68:71], v[16:19], v[212:215]
  v_mfma_f32_16x16x32_bf16 v[208:211], v[68:71], v[12:15], v[208:211]
  v_mfma_f32_16x16x32_bf16 v[224:227], v[72:75], v[12:15], v[224:227]
  ds_read_b64_tr_b16 v[68:69], v93 offset:26624
  v_mfma_f32_16x16x32_bf16 v[228:231], v[72:75], v[16:19], v[228:231]
  ds_read_b64_tr_b16 v[70:71], v93 offset:30208
  v_mfma_f32_16x16x32_bf16 v[232:235], v[72:75], v[20:23], v[232:235]
  ds_read_b64_tr_b16 v[64:65], v95 offset:20480
  v_mfma_f32_16x16x32_bf16 v[236:239], v[72:75], v[24:27], v[236:239]
  ds_read_b64_tr_b16 v[66:67], v95 offset:21504
  s_waitcnt lgkmcnt(6)
  v_mfma_f32_16x16x32_bf16 v[252:255], v[76:79], v[24:27], v[252:255]
  ds_read_b64_tr_b16 v[72:73], v93 offset:33792
  v_mfma_f32_16x16x32_bf16 v[248:251], v[76:79], v[20:23], v[248:251]
  ds_read_b64_tr_b16 v[74:75], v93 offset:37376
  v_mfma_f32_16x16x32_bf16 v[244:247], v[76:79], v[16:19], v[244:247]
  v_mfma_f32_16x16x32_bf16 v[240:243], v[76:79], v[12:15], v[240:243]
  s_waitcnt vmcnt(5)
  s_barrier
  s_waitcnt lgkmcnt(6)
  v_mfma_f32_16x16x32_bf16 v[96:99], v[60:63], v[44:47], v[96:99]
  ds_read_b64_tr_b16 v[76:77], v93 offset:26656
  v_mfma_f32_16x16x32_bf16 v[100:103], v[60:63], v[48:51], v[100:103]
  ds_read_b64_tr_b16 v[78:79], v93 offset:30240
  v_mfma_f32_16x16x32_bf16 v[104:107], v[60:63], v[52:55], v[104:107]
  s_add_u32 m0, s33, 107520
  ds_read_b64 v[12:13], v5 offset:0
  v_mfma_f32_16x16x32_bf16 v[108:111], v[60:63], v[56:59], v[108:111]
  buffer_load_dwordx4 v2, s[12:15], s27 offen lds
  s_add_u32 s27, s27, s30
  ds_read_b64 v[14:15], v5 offset:32
  s_waitcnt lgkmcnt(6)
  v_mfma_f32_16x16x32_bf16 v[124:127], v[64:67], v[56:59], v[124:127]
  ds_read_b64_tr_b16 v[60:61], v93 offset:33824
  v_mfma_f32_16x16x32_bf16 v[120:123], v[64:67], v[52:55], v[120:123]
  ds_read_b64_tr_b16 v[62:63], v93 offset:37408
  v_mfma_f32_16x16x32_bf16 v[116:119], v[64:67], v[48:51], v[116:119]
  s_add_u32 m0, s34, 107520
  ds_read_b64 v[16:17], v5 offset:256
  v_mfma_f32_16x16x32_bf16 v[112:115], v[64:67], v[44:47], v[112:115]
  buffer_load_dwordx4 v3, s[16:19], s28 offen lds
  s_add_u32 s28, s28, s31
  ds_read_b64 v[18:19], v5 offset:288
  v_mfma_f32_16x16x32_bf16 v[128:131], v[68:71], v[44:47], v[128:131]
  ds_read_b64_tr_b16 v[64:65], v93 offset:26688
  v_mfma_f32_16x16x32_bf16 v[132:135], v[68:71], v[48:51], v[132:135]
  ds_read_b64_tr_b16 v[66:67], v93 offset:30272
  v_mfma_f32_16x16x32_bf16 v[136:139], v[68:71], v[52:55], v[136:139]
  s_add_u32 m0, s35, 107520
  ds_read_b64 v[20:21], v5 offset:512
  v_mfma_f32_16x16x32_bf16 v[140:143], v[68:71], v[56:59], v[140:143]
  buffer_load_dwordx4 v4, s[20:23], s29 offen lds
  s_add_u32 s29, s29, s32
  ds_read_b64 v[22:23], v5 offset:544
  s_waitcnt lgkmcnt(12)
  v_mfma_f32_16x16x32_bf16 v[156:159], v[72:75], v[56:59], v[156:159]
  v_mfma_f32_16x16x32_bf16 v[152:155], v[72:75], v[52:55], v[152:155]
  v_mfma_f32_16x16x32_bf16 v[148:151], v[72:75], v[48:51], v[148:151]
  s_add_u32 s50, s26, 262144
  s_add_u32 m0, s24, 49920
  ds_read_b64 v[24:25], v5 offset:768
  v_mfma_f32_16x16x32_bf16 v[144:147], v[72:75], v[44:47], v[144:147]
  buffer_load_dwordx4 v1, s[8:11], s50 offen lds
  ds_read_b64 v[26:27], v5 offset:800
  s_waitcnt lgkmcnt(12)
  v_mfma_f32_16x16x32_bf16 v[160:163], v[76:79], v[44:47], v[160:163]
  ds_read_b64_tr_b16 v[72:73], v93 offset:26720
  v_mfma_f32_16x16x32_bf16 v[164:167], v[76:79], v[48:51], v[164:167]
  ds_read_b64_tr_b16 v[74:75], v93 offset:30304
  v_mfma_f32_16x16x32_bf16 v[168:171], v[76:79], v[52:55], v[168:171]
  s_add_u32 s50, s26, 266240
  s_add_u32 m0, s24, 50960
  ds_read_b64_tr_b16 v[68:69], v93 offset:33856
  ds_read_b64 v[28:29], v5 offset:64
  v_mfma_f32_16x16x32_bf16 v[172:175], v[76:79], v[56:59], v[172:175]
  buffer_load_dwordx4 v1, s[8:11], s50 offen lds
  ds_read_b64_tr_b16 v[70:71], v93 offset:37440
  ds_read_b64 v[30:31], v5 offset:96
  s_waitcnt lgkmcnt(14)
  v_mfma_f32_16x16x32_bf16 v[188:191], v[60:63], v[56:59], v[188:191]
  ds_read_b64_tr_b16 v[76:77], v93 offset:33888
  v_mfma_f32_16x16x32_bf16 v[184:187], v[60:63], v[52:55], v[184:187]
  ds_read_b64_tr_b16 v[78:79], v93 offset:37472
  v_mfma_f32_16x16x32_bf16 v[180:183], v[60:63], v[48:51], v[180:183]
  v_mfma_f32_16x16x32_bf16 v[176:179], v[60:63], v[44:47], v[176:179]
  s_waitcnt lgkmcnt(12)
  v_mfma_f32_16x16x32_bf16 v[192:195], v[64:67], v[44:47], v[192:195]
  ds_read_b64_tr_b16 v[60:61], v7 offset:0
  v_mfma_f32_16x16x32_bf16 v[196:199], v[64:67], v[48:51], v[196:199]
  ds_read_b64_tr_b16 v[62:63], v7 offset:1024
  v_mfma_f32_16x16x32_bf16 v[200:203], v[64:67], v[52:55], v[200:203]
  ds_read_b64 v[32:33], v5 offset:320
  v_mfma_f32_16x16x32_bf16 v[204:207], v[64:67], v[56:59], v[204:207]
  ds_read_b64 v[34:35], v5 offset:352
  s_waitcnt lgkmcnt(7)
  v_mfma_f32_16x16x32_bf16 v[220:223], v[68:71], v[56:59], v[220:223]
  v_mfma_f32_16x16x32_bf16 v[216:219], v[68:71], v[52:55], v[216:219]
  v_mfma_f32_16x16x32_bf16 v[212:215], v[68:71], v[48:51], v[212:215]
  ds_read_b64 v[36:37], v5 offset:576
  v_mfma_f32_16x16x32_bf16 v[208:211], v[68:71], v[44:47], v[208:211]
  ds_read_b64 v[38:39], v5 offset:608
  v_mfma_f32_16x16x32_bf16 v[224:227], v[72:75], v[44:47], v[224:227]
  ds_read_b64_tr_b16 v[68:69], v6 offset:6144
  v_mfma_f32_16x16x32_bf16 v[228:231], v[72:75], v[48:51], v[228:231]
  ds_read_b64_tr_b16 v[70:71], v6 offset:9728
  v_mfma_f32_16x16x32_bf16 v[232:235], v[72:75], v[52:55], v[232:235]
  ds_read_b64_tr_b16 v[64:65], v8 offset:0
  ds_read_b64 v[40:41], v5 offset:832
  v_mfma_f32_16x16x32_bf16 v[236:239], v[72:75], v[56:59], v[236:239]
  ds_read_b64_tr_b16 v[66:67], v8 offset:1024
  ds_read_b64 v[42:43], v5 offset:864
  s_waitcnt lgkmcnt(12)
  v_mfma_f32_16x16x32_bf16 v[252:255], v[76:79], v[56:59], v[252:255]
  ds_read_b64_tr_b16 v[72:73], v6 offset:13312
  v_mfma_f32_16x16x32_bf16 v[248:251], v[76:79], v[52:55], v[248:251]
  ds_read_b64_tr_b16 v[74:75], v6 offset:16896
  v_mfma_f32_16x16x32_bf16 v[244:247], v[76:79], v[48:51], v[244:247]
  s_add_u32 s25, s25, 128
  s_cmp_ge_u32 s25, 2048
  s_cselect_b32 s26, 0x10000000, s25
  v_mfma_f32_16x16x32_bf16 v[240:243], v[76:79], v[44:47], v[240:243]
  s_waitcnt vmcnt(5) lgkmcnt(2)
  s_barrier
  s_sub_u32 s60, s60, 1
  s_cmp_gt_u32 s60, 2
  s_cbranch_scc1 L_loop2
L_loopc2:
  v_mfma_f32_16x16x32_bf16 v[96:99], v[60:63], v[12:15], v[96:99]
  ds_read_b64_tr_b16 v[76:77], v6 offset:6176
  v_mfma_f32_16x16x32_bf16 v[100:103], v[60:63], v[16:19], v[100:103]
  ds_read_b64_tr_b16 v[78:79], v6 offset:9760
  s_cmp_eq_u32 s60, 6
  s_cbranch_scc0 L_nx_21
  s_call_b64 s[74:75], L_x_drain_2
L_nx_21:
  v_mfma_f32_16x16x32_bf16 v[104:107], v[60:63], v[20:23], v[104:107]
  s_add_u32 m0, s33, 128000
  v_mfma_f32_16x16x32_bf16 v[108:111], v[60:63], v[24:27], v[108:111]
  buffer_load_dwordx4 v2, s[12:15], s27 offen lds
  s_add_u32 s27, s27, s30
  v_mfma_f32_16x16x32_bf16 v[124:127], v[64:67], v[24:27], v[124:127]
  ds_read_b64_tr_b16 v[60:61], v6 offset:13344
  v_mfma_f32_16x16x32_bf16 v[120:123], v[64:67], v[20:23], v[120:123]
  ds_read_b64_tr_b16 v[62:63], v6 offset:16928
  v_mfma_f32_16x16x32_bf16 v[116:119], v[64:67], v[16:19], v[116:119]
  s_add_u32 m0, s34, 128000
  v_mfma_f32_16x16x32_bf16 v[112:115], v[64:67], v[12:15], v[112:115]
  buffer_load_dwordx4 v3, s[16:19], s28 offen lds
  s_add_u32 s28, s28, s31
  v_mfma_f32_16x16x32_bf16 v[128:131], v[68:71], v[12:15], v[128:131]
  ds_read_b64_tr_b16 v[64:65], v6 offset:6208
  v_lshlrev_b32 v10, 16, v68
  v_and_b32 v11, s79, v68
  v_mfma_f32_16x16x32_bf16 v[132:135], v[68:71], v[16:19], v[132:135]
  ds_read_b64_tr_b16 v[66:67], v6 offset:9792
  v_add_f32 v90, v90, v10
  v_add_f32 v90, v90, v11
  v_mfma_f32_16x16x32_bf16 v[136:139], v[68:71], v[20:23], v[136:139]
  s_add_u32 m0, s35, 128000
  v_lshlrev_b32 v10, 16, v69
  v_and_b32 v11, s79, v69
  v_mfma_f32_16x16x32_bf16 v[140:143], v[68:71], v[24:27], v[140:143]
  buffer_load_dwordx4 v4, s[20:23], s29 offen lds
  s_add_u32 s29, s29, s32
  v_add_f32 v90, v90, v10
  v_add_f32 v90, v90, v11
  s_waitcnt lgkmcnt(6)
  v_mfma_f32_16x16x32_bf16 v[156:159], v[72:75], v[24:27], v[156:159]
  v_lshlrev_b32 v10, 16, v70
  v_and_b32 v11, s79, v70
  v_mfma_f32_16x16x32_bf16 v[152:155], v[72:75], v[20:23], v[152:155]
  v_add_f32 v90, v90, v10
  v_add_f32 v90, v90, v11
  v_mfma_f32_16x16x32_bf16 v[148:151], v[72:75], v[16:19], v[148:151]
  s_add_u32 s50, s26, 0
  s_add_u32 m0, s24, 0
  v_lshlrev_b32 v10, 16, v71
  v_and_b32 v11, s79, v71
  v_mfma_f32_16x16x32_bf16 v[144:147], v[72:75], v[12:15], v[144:147]
  buffer_load_dwordx4 v1, s[8:11], s50 offen lds
  v_add_f32 v90, v90, v10
  v_add_f32 v90, v90, v11
  s_waitcnt lgkmcnt(4)
  v_mfma_f32_16x16x32_bf16 v[160:163], v[76:79], v[12:15], v[160:163]
  ds_read_b64_tr_b16 v[72:73], v6 offset:6240
  v_mfma_f32_16x16x32_bf16 v[164:167], v[76:79], v[16:19], v[164:167]
  ds_read_b64_tr_b16 v[74:75], v6 offset:9824
  v_mfma_f32_16x16x32_bf16 v[168:171], v[76:79], v[20:23], v[168:171]
  s_add_u32 s50, s26, 4096
  s_add_u32 m0, s24, 1040
  ds_read_b64_tr_b16 v[68:69], v6 offset:13376
  v_mfma_f32_16x16x32_bf16 v[172:175], v[76:79], v[24:27], v[172:175]
  buffer_load_dwordx4 v1, s[8:11], s50 offen lds
  ds_read_b64_tr_b16 v[70:71], v6 offset:16960
  s_waitcnt lgkmcnt(6)
  v_mfma_f32_16x16x32_bf16 v[188:191], v[60:63], v[24:27], v[188:191]
  ds_read_b64_tr_b16 v[76:77], v6 offset:13408
  v_mfma_f32_16x16x32_bf16 v[184:187], v[60:63], v[20:23], v[184:187]
  ds_read_b64_tr_b16 v[78:79], v6 offset:16992
  v_mfma_f32_16x16x32_bf16 v[180:183], v[60:63], v[16:19], v[180:183]
  v_mfma_f32_16x16x32_bf16 v[176:179], v[60:63], v[12:15], v[176:179]
  s_waitcnt lgkmcnt(6)
  v_mfma_f32_16x16x32_bf16 v[192:195], v[64:67], v[12:15], v[192:195]
  ds_read_b64_tr_b16 v[60:61], v7 offset:20480
  v_lshlrev_b32 v10, 16, v64
  v_and_b32 v11, s79, v64
  v_mfma_f32_16x16x32_bf16 v[196:199], v[64:67], v[16:19], v[196:199]
  ds_read_b64_tr_b16 v[62:63], v7 offset:21504
  v_add_f32 v91, v91, v10
  v_add_f32 v91, v91, v11
  v_mfma_f32_16x16x32_bf16 v[200:203], v[64:67], v[20:23], v[200:203]
  v_lshlrev_b32 v10, 16, v65
  v_and_b32 v11, s79, v65
  v_mfma_f32_16x16x32_bf16 v[204:207], v[64:67], v[24:27], v[204:207]
  v_add_f32 v91, v91, v10
  v_add_f32 v91, v91, v11
  s_waitcnt lgkmcnt(4)
  v_mfma_f32_16x16x32_bf16 v[220:223], v[68:71], v[24:27], v[220:223]
  v_lshlrev_b32 v10, 16, v66
  v_and_b32 v11, s79, v66
  v_mfma_f32_16x16x32_bf16 v[216:219], v[68:71], v[20:23], v[216:219]
  v_add_f32 v91, v91, v10
  v_add_f32 v91, v91, v11
  v_mfma_f32_16x16x32_bf16 v[212:215], v[68:71], v[16:19], v[212:215]
  v_lshlrev_b32 v10, 16, v67
  v_and_b32 v11, s79, v67
  v_mfma_f32_16x16x32_bf16 v[208:211], v[68:71], v[12:15], v[208:211]
  v_add_f32 v91, v91, v10
  v_add_f32 v91, v91, v11
  v_mfma_f32_16x16x32_bf16 v[224:227], v[72:75], v[12:15], v[224:227]
  ds_read_b64_tr_b16 v[68:69], v6 offset:26624
  v_mfma_f32_16x16x32_bf16 v[228:231], v[72:75], v[16:19], v[228:231]
  ds_read_b64_tr_b16 v[70:71], v6 offset:30208
  v_mfma_f32_16x16x32_bf16 v[232:235], v[72:75], v[20:23], v[232:235]
  ds_read_b64_tr_b16 v[64:65], v8 offset:20480
  v_mfma_f32_16x16x32_bf16 v[236:239], v[72:75], v[24:27], v[236:239]
  ds_read_b64_tr_b16 v[66:67], v8 offset:21504
  s_cmp_eq_u32 s60, 2
  s_cbranch_scc0 L_nx_22
  s_call_b64 s[74:75], L_x_poll_2
L_nx_22:
  s_waitcnt lgkmcnt(6)
  v_mfma_f32_16x16x32_bf16 v[252:255], v[76:79], v[24:27], v[252:255]
  ds_read_b64_tr_b16 v[72:73], v6 offset:33792
  v_mfma_f32_16x16x32_bf16 v[248:251], v[76:79], v[20:23], v[248:251]
  ds_read_b64_tr_b16 v[74:75], v6 offset:37376
  v_mfma_f32_16x16x32_bf16 v[244:247], v[76:79], v[16:19], v[244:247]
  v_mfma_f32_16x16x32_bf16 v[240:243], v[76:79], v[12:15], v[240:243]
  s_waitcnt vmcnt(5)
  s_barrier
  s_waitcnt lgkmcnt(6)
  v_mfma_f32_16x16x32_bf16 v[96:99], v[60:63], v[28:31], v[96:99]
  ds_read_b64_tr_b16 v[76:77], v6 offset:26656
  v_mfma_f32_16x16x32_bf16 v[100:103], v[60:63], v[32:35], v[100:103]
  ds_read_b64_tr_b16 v[78:79], v6 offset:30240
  v_mfma_f32_16x16x32_bf16 v[104:107], v[60:63], v[36:39], v[104:107]
  s_add_u32 m0, s33, 66560
  ds_read_b64 v[12:13], v5 offset:33280
  v_mfma_f32_16x16x32_bf16 v[108:111], v[60:63], v[40:43], v[108:111]
  buffer_load_dwordx4 v2, s[12:15], s27 offen lds
  s_add_u32 s27, s27, s30
  ds_read_b64 v[14:15], v5 offset:33312
  s_waitcnt lgkmcnt(6)
  v_mfma_f32_16x16x32_bf16 v[124:127], v[64:67], v[40:43], v[124:127]
  ds_read_b64_tr_b16 v[60:61], v6 offset:33824
  v_mfma_f32_16x16x32_bf16 v[120:123], v[64:67], v[36:39], v[120:123]
  ds_read_b64_tr_b16 v[62:63], v6 offset:37408
  v_mfma_f32_16x16x32_bf16 v[116:119], v[64:67], v[32:35], v[116:119]
  s_add_u32 m0, s34, 66560
  ds_read_b64 v[16:17], v5 offset:33536
  v_mfma_f32_16x16x32_bf16 v[112:115], v[64:67], v[28:31], v[112:115]
  buffer_load_dwordx4 v3, s[16:19], s28 offen lds
  s_add_u32 s28, s28, s31
  ds_read_b64 v[18:19], v5 offset:33568
  v_mfma_f32_16x16x32_bf16 v[128:131], v[68:71], v[28:31], v[128:131]
  ds_read_b64_tr_b16 v[64:65], v6 offset:26688
  v_lshlrev_b32 v10, 16, v68
  v_and_b32 v11, s79, v68
  v_mfma_f32_16x16x32_bf16 v[132:135], v[68:71], v[32:35], v[132:135]
  ds_read_b64_tr_b16 v[66:67], v6 offset:30272
  v_add_f32 v90, v90, v10
  v_add_f32 v90, v90, v11
  v_mfma_f32_16x16x32_bf16 v[136:139], v[68:71], v[36:39], v[136:139]
  s_add_u32 m0, s35, 66560
  ds_read_b64 v[20:21], v5 offset:33792
  v_lshlrev_b32 v10, 16, v69
  v_and_b32 v11, s79, v69
  v_mfma_f32_16x16x32_bf16 v[140:143], v[68:71], v[40:43], v[140:143]
  buffer_load_dwordx4 v4, s[20:23], s29 offen lds
  s_add_u32 s29, s29, s32
  ds_read_b64 v[22:23], v5 offset:33824
  v_add_f32 v90, v90, v10
  v_add_f32 v90, v90, v11
  s_waitcnt lgkmcnt(12)
  v_mfma_f32_16x16x32_bf16 v[156:159], v[72:75], v[40:43], v[156:159]
  v_lshlrev_b32 v10, 16, v70
  v_and_b32 v11, s79, v70
  v_mfma_f32_16x16x32_bf16 v[152:155], v[72:75], v[36:39], v[152:155]
  v_add_f32 v90, v90, v10
  v_add_f32 v90, v90, v11
  v_mfma_f32_16x16x32_bf16 v[148:151], v[72:75], v[32:35], v[148:151]
  s_add_u32 s50, s26, 262144
  s_add_u32 m0, s24, 16640
  ds_read_b64 v[24:25], v5 offset:34048
  v_lshlrev_b32 v10, 16, v71
  v_and_b32 v11, s79, v71
  v_mfma_f32_16x16x32_bf16 v[144:147], v[72:75], v[28:31], v[144:147]
  buffer_load_dwordx4 v1, s[8:11], s50 offen lds
  ds_read_b64 v[26:27], v5 offset:34080
  v_add_f32 v90, v90, v10
  v_add_f32 v90, v90, v11
  s_waitcnt lgkmcnt(12)
  v_mfma_f32_16x16x32_bf16 v[160:163], v[76:79], v[28:31], v[160:163]
  ds_read_b64_tr_b16 v[72:73], v6 offset:26720
  v_mfma_f32_16x16x32_bf16 v[164:167], v[76:79], v[32:35], v[164:167]
  ds_read_b64_tr_b16 v[74:75], v6 offset:30304
  v_mfma_f32_16x16x32_bf16 v[168:171], v[76:79], v[36:39], v[168:171]
  s_add_u32 s50, s26, 266240
  s_add_u32 m0, s24, 17680
  ds_read_b64_tr_b16 v[68:69], v6 offset:33856
  ds_read_b64 v[44:45], v5 offset:33344
  v_mfma_f32_16x16x32_bf16 v[172:175], v[76:79], v[40:43], v[172:175]
  buffer_load_dwordx4 v1, s[8:11], s50 offen lds
  ds_read_b64_tr_b16 v[70:71], v6 offset:37440
  ds_read_b64 v[46:47], v5 offset:33376
  s_waitcnt lgkmcnt(14)
  v_mfma_f32_16x16x32_bf16 v[188:191], v[60:63], v[40:43], v[188:191]
  ds_read_b64_tr_b16 v[76:77], v6 offset:33888
  v_mfma_f32_16x16x32_bf16 v[184:187], v[60:63], v[36:39], v[184:187]
  ds_read_b64_tr_b16 v[78:79], v6 offset:37472
  v_mfma_f32_16x16x32_bf16 v[180:183], v[60:63], v[32:35], v[180:183]
  v_mfma_f32_16x16x32_bf16 v[176:179], v[60:63], v[28:31], v[176:179]
  s_waitcnt lgkmcnt(12)
  v_mfma_f32_16x16x32_bf16 v[192:195], v[64:67], v[28:31], v[192:195]
  ds_read_b64_tr_b16 v[60:61], v94 offset:0
  v_lshlrev_b32 v10, 16, v64
  v_and_b32 v11, s79, v64
  v_mfma_f32_16x16x32_bf16 v[196:199], v[64:67], v[32:35], v[196:199]
  ds_read_b64_tr_b16 v[62:63], v94 offset:1024
  v_add_f32 v91, v91, v10
  v_add_f32 v91, v91, v11
  v_mfma_f32_16x16x32_bf16 v[200:203], v[64:67], v[36:39], v[200:203]
  ds_read_b64 v[48:49], v5 offset:33600
  v_lshlrev_b32 v10, 16, v65
  v_and_b32 v11, s79, v65
  v_mfma_f32_16x16x32_bf16 v[204:207], v[64:67], v[40:43], v[204:207]
  ds_read_b64 v[50:51], v5 offset:33632
  v_add_f32 v91, v91, v10
  v_add_f32 v91, v91, v11
  s_waitcnt lgkmcnt(7)
  v_mfma_f32_16x16x32_bf16 v[220:223], v[68:71], v[40:43], v[220:223]
  v_lshlrev_b32 v10, 16, v66
  v_and_b32 v11, s79, v66
  v_mfma_f32_16x16x32_bf16 v[216:219], v[68:71], v[36:39], v[216:219]
  v_add_f32 v91, v91, v10
  v_add_f32 v91, v91, v11
  v_mfma_f32_16x16x32_bf16 v[212:215], v[68:71], v[32:35], v[212:215]
  ds_read_b64 v[52:53], v5 offset:33856
  v_lshlrev_b32 v10, 16, v67
  v_and_b32 v11, s79, v67
  v_mfma_f32_16x16x32_bf16 v[208:211], v[68:71], v[28:31], v[208:211]
  ds_read_b64 v[54:55], v5 offset:33888
  v_add_f32 v91, v91, v10
  v_add_f32 v91, v91, v11
  v_mfma_f32_16x16x32_bf16 v[224:227], v[72:75], v[28:31], v[224:227]
  ds_read_b64_tr_b16 v[68:69], v93 offset:6144
  v_mfma_f32_16x16x32_bf16 v[228:231], v[72:75], v[32:35], v[228:231]
  ds_read_b64_tr_b16 v[70:71], v93 offset:9728
  v_mfma_f32_16x16x32_bf16 v[232:235], v[72:75], v[36:39], v[232:235]
  ds_read_b64_tr_b16 v[64:65], v95 offset:0
  ds_read_b64 v[56:57], v5 offset:34112
  v_mfma_f32_16x16x32_bf16 v[236:239], v[72:75], v[40:43], v[236:239]
  ds_read_b64_tr_b16 v[66:67], v95 offset:1024
  ds_read_b64 v[58:59], v5 offset:34144
  s_waitcnt lgkmcnt(12)
  v_mfma_f32_16x16x32_bf16 v[252:255], v[76:79], v[40:43], v[252:255]
  ds_read_b64_tr_b16 v[72:73], v93 offset:13312
  v_mfma_f32_16x16x32_bf16 v[248:251], v[76:79], v[36:39], v[248:251]
  ds_read_b64_tr_b16 v[74:75], v93 offset:16896
  v_mfma_f32_16x16x32_bf16 v[244:247], v[76:79], v[32:35], v[244:247]
  s_add_u32 s25, s25, 128
  s_cmp_ge_u32 s25, 2048
  s_cselect_b32 s26, 0x10000000, s25
  v_mfma_f32_16x16x32_bf16 v[240:243], v[76:79], v[28:31], v[240:243]
  s_waitcnt vmcnt(5) lgkmcnt(2)
  s_barrier
  v_mfma_f32_16x16x32_bf16 v[96:99], v[60:63], v[12:15], v[96:99]
  ds_read_b64_tr_b16 v[76:77], v93 offset:6176
  v_mfma_f32_16x16x32_bf16 v[100:103], v[60:63], v[16:19], v[100:103]
  ds_read_b64_tr_b16 v[78:79], v93 offset:9760
  s_cmp_eq_u32 s60, 2
  s_cbranch_scc0 L_nx_23
  s_call_b64 s[74:75], L_x_stat_2
L_nx_23:
  s_cmp_eq_u32 s60, 8
  s_cbranch_scc0 L_nx_24
  s_call_b64 s[74:75], L_x_rows_2
L_nx_24:
  v_mfma_f32_16x16x32_bf16 v[104:107], v[60:63], v[20:23], v[104:107]
  s_add_u32 m0, s33, 87040
  v_mfma_f32_16x16x32_bf16 v[108:111], v[60:63], v[24:27], v[108:111]
  buffer_load_dwordx4 v2, s[12:15], s27 offen lds
  s_add_u32 s27, s27, s30
  v_mfma_f32_16x16x32_bf16 v[124:127], v[64:67], v[24:27], v[124:127]
  ds_read_b64_tr_b16 v[60:61], v93 offset:13344
  v_mfma_f32_16x16x32_bf16 v[120:123], v[64:67], v[20:23], v[120:123]
  ds_read_b64_tr_b16 v[62:63], v93 offset:16928
  v_mfma_f32_16x16x32_bf16 v[116:119], v[64:67], v[16:19], v[116:119]
  s_add_u32 m0, s34, 87040
  v_mfma_f32_16x16x32_bf16 v[112:115], v[64:67], v[12:15], v[112:115]
  buffer_load_dwordx4 v3, s[16:19], s28 offen lds
  s_add_u32 s28, s28, s31
  v_mfma_f32_16x16x32_bf16 v[128:131], v[68:71], v[12:15], v[128:131]
  ds_read_b64_tr_b16 v[64:65], v93 offset:6208
  v_lshlrev_b32 v10, 16, v68
  v_and_b32 v11, s79, v68
  v_mfma_f32_16x16x32_bf16 v[132:135], v[68:71], v[16:19], v[132:135]
  ds_read_b64_tr_b16 v[66:67], v93 offset:9792
  v_add_f32 v90, v90, v10
  v_add_f32 v90, v90, v11
  v_mfma_f32_16x16x32_bf16 v[136:139], v[68:71], v[20:23], v[136:139]
  s_add_u32 m0, s35, 87040
  v_lshlrev_b32 v10, 16, v69
  v_and_b32 v11, s79, v69
  v_mfma_f32_16x16x32_bf16 v[140:143], v[68:71], v[24:27], v[140:143]
  buffer_load_dwordx4 v4, s[20:23], s29 offen lds
  s_add_u32 s29, s29, s32
  v_add_f32 v90, v90, v10
  v_add_f32 v90, v90, v11
  s_waitcnt lgkmcnt(6)
  v_mfma_f32_16x16x32_bf16 v[156:159], v[72:75], v[24:27], v[156:159]
  v_lshlrev_b32 v10, 16, v70
  v_and_b32 v11, s79, v70
  v_mfma_f32_16x16x32_bf16 v[152:155], v[72:75], v[20:23], v[152:155]
  v_add_f32 v90, v90, v10
  v_add_f32 v90, v90, v11
  v_mfma_f32_16x16x32_bf16 v[148:151], v[72:75], v[16:19], v[148:151]
  s_add_u32 s50, s26, 0
  s_add_u32 m0, s24, 33280
  v_lshlrev_b32 v10, 16, v71
  v_and_b32 v11, s79, v71
  v_mfma_f32_16x16x32_bf16 v[144:147], v[72:75], v[12:15], v[144:147]
  buffer_load_dwordx4 v1, s[8:11], s50 offen lds
  v_add_f32 v90, v90, v10
  v_add_f32 v90, v90, v11
  s_waitcnt lgkmcnt(4)
  v_mfma_f32_16x16x32_bf16 v[160:163], v[76:79], v[12:15], v[160:163]
  ds_read_b64_tr_b16 v[72:73], v93 offset:6240
  v_mfma_f32_16x16x32_bf16 v[164:167], v[76:79], v[16:19], v[164:167]
  ds_read_b64_tr_b16 v[74:75], v93 offset:9824
  v_mfma_f32_16x16x32_bf16 v[168:171], v[76:79], v[20:23], v[168:171]
  s_add_u32 s50, s26, 4096
  s_add_u32 m0, s24, 34320
  ds_read_b64_tr_b16 v[68:69], v93 offset:13376
  v_mfma_f32_16x16x32_bf16 v[172:175], v[76:79], v[24:27], v[172:175]
  buffer_load_dwordx4 v1, s[8:11], s50 offen lds
  ds_read_b64_tr_b16 v[70:71], v93 offset:16960
  s_waitcnt lgkmcnt(6)
  v_mfma_f32_16x16x32_bf16 v[188:191], v[60:63], v[24:27], v[188:191]
  ds_read_b64_tr_b16 v[76:77], v93 offset:13408
  v_mfma_f32_16x16x32_bf16 v[184:187], v[60:63], v[20:23], v[184:187]
  ds_read_b64_tr_b16 v[78:79], v93 offset:16992
  v_mfma_f32_16x16x32_bf16 v[180:183], v[60:63], v[16:19], v[180:183]
  v_mfma_f32_16x16x32_bf16 v[176:179], v[60:63], v[12:15], v[176:179]
  s_waitcnt lgkmcnt(6)
  v_mfma_f32_16x16x32_bf16 v[192:195], v[64:67], v[12:15], v[192:195]
  ds_read_b64_tr_b16 v[60:61], v94 offset:20480
  v_lshlrev_b32 v10, 16, v64
  v_and_b32 v11, s79, v64
  v_mfma_f32_16x16x32_bf16 v[196:199], v[64:67], v[16:19], v[196:199]
  ds_read_b64_tr_b16 v[62:63], v94 offset:21504
  v_add_f32 v91, v91, v10
  v_add_f32 v91, v91, v11
  v_mfma_f32_16x16x32_bf16 v[200:203], v[64:67], v[20:23], v[200:203]
  v_lshlrev_b32 v10, 16, v65
  v_and_b32 v11, s79, v65
  v_mfma_f32_16x16x32_bf16 v[204:207], v[64:67], v[24:27], v[204:207]
  v_add_f32 v91, v91, v10
  v_add_f32 v91, v91, v11
  s_waitcnt lgkmcnt(4)
  v_mfma_f32_16x16x32_bf16 v[220:223], v[68:71], v[24:27], v[220:223]
  v_lshlrev_b32 v10, 16, v66
  v_and_b32 v11, s79, v66
  v_mfma_f32_16x16x32_bf16 v[216:219], v[68:71], v[20:23], v[216:219]
  v_add_f32 v91, v91, v10
  v_add_f32 v91, v91, v11
  v_mfma_f32_16x16x32_bf16 v[212:215], v[68:71], v[16:19], v[212:215]
  v_lshlrev_b32 v10, 16, v67
  v_and_b32 v11, s79, v67
  v_mfma_f32_16x16x32_bf16 v[208:211], v[68:71], v[12:15], v[208:211]
  v_add_f32 v91, v91, v10
  v_add_f32 v91, v91, v11
  v_mfma_f32_16x16x32_bf16 v[224:227], v[72:75], v[12:15], v[224:227]
  ds_read_b64_tr_b16 v[68:69], v93 offset:26624
  v_mfma_f32_16x16x32_bf16 v[228:231], v[72:75], v[16:19], v[228:231]
  ds_read_b64_tr_b16 v[70:71], v93 offset:30208
  v_mfma_f32_16x16x32_bf16 v[232:235], v[72:75], v[20:23], v[232:235]
  ds_read_b64_tr_b16 v[64:65], v95 offset:20480
  v_mfma_f32_16x16x32_bf16 v[236:239], v[72:75], v[24:27], v[236:239]
  ds_read_b64_tr_b16 v[66:67], v95 offset:21504
  s_waitcnt lgkmcnt(6)
  v_mfma_f32_16x16x32_bf16 v[252:255], v[76:79], v[24:27], v[252:255]
  ds_read_b64_tr_b16 v[72:73], v93 offset:33792
  v_mfma_f32_16x16x32_bf16 v[248:251], v[76:79], v[20:23], v[248:251]
  ds_read_b64_tr_b16 v[74:75], v93 offset:37376
  v_mfma_f32_16x16x32_bf16 v[244:247], v[76:79], v[16:19], v[244:247]
  v_mfma_f32_16x16x32_bf16 v[240:243], v[76:79], v[12:15], v[240:243]
  s_waitcnt vmcnt(5)
  s_barrier
  s_waitcnt lgkmcnt(6)
  v_mfma_f32_16x16x32_bf16 v[96:99], v[60:63], v[44:47], v[96:99]
  ds_read_b64_tr_b16 v[76:77], v93 offset:26656
  v_mfma_f32_16x16x32_bf16 v[100:103], v[60:63], v[48:51], v[100:103]
  ds_read_b64_tr_b16 v[78:79], v93 offset:30240
  v_mfma_f32_16x16x32_bf16 v[104:107], v[60:63], v[52:55], v[104:107]
  s_add_u32 m0, s33, 107520
  ds_read_b64 v[12:13], v5 offset:0
  v_mfma_f32_16x16x32_bf16 v[108:111], v[60:63], v[56:59], v[108:111]
  buffer_load_dwordx4 v2, s[12:15], s27 offen lds
  s_add_u32 s27, s27, s30
  ds_read_b64 v[14:15], v5 offset:32
  s_waitcnt lgkmcnt(6)
  v_mfma_f32_16x16x32_bf16 v[124:127], v[64:67], v[56:59], v[124:127]
  ds_read_b64_tr_b16 v[60:61], v93 offset:33824
  v_mfma_f32_16x16x32_bf16 v[120:123], v[64:67], v[52:55], v[120:123]
  ds_read_b64_tr_b16 v[62:63], v93 offset:37408
  v_mfma_f32_16x16x32_bf16 v[116:119], v[64:67], v[48:51], v[116:119]
  s_add_u32 m0, s34, 107520
  ds_read_b64 v[16:17], v5 offset:256
  v_mfma_f32_16x16x32_bf16 v[112:115], v[64:67], v[44:47], v[112:115]
  buffer_load_dwordx4 v3, s[16:19], s28 offen lds
  s_add_u32 s28, s28, s31
  ds_read_b64 v[18:19], v5 offset:288
  v_mfma_f32_16x16x32_bf16 v[128:131], v[68:71], v[44:47], v[128:131]
  ds_read_b64_tr_b16 v[64:65], v93 offset:26688
  v_lshlrev_b32 v10, 16, v68
  v_and_b32 v11, s79, v68
  v_mfma_f32_16x16x32_bf16 v[132:135], v[68:71], v[48:51], v[132:135]
  ds_read_b64_tr_b16 v[66:67], v93 offset:30272
  v_add_f32 v90, v90, v10
  v_add_f32 v90, v90, v11
  v_mfma_f32_16x16x32_bf16 v[136:139], v[68:71], v[52:55], v[136:139]
  s_add_u32 m0, s35, 107520
  ds_read_b64 v[20:21], v5 offset:512
  v_lshlrev_b32 v10, 16, v69
  v_and_b32 v11, s79, v69
  v_mfma_f32_16x16x32_bf16 v[140:143], v[68:71], v[56:59], v[140:143]
  buffer_load_dwordx4 v4, s[20:23], s29 offen lds
  s_add_u32 s29, s29, s32
  ds_read_b64 v[22:23], v5 offset:544
  v_add_f32 v90, v90, v10
  v_add_f32 v90, v90, v11
  s_waitcnt lgkmcnt(12)
  v_mfma_f32_16x16x32_bf16 v[156:159], v[72:75], v[56:59], v[156:159]
  v_lshlrev_b32 v10, 16, v70
  v_and_b32 v11, s79, v70
  v_mfma_f32_16x16x32_bf16 v[152:155], v[72:75], v[52:55], v[152:155]
  v_add_f32 v90, v90, v10
  v_add_f32 v90, v90, v11
  v_mfma_f32_16x16x32_bf16 v[148:151], v[72:75], v[48:51], v[148:151]
  s_add_u32 s50, s26, 262144
  s_add_u32 m0, s24, 49920
  ds_read_b64 v[24:25], v5 offset:768
  v_lshlrev_b32 v10, 16, v71
  v_and_b32 v11, s79, v71
  v_mfma_f32_16x16x32_bf16 v[144:147], v[72:75], v[44:47], v[144:147]
  buffer_load_dwordx4 v1, s[8:11], s50 offen lds
  ds_read_b64 v[26:27], v5 offset:800
  v_add_f32 v90, v90, v10
  v_add_f32 v90, v90, v11
  s_waitcnt lgkmcnt(12)
  v_mfma_f32_16x16x32_bf16 v[160:163], v[76:79], v[44:47], v[160:163]
  ds_read_b64_tr_b16 v[72:73], v93 offset:26720
  v_mfma_f32_16x16x32_bf16 v[164:167], v[76:79], v[48:51], v[164:167]
  ds_read_b64_tr_b16 v[74:75], v93 offset:30304
  v_mfma_f32_16x16x32_bf16 v[168:171], v[76:79], v[52:55], v[168:171]
  s_add_u32 s50, s26, 266240
  s_add_u32 m0, s24, 50960
  ds_read_b64_tr_b16 v[68:69], v93 offset:33856
  ds_read_b64 v[28:29], v5 offset:64
  v_mfma_f32_16x16x32_bf16 v[172:175], v[76:79], v[56:59], v[172:175]
  buffer_load_dwordx4 v1, s[8:11], s50 offen lds
  ds_read_b64_tr_b16 v[70:71], v93 offset:37440
  ds_read_b64 v[30:31], v5 offset:96
  s_waitcnt lgkmcnt(14)
  v_mfma_f32_16x16x32_bf16 v[188:191], v[60:63], v[56:59], v[188:191]
  ds_read_b64_tr_b16 v[76:77], v93 offset:33888
  v_mfma_f32_16x16x32_bf16 v[184:187], v[60:63], v[52:55], v[184:187]
  ds_read_b64_tr_b16 v[78:79], v93 offset:37472
  v_mfma_f32_16x16x32_bf16 v[180:183], v[60:63], v[48:51], v[180:183]
  v_mfma_f32_16x16x32_bf16 v[176:179], v[60:63], v[44:47], v[176:179]
  s_waitcnt lgkmcnt(12)
  v_mfma_f32_16x16x32_bf16 v[192:195], v[64:67], v[44:47], v[192:195]
  ds_read_b64_tr_b16 v[60:61], v7 offset:0
  v_lshlrev_b32 v10, 16, v64
  v_and_b32 v11, s79, v64
  v_mfma_f32_16x16x32_bf16 v[196:199], v[64:67], v[48:51], v[196:199]
  ds_read_b64_tr_b16 v[62:63], v7 offset:1024
  v_add_f32 v91, v91, v10
  v_add_f32 v91, v91, v11
  v_mfma_f32_16x16x32_bf16 v[200:203], v[64:67], v[52:55], v[200:203]
  ds_read_b64 v[32:33], v5 offset:320
  v_lshlrev_b32 v10, 16, v65
  v_and_b32 v11, s79, v65
  v_mfma_f32_16x16x32_bf16 v[204:207], v[64:67], v[56:59], v[204:207]
  ds_read_b64 v[34:35], v5 offset:352
  v_add_f32 v91, v91, v10
  v_add_f32 v91, v91, v11
  s_waitcnt lgkmcnt(7)
  v_mfma_f32_16x16x32_bf16 v[220:223], v[68:71], v[56:59], v[220:223]
  v_lshlrev_b32 v10, 16, v66
  v_and_b32 v11, s79, v66
  v_mfma_f32_16x16x32_bf16 v[216:219], v[68:71], v[52:55], v[216:219]
  v_add_f32 v91, v91, v10
  v_add_f32 v91, v91, v11
  v_mfma_f32_16x16x32_bf16 v[212:215], v[68:71], v[48:51], v[212:215]
  ds_read_b64 v[36:37], v5 offset:576
  v_lshlrev_b32 v10, 16, v67
  v_and_b32 v11, s79, v67
  v_mfma_f32_16x16x32_bf16 v[208:211], v[68:71], v[44:47], v[208:211]
  ds_read_b64 v[38:39], v5 offset:608
  v_add_f32 v91, v91, v10
  v_add_f32 v91, v91, v11
  v_mfma_f32_16x16x32_bf16 v[224:227], v[72:75], v[44:47], v[224:227]
  ds_read_b64_tr_b16 v[68:69], v6 offset:6144
  v_mfma_f32_16x16x32_bf16 v[228:231], v[72:75], v[48:51], v[228:231]
  ds_read_b64_tr_b16 v[70:71], v6 offset:9728
  v_mfma_f32_16x16x32_bf16 v[232:235], v[72:75], v[52:55], v[232:235]
  ds_read_b64_tr_b16 v[64:65], v8 offset:0
  ds_read_b64 v[40:41], v5 offset:832
  v_mfma_f32_16x16x32_bf16 v[236:239], v[72:75], v[56:59], v[236:239]
  ds_read_b64_tr_b16 v[66:67], v8 offset:1024
  ds_read_b64 v[42:43], v5 offset:864
  s_waitcnt lgkmcnt(12)
  v_mfma_f32_16x16x32_bf16 v[252:255], v[76:79], v[56:59], v[252:255]
  ds_read_b64_tr_b16 v[72:73], v6 offset:13312
  v_mfma_f32_16x16x32_bf16 v[248:251], v[76:79], v[52:55], v[248:251]
  ds_read_b64_tr_b16 v[74:75], v6 offset:16896
  v_mfma_f32_16x16x32_bf16 v[244:247], v[76:79], v[48:51], v[244:247]
  s_add_u32 s25, s25, 128
  s_cmp_ge_u32 s25, 2048
  s_cselect_b32 s26, 0x10000000, s25
  v_mfma_f32_16x16x32_bf16 v[240:243], v[76:79], v[44:47], v[240:243]
  s_waitcnt vmcnt(5) lgkmcnt(2)
  s_barrier
  s_sub_u32 s60, s60, 1
  s_cmp_lt_u32 s60, 2
  s_cbranch_scc1 L_loopt2
  s_call_b64 s[74:75], L_x_cpub_2
  s_cmp_gt_u32 s60, 2
  s_cbranch_scc1 L_loopp2
L_loopt2:
  s_cmp_lg_u32 s60, 0
  s_cbranch_scc1 L_loopc2
  s_branch L_epi0
L_x_drain_2:
  s_waitcnt vmcnt(0)
  s_setpc_b64 s[74:75]
L_x_rows_2:
  s_waitcnt vmcnt(0)
  v_lshlrev_b32 v10, 16, v80
  v_and_b32 v11, s79, v80
  v_mov_b32 v88, v10
  v_mov_b32 v89, v11
  v_lshlrev_b32 v10, 16, v81
  v_and_b32 v11, s79, v81
  v_add_f32 v88, v88, v10
  v_add_f32 v89, v89, v11
  v_lshlrev_b32 v10, 16, v82
  v_and_b32 v11, s79, v82
  v_add_f32 v88, v88, v10
  v_add_f32 v89, v89, v11
  v_lshlrev_b32 v10, 16, v83
  v_and_b32 v11, s79, v83
  v_add_f32 v88, v88, v10
  v_add_f32 v89, v89, v11
  v_lshlrev_b32 v10, 16, v84
  v_and_b32 v11, s79, v84
  v_add_f32 v88, v88, v10
  v_add_f32 v89, v89, v11
  v_lshlrev_b32 v10, 16, v85
  v_and_b32 v11, s79, v85
  v_add_f32 v88, v88, v10
  v_add_f32 v89, v89, v11
  v_lshlrev_b32 v10, 16, v86
  v_and_b32 v11, s79, v86
  v_add_f32 v88, v88, v10
  v_add_f32 v89, v89, v11
  v_lshlrev_b32 v10, 16, v87
  v_and_b32 v11, s79, v87
  v_add_f32 v88, v88, v10
  v_add_f32 v89, v89, v11
  v_add_f32 v88, v88, v89
  s_nop 1
  v_add_f32_dpp v88, v88, v88 quad_perm:[1,0,3,2] row_mask:0xf bank_mask:0xf
  s_nop 1
  v_add_f32_dpp v88, v88, v88 quad_perm:[2,3,0,1] row_mask:0xf bank_mask:0xf
  s_nop 1
  v_add_f32_dpp v88, v88, v88 row_half_mirror row_mask:0xf bank_mask:0xf
  s_nop 1
  v_add_f32_dpp v88, v88, v88 row_mirror row_mask:0xf bank_mask:0xf
  v_mov_b32 v10, v88
  s_nop 1
  v_permlane16_swap_b32 v88, v10
  s_nop 0
  v_add_f32 v88, v88, v10
  v_mov_b32 v10, v88
  s_nop 1
  v_permlane32_swap_b32 v88, v10
  s_nop 0
  v_add_f32 v88, v88, v10
  v_mul_f32 v88, 0xba800000, v88
  v_lshlrev_b32 v10, 16, v80
  v_and_b32 v11, s79, v80
  v_add_f32 v10, v10, v88
  v_add_f32 v11, v11, v88
  v_mul_f32 v89, v10, v10
  v_fmac_f32 v89, v11, v11
  v_lshlrev_b32 v10, 16, v81
  v_and_b32 v11, s79, v81
  v_add_f32 v10, v10, v88
  v_add_f32 v11, v11, v88
  v_fmac_f32 v89, v10, v10
  v_fmac_f32 v89, v11, v11
  v_lshlrev_b32 v10, 16, v82
  v_and_b32 v11, s79, v82
  v_add_f32 v10, v10, v88
  v_add_f32 v11, v11, v88
  v_fmac_f32 v89, v10, v10
  v_fmac_f32 v89, v11, v11
  v_lshlrev_b32 v10, 16, v83
  v_and_b32 v11, s79, v83
  v_add_f32 v10, v10, v88
  v_add_f32 v11, v11, v88
  v_fmac_f32 v89, v10, v10
  v_fmac_f32 v89, v11, v11
  v_lshlrev_b32 v10, 16, v84
  v_and_b32 v11, s79, v84
  v_add_f32 v10, v10, v88
  v_add_f32 v11, v11, v88
  v_fmac_f32 v89, v10, v10
  v_fmac_f32 v89, v11, v11
  v_lshlrev_b32 v10, 16, v85
  v_and_b32 v11, s79, v85
  v_add_f32 v10, v10, v88
  v_add_f32 v11, v11, v88
  v_fmac_f32 v89, v10, v10
  v_fmac_f32 v89, v11, v11
  v_lshlrev_b32 v10, 16, v86
  v_and_b32 v11, s79, v86
  v_add_f32 v10, v10, v88
  v_add_f32 v11, v11, v88
  v_fmac_f32 v89, v10, v10
  v_fmac_f32 v89, v11, v11
  v_lshlrev_b32 v10, 16, v87
  v_and_b32 v11, s79, v87
  v_add_f32 v10, v10, v88
  v_add_f32 v11, v11, v88
  v_fmac_f32 v89, v10, v10
  v_fmac_f32 v89, v11, v11
  s_nop 1
  v_add_f32_dpp v89, v89, v89 quad_perm:[1,0,3,2] row_mask:0xf bank_mask:0xf
  s_nop 1
  v_add_f32_dpp v89, v89, v89 quad_perm:[2,3,0,1] row_mask:0xf bank_mask:0xf
  s_nop 1
  v_add_f32_dpp v89, v89, v89 row_half_mirror row_mask:0xf bank_mask:0xf
  s_nop 1
  v_add_f32_dpp v89, v89, v89 row_mirror row_mask:0xf bank_mask:0xf
  v_mov_b32 v10, v89
  s_nop 1
  v_permlane16_swap_b32 v89, v10
  s_nop 0
  v_add_f32 v89, v89, v10
  v_mov_b32 v10, v89
  s_nop 1
  v_permlane32_swap_b32 v89, v10
  s_nop 0
  v_add_f32 v89, v89, v10
  v_mul_f32 v89, 0x3a800000, v89
  v_cvt_pk_bf16_f32 v10, v88, v89
  v_lshlrev_b32 v80, 16, v10
  v_and_b32 v89, s79, v10
  v_add_f32 v89, 0x3727c5ac, v89
  v_cvt_pk_bf16_f32 v89, v89, v89
  v_lshlrev_b32 v89, 16, v89
  v_sqrt_f32 v89, v89
  s_lshl_b32 s51, s2, 6
  v_cvt_pk_bf16_f32 v89, v89, v89
  s_add_u32 s51, s51, 51380240
  v_lshlrev_b32 v81, 16, v89
  s_mov_b64 exec, 1
  buffer_store_dwordx2 v[80:81], v0, s[64:67], s51 offen sc1
  s_mov_b64 exec, -1
  s_setpc_b64 s[74:75]
L_x_poll_2:
  v_and_b32 v89, 0x70, v9
  v_lshlrev_b32 v89, 1, v89
  buffer_load_dword v88, v89, s[56:59], 0 offen sc1
  s_setpc_b64 s[74:75]
L_x_stat_2:
  s_waitcnt vmcnt(0)
  v_cmp_ne_u32 vcc, 32, v88
  s_nop 4
  s_cbranch_vccz L_x_stat_2_go
  s_sleep 2
  v_and_b32 v89, 0x70, v9
  v_lshlrev_b32 v89, 1, v89
  buffer_load_dword v88, v89, s[56:59], 0 offen sc1
  s_branch L_x_stat_2
L_x_stat_2_go:
  s_lshl_b32 s51, s6, 8
  s_lshl_b32 s55, s7, 5
  s_add_u32 s51, s51, s55
  s_lshl_b32 s55, s3, 2
  s_add_u32 s51, s51, s55
  s_add_u32 s51, s51, 50376704
  v_mov_b32 v88, 1
  s_mov_b64 exec, 1
  buffer_store_dword v88, v0, s[64:67], s51 offen sc1
  s_mov_b64 exec, -1
  v_and_b32 v88, 0xf0, v9
  v_lshrrev_b32 v88, 1, v88
  s_lshl_b32 s51, s7, 11
  s_add_u32 s51, s51, 51381248
  buffer_load_dwordx2 v[80:81], v88, s[64:67], s51 offen offset:0 sc1
  buffer_load_dwordx2 v[82:83], v88, s[64:67], s51 offen offset:128 sc1
  buffer_load_dwordx2 v[84:85], v88, s[64:67], s51 offen offset:256 sc1
  buffer_load_dwordx2 v[86:87], v88, s[64:67], s51 offen offset:384 sc1
  s_setpc_b64 s[74:75]
L_x_cpub_2:
  v_mov_b32 v10, v90
  v_mov_b32 v11, v91
  v_mov_b32 v88, v92
  s_nop 1
  v_permlane16_swap_b32 v90, v10
  v_permlane16_swap_b32 v91, v11
  v_permlane16_swap_b32 v92, v88
  v_add_f32 v90, v90, v10
  v_add_f32 v91, v91, v11
  v_add_f32 v92, v92, v88
  v_mov_b32 v10, v90
  v_mov_b32 v11, v91
  v_mov_b32 v88, v92
  s_nop 1
  v_permlane32_swap_b32 v90, v10
  v_permlane32_swap_b32 v91, v11
  v_permlane32_swap_b32 v92, v88
  v_add_f32 v90, v90, v10
  v_add_f32 v91, v91, v11
  v_add_f32 v92, v92, v88
  v_and_b32 v89, 0xf0, v9
  v_lshrrev_b32 v89, 2, v89
  s_mul_i32 s51, s6, 7680
  s_mul_i32 s52, s7, 1280
  s_add_u32 s51, s51, s52
  s_add_u32 s51, s51, 52428928
  s_mov_b64 exec, 0xffff
  buffer_store_dword v90, v89, s[64:67], s51 offen offset:0 sc1
  buffer_store_dword v91, v89, s[64:67], s51 offen offset:256 sc1
  s_mov_b64 exec, -1
  s_nop 1
  v_mov_b32 v90, 0
  v_mov_b32 v91, 0
  v_mov_b32 v92, 0
  s_setpc_b64 s[74:75]
L_loop3:
  s_cmp_eq_u32 s60, s61
  s_cbranch_scc1 L_loopc3
L_loopp3:
  v_mfma_f32_16x16x32_bf16 v[96:99], v[60:63], v[12:15], v[96:99]
  ds_read_b64_tr_b16 v[76:77], v6 offset:6176
  v_mfma_f32_16x16x32_bf16 v[100:103], v[60:63], v[16:19], v[100:103]
  ds_read_b64_tr_b16 v[78:79], v6 offset:9760
  s_cmp_eq_u32 s60, 6
  s_cbranch_scc0 L_nx_25
  s_call_b64 s[74:75], L_x_drain_3
L_nx_25:
  v_mfma_f32_16x16x32_bf16 v[104:107], v[60:63], v[20:23], v[104:107]
  s_add_u32 m0, s33, 128000
  v_mfma_f32_16x16x32_bf16 v[108:111], v[60:63], v[24:27], v[108:111]
  buffer_load_dwordx4 v2, s[12:15], s27 offen lds
  s_add_u32 s27, s27, s30
  v_mfma_f32_16x16x32_bf16 v[124:127], v[64:67], v[24:27], v[124:127]
  ds_read_b64_tr_b16 v[60:61], v6 offset:13344
  v_mfma_f32_16x16x32_bf16 v[120:123], v[64:67], v[20:23], v[120:123]
  ds_read_b64_tr_b16 v[62:63], v6 offset:16928
  v_mfma_f32_16x16x32_bf16 v[116:119], v[64:67], v[16:19], v[116:119]
  s_add_u32 m0, s34, 128000
  v_mfma_f32_16x16x32_bf16 v[112:115], v[64:67], v[12:15], v[112:115]
  buffer_load_dwordx4 v3, s[16:19], s28 offen lds
  s_add_u32 s28, s28, s31
  s_waitcnt lgkmcnt(4)
  v_mfma_f32_16x16x32_bf16 v[128:131], v[68:71], v[12:15], v[128:131]
  ds_read_b64_tr_b16 v[64:65], v6 offset:6208
  v_mfma_f32_16x16x32_bf16 v[132:135], v[68:71], v[16:19], v[132:135]
  ds_read_b64_tr_b16 v[66:67], v6 offset:9792
  v_mfma_f32_16x16x32_bf16 v[136:139], v[68:71], v[20:23], v[136:139]
  s_add_u32 m0, s35, 128000
  v_mfma_f32_16x16x32_bf16 v[140:143], v[68:71], v[24:27], v[140:143]
  buffer_load_dwordx4 v4, s[20:23], s29 offen lds
  s_add_u32 s29, s29, s32
  v_mfma_f32_16x16x32_bf16 v[156:159], v[72:75], v[24:27], v[156:159]
  ds_read_b64_tr_b16 v[68:69], v6 offset:13376
  v_mfma_f32_16x16x32_bf16 v[152:155], v[72:75], v[20:23], v[152:155]
  ds_read_b64_tr_b16 v[70:71], v6 offset:16960
  v_mfma_f32_16x16x32_bf16 v[148:151], v[72:75], v[16:19], v[148:151]
  s_add_u32 s50, s26, 0
  s_add_u32 m0, s24, 0
  v_mfma_f32_16x16x32_bf16 v[144:147], v[72:75], v[12:15], v[144:147]
  buffer_load_dwordx4 v1, s[8:11], s50 offen lds
  s_waitcnt lgkmcnt(6)
  v_mfma_f32_16x16x32_bf16 v[160:163], v[76:79], v[12:15], v[160:163]
  v_mfma_f32_16x16x32_bf16 v[164:167], v[76:79], v[16:19], v[164:167]
  v_mfma_f32_16x16x32_bf16 v[168:171], v[76:79], v[20:23], v[168:171]
  s_add_u32 s50, s26, 4096
  s_add_u32 m0, s24, 1040
  v_mfma_f32_16x16x32_bf16 v[172:175], v[76:79], v[24:27], v[172:175]
  buffer_load_dwordx4 v1, s[8:11], s50 offen lds
  s_waitcnt lgkmcnt(4)
  v_mfma_f32_16x16x32_bf16 v[188:191], v[60:63], v[24:27], v[188:191]
  ds_read_b64_tr_b16 v[76:77], v6 offset:13408
  v_mfma_f32_16x16x32_bf16 v[184:187], v[60:63], v[20:23], v[184:187]
  ds_read_b64_tr_b16 v[78:79], v6 offset:16992
  v_mfma_f32_16x16x32_bf16 v[180:183], v[60:63], v[16:19], v[180:183]
  ds_read_b64_tr_b16 v[72:73], v6 offset:6240
  v_mfma_f32_16x16x32_bf16 v[176:179], v[60:63], v[12:15], v[176:179]
  ds_read_b64_tr_b16 v[74:75], v6 offset:9824
  s_waitcnt lgkmcnt(6)
  v_mfma_f32_16x16x32_bf16 v[192:195], v[64:67], v[12:15], v[192:195]
  ds_read_b64_tr_b16 v[60:61], v7 offset:20480
  v_mfma_f32_16x16x32_bf16 v[196:199], v[64:67], v[16:19], v[196:199]
  ds_read_b64_tr_b16 v[62:63], v7 offset:21504
  v_mfma_f32_16x16x32_bf16 v[200:203], v[64:67], v[20:23], v[200:203]
  v_mfma_f32_16x16x32_bf16 v[204:207], v[64:67], v[24:27], v[204:207]
  s_waitcnt lgkmcnt(6)
  v_mfma_f32_16x16x32_bf16 v[220:223], v[68:71], v[24:27], v[220:223]
  ds_read_b64_tr_b16 v[64:65], v8 offset:20480
  v_mfma_f32_16x16x32_bf16 v[216:219], v[68:71], v[20:23], v[216:219]
  ds_read_b64_tr_b16 v[66:67], v8 offset:21504
  v_mfma_f32_16x16x32_bf16 v[212:215], v[68:71], v[16:19], v[212:215]
  v_mfma_f32_16x16x32_bf16 v[208:211], v[68:71], v[12:15], v[208:211]
  s_waitcnt lgkmcnt(4)
  v_mfma_f32_16x16x32_bf16 v[224:227], v[72:75], v[12:15], v[224:227]
  v_mfma_f32_16x16x32_bf16 v[228:231], v[72:75], v[16:19], v[228:231]
  v_mfma_f32_16x16x32_bf16 v[232:235], v[72:75], v[20:23], v[232:235]
  v_mfma_f32_16x16x32_bf16 v[236:239], v[72:75], v[24:27], v[236:239]
  s_cmp_eq_u32 s60, 2
  s_cbranch_scc0 L_nx_26
  s_call_b64 s[74:75], L_x_poll_3
L_nx_26:
  v_mfma_f32_16x16x32_bf16 v[252:255], v[76:79], v[24:27], v[252:255]
  ds_read_b64_tr_b16 v[72:73], v6 offset:33792
  v_mfma_f32_16x16x32_bf16 v[248:251], v[76:79], v[20:23], v[248:251]
  ds_read_b64_tr_b16 v[74:75], v6 offset:37376
  v_mfma_f32_16x16x32_bf16 v[244:247], v[76:79], v[16:19], v[244:247]
  ds_read_b64_tr_b16 v[68:69], v6 offset:26624
  v_mfma_f32_16x16x32_bf16 v[240:243], v[76:79], v[12:15], v[240:243]
  ds_read_b64_tr_b16 v[70:71], v6 offset:30208
  s_waitcnt vmcnt(5)
  s_barrier
  s_waitcnt lgkmcnt(6)
  v_mfma_f32_16x16x32_bf16 v[96:99], v[60:63], v[28:31], v[96:99]
  ds_read_b64_tr_b16 v[76:77], v6 offset:26656
  v_mfma_f32_16x16x32_bf16 v[100:103], v[60:63], v[32:35], v[100:103]
  ds_read_b64_tr_b16 v[78:79], v6 offset:30240
  v_mfma_f32_16x16x32_bf16 v[104:107], v[60:63], v[36:39], v[104:107]
  s_add_u32 m0, s33, 66560
  ds_read_b64 v[12:13], v5 offset:33280
  v_mfma_f32_16x16x32_bf16 v[108:111], v[60:63], v[40:43], v[108:111]
  buffer_load_dwordx4 v2, s[12:15], s27 offen lds
  s_add_u32 s27, s27, s30
  ds_read_b64 v[14:15], v5 offset:33312
  s_waitcnt lgkmcnt(8)
  v_mfma_f32_16x16x32_bf16 v[124:127], v[64:67], v[40:43], v[124:127]
  ds_read_b64_tr_b16 v[60:61], v6 offset:33824
  v_mfma_f32_16x16x32_bf16 v[120:123], v[64:67], v[36:39], v[120:123]
  ds_read_b64_tr_b16 v[62:63], v6 offset:37408
  v_mfma_f32_16x16x32_bf16 v[116:119], v[64:67], v[32:35], v[116:119]
  s_add_u32 m0, s34, 66560
  ds_read_b64 v[16:17], v5 offset:33536
  v_mfma_f32_16x16x32_bf16 v[112:115], v[64:67], v[28:31], v[112:115]
  buffer_load_dwordx4 v3, s[16:19], s28 offen lds
  s_add_u32 s28, s28, s31
  ds_read_b64 v[18:19], v5 offset:33568
  s_waitcnt lgkmcnt(8)
  v_mfma_f32_16x16x32_bf16 v[128:131], v[68:71], v[28:31], v[128:131]
  ds_read_b64_tr_b16 v[64:65], v6 offset:26688
  v_mfma_f32_16x16x32_bf16 v[132:135], v[68:71], v[32:35], v[132:135]
  ds_read_b64_tr_b16 v[66:67], v6 offset:30272
  v_mfma_f32_16x16x32_bf16 v[136:139], v[68:71], v[36:39], v[136:139]
  s_add_u32 m0, s35, 66560
  ds_read_b64 v[20:21], v5 offset:33792
  v_mfma_f32_16x16x32_bf16 v[140:143], v[68:71], v[40:43], v[140:143]
  buffer_load_dwordx4 v4, s[20:23], s29 offen lds
  s_add_u32 s29, s29, s32
  ds_read_b64 v[22:23], v5 offset:33824
  v_mfma_f32_16x16x32_bf16 v[156:159], v[72:75], v[40:43], v[156:159]
  ds_read_b64_tr_b16 v[68:69], v6 offset:33856
  v_mfma_f32_16x16x32_bf16 v[152:155], v[72:75], v[36:39], v[152:155]
  ds_read_b64_tr_b16 v[70:71], v6 offset:37440
  v_mfma_f32_16x16x32_bf16 v[148:151], v[72:75], v[32:35], v[148:151]
  s_add_u32 s50, s26, 262144
  s_add_u32 m0, s24, 16640
  ds_read_b64 v[24:25], v5 offset:34048
  v_mfma_f32_16x16x32_bf16 v[144:147], v[72:75], v[28:31], v[144:147]
  buffer_load_dwordx4 v1, s[8:11], s50 offen lds
  ds_read_b64 v[26:27], v5 offset:34080
  s_waitcnt lgkmcnt(14)
  v_mfma_f32_16x16x32_bf16 v[160:163], v[76:79], v[28:31], v[160:163]
  v_mfma_f32_16x16x32_bf16 v[164:167], v[76:79], v[32:35], v[164:167]
  v_mfma_f32_16x16x32_bf16 v[168:171], v[76:79], v[36:39], v[168:171]
  s_add_u32 s50, s26, 266240
  s_add_u32 m0, s24, 17680
  ds_read_b64 v[44:45], v5 offset:33344
  v_mfma_f32_16x16x32_bf16 v[172:175], v[76:79], v[40:43], v[172:175]
  buffer_load_dwordx4 v1, s[8:11], s50 offen lds
  ds_read_b64 v[46:47], v5 offset:33376
  s_waitcnt lgkmcnt(12)
  v_mfma_f32_16x16x32_bf16 v[188:191], v[60:63], v[40:43], v[188:191]
  ds_read_b64_tr_b16 v[76:77], v6 offset:33888
  v_mfma_f32_16x16x32_bf16 v[184:187], v[60:63], v[36:39], v[184:187]
  ds_read_b64_tr_b16 v[78:79], v6 offset:37472
  v_mfma_f32_16x16x32_bf16 v[180:183], v[60:63], v[32:35], v[180:183]
  ds_read_b64_tr_b16 v[72:73], v6 offset:26720
  v_mfma_f32_16x16x32_bf16 v[176:179], v[60:63], v[28:31], v[176:179]
  ds_read_b64_tr_b16 v[74:75], v6 offset:30304
  s_waitcnt lgkmcnt(12)
  v_mfma_f32_16x16x32_bf16 v[192:195], v[64:67], v[28:31], v[192:195]
  ds_read_b64_tr_b16 v[60:61], v94 offset:0
  v_mfma_f32_16x16x32_bf16 v[196:199], v[64:67], v[32:35], v[196:199]
  ds_read_b64_tr_b16 v[62:63], v94 offset:1024
  v_mfma_f32_16x16x32_bf16 v[200:203], v[64:67], v[36:39], v[200:203]
  ds_read_b64 v[48:49], v5 offset:33600
  v_mfma_f32_16x16x32_bf16 v[204:207], v[64:67], v[40:43], v[204:207]
  ds_read_b64 v[50:51], v5 offset:33632
  s_waitcnt lgkmcnt(12)
  v_mfma_f32_16x16x32_bf16 v[220:223], v[68:71], v[40:43], v[220:223]
  ds_read_b64_tr_b16 v[64:65], v95 offset:0
  v_mfma_f32_16x16x32_bf16 v[216:219], v[68:71], v[36:39], v[216:219]
  ds_read_b64_tr_b16 v[66:67], v95 offset:1024
  v_mfma_f32_16x16x32_bf16 v[212:215], v[68:71], v[32:35], v[212:215]
  ds_read_b64 v[52:53], v5 offset:33856
  v_mfma_f32_16x16x32_bf16 v[208:211], v[68:71], v[28:31], v[208:211]
  ds_read_b64 v[54:55], v5 offset:33888
  s_waitcnt lgkmcnt(8)
  v_mfma_f32_16x16x32_bf16 v[224:227], v[72:75], v[28:31], v[224:227]
  v_mfma_f32_16x16x32_bf16 v[228:231], v[72:75], v[32:35], v[228:231]
  v_mfma_f32_16x16x32_bf16 v[232:235], v[72:75], v[36:39], v[232:235]
  ds_read_b64 v[56:57], v5 offset:34112
  v_mfma_f32_16x16x32_bf16 v[236:239], v[72:75], v[40:43], v[236:239]
  ds_read_b64 v[58:59], v5 offset:34144
  v_mfma_f32_16x16x32_bf16 v[252:255], v[76:79], v[40:43], v[252:255]
  ds_read_b64_tr_b16 v[72:73], v93 offset:13312
  v_mfma_f32_16x16x32_bf16 v[248:251], v[76:79], v[36:39], v[248:251]
  ds_read_b64_tr_b16 v[74:75], v93 offset:16896
  v_mfma_f32_16x16x32_bf16 v[244:247], v[76:79], v[32:35], v[244:247]
  ds_read_b64_tr_b16 v[68:69], v93 offset:6144
  s_add_u32 s25, s25, 128
  s_cmp_ge_u32 s25, 2048
  s_cselect_b32 s26, 0x10000000, s25
  v_mfma_f32_16x16x32_bf16 v[240:243], v[76:79], v[28:31], v[240:243]
  ds_read_b64_tr_b16 v[70:71], v93 offset:9728
  s_waitcnt vmcnt(5) lgkmcnt(4)
  s_barrier
  v_mfma_f32_16x16x32_bf16 v[96:99], v[60:63], v[12:15], v[96:99]
  ds_read_b64_tr_b16 v[76:77], v93 offset:6176
  v_mfma_f32_16x16x32_bf16 v[100:103], v[60:63], v[16:19], v[100:103]
  ds_read_b64_tr_b16 v[78:79], v93 offset:9760
  s_cmp_eq_u32 s60, 2
  s_cbranch_scc0 L_nx_27
  s_call_b64 s[74:75], L_x_stat_3
L_nx_27:
  s_cmp_eq_u32 s60, 8
  s_cbranch_scc0 L_nx_28
  s_call_b64 s[74:75], L_x_rows_3
L_nx_28:
  v_mfma_f32_16x16x32_bf16 v[104:107], v[60:63], v[20:23], v[104:107]
  s_add_u32 m0, s33, 87040
  v_mfma_f32_16x16x32_bf16 v[108:111], v[60:63], v[24:27], v[108:111]
  buffer_load_dwordx4 v2, s[12:15], s27 offen lds
  s_add_u32 s27, s27, s30
  v_mfma_f32_16x16x32_bf16 v[124:127], v[64:67], v[24:27], v[124:127]
  ds_read_b64_tr_b16 v[60:61], v93 offset:13344
  v_mfma_f32_16x16x32_bf16 v[120:123], v[64:67], v[20:23], v[120:123]
  ds_read_b64_tr_b16 v[62:63], v93 offset:16928
  v_mfma_f32_16x16x32_bf16 v[116:119], v[64:67], v[16:19], v[116:119]
  s_add_u32 m0, s34, 87040
  v_mfma_f32_16x16x32_bf16 v[112:115], v[64:67], v[12:15], v[112:115]
  buffer_load_dwordx4 v3, s[16:19], s28 offen lds
  s_add_u32 s28, s28, s31
  s_waitcnt lgkmcnt(4)
  v_mfma_f32_16x16x32_bf16 v[128:131], v[68:71], v[12:15], v[128:131]
  ds_read_b64_tr_b16 v[64:65], v93 offset:6208
  v_mfma_f32_16x16x32_bf16 v[132:135], v[68:71], v[16:19], v[132:135]
  ds_read_b64_tr_b16 v[66:67], v93 offset:9792
  v_mfma_f32_16x16x32_bf16 v[136:139], v[68:71], v[20:23], v[136:139]
  s_add_u32 m0, s35, 87040
  v_mfma_f32_16x16x32_bf16 v[140:143], v[68:71], v[24:27], v[140:143]
  buffer_load_dwordx4 v4, s[20:23], s29 offen lds
  s_add_u32 s29, s29, s32
  v_mfma_f32_16x16x32_bf16 v[156:159], v[72:75], v[24:27], v[156:159]
  ds_read_b64_tr_b16 v[68:69], v93 offset:13376
  v_mfma_f32_16x16x32_bf16 v[152:155], v[72:75], v[20:23], v[152:155]
  ds_read_b64_tr_b16 v[70:71], v93 offset:16960
  v_mfma_f32_16x16x32_bf16 v[148:151], v[72:75], v[16:19], v[148:151]
  s_add_u32 s50, s26, 0
  s_add_u32 m0, s24, 33280
  v_mfma_f32_16x16x32_bf16 v[144:147], v[72:75], v[12:15], v[144:147]
  buffer_load_dwordx4 v1, s[8:11], s50 offen lds
  s_waitcnt lgkmcnt(6)
  v_mfma_f32_16x16x32_bf16 v[160:163], v[76:79], v[12:15], v[160:163]
  v_mfma_f32_16x16x32_bf16 v[164:167], v[76:79], v[16:19], v[164:167]
  v_mfma_f32_16x16x32_bf16 v[168:171], v[76:79], v[20:23], v[168:171]
  s_add_u32 s50, s26, 4096
  s_add_u32 m0, s24, 34320
  v_mfma_f32_16x16x32_bf16 v[172:175], v[76:79], v[24:27], v[172:175]
  buffer_load_dwordx4 v1, s[8:11], s50 offen lds
  s_waitcnt lgkmcnt(4)
  v_mfma_f32_16x16x32_bf16 v[188:191], v[60:63], v[24:27], v[188:191]
  ds_read_b64_tr_b16 v[76:77], v93 offset:13408
  v_mfma_f32_16x16x32_bf16 v[184:187], v[60:63], v[20:23], v[184:187]
  ds_read_b64_tr_b16 v[78:79], v93 offset:16992
  v_mfma_f32_16x16x32_bf16 v[180:183], v[60:63], v[16:19], v[180:183]
  ds_read_b64_tr_b16 v[72:73], v93 offset:6240
  v_mfma_f32_16x16x32_bf16 v[176:179], v[60:63], v[12:15], v[176:179]
  ds_read_b64_tr_b16 v[74:75], v93 offset:9824
  s_waitcnt lgkmcnt(6)
  v_mfma_f32_16x16x32_bf16 v[192:195], v[64:67], v[12:15], v[192:195]
  ds_read_b64_tr_b16 v[60:61], v94 offset:20480
  v_mfma_f32_16x16x32_bf16 v[196:199], v[64:67], v[16:19], v[196:199]
  ds_read_b64_tr_b16 v[62:63], v94 offset:21504
  v_mfma_f32_16x16x32_bf16 v[200:203], v[64:67], v[20:23], v[200:203]
  v_mfma_f32_16x16x32_bf16 v[204:207], v[64:67], v[24:27], v[204:207]
  s_waitcnt lgkmcnt(6)
  v_mfma_f32_16x16x32_bf16 v[220:223], v[68:71], v[24:27], v[220:223]
  ds_read_b64_tr_b16 v[64:65], v95 offset:20480
  v_mfma_f32_16x16x32_bf16 v[216:219], v[68:71], v[20:23], v[216:219]
  ds_read_b64_tr_b16 v[66:67], v95 offset:21504
  v_mfma_f32_16x16x32_bf16 v[212:215], v[68:71], v[16:19], v[212:215]
  v_mfma_f32_16x16x32_bf16 v[208:211], v[68:71], v[12:15], v[208:211]
  s_waitcnt lgkmcnt(4)
  v_mfma_f32_16x16x32_bf16 v[224:227], v[72:75], v[12:15], v[224:227]
  v_mfma_f32_16x16x32_bf16 v[228:231], v[72:75], v[16:19], v[228:231]
  v_mfma_f32_16x16x32_bf16 v[232:235], v[72:75], v[20:23], v[232:235]
  v_mfma_f32_16x16x32_bf16 v[236:239], v[72:75], v[24:27], v[236:239]
  v_mfma_f32_16x16x32_bf16 v[252:255], v[76:79], v[24:27], v[252:255]
  ds_read_b64_tr_b16 v[72:73], v93 offset:33792
  v_mfma_f32_16x16x32_bf16 v[248:251], v[76:79], v[20:23], v[248:251]
  ds_read_b64_tr_b16 v[74:75], v93 offset:37376
  v_mfma_f32_16x16x32_bf16 v[244:247], v[76:79], v[16:19], v[244:247]
  ds_read_b64_tr_b16 v[68:69], v93 offset:26624
  v_mfma_f32_16x16x32_bf16 v[240:243], v[76:79], v[12:15], v[240:243]
  ds_read_b64_tr_b16 v[70:71], v93 offset:30208
  s_waitcnt vmcnt(5)
  s_barrier
  s_waitcnt lgkmcnt(6)
  v_mfma_f32_16x16x32_bf16 v[96:99], v[60:63], v[44:47], v[96:99]
  ds_read_b64_tr_b16 v[76:77], v93 offset:26656
  v_mfma_f32_16x16x32_bf16 v[100:103], v[60:63], v[48:51], v[100:103]
  ds_read_b64_tr_b16 v[78:79], v93 offset:30240
  v_mfma_f32_16x16x32_bf16 v[104:107], v[60:63], v[52:55], v[104:107]
  s_add_u32 m0, s33, 107520
  ds_read_b64 v[12:13], v5 offset:0
  v_mfma_f32_16x16x32_bf16 v[108:111], v[60:63], v[56:59], v[108:111]
  buffer_load_dwordx4 v2, s[12:15], s27 offen lds
  s_add_u32 s27, s27, s30
  ds_read_b64 v[14:15], v5 offset:32
  s_waitcnt lgkmcnt(8)
  v_mfma_f32_16x16x32_bf16 v[124:127], v[64:67], v[56:59], v[124:127]
  ds_read_b64_tr_b16 v[60:61], v93 offset:33824
  v_mfma_f32_16x16x32_bf16 v[120:123], v[64:67], v[52:55], v[120:123]
  ds_read_b64_tr_b16 v[62:63], v93 offset:37408
  v_mfma_f32_16x16x32_bf16 v[116:119], v[64:67], v[48:51], v[116:119]
  s_add_u32 m0, s34, 107520
  ds_read_b64 v[16:17], v5 offset:256
  v_mfma_f32_16x16x32_bf16 v[112:115], v[64:67], v[44:47], v[112:115]
  buffer_load_dwordx4 v3, s[16:19], s28 offen lds
  s_add_u32 s28, s28, s31
  ds_read_b64 v[18:19], v5 offset:288
  s_waitcnt lgkmcnt(8)
  v_mfma_f32_16x16x32_bf16 v[128:131], v[68:71], v[44:47], v[128:131]
  ds_read_b64_tr_b16 v[64:65], v93 offset:26688
  v_mfma_f32_16x16x32_bf16 v[132:135], v[68:71], v[48:51], v[132:135]
  ds_read_b64_tr_b16 v[66:67], v93 offset:30272
  v_mfma_f32_16x16x32_bf16 v[136:139], v[68:71], v[52:55], v[136:139]
  s_add_u32 m0, s35, 107520
  ds_read_b64 v[20:21], v5 offset:512
  v_mfma_f32_16x16x32_bf16 v[140:143], v[68:71], v[56:59], v[140:143]
  buffer_load_dwordx4 v4, s[20:23], s29 offen lds
  s_add_u32 s29, s29, s32
  ds_read_b64 v[22:23], v5 offset:544
  v_mfma_f32_16x16x32_bf16 v[156:159], v[72:75], v[56:59], v[156:159]
  ds_read_b64_tr_b16 v[68:69], v93 offset:33856
  v_mfma_f32_16x16x32_bf16 v[152:155], v[72:75], v[52:55], v[152:155]
  ds_read_b64_tr_b16 v[70:71], v93 offset:37440
  v_mfma_f32_16x16x32_bf16 v[148:151], v[72:75], v[48:51], v[148:151]
  s_add_u32 s50, s26, 262144
  s_add_u32 m0, s24, 49920
  ds_read_b64 v[24:25], v5 offset:768
  v_mfma_f32_16x16x32_bf16 v[144:147], v[72:75], v[44:47], v[144:147]
  buffer_load_dwordx4 v1, s[8:11], s50 offen lds
  ds_read_b64 v[26:27], v5 offset:800
  s_waitcnt lgkmcnt(14)
  v_mfma_f32_16x16x32_bf16 v[160:163], v[76:79], v[44:47], v[160:163]
  v_mfma_f32_16x16x32_bf16 v[164:167], v[76:79], v[48:51], v[164:167]
  v_mfma_f32_16x16x32_bf16 v[168:171], v[76:79], v[52:55], v[168:171]
  s_add_u32 s50, s26, 266240
  s_add_u32 m0, s24, 50960
  ds_read_b64 v[28:29], v5 offset:64
  v_mfma_f32_16x16x32_bf16 v[172:175], v[76:79], v[56:59], v[172:175]
  buffer_load_dwordx4 v1, s[8:11], s50 offen lds
  ds_read_b64 v[30:31], v5 offset:96
  s_waitcnt lgkmcnt(12)
  v_mfma_f32_16x16x32_bf16 v[188:191], v[60:63], v[56:59], v[188:191]
  ds_read_b64_tr_b16 v[76:77], v93 offset:33888
  v_mfma_f32_16x16x32_bf16 v[184:187], v[60:63], v[52:55], v[184:187]
  ds_read_b64_tr_b16 v[78:79], v93 offset:37472
  v_mfma_f32_16x16x32_bf16 v[180:183], v[60:63], v[48:51], v[180:183]
  ds_read_b64_tr_b16 v[72:73], v93 offset:26720
  v_mfma_f32_16x16x32_bf16 v[176:179], v[60:63], v[44:47], v[176:179]
  ds_read_b64_tr_b16 v[74:75], v93 offset:30304
  s_waitcnt lgkmcnt(12)
  v_mfma_f32_16x16x32_bf16 v[192:195], v[64:67], v[44:47], v[192:195]
  ds_read_b64_tr_b16 v[60:61], v7 offset:0
  v_mfma_f32_16x16x32_bf16 v[196:199], v[64:67], v[48:51], v[196:199]
  ds_read_b64_tr_b16 v[62:63], v7 offset:1024
  v_mfma_f32_16x16x32_bf16 v[200:203], v[64:67], v[52:55], v[200:203]
  ds_read_b64 v[32:33], v5 offset:320
  v_mfma_f32_16x16x32_bf16 v[204:207], v[64:67], v[56:59], v[204:207]
  ds_read_b64 v[34:35], v5 offset:352
  s_waitcnt lgkmcnt(12)
  v_mfma_f32_16x16x32_bf16 v[220:223], v[68:71], v[56:59], v[220:223]
  ds_read_b64_tr_b16 v[64:65], v8 offset:0
  v_mfma_f32_16x16x32_bf16 v[216:219], v[68:71], v[52:55], v[216:219]
  ds_read_b64_tr_b16 v[66:67], v8 offset:1024
  v_mfma_f32_16x16x32_bf16 v[212:215], v[68:71], v[48:51], v[212:215]
  ds_read_b64 v[36:37], v5 offset:576
  v_mfma_f32_16x16x32_bf16 v[208:211], v[68:71], v[44:47], v[208:211]
  ds_read_b64 v[38:39], v5 offset:608
  s_waitcnt lgkmcnt(8)
  v_mfma_f32_16x16x32_bf16 v[224:227], v[72:75], v[44:47], v[224:227]
  v_mfma_f32_16x16x32_bf16 v[228:231], v[72:75], v[48:51], v[228:231]
  v_mfma_f32_16x16x32_bf16 v[232:235], v[72:75], v[52:55], v[232:235]
  ds_read_b64 v[40:41], v5 offset:832
  v_mfma_f32_16x16x32_bf16 v[236:239], v[72:75], v[56:59], v[236:239]
  ds_read_b64 v[42:43], v5 offset:864
  v_mfma_f32_16x16x32_bf16 v[252:255], v[76:79], v[56:59], v[252:255]
  ds_read_b64_tr_b16 v[72:73], v6 offset:13312
  v_mfma_f32_16x16x32_bf16 v[248:251], v[76:79], v[52:55], v[248:251]
  ds_read_b64_tr_b16 v[74:75], v6 offset:16896
  v_mfma_f32_16x16x32_bf16 v[244:247], v[76:79], v[48:51], v[244:247]
  ds_read_b64_tr_b16 v[68:69], v6 offset:6144
  s_add_u32 s25, s25, 128
  s_cmp_ge_u32 s25, 2048
  s_cselect_b32 s26, 0x10000000, s25
  v_mfma_f32_16x16x32_bf16 v[240:243], v[76:79], v[44:47], v[240:243]
  ds_read_b64_tr_b16 v[70:71], v6 offset:9728
  s_waitcnt vmcnt(5) lgkmcnt(4)
  s_barrier
  s_sub_u32 s60, s60, 1
  s_cmp_gt_u32 s60, 2
  s_cbranch_scc1 L_loop3
L_loopc3:
  v_mfma_f32_16x16x32_bf16 v[96:99], v[60:63], v[12:15], v[96:99]
  ds_read_b64_tr_b16 v[76:77], v6 offset:6176
  v_mfma_f32_16x16x32_bf16 v[100:103], v[60:63], v[16:19], v[100:103]
  ds_read_b64_tr_b16 v[78:79], v6 offset:9760
  s_cmp_eq_u32 s60, 6
  s_cbranch_scc0 L_nx_29
  s_call_b64 s[74:75], L_x_drain_3
L_nx_29:
  v_mfma_f32_16x16x32_bf16 v[104:107], v[60:63], v[20:23], v[104:107]
  s_add_u32 m0, s33, 128000
  v_mfma_f32_16x16x32_bf16 v[108:111], v[60:63], v[24:27], v[108:111]
  buffer_load_dwordx4 v2, s[12:15], s27 offen lds
  s_add_u32 s27, s27, s30
  v_mfma_f32_16x16x32_bf16 v[124:127], v[64:67], v[24:27], v[124:127]
  ds_read_b64_tr_b16 v[60:61], v6 offset:13344
  v_mfma_f32_16x16x32_bf16 v[120:123], v[64:67], v[20:23], v[120:123]
  ds_read_b64_tr_b16 v[62:63], v6 offset:16928
  v_mfma_f32_16x16x32_bf16 v[116:119], v[64:67], v[16:19], v[116:119]
  s_add_u32 m0, s34, 128000
  v_mfma_f32_16x16x32_bf16 v[112:115], v[64:67], v[12:15], v[112:115]
  buffer_load_dwordx4 v3, s[16:19], s28 offen lds
  s_add_u32 s28, s28, s31
  s_waitcnt lgkmcnt(4)
  v_mfma_f32_16x16x32_bf16 v[128:131], v[68:71], v[12:15], v[128:131]
  ds_read_b64_tr_b16 v[64:65], v6 offset:6208
  v_mfma_f32_16x16x32_bf16 v[132:135], v[68:71], v[16:19], v[132:135]
  ds_read_b64_tr_b16 v[66:67], v6 offset:9792
  v_mfma_f32_16x16x32_bf16 v[136:139], v[68:71], v[20:23], v[136:139]
  s_add_u32 m0, s35, 128000
  v_mfma_f32_16x16x32_bf16 v[140:143], v[68:71], v[24:27], v[140:143]
  buffer_load_dwordx4 v4, s[20:23], s29 offen lds
  s_add_u32 s29, s29, s32
  v_mfma_f32_16x16x32_bf16 v[156:159], v[72:75], v[24:27], v[156:159]
  ds_read_b64_tr_b16 v[68:69], v6 offset:13376
  v_lshlrev_b32 v10, 16, v72
  v_and_b32 v11, s79, v72
  v_mfma_f32_16x16x32_bf16 v[152:155], v[72:75], v[20:23], v[152:155]
  ds_read_b64_tr_b16 v[70:71], v6 offset:16960
  v_add_f32 v90, v90, v10
  v_add_f32 v90, v90, v11
  v_mfma_f32_16x16x32_bf16 v[148:151], v[72:75], v[16:19], v[148:151]
  s_add_u32 s50, s26, 0
  s_add_u32 m0, s24, 0
  v_lshlrev_b32 v10, 16, v73
  v_and_b32 v11, s79, v73
  v_mfma_f32_16x16x32_bf16 v[144:147], v[72:75], v[12:15], v[144:147]
  buffer_load_dwordx4 v1, s[8:11], s50 offen lds
  v_add_f32 v90, v90, v10
  v_add_f32 v90, v90, v11
  s_waitcnt lgkmcnt(6)
  v_mfma_f32_16x16x32_bf16 v[160:163], v[76:79], v[12:15], v[160:163]
  v_lshlrev_b32 v10, 16, v74
  v_and_b32 v11, s79, v74
  v_mfma_f32_16x16x32_bf16 v[164:167], v[76:79], v[16:19], v[164:167]
  v_add_f32 v90, v90, v10
  v_add_f32 v90, v90, v11
  v_mfma_f32_16x16x32_bf16 v[168:171], v[76:79], v[20:23], v[168:171]
  s_add_u32 s50, s26, 4096
  s_add_u32 m0, s24, 1040
  v_lshlrev_b32 v10, 16, v75
  v_and_b32 v11, s79, v75
  v_mfma_f32_16x16x32_bf16 v[172:175], v[76:79], v[24:27], v[172:175]
  buffer_load_dwordx4 v1, s[8:11], s50 offen lds
  v_add_f32 v90, v90, v10
  v_add_f32 v90, v90, v11
  s_waitcnt lgkmcnt(4)
  v_mfma_f32_16x16x32_bf16 v[188:191], v[60:63], v[24:27], v[188:191]
  ds_read_b64_tr_b16 v[76:77], v6 offset:13408
  v_mfma_f32_16x16x32_bf16 v[184:187], v[60:63], v[20:23], v[184:187]
  ds_read_b64_tr_b16 v[78:79], v6 offset:16992
  v_mfma_f32_16x16x32_bf16 v[180:183], v[60:63], v[16:19], v[180:183]
  ds_read_b64_tr_b16 v[72:73], v6 offset:6240
  v_mfma_f32_16x16x32_bf16 v[176:179], v[60:63], v[12:15], v[176:179]
  ds_read_b64_tr_b16 v[74:75], v6 offset:9824
  s_waitcnt lgkmcnt(6)
  v_mfma_f32_16x16x32_bf16 v[192:195], v[64:67], v[12:15], v[192:195]
  ds_read_b64_tr_b16 v[60:61], v7 offset:20480
  v_mfma_f32_16x16x32_bf16 v[196:199], v[64:67], v[16:19], v[196:199]
  ds_read_b64_tr_b16 v[62:63], v7 offset:21504
  v_mfma_f32_16x16x32_bf16 v[200:203], v[64:67], v[20:23], v[200:203]
  v_mfma_f32_16x16x32_bf16 v[204:207], v[64:67], v[24:27], v[204:207]
  s_waitcnt lgkmcnt(6)
  v_mfma_f32_16x16x32_bf16 v[220:223], v[68:71], v[24:27], v[220:223]
  ds_read_b64_tr_b16 v[64:65], v8 offset:20480
  v_lshlrev_b32 v10, 16, v68
  v_and_b32 v11, s79, v68
  v_mfma_f32_16x16x32_bf16 v[216:219], v[68:71], v[20:23], v[216:219]
  ds_read_b64_tr_b16 v[66:67], v8 offset:21504
  v_add_f32 v91, v91, v10
  v_add_f32 v91, v91, v11
  v_mfma_f32_16x16x32_bf16 v[212:215], v[68:71], v[16:19], v[212:215]
  v_lshlrev_b32 v10, 16, v69
  v_and_b32 v11, s79, v69
  v_mfma_f32_16x16x32_bf16 v[208:211], v[68:71], v[12:15], v[208:211]
  v_add_f32 v91, v91, v10
  v_add_f32 v91, v91, v11
  s_waitcnt lgkmcnt(4)
  v_mfma_f32_16x16x32_bf16 v[224:227], v[72:75], v[12:15], v[224:227]
  v_lshlrev_b32 v10, 16, v70
  v_and_b32 v11, s79, v70
  v_mfma_f32_16x16x32_bf16 v[228:231], v[72:75], v[16:19], v[228:231]
  v_add_f32 v91, v91, v10
  v_add_f32 v91, v91, v11
  v_mfma_f32_16x16x32_bf16 v[232:235], v[72:75], v[20:23], v[232:235]
  v_lshlrev_b32 v10, 16, v71
  v_and_b32 v11, s79, v71
  v_mfma_f32_16x16x32_bf16 v[236:239], v[72:75], v[24:27], v[236:239]
  v_add_f32 v91, v91, v10
  v_add_f32 v91, v91, v11
  s_cmp_eq_u32 s60, 2
  s_cbranch_scc0 L_nx_30
  s_call_b64 s[74:75], L_x_poll_3
L_nx_30:
  v_mfma_f32_16x16x32_bf16 v[252:255], v[76:79], v[24:27], v[252:255]
  ds_read_b64_tr_b16 v[72:73], v6 offset:33792
  v_mfma_f32_16x16x32_bf16 v[248:251], v[76:79], v[20:23], v[248:251]
  ds_read_b64_tr_b16 v[74:75], v6 offset:37376
  v_mfma_f32_16x16x32_bf16 v[244:247], v[76:79], v[16:19], v[244:247]
  ds_read_b64_tr_b16 v[68:69], v6 offset:26624
  v_mfma_f32_16x16x32_bf16 v[240:243], v[76:79], v[12:15], v[240:243]
  ds_read_b64_tr_b16 v[70:71], v6 offset:30208
  s_waitcnt vmcnt(5)
  s_barrier
  s_waitcnt lgkmcnt(6)
  v_mfma_f32_16x16x32_bf16 v[96:99], v[60:63], v[28:31], v[96:99]
  ds_read_b64_tr_b16 v[76:77], v6 offset:26656
  v_mfma_f32_16x16x32_bf16 v[100:103], v[60:63], v[32:35], v[100:103]
  ds_read_b64_tr_b16 v[78:79], v6 offset:30240
  v_mfma_f32_16x16x32_bf16 v[104:107], v[60:63], v[36:39], v[104:107]
  s_add_u32 m0, s33, 66560
  ds_read_b64 v[12:13], v5 offset:33280
  v_mfma_f32_16x16x32_bf16 v[108:111], v[60:63], v[40:43], v[108:111]
  buffer_load_dwordx4 v2, s[12:15], s27 offen lds
  s_add_u32 s27, s27, s30
  ds_read_b64 v[14:15], v5 offset:33312
  s_waitcnt lgkmcnt(8)
  v_mfma_f32_16x16x32_bf16 v[124:127], v[64:67], v[40:43], v[124:127]
  ds_read_b64_tr_b16 v[60:61], v6 offset:33824
  v_mfma_f32_16x16x32_bf16 v[120:123], v[64:67], v[36:39], v[120:123]
  ds_read_b64_tr_b16 v[62:63], v6 offset:37408
  v_mfma_f32_16x16x32_bf16 v[116:119], v[64:67], v[32:35], v[116:119]
  s_add_u32 m0, s34, 66560
  ds_read_b64 v[16:17], v5 offset:33536
  v_mfma_f32_16x16x32_bf16 v[112:115], v[64:67], v[28:31], v[112:115]
  buffer_load_dwordx4 v3, s[16:19], s28 offen lds
  s_add_u32 s28, s28, s31
  ds_read_b64 v[18:19], v5 offset:33568
  s_waitcnt lgkmcnt(8)
  v_mfma_f32_16x16x32_bf16 v[128:131], v[68:71], v[28:31], v[128:131]
  ds_read_b64_tr_b16 v[64:65], v6 offset:26688
  v_mfma_f32_16x16x32_bf16 v[132:135], v[68:71], v[32:35], v[132:135]
  ds_read_b64_tr_b16 v[66:67], v6 offset:30272
  v_mfma_f32_16x16x32_bf16 v[136:139], v[68:71], v[36:39], v[136:139]
  s_add_u32 m0, s35, 66560
  ds_read_b64 v[20:21], v5 offset:33792
  v_mfma_f32_16x16x32_bf16 v[140:143], v[68:71], v[40:43], v[140:143]
  buffer_load_dwordx4 v4, s[20:23], s29 offen lds
  s_add_u32 s29, s29, s32
  ds_read_b64 v[22:23], v5 offset:33824
  v_mfma_f32_16x16x32_bf16 v[156:159], v[72:75], v[40:43], v[156:159]
  ds_read_b64_tr_b16 v[68:69], v6 offset:33856
  v_lshlrev_b32 v10, 16, v72
  v_and_b32 v11, s79, v72
  v_mfma_f32_16x16x32_bf16 v[152:155], v[72:75], v[36:39], v[152:155]
  ds_read_b64_tr_b16 v[70:71], v6 offset:37440
  v_add_f32 v90, v90, v10
  v_add_f32 v90, v90, v11
  v_mfma_f32_16x16x32_bf16 v[148:151], v[72:75], v[32:35], v[148:151]
  s_add_u32 s50, s26, 262144
  s_add_u32 m0, s24, 16640
  ds_read_b64 v[24:25], v5 offset:34048
  v_lshlrev_b32 v10, 16, v73
  v_and_b32 v11, s79, v73
  v_mfma_f32_16x16x32_bf16 v[144:147], v[72:75], v[28:31], v[144:147]
  buffer_load_dwordx4 v1, s[8:11], s50 offen lds
  ds_read_b64 v[26:27], v5 offset:34080
  v_add_f32 v90, v90, v10
  v_add_f32 v90, v90, v11
  s_waitcnt lgkmcnt(14)
  v_mfma_f32_16x16x32_bf16 v[160:163], v[76:79], v[28:31], v[160:163]
  v_lshlrev_b32 v10, 16, v74
  v_and_b32 v11, s79, v74
  v_mfma_f32_16x16x32_bf16 v[164:167], v[76:79], v[32:35], v[164:167]
  v_add_f32 v90, v90, v10
  v_add_f32 v90, v90, v11
  v_mfma_f32_16x16x32_bf16 v[168:171], v[76:79], v[36:39], v[168:171]
  s_add_u32 s50, s26, 266240
  s_add_u32 m0, s24, 17680
  ds_read_b64 v[44:45], v5 offset:33344
  v_lshlrev_b32 v10, 16, v75
  v_and_b32 v11, s79, v75
  v_mfma_f32_16x16x32_bf16 v[172:175], v[76:79], v[40:43], v[172:175]
  buffer_load_dwordx4 v1, s[8:11], s50 offen lds
  ds_read_b64 v[46:47], v5 offset:33376
  v_add_f32 v90, v90, v10
  v_add_f32 v90, v90, v11
  s_waitcnt lgkmcnt(12)
  v_mfma_f32_16x16x32_bf16 v[188:191], v[60:63], v[40:43], v[188:191]
  ds_read_b64_tr_b16 v[76:77], v6 offset:33888
  v_mfma_f32_16x16x32_bf16 v[184:187], v[60:63], v[36:39], v[184:187]
  ds_read_b64_tr_b16 v[78:79], v6 offset:37472
  v_mfma_f32_16x16x32_bf16 v[180:183], v[60:63], v[32:35], v[180:183]
  ds_read_b64_tr_b16 v[72:73], v6 offset:26720
  v_mfma_f32_16x16x32_bf16 v[176:179], v[60:63], v[28:31], v[176:179]
  ds_read_b64_tr_b16 v[74:75], v6 offset:30304
  s_waitcnt lgkmcnt(12)
  v_mfma_f32_16x16x32_bf16 v[192:195], v[64:67], v[28:31], v[192:195]
  ds_read_b64_tr_b16 v[60:61], v94 offset:0
  v_mfma_f32_16x16x32_bf16 v[196:199], v[64:67], v[32:35], v[196:199]
  ds_read_b64_tr_b16 v[62:63], v94 offset:1024
  v_mfma_f32_16x16x32_bf16 v[200:203], v[64:67], v[36:39], v[200:203]
  ds_read_b64 v[48:49], v5 offset:33600
  v_mfma_f32_16x16x32_bf16 v[204:207], v[64:67], v[40:43], v[204:207]
  ds_read_b64 v[50:51], v5 offset:33632
  s_waitcnt lgkmcnt(12)
  v_mfma_f32_16x16x32_bf16 v[220:223], v[68:71], v[40:43], v[220:223]
  ds_read_b64_tr_b16 v[64:65], v95 offset:0
  v_lshlrev_b32 v10, 16, v68
  v_and_b32 v11, s79, v68
  v_mfma_f32_16x16x32_bf16 v[216:219], v[68:71], v[36:39], v[216:219]
  ds_read_b64_tr_b16 v[66:67], v95 offset:1024
  v_add_f32 v91, v91, v10
  v_add_f32 v91, v91, v11
  v_mfma_f32_16x16x32_bf16 v[212:215], v[68:71], v[32:35], v[212:215]
  ds_read_b64 v[52:53], v5 offset:33856
  v_lshlrev_b32 v10, 16, v69
  v_and_b32 v11, s79, v69
  v_mfma_f32_16x16x32_bf16 v[208:211], v[68:71], v[28:31], v[208:211]
  ds_read_b64 v[54:55], v5 offset:33888
  v_add_f32 v91, v91, v10
  v_add_f32 v91, v91, v11
  s_waitcnt lgkmcnt(8)
  v_mfma_f32_16x16x32_bf16 v[224:227], v[72:75], v[28:31], v[224:227]
  v_lshlrev_b32 v10, 16, v70
  v_and_b32 v11, s79, v70
  v_mfma_f32_16x16x32_bf16 v[228:231], v[72:75], v[32:35], v[228:231]
  v_add_f32 v91, v91, v10
  v_add_f32 v91, v91, v11
  v_mfma_f32_16x16x32_bf16 v[232:235], v[72:75], v[36:39], v[232:235]
  ds_read_b64 v[56:57], v5 offset:34112
  v_lshlrev_b32 v10, 16, v71
  v_and_b32 v11, s79, v71
  v_mfma_f32_16x16x32_bf16 v[236:239], v[72:75], v[40:43], v[236:239]
  ds_read_b64 v[58:59], v5 offset:34144
  v_add_f32 v91, v91, v10
  v_add_f32 v91, v91, v11
  v_mfma_f32_16x16x32_bf16 v[252:255], v[76:79], v[40:43], v[252:255]
  ds_read_b64_tr_b16 v[72:73], v93 offset:13312
  v_mfma_f32_16x16x32_bf16 v[248:251], v[76:79], v[36:39], v[248:251]
  ds_read_b64_tr_b16 v[74:75], v93 offset:16896
  v_mfma_f32_16x16x32_bf16 v[244:247], v[76:79], v[32:35], v[244:247]
  ds_read_b64_tr_b16 v[68:69], v93 offset:6144
  s_add_u32 s25, s25, 128
  s_cmp_ge_u32 s25, 2048
  s_cselect_b32 s26, 0x10000000, s25
  v_mfma_f32_16x16x32_bf16 v[240:243], v[76:79], v[28:31], v[240:243]
  ds_read_b64_tr_b16 v[70:71], v93 offset:9728
  s_waitcnt vmcnt(5) lgkmcnt(4)
  s_barrier
  v_mfma_f32_16x16x32_bf16 v[96:99], v[60:63], v[12:15], v[96:99]
  ds_read_b64_tr_b16 v[76:77], v93 offset:6176
  v_mfma_f32_16x16x32_bf16 v[100:103], v[60:63], v[16:19], v[100:103]
  ds_read_b64_tr_b16 v[78:79], v93 offset:9760
  s_cmp_eq_u32 s60, 2
  s_cbranch_scc0 L_nx_31
  s_call_b64 s[74:75], L_x_stat_3
L_nx_31:
  s_cmp_eq_u32 s60, 8
  s_cbranch_scc0 L_nx_32
  s_call_b64 s[74:75], L_x_rows_3
L_nx_32:
  v_mfma_f32_16x16x32_bf16 v[104:107], v[60:63], v[20:23], v[104:107]
  s_add_u32 m0, s33, 87040
  v_mfma_f32_16x16x32_bf16 v[108:111], v[60:63], v[24:27], v[108:111]
  buffer_load_dwordx4 v2, s[12:15], s27 offen lds
  s_add_u32 s27, s27, s30
  v_mfma_f32_16x16x32_bf16 v[124:127], v[64:67], v[24:27], v[124:127]
  ds_read_b64_tr_b16 v[60:61], v93 offset:13344
  v_mfma_f32_16x16x32_bf16 v[120:123], v[64:67], v[20:23], v[120:123]
  ds_read_b64_tr_b16 v[62:63], v93 offset:16928
  v_mfma_f32_16x16x32_bf16 v[116:119], v[64:67], v[16:19], v[116:119]
  s_add_u32 m0, s34, 87040
  v_mfma_f32_16x16x32_bf16 v[112:115], v[64:67], v[12:15], v[112:115]
  buffer_load_dwordx4 v3, s[16:19], s28 offen lds
  s_add_u32 s28, s28, s31
  s_waitcnt lgkmcnt(4)
  v_mfma_f32_16x16x32_bf16 v[128:131], v[68:71], v[12:15], v[128:131]
  ds_read_b64_tr_b16 v[64:65], v93 offset:6208
  v_mfma_f32_16x16x32_bf16 v[132:135], v[68:71], v[16:19], v[132:135]
  ds_read_b64_tr_b16 v[66:67], v93 offset:9792
  v_mfma_f32_16x16x32_bf16 v[136:139], v[68:71], v[20:23], v[136:139]
  s_add_u32 m0, s35, 87040
  v_mfma_f32_16x16x32_bf16 v[140:143], v[68:71], v[24:27], v[140:143]
  buffer_load_dwordx4 v4, s[20:23], s29 offen lds
  s_add_u32 s29, s29, s32
  v_mfma_f32_16x16x32_bf16 v[156:159], v[72:75], v[24:27], v[156:159]
  ds_read_b64_tr_b16 v[68:69], v93 offset:13376
  v_lshlrev_b32 v10, 16, v72
  v_and_b32 v11, s79, v72
  v_mfma_f32_16x16x32_bf16 v[152:155], v[72:75], v[20:23], v[152:155]
  ds_read_b64_tr_b16 v[70:71], v93 offset:16960
  v_add_f32 v90, v90, v10
  v_add_f32 v90, v90, v11
  v_mfma_f32_16x16x32_bf16 v[148:151], v[72:75], v[16:19], v[148:151]
  s_add_u32 s50, s26, 0
  s_add_u32 m0, s24, 33280
  v_lshlrev_b32 v10, 16, v73
  v_and_b32 v11, s79, v73
  v_mfma_f32_16x16x32_bf16 v[144:147], v[72:75], v[12:15], v[144:147]
  buffer_load_dwordx4 v1, s[8:11], s50 offen lds
  v_add_f32 v90, v90, v10
  v_add_f32 v90, v90, v11
  s_waitcnt lgkmcnt(6)
  v_mfma_f32_16x16x32_bf16 v[160:163], v[76:79], v[12:15], v[160:163]
  v_lshlrev_b32 v10, 16, v74
  v_and_b32 v11, s79, v74
  v_mfma_f32_16x16x32_bf16 v[164:167], v[76:79], v[16:19], v[164:167]
  v_add_f32 v90, v90, v10
  v_add_f32 v90, v90, v11
  v_mfma_f32_16x16x32_bf16 v[168:171], v[76:79], v[20:23], v[168:171]
  s_add_u32 s50, s26, 4096
  s_add_u32 m0, s24, 34320
  v_lshlrev_b32 v10, 16, v75
  v_and_b32 v11, s79, v75
  v_mfma_f32_16x16x32_bf16 v[172:175], v[76:79], v[24:27], v[172:175]
  buffer_load_dwordx4 v1, s[8:11], s50 offen lds
  v_add_f32 v90, v90, v10
  v_add_f32 v90, v90, v11
  s_waitcnt lgkmcnt(4)
  v_mfma_f32_16x16x32_bf16 v[188:191], v[60:63], v[24:27], v[188:191]
  ds_read_b64_tr_b16 v[76:77], v93 offset:13408
  v_mfma_f32_16x16x32_bf16 v[184:187], v[60:63], v[20:23], v[184:187]
  ds_read_b64_tr_b16 v[78:79], v93 offset:16992
  v_mfma_f32_16x16x32_bf16 v[180:183], v[60:63], v[16:19], v[180:183]
  ds_read_b64_tr_b16 v[72:73], v93 offset:6240
  v_mfma_f32_16x16x32_bf16 v[176:179], v[60:63], v[12:15], v[176:179]
  ds_read_b64_tr_b16 v[74:75], v93 offset:9824
  s_waitcnt lgkmcnt(6)
  v_mfma_f32_16x16x32_bf16 v[192:195], v[64:67], v[12:15], v[192:195]
  ds_read_b64_tr_b16 v[60:61], v94 offset:20480
  v_mfma_f32_16x16x32_bf16 v[196:199], v[64:67], v[16:19], v[196:199]
  ds_read_b64_tr_b16 v[62:63], v94 offset:21504
  v_mfma_f32_16x16x32_bf16 v[200:203], v[64:67], v[20:23], v[200:203]
  v_mfma_f32_16x16x32_bf16 v[204:207], v[64:67], v[24:27], v[204:207]
  s_waitcnt lgkmcnt(6)
  v_mfma_f32_16x16x32_bf16 v[220:223], v[68:71], v[24:27], v[220:223]
  ds_read_b64_tr_b16 v[64:65], v95 offset:20480
  v_lshlrev_b32 v10, 16, v68
  v_and_b32 v11, s79, v68
  v_mfma_f32_16x16x32_bf16 v[216:219], v[68:71], v[20:23], v[216:219]
  ds_read_b64_tr_b16 v[66:67], v95 offset:21504
  v_add_f32 v91, v91, v10
  v_add_f32 v91, v91, v11
  v_mfma_f32_16x16x32_bf16 v[212:215], v[68:71], v[16:19], v[212:215]
  v_lshlrev_b32 v10, 16, v69
  v_and_b32 v11, s79, v69
  v_mfma_f32_16x16x32_bf16 v[208:211], v[68:71], v[12:15], v[208:211]
  v_add_f32 v91, v91, v10
  v_add_f32 v91, v91, v11
  s_waitcnt lgkmcnt(4)
  v_mfma_f32_16x16x32_bf16 v[224:227], v[72:75], v[12:15], v[224:227]
  v_lshlrev_b32 v10, 16, v70
  v_and_b32 v11, s79, v70
  v_mfma_f32_16x16x32_bf16 v[228:231], v[72:75], v[16:19], v[228:231]
  v_add_f32 v91, v91, v10
  v_add_f32 v91, v91, v11
  v_mfma_f32_16x16x32_bf16 v[232:235], v[72:75], v[20:23], v[232:235]
  v_lshlrev_b32 v10, 16, v71
  v_and_b32 v11, s79, v71
  v_mfma_f32_16x16x32_bf16 v[236:239], v[72:75], v[24:27], v[236:239]
  v_add_f32 v91, v91, v10
  v_add_f32 v91, v91, v11
  v_mfma_f32_16x16x32_bf16 v[252:255], v[76:79], v[24:27], v[252:255]
  ds_read_b64_tr_b16 v[72:73], v93 offset:33792
  v_mfma_f32_16x16x32_bf16 v[248:251], v[76:79], v[20:23], v[248:251]
  ds_read_b64_tr_b16 v[74:75], v93 offset:37376
  v_mfma_f32_16x16x32_bf16 v[244:247], v[76:79], v[16:19], v[244:247]
  ds_read_b64_tr_b16 v[68:69], v93 offset:26624
  v_mfma_f32_16x16x32_bf16 v[240:243], v[76:79], v[12:15], v[240:243]
  ds_read_b64_tr_b16 v[70:71], v93 offset:30208
  s_waitcnt vmcnt(5)
  s_barrier
  s_waitcnt lgkmcnt(6)
  v_mfma_f32_16x16x32_bf16 v[96:99], v[60:63], v[44:47], v[96:99]
  ds_read_b64_tr_b16 v[76:77], v93 offset:26656
  v_mfma_f32_16x16x32_bf16 v[100:103], v[60:63], v[48:51], v[100:103]
  ds_read_b64_tr_b16 v[78:79], v93 offset:30240
  v_mfma_f32_16x16x32_bf16 v[104:107], v[60:63], v[52:55], v[104:107]
  s_add_u32 m0, s33, 107520
  ds_read_b64 v[12:13], v5 offset:0
  v_mfma_f32_16x16x32_bf16 v[108:111], v[60:63], v[56:59], v[108:111]
  buffer_load_dwordx4 v2, s[12:15], s27 offen lds
  s_add_u32 s27, s27, s30
  ds_read_b64 v[14:15], v5 offset:32
  s_waitcnt lgkmcnt(8)
  v_mfma_f32_16x16x32_bf16 v[124:127], v[64:67], v[56:59], v[124:127]
  ds_read_b64_tr_b16 v[60:61], v93 offset:33824
  v_mfma_f32_16x16x32_bf16 v[120:123], v[64:67], v[52:55], v[120:123]
  ds_read_b64_tr_b16 v[62:63], v93 offset:37408
  v_mfma_f32_16x16x32_bf16 v[116:119], v[64:67], v[48:51], v[116:119]
  s_add_u32 m0, s34, 107520
  ds_read_b64 v[16:17], v5 offset:256
  v_mfma_f32_16x16x32_bf16 v[112:115], v[64:67], v[44:47], v[112:115]
  buffer_load_dwordx4 v3, s[16:19], s28 offen lds
  s_add_u32 s28, s28, s31
  ds_read_b64 v[18:19], v5 offset:288
  s_waitcnt lgkmcnt(8)
  v_mfma_f32_16x16x32_bf16 v[128:131], v[68:71], v[44:47], v[128:131]
  ds_read_b64_tr_b16 v[64:65], v93 offset:26688
  v_mfma_f32_16x16x32_bf16 v[132:135], v[68:71], v[48:51], v[132:135]
  ds_read_b64_tr_b16 v[66:67], v93 offset:30272
  v_mfma_f32_16x16x32_bf16 v[136:139], v[68:71], v[52:55], v[136:139]
  s_add_u32 m0, s35, 107520
  ds_read_b64 v[20:21], v5 offset:512
  v_mfma_f32_16x16x32_bf16 v[140:143], v[68:71], v[56:59], v[140:143]
  buffer_load_dwordx4 v4, s[20:23], s29 offen lds
  s_add_u32 s29, s29, s32
  ds_read_b64 v[22:23], v5 offset:544
  v_mfma_f32_16x16x32_bf16 v[156:159], v[72:75], v[56:59], v[156:159]
  ds_read_b64_tr_b16 v[68:69], v93 offset:33856
  v_lshlrev_b32 v10, 16, v72
  v_and_b32 v11, s79, v72
  v_mfma_f32_16x16x32_bf16 v[152:155], v[72:75], v[52:55], v[152:155]
  ds_read_b64_tr_b16 v[70:71], v93 offset:37440
  v_add_f32 v90, v90, v10
  v_add_f32 v90, v90, v11
  v_mfma_f32_16x16x32_bf16 v[148:151], v[72:75], v[48:51], v[148:151]
  s_add_u32 s50, s26, 262144
  s_add_u32 m0, s24, 49920
  ds_read_b64 v[24:25], v5 offset:768
  v_lshlrev_b32 v10, 16, v73
  v_and_b32 v11, s79, v73
  v_mfma_f32_16x16x32_bf16 v[144:147], v[72:75], v[44:47], v[144:147]
  buffer_load_dwordx4 v1, s[8:11], s50 offen lds
  ds_read_b64 v[26:27], v5 offset:800
  v_add_f32 v90, v90, v10
  v_add_f32 v90, v90, v11
  s_waitcnt lgkmcnt(14)
  v_mfma_f32_16x16x32_bf16 v[160:163], v[76:79], v[44:47], v[160:163]
  v_lshlrev_b32 v10, 16, v74
  v_and_b32 v11, s79, v74
  v_mfma_f32_16x16x32_bf16 v[164:167], v[76:79], v[48:51], v[164:167]
  v_add_f32 v90, v90, v10
  v_add_f32 v90, v90, v11
  v_mfma_f32_16x16x32_bf16 v[168:171], v[76:79], v[52:55], v[168:171]
  s_add_u32 s50, s26, 266240
  s_add_u32 m0, s24, 50960
  ds_read_b64 v[28:29], v5 offset:64
  v_lshlrev_b32 v10, 16, v75
  v_and_b32 v11, s79, v75
  v_mfma_f32_16x16x32_bf16 v[172:175], v[76:79], v[56:59], v[172:175]
  buffer_load_dwordx4 v1, s[8:11], s50 offen lds
  ds_read_b64 v[30:31], v5 offset:96
  v_add_f32 v90, v90, v10
  v_add_f32 v90, v90, v11
  s_waitcnt lgkmcnt(12)
  v_mfma_f32_16x16x32_bf16 v[188:191], v[60:63], v[56:59], v[188:191]
  ds_read_b64_tr_b16 v[76:77], v93 offset:33888
  v_mfma_f32_16x16x32_bf16 v[184:187], v[60:63], v[52:55], v[184:187]
  ds_read_b64_tr_b16 v[78:79], v93 offset:37472
  v_mfma_f32_16x16x32_bf16 v[180:183], v[60:63], v[48:51], v[180:183]
  ds_read_b64_tr_b16 v[72:73], v93 offset:26720
  v_mfma_f32_16x16x32_bf16 v[176:179], v[60:63], v[44:47], v[176:179]
  ds_read_b64_tr_b16 v[74:75], v93 offset:30304
  s_waitcnt lgkmcnt(12)
  v_mfma_f32_16x16x32_bf16 v[192:195], v[64:67], v[44:47], v[192:195]
  ds_read_b64_tr_b16 v[60:61], v7 offset:0
  v_mfma_f32_16x16x32_bf16 v[196:199], v[64:67], v[48:51], v[196:199]
  ds_read_b64_tr_b16 v[62:63], v7 offset:1024
  v_mfma_f32_16x16x32_bf16 v[200:203], v[64:67], v[52:55], v[200:203]
  ds_read_b64 v[32:33], v5 offset:320
  v_mfma_f32_16x16x32_bf16 v[204:207], v[64:67], v[56:59], v[204:207]
  ds_read_b64 v[34:35], v5 offset:352
  s_waitcnt lgkmcnt(12)
  v_mfma_f32_16x16x32_bf16 v[220:223], v[68:71], v[56:59], v[220:223]
  ds_read_b64_tr_b16 v[64:65], v8 offset:0
  v_lshlrev_b32 v10, 16, v68
  v_and_b32 v11, s79, v68
  v_mfma_f32_16x16x32_bf16 v[216:219], v[68:71], v[52:55], v[216:219]
  ds_read_b64_tr_b16 v[66:67], v8 offset:1024
  v_add_f32 v91, v91, v10
  v_add_f32 v91, v91, v11
  v_mfma_f32_16x16x32_bf16 v[212:215], v[68:71], v[48:51], v[212:215]
  ds_read_b64 v[36:37], v5 offset:576
  v_lshlrev_b32 v10, 16, v69
  v_and_b32 v11, s79, v69
  v_mfma_f32_16x16x32_bf16 v[208:211], v[68:71], v[44:47], v[208:211]
  ds_read_b64 v[38:39], v5 offset:608
  v_add_f32 v91, v91, v10
  v_add_f32 v91, v91, v11
  s_waitcnt lgkmcnt(8)
  v_mfma_f32_16x16x32_bf16 v[224:227], v[72:75], v[44:47], v[224:227]
  v_lshlrev_b32 v10, 16, v70
  v_and_b32 v11, s79, v70
  v_mfma_f32_16x16x32_bf16 v[228:231], v[72:75], v[48:51], v[228:231]
  v_add_f32 v91, v91, v10
  v_add_f32 v91, v91, v11
  v_mfma_f32_16x16x32_bf16 v[232:235], v[72:75], v[52:55], v[232:235]
  ds_read_b64 v[40:41], v5 offset:832
  v_lshlrev_b32 v10, 16, v71
  v_and_b32 v11, s79, v71
  v_mfma_f32_16x16x32_bf16 v[236:239], v[72:75], v[56:59], v[236:239]
  ds_read_b64 v[42:43], v5 offset:864
  v_add_f32 v91, v91, v10
  v_add_f32 v91, v91, v11
  v_mfma_f32_16x16x32_bf16 v[252:255], v[76:79], v[56:59], v[252:255]
  ds_read_b64_tr_b16 v[72:73], v6 offset:13312
  v_mfma_f32_16x16x32_bf16 v[248:251], v[76:79], v[52:55], v[248:251]
  ds_read_b64_tr_b16 v[74:75], v6 offset:16896
  v_mfma_f32_16x16x32_bf16 v[244:247], v[76:79], v[48:51], v[244:247]
  ds_read_b64_tr_b16 v[68:69], v6 offset:6144
  s_add_u32 s25, s25, 128
  s_cmp_ge_u32 s25, 2048
  s_cselect_b32 s26, 0x10000000, s25
  v_mfma_f32_16x16x32_bf16 v[240:243], v[76:79], v[44:47], v[240:243]
  ds_read_b64_tr_b16 v[70:71], v6 offset:9728
  s_waitcnt vmcnt(5) lgkmcnt(4)
  s_barrier
  s_sub_u32 s60, s60, 1
  s_cmp_lt_u32 s60, 2
  s_cbranch_scc1 L_loopt3
  s_call_b64 s[74:75], L_x_cpub_3
  s_cmp_gt_u32 s60, 2
  s_cbranch_scc1 L_loopp3
L_loopt3:
  s_cmp_lg_u32 s60, 0
  s_cbranch_scc1 L_loopc3
  s_branch L_epi0
L_x_drain_3:
  s_waitcnt vmcnt(0)
  s_setpc_b64 s[74:75]
L_x_rows_3:
  s_waitcnt vmcnt(0)
  v_lshlrev_b32 v10, 16, v80
  v_and_b32 v11, s79, v80
  v_mov_b32 v88, v10
  v_mov_b32 v89, v11
  v_lshlrev_b32 v10, 16, v81
  v_and_b32 v11, s79, v81
  v_add_f32 v88, v88, v10
  v_add_f32 v89, v89, v11
  v_lshlrev_b32 v10, 16, v82
  v_and_b32 v11, s79, v82
  v_add_f32 v88, v88, v10
  v_add_f32 v89, v89, v11
  v_lshlrev_b32 v10, 16, v83
  v_and_b32 v11, s79, v83
  v_add_f32 v88, v88, v10
  v_add_f32 v89, v89, v11
  v_lshlrev_b32 v10, 16, v84
  v_and_b32 v11, s79, v84
  v_add_f32 v88, v88, v10
  v_add_f32 v89, v89, v11
  v_lshlrev_b32 v10, 16, v85
  v_and_b32 v11, s79, v85
  v_add_f32 v88, v88, v10
  v_add_f32 v89, v89, v11
  v_lshlrev_b32 v10, 16, v86
  v_and_b32 v11, s79, v86
  v_add_f32 v88, v88, v10
  v_add_f32 v89, v89, v11
  v_lshlrev_b32 v10, 16, v87
  v_and_b32 v11, s79, v87
  v_add_f32 v88, v88, v10
  v_add_f32 v89, v89, v11
  v_add_f32 v88, v88, v89
  s_nop 1
  v_add_f32_dpp v88, v88, v88 quad_perm:[1,0,3,2] row_mask:0xf bank_mask:0xf
  s_nop 1
  v_add_f32_dpp v88, v88, v88 quad_perm:[2,3,0,1] row_mask:0xf bank_mask:0xf
  s_nop 1
  v_add_f32_dpp v88, v88, v88 row_half_mirror row_mask:0xf bank_mask:0xf
  s_nop 1
  v_add_f32_dpp v88, v88, v88 row_mirror row_mask:0xf bank_mask:0xf
  v_mov_b32 v10, v88
  s_nop 1
  v_permlane16_swap_b32 v88, v10
  s_nop 0
  v_add_f32 v88, v88, v10
  v_mov_b32 v10, v88
  s_nop 1
  v_permlane32_swap_b32 v88, v10
  s_nop 0
  v_add_f32 v88, v88, v10
  v_mul_f32 v88, 0xba800000, v88
  v_lshlrev_b32 v10, 16, v80
  v_and_b32 v11, s79, v80
  v_add_f32 v10, v10, v88
  v_add_f32 v11, v11, v88
  v_mul_f32 v89, v10, v10
  v_fmac_f32 v89, v11, v11
  v_lshlrev_b32 v10, 16, v81
  v_and_b32 v11, s79, v81
  v_add_f32 v10, v10, v88
  v_add_f32 v11, v11, v88
  v_fmac_f32 v89, v10, v10
  v_fmac_f32 v89, v11, v11
  v_lshlrev_b32 v10, 16, v82
  v_and_b32 v11, s79, v82
  v_add_f32 v10, v10, v88
  v_add_f32 v11, v11, v88
  v_fmac_f32 v89, v10, v10
  v_fmac_f32 v89, v11, v11
  v_lshlrev_b32 v10, 16, v83
  v_and_b32 v11, s79, v83
  v_add_f32 v10, v10, v88
  v_add_f32 v11, v11, v88
  v_fmac_f32 v89, v10, v10
  v_fmac_f32 v89, v11, v11
  v_lshlrev_b32 v10, 16, v84
  v_and_b32 v11, s79, v84
  v_add_f32 v10, v10, v88
  v_add_f32 v11, v11, v88
  v_fmac_f32 v89, v10, v10
  v_fmac_f32 v89, v11, v11
  v_lshlrev_b32 v10, 16, v85
  v_and_b32 v11, s79, v85
  v_add_f32 v10, v10, v88
  v_add_f32 v11, v11, v88
  v_fmac_f32 v89, v10, v10
  v_fmac_f32 v89, v11, v11
  v_lshlrev_b32 v10, 16, v86
  v_and_b32 v11, s79, v86
  v_add_f32 v10, v10, v88
  v_add_f32 v11, v11, v88
  v_fmac_f32 v89, v10, v10
  v_fmac_f32 v89, v11, v11
  v_lshlrev_b32 v10, 16, v87
  v_and_b32 v11, s79, v87
  v_add_f32 v10, v10, v88
  v_add_f32 v11, v11, v88
  v_fmac_f32 v89, v10, v10
  v_fmac_f32 v89, v11, v11
  s_nop 1
  v_add_f32_dpp v89, v89, v89 quad_perm:[1,0,3,2] row_mask:0xf bank_mask:0xf
  s_nop 1
  v_add_f32_dpp v89, v89, v89 quad_perm:[2,3,0,1] row_mask:0xf bank_mask:0xf
  s_nop 1
  v_add_f32_dpp v89, v89, v89 row_half_mirror row_mask:0xf bank_mask:0xf
  s_nop 1
  v_add_f32_dpp v89, v89, v89 row_mirror row_mask:0xf bank_mask:0xf
  v_mov_b32 v10, v89
  s_nop 1
  v_permlane16_swap_b32 v89, v10
  s_nop 0
  v_add_f32 v89, v89, v10
  v_mov_b32 v10, v89
  s_nop 1
  v_permlane32_swap_b32 v89, v10
  s_nop 0
  v_add_f32 v89, v89, v10
  v_mul_f32 v89, 0x3a800000, v89
  v_cvt_pk_bf16_f32 v10, v88, v89
  v_lshlrev_b32 v80, 16, v10
  v_and_b32 v89, s79, v10
  v_add_f32 v89, 0x3727c5ac, v89
  v_cvt_pk_bf16_f32 v89, v89, v89
  v_lshlrev_b32 v89, 16, v89
  v_sqrt_f32 v89, v89
  s_lshl_b32 s51, s2, 6
  v_cvt_pk_bf16_f32 v89, v89, v89
  s_add_u32 s51, s51, 51380248
  v_lshlrev_b32 v81, 16, v89
  s_mov_b64 exec, 1
  buffer_store_dwordx2 v[80:81], v0, s[64:67], s51 offen sc1
  s_mov_b64 exec, -1
  s_setpc_b64 s[74:75]
L_x_poll_3:
  v_and_b32 v89, 0x70, v9
  v_lshlrev_b32 v89, 1, v89
  buffer_load_dword v88, v89, s[56:59], 0 offen sc1
  s_setpc_b64 s[74:75]
L_x_stat_3:
  s_waitcnt vmcnt(0)
  v_cmp_ne_u32 vcc, 32, v88
  s_nop 4
  s_cbranch_vccz L_x_stat_3_go
  s_sleep 2
  v_and_b32 v89, 0x70, v9
  v_lshlrev_b32 v89, 1, v89
  buffer_load_dword v88, v89, s[56:59], 0 offen sc1
  s_branch L_x_stat_3
L_x_stat_3_go:
  s_lshl_b32 s51, s6, 8
  s_lshl_b32 s55, s7, 5
  s_add_u32 s51, s51, s55
  s_lshl_b32 s55, s3, 2
  s_add_u32 s51, s51, s55
  s_add_u32 s51, s51, 50376704
  v_mov_b32 v88, 1
  s_mov_b64 exec, 1
  buffer_store_dword v88, v0, s[64:67], s51 offen sc1
  s_mov_b64 exec, -1
  v_and_b32 v88, 0xf0, v9
  v_lshrrev_b32 v88, 1, v88
  s_lshl_b32 s51, s7, 11
  s_add_u32 s51, s51, 51381760
  buffer_load_dwordx2 v[80:81], v88, s[64:67], s51 offen offset:0 sc1
  buffer_load_dwordx2 v[82:83], v88, s[64:67], s51 offen offset:128 sc1
  buffer_load_dwordx2 v[84:85], v88, s[64:67], s51 offen offset:256 sc1
  buffer_load_dwordx2 v[86:87], v88, s[64:67], s51 offen offset:384 sc1
  s_setpc_b64 s[74:75]
L_x_cpub_3:
  v_mov_b32 v10, v90
  v_mov_b32 v11, v91
  v_mov_b32 v88, v92
  s_nop 1
  v_permlane16_swap_b32 v90, v10
  v_permlane16_swap_b32 v91, v11
  v_permlane16_swap_b32 v92, v88
  v_add_f32 v90, v90, v10
  v_add_f32 v91, v91, v11
  v_add_f32 v92, v92, v88
  v_mov_b32 v10, v90
  v_mov_b32 v11, v91
  v_mov_b32 v88, v92
  s_nop 1
  v_permlane32_swap_b32 v90, v10
  v_permlane32_swap_b32 v91, v11
  v_permlane32_swap_b32 v92, v88
  v_add_f32 v90, v90, v10
  v_add_f32 v91, v91, v11
  v_add_f32 v92, v92, v88
  v_and_b32 v89, 0xf0, v9
  v_lshrrev_b32 v89, 2, v89
  s_mul_i32 s51, s6, 7680
  s_mul_i32 s52, s7, 1280
  s_add_u32 s51, s51, s52
  s_add_u32 s51, s51, 52428992
  s_mov_b64 exec, 0xffff
  buffer_store_dword v90, v89, s[64:67], s51 offen offset:0 sc1
  buffer_store_dword v91, v89, s[64:67], s51 offen offset:256 sc1
  s_mov_b64 exec, -1
  s_nop 1
  v_mov_b32 v90, 0
  v_mov_b32 v91, 0
  v_mov_b32 v92, 0
  s_setpc_b64 s[74:75]
L_epi0:
  s_waitcnt vmcnt(0) lgkmcnt(0)
  v_lshrrev_b32 v54, 8, v9
  v_lshlrev_b32 v52, 4, v54
  v_and_b32 v55, 0xf0, v9
  v_lshrrev_b32 v12, 2, v55
  v_lshrrev_b32 v56, 6, v55
  v_lshl_add_u32 v56, v54, 2, v56
  v_lshlrev_b32 v56, 6, v56
  v_and_b32 v57, 12, v12
  v_lshl_add_u32 v56, v57, 1, v56
  v_add_u32 v56, 154112, v56
  v_mul_u32_u24 v13, 1280, v54
  s_lshl_b32 s50, s4, 6
  s_add_u32 s50, s50, 156160
  v_add3_u32 v13, v13, v12, s50
  v_cmp_gt_u32 vcc, 2, v54
  ds_read_b32 v16, v13 offset:0
  ds_read_b32 v17, v13 offset:5120
  ds_read_b32 v18, v13 offset:256
  ds_read_b32 v19, v13 offset:5376
  ds_read_b32 v20, v13 offset:512
  ds_read_b32 v21, v13 offset:5632
  s_waitcnt lgkmcnt(0)
  v_cndmask_b32 v17, 0, v17, vcc
  v_add_f32 v90, v90, v16
  v_add_f32 v90, v90, v17
  v_cndmask_b32 v19, 0, v19, vcc
  v_add_f32 v91, v91, v18
  v_add_f32 v91, v91, v19
  v_cndmask_b32 v21, 0, v21, vcc
  v_add_f32 v92, v92, v20
  v_add_f32 v92, v92, v21
  v_mov_b32 v13, v90
  v_mov_b32 v14, v91
  v_mov_b32 v15, v92
  s_nop 1
  v_permlane16_swap_b32 v90, v13
  v_permlane16_swap_b32 v91, v14
  v_permlane16_swap_b32 v92, v15
  v_add_f32 v90, v90, v13
  v_add_f32 v91, v91, v14
  v_add_f32 v92, v92, v15
  v_mov_b32 v13, v90
  v_mov_b32 v14, v91
  v_mov_b32 v15, v92
  s_nop 1
  v_permlane32_swap_b32 v90, v13
  v_permlane32_swap_b32 v91, v14
  v_permlane32_swap_b32 v92, v15
  v_add_f32 v90, v90, v13
  v_add_f32 v91, v91, v14
  v_add_f32 v92, v92, v15
  s_lshl_b32 s50, s4, 6
  s_add_u32 s50, s50, 148480
  v_add_u32 v13, s50, v12
  ds_write_b32 v13, v90
  ds_write_b32 v13, v91 offset:256
  s_cmp_lt_u32 s4, 2
  s_cselect_b32 s50, s50, 149248
  v_add_u32 v14, s50, v12
  ds_write_b32 v14, v92 offset:512
  v_rcp_f32 v2, v81
  v_rcp_f32 v3, v83
  v_rcp_f32 v4, v85
  v_rcp_f32 v5, v87
  s_nop 0
  v_mul_f32 v0, s72, v2
  v_mul_f32 v1, s72, v3
  v_mul_f32 v10, s72, v4
  v_mul_f32 v11, s72, v5
  v_add_u32 v52, 148480, v52
  s_lshl_b32 s54, s4, 13
  s_add_u32 s54, s54, 102400
  v_add_u32 v53, s54, v9
  s_lshl_b32 s50, s7, 14
  s_lshl_b32 s55, s4, 12
  s_add_u32 s50, s50, s55
  s_add_u32 s50, s50, 8388608
  s_mul_i32 s51, s6, 393216
  s_add_u32 s51, s51, s50
  s_waitcnt lgkmcnt(0)
  s_barrier
  ds_read_b128 v[20:23], v52 offset:128
  ds_read_b128 v[24:27], v52 offset:192
  ds_read_b128 v[28:31], v52 offset:256
  ds_read_b128 v[32:35], v52 offset:320
  ds_read_b128 v[12:15], v52 offset:0
  ds_read_b128 v[16:19], v52 offset:64
  ds_read_b128 v[36:39], v52 offset:384
  ds_read_b128 v[40:43], v52 offset:448
  ds_read_b128 v[44:47], v52 offset:512
  ds_read_b128 v[48:51], v52 offset:576
  s_waitcnt lgkmcnt(6)
  v_fma_f32 v160, v28, v80, v160
  v_fma_f32 v161, v29, v80, v161
  v_fma_f32 v162, v30, v80, v162
  v_fma_f32 v163, v31, v80, v163
  v_fma_f32 v176, v32, v80, v176
  v_fma_f32 v177, v33, v80, v177
  v_fma_f32 v178, v34, v80, v178
  v_fma_f32 v179, v35, v80, v179
  v_mul_f32 v76, v160, v0
  v_mul_f32 v77, v161, v0
  v_mul_f32 v78, v162, v0
  v_mul_f32 v79, v163, v0
  v_exp_f32 v76, v76
  v_exp_f32 v77, v77
  v_exp_f32 v78, v78
  v_exp_f32 v79, v79
  v_fma_f32 v76, v76, v81, v81
  v_fma_f32 v77, v77, v81, v81
  v_fma_f32 v78, v78, v81, v81
  v_fma_f32 v79, v79, v81, v81
  v_rcp_f32 v76, v76
  v_rcp_f32 v77, v77
  v_rcp_f32 v78, v78
  v_rcp_f32 v79, v79
  v_mul_f32 v76, v76, v176
  v_mul_f32 v77, v77, v177
  v_mul_f32 v78, v78, v178
  v_mul_f32 v79, v79, v179
  v_cvt_pk_bf16_f32 v160, v76, v77
  v_cvt_pk_bf16_f32 v161, v78, v79
  v_fma_f32 v128, v20, v80, v128
  v_fma_f32 v129, v21, v80, v129
  v_fma_f32 v130, v22, v80, v130
  v_fma_f32 v131, v23, v80, v131
  v_fma_f32 v144, v24, v80, v144
  v_fma_f32 v145, v25, v80, v145
  v_fma_f32 v146, v26, v80, v146
  v_fma_f32 v147, v27, v80, v147
  v_mul_f32 v72, v128, v0
  v_mul_f32 v73, v129, v0
  v_mul_f32 v74, v130, v0
  v_mul_f32 v75, v131, v0
  v_exp_f32 v72, v72
  v_exp_f32 v73, v73
  v_exp_f32 v74, v74
  v_exp_f32 v75, v75
  v_fma_f32 v72, v72, v81, v81
  v_fma_f32 v73, v73, v81, v81
  v_fma_f32 v74, v74, v81, v81
  v_fma_f32 v75, v75, v81, v81
  v_rcp_f32 v72, v72
  v_rcp_f32 v73, v73
  v_rcp_f32 v74, v74
  v_rcp_f32 v75, v75
  v_mul_f32 v72, v72, v144
  v_mul_f32 v73, v73, v145
  v_mul_f32 v74, v74, v146
  v_mul_f32 v75, v75, v147
  v_cvt_pk_bf16_f32 v128, v72, v73
  v_cvt_pk_bf16_f32 v129, v74, v75
  v_mov_b32 v130, v160
  v_mov_b32 v131, v161
  buffer_store_dwordx4 v[128:131], v9, s[64:67], s51 offen offset:0 sc1
  v_fma_f32 v164, v28, v82, v164
  v_fma_f32 v165, v29, v82, v165
  v_fma_f32 v166, v30, v82, v166
  v_fma_f32 v167, v31, v82, v167
  v_fma_f32 v180, v32, v82, v180
  v_fma_f32 v181, v33, v82, v181
  v_fma_f32 v182, v34, v82, v182
  v_fma_f32 v183, v35, v82, v183
  v_mul_f32 v76, v164, v1
  v_mul_f32 v77, v165, v1
  v_mul_f32 v78, v166, v1
  v_mul_f32 v79, v167, v1
  v_exp_f32 v76, v76
  v_exp_f32 v77, v77
  v_exp_f32 v78, v78
  v_exp_f32 v79, v79
  v_fma_f32 v76, v76, v83, v83
  v_fma_f32 v77, v77, v83, v83
  v_fma_f32 v78, v78, v83, v83
  v_fma_f32 v79, v79, v83, v83
  v_rcp_f32 v76, v76
  v_rcp_f32 v77, v77
  v_rcp_f32 v78, v78
  v_rcp_f32 v79, v79
  v_mul_f32 v76, v76, v180
  v_mul_f32 v77, v77, v181
  v_mul_f32 v78, v78, v182
  v_mul_f32 v79, v79, v183
  v_cvt_pk_bf16_f32 v164, v76, v77
  v_cvt_pk_bf16_f32 v165, v78, v79
  v_fma_f32 v132, v20, v82, v132
  v_fma_f32 v133, v21, v82, v133
  v_fma_f32 v134, v22, v82, v134
  v_fma_f32 v135, v23, v82, v135
  v_fma_f32 v148, v24, v82, v148
  v_fma_f32 v149, v25, v82, v149
  v_fma_f32 v150, v26, v82, v150
  v_fma_f32 v151, v27, v82, v151
  v_mul_f32 v72, v132, v1
  v_mul_f32 v73, v133, v1
  v_mul_f32 v74, v134, v1
  v_mul_f32 v75, v135, v1
  v_exp_f32 v72, v72
  v_exp_f32 v73, v73
  v_exp_f32 v74, v74
  v_exp_f32 v75, v75
  v_fma_f32 v72, v72, v83, v83
  v_fma_f32 v73, v73, v83, v83
  v_fma_f32 v74, v74, v83, v83
  v_fma_f32 v75, v75, v83, v83
  v_rcp_f32 v72, v72
  v_rcp_f32 v73, v73
  v_rcp_f32 v74, v74
  v_rcp_f32 v75, v75
  v_mul_f32 v72, v72, v148
  v_mul_f32 v73, v73, v149
  v_mul_f32 v74, v74, v150
  v_mul_f32 v75, v75, v151
  v_cvt_pk_bf16_f32 v132, v72, v73
  v_cvt_pk_bf16_f32 v133, v74, v75
  v_mov_b32 v134, v164
  v_mov_b32 v135, v165
  buffer_store_dwordx4 v[132:135], v9, s[64:67], s51 offen offset:1024 sc1
  v_fma_f32 v168, v28, v84, v168
  v_fma_f32 v169, v29, v84, v169
  v_fma_f32 v170, v30, v84, v170
  v_fma_f32 v171, v31, v84, v171
  v_fma_f32 v184, v32, v84, v184
  v_fma_f32 v185, v33, v84, v185
  v_fma_f32 v186, v34, v84, v186
  v_fma_f32 v187, v35, v84, v187
  v_mul_f32 v76, v168, v10
  v_mul_f32 v77, v169, v10
  v_mul_f32 v78, v170, v10
  v_mul_f32 v79, v171, v10
  v_exp_f32 v76, v76
  v_exp_f32 v77, v77
  v_exp_f32 v78, v78
  v_exp_f32 v79, v79
  v_fma_f32 v76, v76, v85, v85
  v_fma_f32 v77, v77, v85, v85
  v_fma_f32 v78, v78, v85, v85
  v_fma_f32 v79, v79, v85, v85
  v_rcp_f32 v76, v76
  v_rcp_f32 v77, v77
  v_rcp_f32 v78, v78
  v_rcp_f32 v79, v79
  v_mul_f32 v76, v76, v184
  v_mul_f32 v77, v77, v185
  v_mul_f32 v78, v78, v186
  v_mul_f32 v79, v79, v187
  v_cvt_pk_bf16_f32 v168, v76, v77
  v_cvt_pk_bf16_f32 v169, v78, v79
  v_fma_f32 v136, v20, v84, v136
  v_fma_f32 v137, v21, v84, v137
  v_fma_f32 v138, v22, v84, v138
  v_fma_f32 v139, v23, v84, v139
  v_fma_f32 v152, v24, v84, v152
  v_fma_f32 v153, v25, v84, v153
  v_fma_f32 v154, v26, v84, v154
  v_fma_f32 v155, v27, v84, v155
  v_mul_f32 v72, v136, v10
  v_mul_f32 v73, v137, v10
  v_mul_f32 v74, v138, v10
  v_mul_f32 v75, v139, v10
  v_exp_f32 v72, v72
  v_exp_f32 v73, v73
  v_exp_f32 v74, v74
  v_exp_f32 v75, v75
  v_fma_f32 v72, v72, v85, v85
  v_fma_f32 v73, v73, v85, v85
  v_fma_f32 v74, v74, v85, v85
  v_fma_f32 v75, v75, v85, v85
  v_rcp_f32 v72, v72
  v_rcp_f32 v73, v73
  v_rcp_f32 v74, v74
  v_rcp_f32 v75, v75
  v_mul_f32 v72, v72, v152
  v_mul_f32 v73, v73, v153
  v_mul_f32 v74, v74, v154
  v_mul_f32 v75, v75, v155
  v_cvt_pk_bf16_f32 v136, v72, v73
  v_cvt_pk_bf16_f32 v137, v74, v75
  v_mov_b32 v138, v168
  v_mov_b32 v139, v169
  buffer_store_dwordx4 v[136:139], v9, s[64:67], s51 offen offset:2048 sc1
  v_fma_f32 v172, v28, v86, v172
  v_fma_f32 v173, v29, v86, v173
  v_fma_f32 v174, v30, v86, v174
  v_fma_f32 v175, v31, v86, v175
  v_fma_f32 v188, v32, v86, v188
  v_fma_f32 v189, v33, v86, v189
  v_fma_f32 v190, v34, v86, v190
  v_fma_f32 v191, v35, v86, v191
  v_mul_f32 v76, v172, v11
  v_mul_f32 v77, v173, v11
  v_mul_f32 v78, v174, v11
  v_mul_f32 v79, v175, v11
  v_exp_f32 v76, v76
  v_exp_f32 v77, v77
  v_exp_f32 v78, v78
  v_exp_f32 v79, v79
  v_fma_f32 v76, v76, v87, v87
  v_fma_f32 v77, v77, v87, v87
  v_fma_f32 v78, v78, v87, v87
  v_fma_f32 v79, v79, v87, v87
  v_rcp_f32 v76, v76
  v_rcp_f32 v77, v77
  v_rcp_f32 v78, v78
  v_rcp_f32 v79, v79
  v_mul_f32 v76, v76, v188
  v_mul_f32 v77, v77, v189
  v_mul_f32 v78, v78, v190
  v_mul_f32 v79, v79, v191
  v_cvt_pk_bf16_f32 v172, v76, v77
  v_cvt_pk_bf16_f32 v173, v78, v79
  v_fma_f32 v140, v20, v86, v140
  v_fma_f32 v141, v21, v86, v141
  v_fma_f32 v142, v22, v86, v142
  v_fma_f32 v143, v23, v86, v143
  v_fma_f32 v156, v24, v86, v156
  v_fma_f32 v157, v25, v86, v157
  v_fma_f32 v158, v26, v86, v158
  v_fma_f32 v159, v27, v86, v159
  v_mul_f32 v72, v140, v11
  v_mul_f32 v73, v141, v11
  v_mul_f32 v74, v142, v11
  v_mul_f32 v75, v143, v11
  v_exp_f32 v72, v72
  v_exp_f32 v73, v73
  v_exp_f32 v74, v74
  v_exp_f32 v75, v75
  v_fma_f32 v72, v72, v87, v87
  v_fma_f32 v73, v73, v87, v87
  v_fma_f32 v74, v74, v87, v87
  v_fma_f32 v75, v75, v87, v87
  v_rcp_f32 v72, v72
  v_rcp_f32 v73, v73
  v_rcp_f32 v74, v74
  v_rcp_f32 v75, v75
  v_mul_f32 v72, v72, v156
  v_mul_f32 v73, v73, v157
  v_mul_f32 v74, v74, v158
  v_mul_f32 v75, v75, v159
  v_cvt_pk_bf16_f32 v140, v72, v73
  v_cvt_pk_bf16_f32 v141, v74, v75
  v_mov_b32 v142, v172
  v_mov_b32 v143, v173
  buffer_store_dwordx4 v[140:143], v9, s[64:67], s51 offen offset:3072 sc1
  s_add_u32 s51, s51, 131072
  s_waitcnt lgkmcnt(0)
  v_fma_f32 v224, v44, v80, v224
  v_fma_f32 v225, v45, v80, v225
  v_fma_f32 v226, v46, v80, v226
  v_fma_f32 v227, v47, v80, v227
  v_fma_f32 v240, v48, v80, v240
  v_fma_f32 v241, v49, v80, v241
  v_fma_f32 v242, v50, v80, v242
  v_fma_f32 v243, v51, v80, v243
  v_mul_f32 v76, v224, v0
  v_mul_f32 v77, v225, v0
  v_mul_f32 v78, v226, v0
  v_mul_f32 v79, v227, v0
  v_exp_f32 v76, v76
  v_exp_f32 v77, v77
  v_exp_f32 v78, v78
  v_exp_f32 v79, v79
  v_fma_f32 v76, v76, v81, v81
  v_fma_f32 v77, v77, v81, v81
  v_fma_f32 v78, v78, v81, v81
  v_fma_f32 v79, v79, v81, v81
  v_rcp_f32 v76, v76
  v_rcp_f32 v77, v77
  v_rcp_f32 v78, v78
  v_rcp_f32 v79, v79
  v_mul_f32 v76, v76, v240
  v_mul_f32 v77, v77, v241
  v_mul_f32 v78, v78, v242
  v_mul_f32 v79, v79, v243
  v_cvt_pk_bf16_f32 v224, v76, v77
  v_cvt_pk_bf16_f32 v225, v78, v79
  v_fma_f32 v192, v36, v80, v192
  v_fma_f32 v193, v37, v80, v193
  v_fma_f32 v194, v38, v80, v194
  v_fma_f32 v195, v39, v80, v195
  v_fma_f32 v208, v40, v80, v208
  v_fma_f32 v209, v41, v80, v209
  v_fma_f32 v210, v42, v80, v210
  v_fma_f32 v211, v43, v80, v211
  v_mul_f32 v72, v192, v0
  v_mul_f32 v73, v193, v0
  v_mul_f32 v74, v194, v0
  v_mul_f32 v75, v195, v0
  v_exp_f32 v72, v72
  v_exp_f32 v73, v73
  v_exp_f32 v74, v74
  v_exp_f32 v75, v75
  v_fma_f32 v72, v72, v81, v81
  v_fma_f32 v73, v73, v81, v81
  v_fma_f32 v74, v74, v81, v81
  v_fma_f32 v75, v75, v81, v81
  v_rcp_f32 v72, v72
  v_rcp_f32 v73, v73
  v_rcp_f32 v74, v74
  v_rcp_f32 v75, v75
  v_mul_f32 v72, v72, v208
  v_mul_f32 v73, v73, v209
  v_mul_f32 v74, v74, v210
  v_mul_f32 v75, v75, v211
  v_cvt_pk_bf16_f32 v192, v72, v73
  v_cvt_pk_bf16_f32 v193, v74, v75
  v_mov_b32 v194, v224
  v_mov_b32 v195, v225
  buffer_store_dwordx4 v[192:195], v9, s[64:67], s51 offen offset:0 sc1
  v_fma_f32 v228, v44, v82, v228
  v_fma_f32 v229, v45, v82, v229
  v_fma_f32 v230, v46, v82, v230
  v_fma_f32 v231, v47, v82, v231
  v_fma_f32 v244, v48, v82, v244
  v_fma_f32 v245, v49, v82, v245
  v_fma_f32 v246, v50, v82, v246
  v_fma_f32 v247, v51, v82, v247
  v_mul_f32 v76, v228, v1
  v_mul_f32 v77, v229, v1
  v_mul_f32 v78, v230, v1
  v_mul_f32 v79, v231, v1
  v_exp_f32 v76, v76
  v_exp_f32 v77, v77
  v_exp_f32 v78, v78
  v_exp_f32 v79, v79
  v_fma_f32 v76, v76, v83, v83
  v_fma_f32 v77, v77, v83, v83
  v_fma_f32 v78, v78, v83, v83
  v_fma_f32 v79, v79, v83, v83
  v_rcp_f32 v76, v76
  v_rcp_f32 v77, v77
  v_rcp_f32 v78, v78
  v_rcp_f32 v79, v79
  v_mul_f32 v76, v76, v244
  v_mul_f32 v77, v77, v245
  v_mul_f32 v78, v78, v246
  v_mul_f32 v79, v79, v247
  v_cvt_pk_bf16_f32 v228, v76, v77
  v_cvt_pk_bf16_f32 v229, v78, v79
  v_fma_f32 v196, v36, v82, v196
  v_fma_f32 v197, v37, v82, v197
  v_fma_f32 v198, v38, v82, v198
  v_fma_f32 v199, v39, v82, v199
  v_fma_f32 v212, v40, v82, v212
  v_fma_f32 v213, v41, v82, v213
  v_fma_f32 v214, v42, v82, v214
  v_fma_f32 v215, v43, v82, v215
  v_mul_f32 v72, v196, v1
  v_mul_f32 v73, v197, v1
  v_mul_f32 v74, v198, v1
  v_mul_f32 v75, v199, v1
  v_exp_f32 v72, v72
  v_exp_f32 v73, v73
  v_exp_f32 v74, v74
  v_exp_f32 v75, v75
  v_fma_f32 v72, v72, v83, v83
  v_fma_f32 v73, v73, v83, v83
  v_fma_f32 v74, v74, v83, v83
  v_fma_f32 v75, v75, v83, v83
  v_rcp_f32 v72, v72
  v_rcp_f32 v73, v73
  v_rcp_f32 v74, v74
  v_rcp_f32 v75, v75
  v_mul_f32 v72, v72, v212
  v_mul_f32 v73, v73, v213
  v_mul_f32 v74, v74, v214
  v_mul_f32 v75, v75, v215
  v_cvt_pk_bf16_f32 v196, v72, v73
  v_cvt_pk_bf16_f32 v197, v74, v75
  v_mov_b32 v198, v228
  v_mov_b32 v199, v229
  buffer_store_dwordx4 v[196:199], v9, s[64:67], s51 offen offset:1024 sc1
  v_fma_f32 v232, v44, v84, v232
  v_fma_f32 v233, v45, v84, v233
  v_fma_f32 v234, v46, v84, v234
  v_fma_f32 v235, v47, v84, v235
  v_fma_f32 v248, v48, v84, v248
  v_fma_f32 v249, v49, v84, v249
  v_fma_f32 v250, v50, v84, v250
  v_fma_f32 v251, v51, v84, v251
  v_mul_f32 v76, v232, v10
  v_mul_f32 v77, v233, v10
  v_mul_f32 v78, v234, v10
  v_mul_f32 v79, v235, v10
  v_exp_f32 v76, v76
  v_exp_f32 v77, v77
  v_exp_f32 v78, v78
  v_exp_f32 v79, v79
  v_fma_f32 v76, v76, v85, v85
  v_fma_f32 v77, v77, v85, v85
  v_fma_f32 v78, v78, v85, v85
  v_fma_f32 v79, v79, v85, v85
  v_rcp_f32 v76, v76
  v_rcp_f32 v77, v77
  v_rcp_f32 v78, v78
  v_rcp_f32 v79, v79
  v_mul_f32 v76, v76, v248
  v_mul_f32 v77, v77, v249
  v_mul_f32 v78, v78, v250
  v_mul_f32 v79, v79, v251
  v_cvt_pk_bf16_f32 v232, v76, v77
  v_cvt_pk_bf16_f32 v233, v78, v79
  v_fma_f32 v200, v36, v84, v200
  v_fma_f32 v201, v37, v84, v201
  v_fma_f32 v202, v38, v84, v202
  v_fma_f32 v203, v39, v84, v203
  v_fma_f32 v216, v40, v84, v216
  v_fma_f32 v217, v41, v84, v217
  v_fma_f32 v218, v42, v84, v218
  v_fma_f32 v219, v43, v84, v219
  v_mul_f32 v72, v200, v10
  v_mul_f32 v73, v201, v10
  v_mul_f32 v74, v202, v10
  v_mul_f32 v75, v203, v10
  v_exp_f32 v72, v72
  v_exp_f32 v73, v73
  v_exp_f32 v74, v74
  v_exp_f32 v75, v75
  v_fma_f32 v72, v72, v85, v85
  v_fma_f32 v73, v73, v85, v85
  v_fma_f32 v74, v74, v85, v85
  v_fma_f32 v75, v75, v85, v85
  v_rcp_f32 v72, v72
  v_rcp_f32 v73, v73
  v_rcp_f32 v74, v74
  v_rcp_f32 v75, v75
  v_mul_f32 v72, v72, v216
  v_mul_f32 v73, v73, v217
  v_mul_f32 v74, v74, v218
  v_mul_f32 v75, v75, v219
  v_cvt_pk_bf16_f32 v200, v72, v73
  v_cvt_pk_bf16_f32 v201, v74, v75
  v_mov_b32 v202, v232
  v_mov_b32 v203, v233
  buffer_store_dwordx4 v[200:203], v9, s[64:67], s51 offen offset:2048 sc1
  v_fma_f32 v236, v44, v86, v236
  v_fma_f32 v237, v45, v86, v237
  v_fma_f32 v238, v46, v86, v238
  v_fma_f32 v239, v47, v86, v239
  v_fma_f32 v252, v48, v86, v252
  v_fma_f32 v253, v49, v86, v253
  v_fma_f32 v254, v50, v86, v254
  v_fma_f32 v255, v51, v86, v255
  v_mul_f32 v76, v236, v11
  v_mul_f32 v77, v237, v11
  v_mul_f32 v78, v238, v11
  v_mul_f32 v79, v239, v11
  v_exp_f32 v76, v76
  v_exp_f32 v77, v77
  v_exp_f32 v78, v78
  v_exp_f32 v79, v79
  v_fma_f32 v76, v76, v87, v87
  v_fma_f32 v77, v77, v87, v87
  v_fma_f32 v78, v78, v87, v87
  v_fma_f32 v79, v79, v87, v87
  v_rcp_f32 v76, v76
  v_rcp_f32 v77, v77
  v_rcp_f32 v78, v78
  v_rcp_f32 v79, v79
  v_mul_f32 v76, v76, v252
  v_mul_f32 v77, v77, v253
  v_mul_f32 v78, v78, v254
  v_mul_f32 v79, v79, v255
  v_cvt_pk_bf16_f32 v236, v76, v77
  v_cvt_pk_bf16_f32 v237, v78, v79
  v_fma_f32 v204, v36, v86, v204
  v_fma_f32 v205, v37, v86, v205
  v_fma_f32 v206, v38, v86, v206
  v_fma_f32 v207, v39, v86, v207
  v_fma_f32 v220, v40, v86, v220
  v_fma_f32 v221, v41, v86, v221
  v_fma_f32 v222, v42, v86, v222
  v_fma_f32 v223, v43, v86, v223
  v_mul_f32 v72, v204, v11
  v_mul_f32 v73, v205, v11
  v_mul_f32 v74, v206, v11
  v_mul_f32 v75, v207, v11
  v_exp_f32 v72, v72
  v_exp_f32 v73, v73
  v_exp_f32 v74, v74
  v_exp_f32 v75, v75
  v_fma_f32 v72, v72, v87, v87
  v_fma_f32 v73, v73, v87, v87
  v_fma_f32 v74, v74, v87, v87
  v_fma_f32 v75, v75, v87, v87
  v_rcp_f32 v72, v72
  v_rcp_f32 v73, v73
  v_rcp_f32 v74, v74
  v_rcp_f32 v75, v75
  v_mul_f32 v72, v72, v220
  v_mul_f32 v73, v73, v221
  v_mul_f32 v74, v74, v222
  v_mul_f32 v75, v75, v223
  v_cvt_pk_bf16_f32 v204, v72, v73
  v_cvt_pk_bf16_f32 v205, v74, v75
  v_mov_b32 v206, v236
  v_mov_b32 v207, v237
  buffer_store_dwordx4 v[204:207], v9, s[64:67], s51 offen offset:3072 sc1
  v_fma_f32 v96, v12, v80, v96
  v_fma_f32 v97, v13, v80, v97
  v_fma_f32 v98, v14, v80, v98
  v_fma_f32 v99, v15, v80, v99
  v_mul_f32 v96, v96, v2
  v_mul_f32 v97, v97, v2
  v_mul_f32 v98, v98, v2
  v_mul_f32 v99, v99, v2
  v_cvt_pk_bf16_f32 v96, v96, v97
  v_cvt_pk_bf16_f32 v97, v98, v99
  v_fma_f32 v112, v16, v80, v112
  v_fma_f32 v113, v17, v80, v113
  v_fma_f32 v114, v18, v80, v114
  v_fma_f32 v115, v19, v80, v115
  v_mul_f32 v112, v112, v2
  v_mul_f32 v113, v113, v2
  v_mul_f32 v114, v114, v2
  v_mul_f32 v115, v115, v2
  v_cvt_pk_bf16_f32 v98, v112, v113
  v_cvt_pk_bf16_f32 v99, v114, v115
  v_fma_f32 v100, v12, v82, v100
  v_fma_f32 v101, v13, v82, v101
  v_fma_f32 v102, v14, v82, v102
  v_fma_f32 v103, v15, v82, v103
  v_mul_f32 v100, v100, v3
  v_mul_f32 v101, v101, v3
  v_mul_f32 v102, v102, v3
  v_mul_f32 v103, v103, v3
  v_cvt_pk_bf16_f32 v100, v100, v101
  v_cvt_pk_bf16_f32 v101, v102, v103
  v_fma_f32 v116, v16, v82, v116
  v_fma_f32 v117, v17, v82, v117
  v_fma_f32 v118, v18, v82, v118
  v_fma_f32 v119, v19, v82, v119
  v_mul_f32 v116, v116, v3
  v_mul_f32 v117, v117, v3
  v_mul_f32 v118, v118, v3
  v_mul_f32 v119, v119, v3
  v_cvt_pk_bf16_f32 v102, v116, v117
  v_cvt_pk_bf16_f32 v103, v118, v119
  v_fma_f32 v104, v12, v84, v104
  v_fma_f32 v105, v13, v84, v105
  v_fma_f32 v106, v14, v84, v106
  v_fma_f32 v107, v15, v84, v107
  v_mul_f32 v104, v104, v4
  v_mul_f32 v105, v105, v4
  v_mul_f32 v106, v106, v4
  v_mul_f32 v107, v107, v4
  v_cvt_pk_bf16_f32 v104, v104, v105
  v_cvt_pk_bf16_f32 v105, v106, v107
  v_fma_f32 v120, v16, v84, v120
  v_fma_f32 v121, v17, v84, v121
  v_fma_f32 v122, v18, v84, v122
  v_fma_f32 v123, v19, v84, v123
  v_mul_f32 v120, v120, v4
  v_mul_f32 v121, v121, v4
  v_mul_f32 v122, v122, v4
  v_mul_f32 v123, v123, v4
  v_cvt_pk_bf16_f32 v106, v120, v121
  v_cvt_pk_bf16_f32 v107, v122, v123
  v_fma_f32 v108, v12, v86, v108
  v_fma_f32 v109, v13, v86, v109
  v_fma_f32 v110, v14, v86, v110
  v_fma_f32 v111, v15, v86, v111
  v_mul_f32 v108, v108, v5
  v_mul_f32 v109, v109, v5
  v_mul_f32 v110, v110, v5
  v_mul_f32 v111, v111, v5
  v_cvt_pk_bf16_f32 v108, v108, v109
  v_cvt_pk_bf16_f32 v109, v110, v111
  v_fma_f32 v124, v16, v86, v124
  v_fma_f32 v125, v17, v86, v125
  v_fma_f32 v126, v18, v86, v126
  v_fma_f32 v127, v19, v86, v127
  v_mul_f32 v124, v124, v5
  v_mul_f32 v125, v125, v5
  v_mul_f32 v126, v126, v5
  v_mul_f32 v127, v127, v5
  v_cvt_pk_bf16_f32 v110, v124, v125
  v_cvt_pk_bf16_f32 v111, v126, v127
  s_barrier
  ds_read_b128 v[12:15], v53 offset:0
  ds_read_b128 v[16:19], v53 offset:1024
  ds_read_b128 v[20:23], v53 offset:2048
  ds_read_b128 v[24:27], v53 offset:3072
  ds_read_b128 v[28:31], v53 offset:4096
  ds_read_b128 v[32:35], v53 offset:5120
  ds_read_b128 v[36:39], v53 offset:6144
  s_lshl_b32 s53, s7, 11
  s_lshl_b32 s55, s3, 7
  s_add_u32 s53, s53, s55
  s_lshl_b32 s55, s6, 2
  s_add_u32 s53, s53, s55
  s_add_u32 s53, s53, 50331648
  v_mov_b32 v58, 1
  v_mov_b32 v59, 0
  s_waitcnt vmcnt(4)
  s_mov_b64 exec, 1
  buffer_store_dword v58, v59, s[64:67], s53 offen sc1
  s_mov_b64 exec, -1
  ds_read_b64_tr_b16 v[88:89], v56 offset:0
  ds_read_b64_tr_b16 v[90:91], v56 offset:1024
  ds_read_b64_tr_b16 v[92:93], v56 offset:32
  ds_read_b64_tr_b16 v[94:95], v56 offset:1056
  s_waitcnt lgkmcnt(0)
  v_lshrrev_b32 v232, 4, v9
  v_lshrrev_b32 v233, 4, v232
  v_and_b32 v232, 15, v232
  v_lshrrev_b32 v234, 2, v232
  v_and_b32 v235, 3, v232
  v_cmp_eq_u32 vcc, v234, v233
  v_and_b32 v236, 1, v235
  v_lshlrev_b32 v236, 4, v236
  v_mov_b32 v237, 0x3f80
  v_lshlrev_b32 v237, v236, v237
  v_cndmask_b32 v237, 0, v237, vcc
  v_cmp_gt_u32 vcc, 2, v235
  v_mov_b32 v204, 0
  v_mov_b32 v205, 0
  v_cndmask_b32 v206, 0, v237, vcc
  v_cndmask_b32 v207, v237, 0, vcc
  v_mov_b32 v208, 0
  v_mov_b32 v209, 0
  v_mov_b32 v212, s78
  v_mov_b32 v213, s78
  v_mov_b32 v214, s78
  v_mov_b32 v215, s78
  v_mfma_f32_16x16x32_bf16 v[224:227], v[88:91], v[12:15], 0
  v_mfma_f32_16x16x32_bf16 v[228:231], v[92:95], v[12:15], 0
  s_nop 7
  v_max3_f32 v232, v224, v225, v226
  v_min3_f32 v233, v224, v225, v226
  v_max3_f32 v232, v232, v227, v228
  v_min3_f32 v233, v233, v227, v228
  v_max3_f32 v232, v232, v229, v230
  v_min3_f32 v233, v233, v229, v230
  v_max_f32 v232, v232, v231
  v_min_f32 v233, v233, v231
  v_mov_b32 v234, v232
  v_mov_b32 v235, v233
  s_nop 1
  v_permlane16_swap_b32 v232, v234
  v_permlane16_swap_b32 v233, v235
  v_max_f32 v232, v232, v234
  v_min_f32 v233, v233, v235
  v_mov_b32 v234, v232
  v_mov_b32 v235, v233
  s_nop 1
  v_permlane32_swap_b32 v232, v234
  v_permlane32_swap_b32 v233, v235
  v_max_f32 v232, v232, v234
  v_min_f32 v233, v233, v235
  v_mul_f32 v232, s72, v232
  v_mul_f32 v233, s73, v233
  v_fma_f32 v236, v224, s73, v232
  v_fma_f32 v244, v224, s72, v233
  v_fma_f32 v237, v225, s73, v232
  v_fma_f32 v245, v225, s72, v233
  v_fma_f32 v238, v226, s73, v232
  v_fma_f32 v246, v226, s72, v233
  v_fma_f32 v239, v227, s73, v232
  v_fma_f32 v247, v227, s72, v233
  v_fma_f32 v240, v228, s73, v232
  v_fma_f32 v248, v228, s72, v233
  v_fma_f32 v241, v229, s73, v232
  v_fma_f32 v249, v229, s72, v233
  v_fma_f32 v242, v230, s73, v232
  v_fma_f32 v250, v230, s72, v233
  v_fma_f32 v243, v231, s73, v232
  v_fma_f32 v251, v231, s72, v233
  v_exp_f32 v236, v236
  v_exp_f32 v244, v244
  v_exp_f32 v237, v237
  v_exp_f32 v245, v245
  v_exp_f32 v238, v238
  v_exp_f32 v246, v246
  v_exp_f32 v239, v239
  v_exp_f32 v247, v247
  v_exp_f32 v240, v240
  v_exp_f32 v248, v248
  v_exp_f32 v241, v241
  v_exp_f32 v249, v249
  v_exp_f32 v242, v242
  v_exp_f32 v250, v250
  v_exp_f32 v243, v243
  v_exp_f32 v251, v251
  v_add_f32 v252, v236, v237
  v_add_f32 v253, v244, v245
  v_add_f32 v252, v252, v238
  v_add_f32 v253, v253, v246
  v_add_f32 v252, v252, v239
  v_add_f32 v253, v253, v247
  v_add_f32 v252, v252, v240
  v_add_f32 v253, v253, v248
  v_add_f32 v252, v252, v241
  v_add_f32 v253, v253, v249
  v_add_f32 v252, v252, v242
  v_add_f32 v253, v253, v250
  v_add_f32 v252, v252, v243
  v_add_f32 v253, v253, v251
  v_mov_b32 v234, v252
  v_mov_b32 v235, v253
  s_nop 1
  v_permlane16_swap_b32 v252, v234
  v_permlane16_swap_b32 v253, v235
  v_add_f32 v252, v252, v234
  v_add_f32 v253, v253, v235
  v_mov_b32 v234, v252
  v_mov_b32 v235, v253
  s_nop 1
  v_permlane32_swap_b32 v252, v234
  v_permlane32_swap_b32 v253, v235
  v_add_f32 v252, v252, v234
  v_add_f32 v253, v253, v235
  v_rcp_f32 v252, v252
  v_rcp_f32 v253, v253
  s_nop 0
  v_mul_f32 v236, v236, v252
  v_mul_f32 v244, v244, v253
  v_mul_f32 v237, v237, v252
  v_mul_f32 v245, v245, v253
  v_mul_f32 v238, v238, v252
  v_mul_f32 v246, v246, v253
  v_mul_f32 v239, v239, v252
  v_mul_f32 v247, v247, v253
  v_mul_f32 v240, v240, v252
  v_mul_f32 v248, v248, v253
  v_mul_f32 v241, v241, v252
  v_mul_f32 v249, v249, v253
  v_mul_f32 v242, v242, v252
  v_mul_f32 v250, v250, v253
  v_mul_f32 v243, v243, v252
  v_mul_f32 v251, v251, v253
  v_cvt_pk_bf16_f32 v216, v236, v237
  v_cvt_pk_bf16_f32 v220, v244, v245
  v_cvt_pk_bf16_f32 v217, v238, v239
  v_cvt_pk_bf16_f32 v221, v246, v247
  v_cvt_pk_bf16_f32 v218, v240, v241
  v_cvt_pk_bf16_f32 v222, v248, v249
  v_cvt_pk_bf16_f32 v219, v242, v243
  v_cvt_pk_bf16_f32 v223, v250, v251
  s_nop 1
  v_mfma_f32_16x16x32_bf16 v[172:175], v[216:219], v[206:209], 0
  v_mfma_f32_16x16x32_bf16 v[176:179], v[216:219], v[204:207], 0
  v_mfma_f32_16x16x32_bf16 v[180:183], v[220:223], v[206:209], 0
  v_mfma_f32_16x16x32_bf16 v[184:187], v[220:223], v[204:207], 0
  v_mfma_f32_16x16x32_bf16 v[224:227], v[88:91], v[16:19], 0
  v_mfma_f32_16x16x32_bf16 v[228:231], v[92:95], v[16:19], 0
  s_nop 7
  v_max3_f32 v232, v224, v225, v226
  v_min3_f32 v233, v224, v225, v226
  v_max3_f32 v232, v232, v227, v228
  v_min3_f32 v233, v233, v227, v228
  v_max3_f32 v232, v232, v229, v230
  v_min3_f32 v233, v233, v229, v230
  v_max_f32 v232, v232, v231
  v_min_f32 v233, v233, v231
  v_mov_b32 v234, v232
  v_mov_b32 v235, v233
  s_nop 1
  v_permlane16_swap_b32 v232, v234
  v_permlane16_swap_b32 v233, v235
  v_max_f32 v232, v232, v234
  v_min_f32 v233, v233, v235
  v_mov_b32 v234, v232
  v_mov_b32 v235, v233
  s_nop 1
  v_permlane32_swap_b32 v232, v234
  v_permlane32_swap_b32 v233, v235
  v_max_f32 v232, v232, v234
  v_min_f32 v233, v233, v235
  v_mul_f32 v232, s72, v232
  v_mul_f32 v233, s73, v233
  v_fma_f32 v236, v224, s73, v232
  v_fma_f32 v244, v224, s72, v233
  v_fma_f32 v237, v225, s73, v232
  v_fma_f32 v245, v225, s72, v233
  v_fma_f32 v238, v226, s73, v232
  v_fma_f32 v246, v226, s72, v233
  v_fma_f32 v239, v227, s73, v232
  v_fma_f32 v247, v227, s72, v233
  v_fma_f32 v240, v228, s73, v232
  v_fma_f32 v248, v228, s72, v233
  v_fma_f32 v241, v229, s73, v232
  v_fma_f32 v249, v229, s72, v233
  v_fma_f32 v242, v230, s73, v232
  v_fma_f32 v250, v230, s72, v233
  v_fma_f32 v243, v231, s73, v232
  v_fma_f32 v251, v231, s72, v233
  v_exp_f32 v236, v236
  v_exp_f32 v244, v244
  v_exp_f32 v237, v237
  v_exp_f32 v245, v245
  v_exp_f32 v238, v238
  v_exp_f32 v246, v246
  v_exp_f32 v239, v239
  v_exp_f32 v247, v247
  v_exp_f32 v240, v240
  v_exp_f32 v248, v248
  v_exp_f32 v241, v241
  v_exp_f32 v249, v249
  v_exp_f32 v242, v242
  v_exp_f32 v250, v250
  v_exp_f32 v243, v243
  v_exp_f32 v251, v251
  v_add_f32 v252, v236, v237
  v_add_f32 v253, v244, v245
  v_add_f32 v252, v252, v238
  v_add_f32 v253, v253, v246
  v_add_f32 v252, v252, v239
  v_add_f32 v253, v253, v247
  v_add_f32 v252, v252, v240
  v_add_f32 v253, v253, v248
  v_add_f32 v252, v252, v241
  v_add_f32 v253, v253, v249
  v_add_f32 v252, v252, v242
  v_add_f32 v253, v253, v250
  v_add_f32 v252, v252, v243
  v_add_f32 v253, v253, v251
  v_mov_b32 v234, v252
  v_mov_b32 v235, v253
  s_nop 1
  v_permlane16_swap_b32 v252, v234
  v_permlane16_swap_b32 v253, v235
  v_add_f32 v252, v252, v234
  v_add_f32 v253, v253, v235
  v_mov_b32 v234, v252
  v_mov_b32 v235, v253
  s_nop 1
  v_permlane32_swap_b32 v252, v234
  v_permlane32_swap_b32 v253, v235
  v_add_f32 v252, v252, v234
  v_add_f32 v253, v253, v235
  v_rcp_f32 v252, v252
  v_rcp_f32 v253, v253
  s_nop 0
  v_mul_f32 v236, v236, v252
  v_mul_f32 v244, v244, v253
  v_mul_f32 v237, v237, v252
  v_mul_f32 v245, v245, v253
  v_mul_f32 v238, v238, v252
  v_mul_f32 v246, v246, v253
  v_mul_f32 v239, v239, v252
  v_mul_f32 v247, v247, v253
  v_mul_f32 v240, v240, v252
  v_mul_f32 v248, v248, v253
  v_mul_f32 v241, v241, v252
  v_mul_f32 v249, v249, v253
  v_mul_f32 v242, v242, v252
  v_mul_f32 v250, v250, v253
  v_mul_f32 v243, v243, v252
  v_mul_f32 v251, v251, v253
  v_cvt_pk_bf16_f32 v216, v236, v237
  v_cvt_pk_bf16_f32 v220, v244, v245
  v_cvt_pk_bf16_f32 v217, v238, v239
  v_cvt_pk_bf16_f32 v221, v246, v247
  v_cvt_pk_bf16_f32 v218, v240, v241
  v_cvt_pk_bf16_f32 v222, v248, v249
  v_cvt_pk_bf16_f32 v219, v242, v243
  v_cvt_pk_bf16_f32 v223, v250, v251
  s_nop 1
  v_mfma_f32_16x16x32_bf16 v[188:191], v[216:219], v[206:209], 0
  v_mfma_f32_16x16x32_bf16 v[192:195], v[216:219], v[204:207], 0
  v_mfma_f32_16x16x32_bf16 v[196:199], v[220:223], v[206:209], 0
  v_mfma_f32_16x16x32_bf16 v[200:203], v[220:223], v[204:207], 0
  v_cvt_pk_bf16_f32 v224, v172, v173
  v_cvt_pk_bf16_f32 v225, v174, v175
  v_cvt_pk_bf16_f32 v228, v176, v177
  v_cvt_pk_bf16_f32 v229, v178, v179
  v_cvt_pk_bf16_f32 v232, v180, v181
  v_cvt_pk_bf16_f32 v233, v182, v183
  v_cvt_pk_bf16_f32 v236, v184, v185
  v_cvt_pk_bf16_f32 v237, v186, v187
  v_cvt_pk_bf16_f32 v226, v188, v189
  v_cvt_pk_bf16_f32 v227, v190, v191
  v_cvt_pk_bf16_f32 v230, v192, v193
  v_cvt_pk_bf16_f32 v231, v194, v195
  v_cvt_pk_bf16_f32 v234, v196, v197
  v_cvt_pk_bf16_f32 v235, v198, v199
  v_cvt_pk_bf16_f32 v238, v200, v201
  v_cvt_pk_bf16_f32 v239, v202, v203
  s_nop 1
  v_mfma_f32_16x16x32_bf16 v[124:127], v[224:227], v[20:23], 0
  v_mfma_f32_16x16x32_bf16 v[128:131], v[224:227], v[24:27], 0
  v_mfma_f32_16x16x32_bf16 v[132:135], v[224:227], v[212:215], 0
  v_mfma_f32_16x16x32_bf16 v[136:139], v[228:231], v[20:23], 0
  v_mfma_f32_16x16x32_bf16 v[140:143], v[228:231], v[24:27], 0
  v_mfma_f32_16x16x32_bf16 v[144:147], v[228:231], v[212:215], 0
  v_mfma_f32_16x16x32_bf16 v[148:151], v[232:235], v[20:23], 0
  v_mfma_f32_16x16x32_bf16 v[152:155], v[232:235], v[24:27], 0
  v_mfma_f32_16x16x32_bf16 v[156:159], v[232:235], v[212:215], 0
  v_mfma_f32_16x16x32_bf16 v[160:163], v[236:239], v[20:23], 0
  v_mfma_f32_16x16x32_bf16 v[164:167], v[236:239], v[24:27], 0
  v_mfma_f32_16x16x32_bf16 v[168:171], v[236:239], v[212:215], 0
  s_nop 3
  v_mfma_f32_16x16x32_bf16 v[224:227], v[88:91], v[28:31], 0
  v_mfma_f32_16x16x32_bf16 v[228:231], v[92:95], v[28:31], 0
  s_nop 7
  v_max3_f32 v232, v224, v225, v226
  v_min3_f32 v233, v224, v225, v226
  v_max3_f32 v232, v232, v227, v228
  v_min3_f32 v233, v233, v227, v228
  v_max3_f32 v232, v232, v229, v230
  v_min3_f32 v233, v233, v229, v230
  v_max_f32 v232, v232, v231
  v_min_f32 v233, v233, v231
  v_mov_b32 v234, v232
  v_mov_b32 v235, v233
  s_nop 1
  v_permlane16_swap_b32 v232, v234
  v_permlane16_swap_b32 v233, v235
  v_max_f32 v232, v232, v234
  v_min_f32 v233, v233, v235
  v_mov_b32 v234, v232
  v_mov_b32 v235, v233
  s_nop 1
  v_permlane32_swap_b32 v232, v234
  v_permlane32_swap_b32 v233, v235
  v_max_f32 v232, v232, v234
  v_min_f32 v233, v233, v235
  v_mul_f32 v232, s72, v232
  v_mul_f32 v233, s73, v233
  v_fma_f32 v236, v224, s73, v232
  v_fma_f32 v244, v224, s72, v233
  v_fma_f32 v237, v225, s73, v232
  v_fma_f32 v245, v225, s72, v233
  v_fma_f32 v238, v226, s73, v232
  v_fma_f32 v246, v226, s72, v233
  v_fma_f32 v239, v227, s73, v232
  v_fma_f32 v247, v227, s72, v233
  v_fma_f32 v240, v228, s73, v232
  v_fma_f32 v248, v228, s72, v233
  v_fma_f32 v241, v229, s73, v232
  v_fma_f32 v249, v229, s72, v233
  v_fma_f32 v242, v230, s73, v232
  v_fma_f32 v250, v230, s72, v233
  v_fma_f32 v243, v231, s73, v232
  v_fma_f32 v251, v231, s72, v233
  v_exp_f32 v236, v236
  v_exp_f32 v244, v244
  v_exp_f32 v237, v237
  v_exp_f32 v245, v245
  v_exp_f32 v238, v238
  v_exp_f32 v246, v246
  v_exp_f32 v239, v239
  v_exp_f32 v247, v247
  v_exp_f32 v240, v240
  v_exp_f32 v248, v248
  v_exp_f32 v241, v241
  v_exp_f32 v249, v249
  v_exp_f32 v242, v242
  v_exp_f32 v250, v250
  v_exp_f32 v243, v243
  v_exp_f32 v251, v251
  v_add_f32 v252, v236, v237
  v_add_f32 v253, v244, v245
  v_add_f32 v252, v252, v238
  v_add_f32 v253, v253, v246
  v_add_f32 v252, v252, v239
  v_add_f32 v253, v253, v247
  v_add_f32 v252, v252, v240
  v_add_f32 v253, v253, v248
  v_add_f32 v252, v252, v241
  v_add_f32 v253, v253, v249
  v_add_f32 v252, v252, v242
  v_add_f32 v253, v253, v250
  v_add_f32 v252, v252, v243
  v_add_f32 v253, v253, v251
  v_mov_b32 v234, v252
  v_mov_b32 v235, v253
  s_nop 1
  v_permlane16_swap_b32 v252, v234
  v_permlane16_swap_b32 v253, v235
  v_add_f32 v252, v252, v234
  v_add_f32 v253, v253, v235
  v_mov_b32 v234, v252
  v_mov_b32 v235, v253
  s_nop 1
  v_permlane32_swap_b32 v252, v234
  v_permlane32_swap_b32 v253, v235
  v_add_f32 v252, v252, v234
  v_add_f32 v253, v253, v235
  v_rcp_f32 v252, v252
  v_rcp_f32 v253, v253
  s_nop 0
  v_mul_f32 v236, v236, v252
  v_mul_f32 v244, v244, v253
  v_mul_f32 v237, v237, v252
  v_mul_f32 v245, v245, v253
  v_mul_f32 v238, v238, v252
  v_mul_f32 v246, v246, v253
  v_mul_f32 v239, v239, v252
  v_mul_f32 v247, v247, v253
  v_mul_f32 v240, v240, v252
  v_mul_f32 v248, v248, v253
  v_mul_f32 v241, v241, v252
  v_mul_f32 v249, v249, v253
  v_mul_f32 v242, v242, v252
  v_mul_f32 v250, v250, v253
  v_mul_f32 v243, v243, v252
  v_mul_f32 v251, v251, v253
  v_cvt_pk_bf16_f32 v216, v236, v237
  v_cvt_pk_bf16_f32 v220, v244, v245
  v_cvt_pk_bf16_f32 v217, v238, v239
  v_cvt_pk_bf16_f32 v221, v246, v247
  v_cvt_pk_bf16_f32 v218, v240, v241
  v_cvt_pk_bf16_f32 v222, v248, v249
  v_cvt_pk_bf16_f32 v219, v242, v243
  v_cvt_pk_bf16_f32 v223, v250, v251
  s_nop 1
  v_mfma_f32_16x16x32_bf16 v[188:191], v[216:219], v[206:209], 0
  v_mfma_f32_16x16x32_bf16 v[192:195], v[216:219], v[204:207], 0
  v_mfma_f32_16x16x32_bf16 v[196:199], v[220:223], v[206:209], 0
  v_mfma_f32_16x16x32_bf16 v[200:203], v[220:223], v[204:207], 0
  v_mov_b32 v224, 0
  v_mov_b32 v225, 0
  v_mov_b32 v228, 0
  v_mov_b32 v229, 0
  v_mov_b32 v232, 0
  v_mov_b32 v233, 0
  v_mov_b32 v236, 0
  v_mov_b32 v237, 0
  v_cvt_pk_bf16_f32 v226, v188, v189
  v_cvt_pk_bf16_f32 v227, v190, v191
  v_cvt_pk_bf16_f32 v230, v192, v193
  v_cvt_pk_bf16_f32 v231, v194, v195
  v_cvt_pk_bf16_f32 v234, v196, v197
  v_cvt_pk_bf16_f32 v235, v198, v199
  v_cvt_pk_bf16_f32 v238, v200, v201
  v_cvt_pk_bf16_f32 v239, v202, v203
  s_nop 1
  v_mfma_f32_16x16x32_bf16 v[124:127], v[224:227], v[32:35], v[124:127]
  v_mfma_f32_16x16x32_bf16 v[128:131], v[224:227], v[36:39], v[128:131]
  v_mfma_f32_16x16x32_bf16 v[132:135], v[224:227], v[212:215], v[132:135]
  v_mfma_f32_16x16x32_bf16 v[136:139], v[228:231], v[32:35], v[136:139]
  v_mfma_f32_16x16x32_bf16 v[140:143], v[228:231], v[36:39], v[140:143]
  v_mfma_f32_16x16x32_bf16 v[144:147], v[228:231], v[212:215], v[144:147]
  v_mfma_f32_16x16x32_bf16 v[148:151], v[232:235], v[32:35], v[148:151]
  v_mfma_f32_16x16x32_bf16 v[152:155], v[232:235], v[36:39], v[152:155]
  v_mfma_f32_16x16x32_bf16 v[156:159], v[232:235], v[212:215], v[156:159]
  v_mfma_f32_16x16x32_bf16 v[160:163], v[236:239], v[32:35], v[160:163]
  v_mfma_f32_16x16x32_bf16 v[164:167], v[236:239], v[36:39], v[164:167]
  v_mfma_f32_16x16x32_bf16 v[168:171], v[236:239], v[212:215], v[168:171]
  s_nop 7
  s_mul_i32 s51, s3, 12288
  v_add_u32 v20, s51, v9
  ds_write_b128 v20, v[124:127] offset:0
  ds_write_b128 v20, v[128:131] offset:1024
  ds_write_b128 v20, v[132:135] offset:2048
  ds_write_b128 v20, v[136:139] offset:3072
  ds_write_b128 v20, v[140:143] offset:4096
  ds_write_b128 v20, v[144:147] offset:5120
  ds_write_b128 v20, v[148:151] offset:6144
  ds_write_b128 v20, v[152:155] offset:7168
  ds_write_b128 v20, v[156:159] offset:8192
  ds_write_b128 v20, v[160:163] offset:9216
  ds_write_b128 v20, v[164:167] offset:10240
  ds_write_b128 v20, v[168:171] offset:11264
  s_waitcnt lgkmcnt(0)
  s_barrier
  s_lshr_b32 s50, s3, 1
  s_mul_i32 s50, s50, 3
  s_and_b32 s51, s3, 1
  s_add_u32 s50, s50, s51
  s_lshl_b32 s50, s50, 10
  v_add_u32 v20, s50, v9
  v_add_u32 v22, 49152, v20
  ds_read_b128 v[124:127], v20 offset:0
  ds_read_b128 v[128:131], v20 offset:12288
  ds_read_b128 v[132:135], v20 offset:24576
  ds_read_b128 v[136:139], v20 offset:36864
  ds_read_b128 v[140:143], v22 offset:0
  ds_read_b128 v[144:147], v22 offset:12288
  ds_read_b128 v[148:151], v22 offset:24576
  ds_read_b128 v[152:155], v22 offset:36864
  s_mul_i32 s50, s3, 3072
  v_add_u32 v21, s50, v9
  v_add_u32 v23, 49152, v21
  ds_read_b128 v[156:159], v21 offset:2048
  ds_read_b128 v[160:163], v21 offset:14336
  ds_read_b128 v[164:167], v21 offset:26624
  ds_read_b128 v[168:171], v21 offset:38912
  ds_read_b128 v[172:175], v23 offset:2048
  ds_read_b128 v[176:179], v23 offset:14336
  ds_read_b128 v[180:183], v23 offset:26624
  ds_read_b128 v[184:187], v23 offset:38912
  s_lshl_b32 s50, s6, 3
  s_add_u32 s50, s50, s7
  s_mul_i32 s50, s50, 8448
  s_add_u32 s50, s50, 29360128
  s_lshl_b32 s51, s3, 10
  s_add_u32 s51, s51, s50
  s_waitcnt lgkmcnt(0)
  v_add_f32 v124, v124, v140
  v_add_f32 v125, v125, v141
  v_add_f32 v126, v126, v142
  v_add_f32 v127, v127, v143
  v_add_f32 v128, v128, v144
  v_add_f32 v129, v129, v145
  v_add_f32 v130, v130, v146
  v_add_f32 v131, v131, v147
  v_add_f32 v132, v132, v148
  v_add_f32 v133, v133, v149
  v_add_f32 v134, v134, v150
  v_add_f32 v135, v135, v151
  v_add_f32 v136, v136, v152
  v_add_f32 v137, v137, v153
  v_add_f32 v138, v138, v154
  v_add_f32 v139, v139, v155
  v_add_f32 v124, v124, v132
  v_add_f32 v125, v125, v133
  v_add_f32 v126, v126, v134
  v_add_f32 v127, v127, v135
  v_add_f32 v128, v128, v136
  v_add_f32 v129, v129, v137
  v_add_f32 v130, v130, v138
  v_add_f32 v131, v131, v139
  v_add_f32 v124, v124, v128
  v_add_f32 v125, v125, v129
  v_add_f32 v126, v126, v130
  v_add_f32 v127, v127, v131
  v_add_f32 v156, v156, v172
  v_add_f32 v157, v157, v173
  v_add_f32 v158, v158, v174
  v_add_f32 v159, v159, v175
  v_add_f32 v160, v160, v176
  v_add_f32 v161, v161, v177
  v_add_f32 v162, v162, v178
  v_add_f32 v163, v163, v179
  v_add_f32 v164, v164, v180
  v_add_f32 v165, v165, v181
  v_add_f32 v166, v166, v182
  v_add_f32 v167, v167, v183
  v_add_f32 v168, v168, v184
  v_add_f32 v169, v169, v185
  v_add_f32 v170, v170, v186
  v_add_f32 v171, v171, v187
  v_add_f32 v156, v156, v164
  v_add_f32 v157, v157, v165
  v_add_f32 v158, v158, v166
  v_add_f32 v159, v159, v167
  v_add_f32 v160, v160, v168
  v_add_f32 v161, v161, v169
  v_add_f32 v162, v162, v170
  v_add_f32 v163, v163, v171
  v_add_f32 v156, v156, v160
  v_add_f32 v157, v157, v161
  v_add_f32 v158, v158, v162
  v_add_f32 v159, v159, v163
  buffer_store_dwordx4 v[124:127], v9, s[64:67], s51 offen sc1
  s_lshl_b32 s51, s3, 6
  s_add_u32 s51, s51, s50
  s_add_u32 s51, s51, 8192
  v_lshrrev_b32 v21, 4, v9
  v_and_b32 v22, 15, v21
  v_cmp_eq_u32 vcc, 0, v22
  s_and_saveexec_b64 s[52:53], vcc
  buffer_store_dwordx4 v[156:159], v21, s[64:67], s51 offen sc1
  s_mov_b64 exec, -1
  s_branch L_p2_prod
L_pro_w1:
  ds_read_b64_tr_b16 v[60:61], v7 offset:2048
  ds_read_b64_tr_b16 v[62:63], v7 offset:3072
  ds_read_b64_tr_b16 v[64:65], v8 offset:2048
  ds_read_b64_tr_b16 v[66:67], v8 offset:3072
  ds_read_b64_tr_b16 v[68:69], v7 offset:4096
  ds_read_b64_tr_b16 v[70:71], v7 offset:5120
  ds_read_b64_tr_b16 v[72:73], v8 offset:4096
  ds_read_b64_tr_b16 v[74:75], v8 offset:5120
  s_waitcnt lgkmcnt(8)
  s_barrier
  s_waitcnt lgkmcnt(0)
  s_mov_b32 s60, 8
  s_cmp_eq_u32 s4, 1
  s_cbranch_scc1 L_loop5
  s_cmp_eq_u32 s4, 2
  s_cbranch_scc1 L_loop6
  s_cmp_eq_u32 s4, 3
  s_cbranch_scc1 L_loop7
L_loop4:
  s_cmp_eq_u32 s60, s61
  s_cbranch_scc1 L_loopc4
L_loopp4:
  v_mfma_f32_16x16x32_bf16 v[96:99], v[60:63], v[12:15], v[96:99]
  ds_read_b64_tr_b16 v[76:77], v6 offset:6272
  v_mfma_f32_16x16x32_bf16 v[100:103], v[60:63], v[16:19], v[100:103]
  ds_read_b64_tr_b16 v[78:79], v6 offset:9856
  s_cmp_eq_u32 s60, 6
  s_cbranch_scc0 L_nx_33
  s_call_b64 s[74:75], L_x_drain_4
L_nx_33:
  v_mfma_f32_16x16x32_bf16 v[104:107], v[60:63], v[20:23], v[104:107]
  s_add_u32 m0, s33, 128000
  ds_read_b64_tr_b16 v[72:73], v8 offset:4096
  v_mfma_f32_16x16x32_bf16 v[108:111], v[60:63], v[24:27], v[108:111]
  buffer_load_dwordx4 v2, s[12:15], s27 offen lds
  s_add_u32 s27, s27, s30
  ds_read_b64_tr_b16 v[74:75], v8 offset:5120
  v_mfma_f32_16x16x32_bf16 v[124:127], v[64:67], v[24:27], v[124:127]
  v_mfma_f32_16x16x32_bf16 v[120:123], v[64:67], v[20:23], v[120:123]
  v_mfma_f32_16x16x32_bf16 v[116:119], v[64:67], v[16:19], v[116:119]
  s_add_u32 m0, s34, 128000
  v_mfma_f32_16x16x32_bf16 v[112:115], v[64:67], v[12:15], v[112:115]
  buffer_load_dwordx4 v3, s[16:19], s28 offen lds
  s_add_u32 s28, s28, s31
  v_mfma_f32_16x16x32_bf16 v[128:131], v[12:15], v[68:71], v[128:131]
  ds_read_b64_tr_b16 v[64:65], v6 offset:6304
  v_mfma_f32_16x16x32_bf16 v[132:135], v[16:19], v[68:71], v[132:135]
  ds_read_b64_tr_b16 v[66:67], v6 offset:9888
  v_mfma_f32_16x16x32_bf16 v[136:139], v[20:23], v[68:71], v[136:139]
  s_add_u32 m0, s35, 128000
  ds_read_b64_tr_b16 v[60:61], v6 offset:13440
  v_mfma_f32_16x16x32_bf16 v[140:143], v[24:27], v[68:71], v[140:143]
  buffer_load_dwordx4 v4, s[20:23], s29 offen lds
  s_add_u32 s29, s29, s32
  ds_read_b64_tr_b16 v[62:63], v6 offset:17024
  s_waitcnt lgkmcnt(4)
  v_mfma_f32_16x16x32_bf16 v[156:159], v[24:27], v[72:75], v[156:159]
  ds_read_b64_tr_b16 v[68:69], v6 offset:13472
  v_mfma_f32_16x16x32_bf16 v[152:155], v[20:23], v[72:75], v[152:155]
  ds_read_b64_tr_b16 v[70:71], v6 offset:17056
  v_mfma_f32_16x16x32_bf16 v[148:151], v[16:19], v[72:75], v[148:151]
  s_add_u32 s50, s26, 0
  s_add_u32 m0, s24, 0
  v_mfma_f32_16x16x32_bf16 v[144:147], v[12:15], v[72:75], v[144:147]
  buffer_load_dwordx4 v1, s[8:11], s50 offen lds
  v_mfma_f32_16x16x32_bf16 v[160:163], v[76:79], v[12:15], v[160:163]
  ds_read_b64_tr_b16 v[72:73], v6 offset:6336
  v_mfma_f32_16x16x32_bf16 v[164:167], v[76:79], v[16:19], v[164:167]
  ds_read_b64_tr_b16 v[74:75], v6 offset:9920
  v_mfma_f32_16x16x32_bf16 v[168:171], v[76:79], v[20:23], v[168:171]
  s_add_u32 s50, s26, 4096
  s_add_u32 m0, s24, 1040
  v_mfma_f32_16x16x32_bf16 v[172:175], v[76:79], v[24:27], v[172:175]
  buffer_load_dwordx4 v1, s[8:11], s50 offen lds
  s_waitcnt lgkmcnt(4)
  v_mfma_f32_16x16x32_bf16 v[188:191], v[60:63], v[24:27], v[188:191]
  v_mfma_f32_16x16x32_bf16 v[184:187], v[60:63], v[20:23], v[184:187]
  v_mfma_f32_16x16x32_bf16 v[180:183], v[60:63], v[16:19], v[180:183]
  v_mfma_f32_16x16x32_bf16 v[176:179], v[60:63], v[12:15], v[176:179]
  v_mfma_f32_16x16x32_bf16 v[192:195], v[64:67], v[12:15], v[192:195]
  ds_read_b64_tr_b16 v[60:61], v7 offset:22528
  v_mfma_f32_16x16x32_bf16 v[196:199], v[64:67], v[16:19], v[196:199]
  ds_read_b64_tr_b16 v[62:63], v7 offset:23552
  v_mfma_f32_16x16x32_bf16 v[200:203], v[64:67], v[20:23], v[200:203]
  ds_read_b64_tr_b16 v[76:77], v6 offset:13504
  v_mfma_f32_16x16x32_bf16 v[204:207], v[64:67], v[24:27], v[204:207]
  ds_read_b64_tr_b16 v[78:79], v6 offset:17088
  s_waitcnt lgkmcnt(6)
  v_mfma_f32_16x16x32_bf16 v[220:223], v[68:71], v[24:27], v[220:223]
  ds_read_b64_tr_b16 v[64:65], v8 offset:22528
  v_mfma_f32_16x16x32_bf16 v[216:219], v[68:71], v[20:23], v[216:219]
  ds_read_b64_tr_b16 v[66:67], v8 offset:23552
  v_mfma_f32_16x16x32_bf16 v[212:215], v[68:71], v[16:19], v[212:215]
  v_mfma_f32_16x16x32_bf16 v[208:211], v[68:71], v[12:15], v[208:211]
  s_waitcnt lgkmcnt(6)
  v_mfma_f32_16x16x32_bf16 v[224:227], v[72:75], v[12:15], v[224:227]
  ds_read_b64_tr_b16 v[68:69], v7 offset:24576
  v_mfma_f32_16x16x32_bf16 v[228:231], v[72:75], v[16:19], v[228:231]
  ds_read_b64_tr_b16 v[70:71], v7 offset:25600
  v_mfma_f32_16x16x32_bf16 v[232:235], v[72:75], v[20:23], v[232:235]
  v_mfma_f32_16x16x32_bf16 v[236:239], v[72:75], v[24:27], v[236:239]
  s_cmp_eq_u32 s60, 2
  s_cbranch_scc0 L_nx_34
  s_call_b64 s[74:75], L_x_poll_4
L_nx_34:
  s_waitcnt lgkmcnt(4)
  v_mfma_f32_16x16x32_bf16 v[252:255], v[76:79], v[24:27], v[252:255]
  v_mfma_f32_16x16x32_bf16 v[248:251], v[76:79], v[20:23], v[248:251]
  v_mfma_f32_16x16x32_bf16 v[244:247], v[76:79], v[16:19], v[244:247]
  v_mfma_f32_16x16x32_bf16 v[240:243], v[76:79], v[12:15], v[240:243]
  s_waitcnt vmcnt(5)
  s_barrier
  v_mfma_f32_16x16x32_bf16 v[96:99], v[60:63], v[28:31], v[96:99]
  ds_read_b64_tr_b16 v[76:77], v6 offset:26752
  v_mfma_f32_16x16x32_bf16 v[100:103], v[60:63], v[32:35], v[100:103]
  ds_read_b64_tr_b16 v[78:79], v6 offset:30336
  v_mfma_f32_16x16x32_bf16 v[104:107], v[60:63], v[36:39], v[104:107]
  s_add_u32 m0, s33, 66560
  ds_read_b64_tr_b16 v[72:73], v8 offset:24576
  ds_read_b64 v[12:13], v5 offset:33280
  v_mfma_f32_16x16x32_bf16 v[108:111], v[60:63], v[40:43], v[108:111]
  buffer_load_dwordx4 v2, s[12:15], s27 offen lds
  s_add_u32 s27, s27, s30
  ds_read_b64_tr_b16 v[74:75], v8 offset:25600
  ds_read_b64 v[14:15], v5 offset:33312
  s_waitcnt lgkmcnt(8)
  v_mfma_f32_16x16x32_bf16 v[124:127], v[64:67], v[40:43], v[124:127]
  v_mfma_f32_16x16x32_bf16 v[120:123], v[64:67], v[36:39], v[120:123]
  v_mfma_f32_16x16x32_bf16 v[116:119], v[64:67], v[32:35], v[116:119]
  s_add_u32 m0, s34, 66560
  ds_read_b64 v[16:17], v5 offset:33536
  v_mfma_f32_16x16x32_bf16 v[112:115], v[64:67], v[28:31], v[112:115]
  buffer_load_dwordx4 v3, s[16:19], s28 offen lds
  s_add_u32 s28, s28, s31
  ds_read_b64 v[18:19], v5 offset:33568
  s_waitcnt lgkmcnt(8)
  v_mfma_f32_16x16x32_bf16 v[128:131], v[28:31], v[68:71], v[128:131]
  ds_read_b64_tr_b16 v[64:65], v6 offset:26784
  v_mfma_f32_16x16x32_bf16 v[132:135], v[32:35], v[68:71], v[132:135]
  ds_read_b64_tr_b16 v[66:67], v6 offset:30368
  v_mfma_f32_16x16x32_bf16 v[136:139], v[36:39], v[68:71], v[136:139]
  s_add_u32 m0, s35, 66560
  ds_read_b64_tr_b16 v[60:61], v6 offset:33920
  ds_read_b64 v[20:21], v5 offset:33792
  v_mfma_f32_16x16x32_bf16 v[140:143], v[40:43], v[68:71], v[140:143]
  buffer_load_dwordx4 v4, s[20:23], s29 offen lds
  s_add_u32 s29, s29, s32
  ds_read_b64_tr_b16 v[62:63], v6 offset:37504
  ds_read_b64 v[22:23], v5 offset:33824
  s_waitcnt lgkmcnt(9)
  v_mfma_f32_16x16x32_bf16 v[156:159], v[40:43], v[72:75], v[156:159]
  ds_read_b64_tr_b16 v[68:69], v6 offset:33952
  v_mfma_f32_16x16x32_bf16 v[152:155], v[36:39], v[72:75], v[152:155]
  ds_read_b64_tr_b16 v[70:71], v6 offset:37536
  v_mfma_f32_16x16x32_bf16 v[148:151], v[32:35], v[72:75], v[148:151]
  s_add_u32 s50, s26, 262144
  s_add_u32 m0, s24, 16640
  ds_read_b64 v[24:25], v5 offset:34048
  v_mfma_f32_16x16x32_bf16 v[144:147], v[28:31], v[72:75], v[144:147]
  buffer_load_dwordx4 v1, s[8:11], s50 offen lds
  ds_read_b64 v[26:27], v5 offset:34080
  v_mfma_f32_16x16x32_bf16 v[160:163], v[76:79], v[28:31], v[160:163]
  ds_read_b64_tr_b16 v[72:73], v6 offset:26816
  v_mfma_f32_16x16x32_bf16 v[164:167], v[76:79], v[32:35], v[164:167]
  ds_read_b64_tr_b16 v[74:75], v6 offset:30400
  v_mfma_f32_16x16x32_bf16 v[168:171], v[76:79], v[36:39], v[168:171]
  s_add_u32 s50, s26, 266240
  s_add_u32 m0, s24, 17680
  ds_read_b64 v[44:45], v5 offset:33344
  v_mfma_f32_16x16x32_bf16 v[172:175], v[76:79], v[40:43], v[172:175]
  buffer_load_dwordx4 v1, s[8:11], s50 offen lds
  ds_read_b64 v[46:47], v5 offset:33376
  s_waitcnt lgkmcnt(9)
  v_mfma_f32_16x16x32_bf16 v[188:191], v[60:63], v[40:43], v[188:191]
  v_mfma_f32_16x16x32_bf16 v[184:187], v[60:63], v[36:39], v[184:187]
  v_mfma_f32_16x16x32_bf16 v[180:183], v[60:63], v[32:35], v[180:183]
  v_mfma_f32_16x16x32_bf16 v[176:179], v[60:63], v[28:31], v[176:179]
  v_mfma_f32_16x16x32_bf16 v[192:195], v[64:67], v[28:31], v[192:195]
  ds_read_b64_tr_b16 v[60:61], v94 offset:2048
  v_mfma_f32_16x16x32_bf16 v[196:199], v[64:67], v[32:35], v[196:199]
  ds_read_b64_tr_b16 v[62:63], v94 offset:3072
  v_mfma_f32_16x16x32_bf16 v[200:203], v[64:67], v[36:39], v[200:203]
  ds_read_b64_tr_b16 v[76:77], v6 offset:33984
  ds_read_b64 v[48:49], v5 offset:33600
  v_mfma_f32_16x16x32_bf16 v[204:207], v[64:67], v[40:43], v[204:207]
  ds_read_b64_tr_b16 v[78:79], v6 offset:37568
  ds_read_b64 v[50:51], v5 offset:33632
  s_waitcnt lgkmcnt(12)
  v_mfma_f32_16x16x32_bf16 v[220:223], v[68:71], v[40:43], v[220:223]
  ds_read_b64_tr_b16 v[64:65], v95 offset:2048
  v_mfma_f32_16x16x32_bf16 v[216:219], v[68:71], v[36:39], v[216:219]
  ds_read_b64_tr_b16 v[66:67], v95 offset:3072
  v_mfma_f32_16x16x32_bf16 v[212:215], v[68:71], v[32:35], v[212:215]
  ds_read_b64 v[52:53], v5 offset:33856
  v_mfma_f32_16x16x32_bf16 v[208:211], v[68:71], v[28:31], v[208:211]
  ds_read_b64 v[54:55], v5 offset:33888
  s_waitcnt lgkmcnt(12)
  v_mfma_f32_16x16x32_bf16 v[224:227], v[72:75], v[28:31], v[224:227]
  ds_read_b64_tr_b16 v[68:69], v94 offset:4096
  v_mfma_f32_16x16x32_bf16 v[228:231], v[72:75], v[32:35], v[228:231]
  ds_read_b64_tr_b16 v[70:71], v94 offset:5120
  v_mfma_f32_16x16x32_bf16 v[232:235], v[72:75], v[36:39], v[232:235]
  ds_read_b64 v[56:57], v5 offset:34112
  v_mfma_f32_16x16x32_bf16 v[236:239], v[72:75], v[40:43], v[236:239]
  ds_read_b64 v[58:59], v5 offset:34144
  s_cmp_eq_u32 s60, 3
  s_cbranch_scc0 L_nx_35
  s_call_b64 s[74:75], L_x_wphi_4
L_nx_35:
  s_waitcnt lgkmcnt(9)
  v_mfma_f32_16x16x32_bf16 v[252:255], v[76:79], v[40:43], v[252:255]
  v_mfma_f32_16x16x32_bf16 v[248:251], v[76:79], v[36:39], v[248:251]
  v_mfma_f32_16x16x32_bf16 v[244:247], v[76:79], v[32:35], v[244:247]
  s_add_u32 s25, s25, 128
  s_cmp_ge_u32 s25, 2048
  s_cselect_b32 s26, 0x10000000, s25
  v_mfma_f32_16x16x32_bf16 v[240:243], v[76:79], v[28:31], v[240:243]
  s_waitcnt vmcnt(5) lgkmcnt(0)
  s_barrier
  v_mfma_f32_16x16x32_bf16 v[96:99], v[60:63], v[12:15], v[96:99]
  ds_read_b64_tr_b16 v[76:77], v93 offset:6272
  v_mfma_f32_16x16x32_bf16 v[100:103], v[60:63], v[16:19], v[100:103]
  ds_read_b64_tr_b16 v[78:79], v93 offset:9856
  s_cmp_eq_u32 s60, 2
  s_cbranch_scc0 L_nx_36
  s_call_b64 s[74:75], L_x_stat_4
L_nx_36:
  s_cmp_eq_u32 s60, 8
  s_cbranch_scc0 L_nx_37
  s_call_b64 s[74:75], L_x_rows_4
L_nx_37:
  v_mfma_f32_16x16x32_bf16 v[104:107], v[60:63], v[20:23], v[104:107]
  s_add_u32 m0, s33, 87040
  ds_read_b64_tr_b16 v[72:73], v95 offset:4096
  v_mfma_f32_16x16x32_bf16 v[108:111], v[60:63], v[24:27], v[108:111]
  buffer_load_dwordx4 v2, s[12:15], s27 offen lds
  s_add_u32 s27, s27, s30
  ds_read_b64_tr_b16 v[74:75], v95 offset:5120
  v_mfma_f32_16x16x32_bf16 v[124:127], v[64:67], v[24:27], v[124:127]
  v_mfma_f32_16x16x32_bf16 v[120:123], v[64:67], v[20:23], v[120:123]
  v_mfma_f32_16x16x32_bf16 v[116:119], v[64:67], v[16:19], v[116:119]
  s_add_u32 m0, s34, 87040
  v_mfma_f32_16x16x32_bf16 v[112:115], v[64:67], v[12:15], v[112:115]
  buffer_load_dwordx4 v3, s[16:19], s28 offen lds
  s_add_u32 s28, s28, s31
  v_mfma_f32_16x16x32_bf16 v[128:131], v[12:15], v[68:71], v[128:131]
  ds_read_b64_tr_b16 v[64:65], v93 offset:6304
  v_mfma_f32_16x16x32_bf16 v[132:135], v[16:19], v[68:71], v[132:135]
  ds_read_b64_tr_b16 v[66:67], v93 offset:9888
  v_mfma_f32_16x16x32_bf16 v[136:139], v[20:23], v[68:71], v[136:139]
  s_add_u32 m0, s35, 87040
  ds_read_b64_tr_b16 v[60:61], v93 offset:13440
  v_mfma_f32_16x16x32_bf16 v[140:143], v[24:27], v[68:71], v[140:143]
  buffer_load_dwordx4 v4, s[20:23], s29 offen lds
  s_add_u32 s29, s29, s32
  ds_read_b64_tr_b16 v[62:63], v93 offset:17024
  s_waitcnt lgkmcnt(4)
  v_mfma_f32_16x16x32_bf16 v[156:159], v[24:27], v[72:75], v[156:159]
  ds_read_b64_tr_b16 v[68:69], v93 offset:13472
  v_mfma_f32_16x16x32_bf16 v[152:155], v[20:23], v[72:75], v[152:155]
  ds_read_b64_tr_b16 v[70:71], v93 offset:17056
  v_mfma_f32_16x16x32_bf16 v[148:151], v[16:19], v[72:75], v[148:151]
  s_add_u32 s50, s26, 0
  s_add_u32 m0, s24, 33280
  v_mfma_f32_16x16x32_bf16 v[144:147], v[12:15], v[72:75], v[144:147]
  buffer_load_dwordx4 v1, s[8:11], s50 offen lds
  v_mfma_f32_16x16x32_bf16 v[160:163], v[76:79], v[12:15], v[160:163]
  ds_read_b64_tr_b16 v[72:73], v93 offset:6336
  v_mfma_f32_16x16x32_bf16 v[164:167], v[76:79], v[16:19], v[164:167]
  ds_read_b64_tr_b16 v[74:75], v93 offset:9920
  v_mfma_f32_16x16x32_bf16 v[168:171], v[76:79], v[20:23], v[168:171]
  s_add_u32 s50, s26, 4096
  s_add_u32 m0, s24, 34320
  v_mfma_f32_16x16x32_bf16 v[172:175], v[76:79], v[24:27], v[172:175]
  buffer_load_dwordx4 v1, s[8:11], s50 offen lds
  s_waitcnt lgkmcnt(4)
  v_mfma_f32_16x16x32_bf16 v[188:191], v[60:63], v[24:27], v[188:191]
  v_mfma_f32_16x16x32_bf16 v[184:187], v[60:63], v[20:23], v[184:187]
  v_mfma_f32_16x16x32_bf16 v[180:183], v[60:63], v[16:19], v[180:183]
  v_mfma_f32_16x16x32_bf16 v[176:179], v[60:63], v[12:15], v[176:179]
  v_mfma_f32_16x16x32_bf16 v[192:195], v[64:67], v[12:15], v[192:195]
  ds_read_b64_tr_b16 v[60:61], v94 offset:22528
  v_mfma_f32_16x16x32_bf16 v[196:199], v[64:67], v[16:19], v[196:199]
  ds_read_b64_tr_b16 v[62:63], v94 offset:23552
  v_mfma_f32_16x16x32_bf16 v[200:203], v[64:67], v[20:23], v[200:203]
  ds_read_b64_tr_b16 v[76:77], v93 offset:13504
  v_mfma_f32_16x16x32_bf16 v[204:207], v[64:67], v[24:27], v[204:207]
  ds_read_b64_tr_b16 v[78:79], v93 offset:17088
  s_waitcnt lgkmcnt(6)
  v_mfma_f32_16x16x32_bf16 v[220:223], v[68:71], v[24:27], v[220:223]
  ds_read_b64_tr_b16 v[64:65], v95 offset:22528
  v_mfma_f32_16x16x32_bf16 v[216:219], v[68:71], v[20:23], v[216:219]
  ds_read_b64_tr_b16 v[66:67], v95 offset:23552
  v_mfma_f32_16x16x32_bf16 v[212:215], v[68:71], v[16:19], v[212:215]
  v_mfma_f32_16x16x32_bf16 v[208:211], v[68:71], v[12:15], v[208:211]
  s_waitcnt lgkmcnt(6)
  v_mfma_f32_16x16x32_bf16 v[224:227], v[72:75], v[12:15], v[224:227]
  ds_read_b64_tr_b16 v[68:69], v94 offset:24576
  v_mfma_f32_16x16x32_bf16 v[228:231], v[72:75], v[16:19], v[228:231]
  ds_read_b64_tr_b16 v[70:71], v94 offset:25600
  v_mfma_f32_16x16x32_bf16 v[232:235], v[72:75], v[20:23], v[232:235]
  v_mfma_f32_16x16x32_bf16 v[236:239], v[72:75], v[24:27], v[236:239]
  s_waitcnt lgkmcnt(4)
  v_mfma_f32_16x16x32_bf16 v[252:255], v[76:79], v[24:27], v[252:255]
  v_mfma_f32_16x16x32_bf16 v[248:251], v[76:79], v[20:23], v[248:251]
  v_mfma_f32_16x16x32_bf16 v[244:247], v[76:79], v[16:19], v[244:247]
  v_mfma_f32_16x16x32_bf16 v[240:243], v[76:79], v[12:15], v[240:243]
  s_waitcnt vmcnt(5)
  s_barrier
  v_mfma_f32_16x16x32_bf16 v[96:99], v[60:63], v[44:47], v[96:99]
  ds_read_b64_tr_b16 v[76:77], v93 offset:26752
  v_mfma_f32_16x16x32_bf16 v[100:103], v[60:63], v[48:51], v[100:103]
  ds_read_b64_tr_b16 v[78:79], v93 offset:30336
  v_mfma_f32_16x16x32_bf16 v[104:107], v[60:63], v[52:55], v[104:107]
  s_add_u32 m0, s33, 107520
  ds_read_b64_tr_b16 v[72:73], v95 offset:24576
  ds_read_b64 v[12:13], v5 offset:0
  v_mfma_f32_16x16x32_bf16 v[108:111], v[60:63], v[56:59], v[108:111]
  buffer_load_dwordx4 v2, s[12:15], s27 offen lds
  s_add_u32 s27, s27, s30
  ds_read_b64_tr_b16 v[74:75], v95 offset:25600
  ds_read_b64 v[14:15], v5 offset:32
  s_waitcnt lgkmcnt(8)
  v_mfma_f32_16x16x32_bf16 v[124:127], v[64:67], v[56:59], v[124:127]
  v_mfma_f32_16x16x32_bf16 v[120:123], v[64:67], v[52:55], v[120:123]
  v_mfma_f32_16x16x32_bf16 v[116:119], v[64:67], v[48:51], v[116:119]
  s_add_u32 m0, s34, 107520
  ds_read_b64 v[16:17], v5 offset:256
  v_mfma_f32_16x16x32_bf16 v[112:115], v[64:67], v[44:47], v[112:115]
  buffer_load_dwordx4 v3, s[16:19], s28 offen lds
  s_add_u32 s28, s28, s31
  ds_read_b64 v[18:19], v5 offset:288
  s_waitcnt lgkmcnt(8)
  v_mfma_f32_16x16x32_bf16 v[128:131], v[44:47], v[68:71], v[128:131]
  ds_read_b64_tr_b16 v[64:65], v93 offset:26784
  v_mfma_f32_16x16x32_bf16 v[132:135], v[48:51], v[68:71], v[132:135]
  ds_read_b64_tr_b16 v[66:67], v93 offset:30368
  v_mfma_f32_16x16x32_bf16 v[136:139], v[52:55], v[68:71], v[136:139]
  s_add_u32 m0, s35, 107520
  ds_read_b64_tr_b16 v[60:61], v93 offset:33920
  ds_read_b64 v[20:21], v5 offset:512
  v_mfma_f32_16x16x32_bf16 v[140:143], v[56:59], v[68:71], v[140:143]
  buffer_load_dwordx4 v4, s[20:23], s29 offen lds
  s_add_u32 s29, s29, s32
  ds_read_b64_tr_b16 v[62:63], v93 offset:37504
  ds_read_b64 v[22:23], v5 offset:544
  s_waitcnt lgkmcnt(9)
  v_mfma_f32_16x16x32_bf16 v[156:159], v[56:59], v[72:75], v[156:159]
  ds_read_b64_tr_b16 v[68:69], v93 offset:33952
  v_mfma_f32_16x16x32_bf16 v[152:155], v[52:55], v[72:75], v[152:155]
  ds_read_b64_tr_b16 v[70:71], v93 offset:37536
  v_mfma_f32_16x16x32_bf16 v[148:151], v[48:51], v[72:75], v[148:151]
  s_add_u32 s50, s26, 262144
  s_add_u32 m0, s24, 49920
  ds_read_b64 v[24:25], v5 offset:768
  v_mfma_f32_16x16x32_bf16 v[144:147], v[44:47], v[72:75], v[144:147]
  buffer_load_dwordx4 v1, s[8:11], s50 offen lds
  ds_read_b64 v[26:27], v5 offset:800
  v_mfma_f32_16x16x32_bf16 v[160:163], v[76:79], v[44:47], v[160:163]
  ds_read_b64_tr_b16 v[72:73], v93 offset:26816
  v_mfma_f32_16x16x32_bf16 v[164:167], v[76:79], v[48:51], v[164:167]
  ds_read_b64_tr_b16 v[74:75], v93 offset:30400
  v_mfma_f32_16x16x32_bf16 v[168:171], v[76:79], v[52:55], v[168:171]
  s_add_u32 s50, s26, 266240
  s_add_u32 m0, s24, 50960
  ds_read_b64 v[28:29], v5 offset:64
  v_mfma_f32_16x16x32_bf16 v[172:175], v[76:79], v[56:59], v[172:175]
  buffer_load_dwordx4 v1, s[8:11], s50 offen lds
  ds_read_b64 v[30:31], v5 offset:96
  s_waitcnt lgkmcnt(9)
  v_mfma_f32_16x16x32_bf16 v[188:191], v[60:63], v[56:59], v[188:191]
  v_mfma_f32_16x16x32_bf16 v[184:187], v[60:63], v[52:55], v[184:187]
  v_mfma_f32_16x16x32_bf16 v[180:183], v[60:63], v[48:51], v[180:183]
  v_mfma_f32_16x16x32_bf16 v[176:179], v[60:63], v[44:47], v[176:179]
  v_mfma_f32_16x16x32_bf16 v[192:195], v[64:67], v[44:47], v[192:195]
  ds_read_b64_tr_b16 v[60:61], v7 offset:2048
  v_mfma_f32_16x16x32_bf16 v[196:199], v[64:67], v[48:51], v[196:199]
  ds_read_b64_tr_b16 v[62:63], v7 offset:3072
  v_mfma_f32_16x16x32_bf16 v[200:203], v[64:67], v[52:55], v[200:203]
  ds_read_b64_tr_b16 v[76:77], v93 offset:33984
  ds_read_b64 v[32:33], v5 offset:320
  v_mfma_f32_16x16x32_bf16 v[204:207], v[64:67], v[56:59], v[204:207]
  ds_read_b64_tr_b16 v[78:79], v93 offset:37568
  ds_read_b64 v[34:35], v5 offset:352
  s_waitcnt lgkmcnt(12)
  v_mfma_f32_16x16x32_bf16 v[220:223], v[68:71], v[56:59], v[220:223]
  ds_read_b64_tr_b16 v[64:65], v8 offset:2048
  v_mfma_f32_16x16x32_bf16 v[216:219], v[68:71], v[52:55], v[216:219]
  ds_read_b64_tr_b16 v[66:67], v8 offset:3072
  v_mfma_f32_16x16x32_bf16 v[212:215], v[68:71], v[48:51], v[212:215]
  ds_read_b64 v[36:37], v5 offset:576
  v_mfma_f32_16x16x32_bf16 v[208:211], v[68:71], v[44:47], v[208:211]
  ds_read_b64 v[38:39], v5 offset:608
  s_waitcnt lgkmcnt(12)
  v_mfma_f32_16x16x32_bf16 v[224:227], v[72:75], v[44:47], v[224:227]
  ds_read_b64_tr_b16 v[68:69], v7 offset:4096
  v_mfma_f32_16x16x32_bf16 v[228:231], v[72:75], v[48:51], v[228:231]
  ds_read_b64_tr_b16 v[70:71], v7 offset:5120
  v_mfma_f32_16x16x32_bf16 v[232:235], v[72:75], v[52:55], v[232:235]
  ds_read_b64 v[40:41], v5 offset:832
  v_mfma_f32_16x16x32_bf16 v[236:239], v[72:75], v[56:59], v[236:239]
  ds_read_b64 v[42:43], v5 offset:864
  s_waitcnt lgkmcnt(9)
  v_mfma_f32_16x16x32_bf16 v[252:255], v[76:79], v[56:59], v[252:255]
  v_mfma_f32_16x16x32_bf16 v[248:251], v[76:79], v[52:55], v[248:251]
  v_mfma_f32_16x16x32_bf16 v[244:247], v[76:79], v[48:51], v[244:247]
  s_add_u32 s25, s25, 128
  s_cmp_ge_u32 s25, 2048
  s_cselect_b32 s26, 0x10000000, s25
  v_mfma_f32_16x16x32_bf16 v[240:243], v[76:79], v[44:47], v[240:243]
  s_waitcnt vmcnt(5) lgkmcnt(0)
  s_barrier
  s_sub_u32 s60, s60, 1
  s_cmp_gt_u32 s60, 2
  s_cbranch_scc1 L_loop4
L_loopc4:
  v_mfma_f32_16x16x32_bf16 v[96:99], v[60:63], v[12:15], v[96:99]
  ds_read_b64_tr_b16 v[76:77], v6 offset:6272
  v_lshlrev_b32 v10, 16, v60
  v_and_b32 v11, s79, v60
  v_mfma_f32_16x16x32_bf16 v[100:103], v[60:63], v[16:19], v[100:103]
  ds_read_b64_tr_b16 v[78:79], v6 offset:9856
  v_add_f32 v90, v90, v10
  v_add_f32 v90, v90, v11
  s_cmp_eq_u32 s60, 6
  s_cbranch_scc0 L_nx_38
  s_call_b64 s[74:75], L_x_drain_4
L_nx_38:
  v_mfma_f32_16x16x32_bf16 v[104:107], v[60:63], v[20:23], v[104:107]
  s_add_u32 m0, s33, 128000
  v_lshlrev_b32 v10, 16, v61
  v_and_b32 v11, s79, v61
  ds_read_b64_tr_b16 v[72:73], v8 offset:4096
  v_mfma_f32_16x16x32_bf16 v[108:111], v[60:63], v[24:27], v[108:111]
  buffer_load_dwordx4 v2, s[12:15], s27 offen lds
  s_add_u32 s27, s27, s30
  v_add_f32 v90, v90, v10
  v_add_f32 v90, v90, v11
  ds_read_b64_tr_b16 v[74:75], v8 offset:5120
  v_mfma_f32_16x16x32_bf16 v[124:127], v[64:67], v[24:27], v[124:127]
  v_lshlrev_b32 v10, 16, v62
  v_and_b32 v11, s79, v62
  v_mfma_f32_16x16x32_bf16 v[120:123], v[64:67], v[20:23], v[120:123]
  v_add_f32 v90, v90, v10
  v_add_f32 v90, v90, v11
  v_mfma_f32_16x16x32_bf16 v[116:119], v[64:67], v[16:19], v[116:119]
  s_add_u32 m0, s34, 128000
  v_lshlrev_b32 v10, 16, v63
  v_and_b32 v11, s79, v63
  v_mfma_f32_16x16x32_bf16 v[112:115], v[64:67], v[12:15], v[112:115]
  buffer_load_dwordx4 v3, s[16:19], s28 offen lds
  s_add_u32 s28, s28, s31
  v_add_f32 v90, v90, v10
  v_add_f32 v90, v90, v11
  v_mfma_f32_16x16x32_bf16 v[128:131], v[12:15], v[68:71], v[128:131]
  ds_read_b64_tr_b16 v[64:65], v6 offset:6304
  v_mfma_f32_16x16x32_bf16 v[132:135], v[16:19], v[68:71], v[132:135]
  ds_read_b64_tr_b16 v[66:67], v6 offset:9888
  v_mfma_f32_16x16x32_bf16 v[136:139], v[20:23], v[68:71], v[136:139]
  s_add_u32 m0, s35, 128000
  ds_read_b64_tr_b16 v[60:61], v6 offset:13440
  v_mfma_f32_16x16x32_bf16 v[140:143], v[24:27], v[68:71], v[140:143]
  buffer_load_dwordx4 v4, s[20:23], s29 offen lds
  s_add_u32 s29, s29, s32
  ds_read_b64_tr_b16 v[62:63], v6 offset:17024
  s_waitcnt lgkmcnt(4)
  v_mfma_f32_16x16x32_bf16 v[156:159], v[24:27], v[72:75], v[156:159]
  ds_read_b64_tr_b16 v[68:69], v6 offset:13472
  v_mfma_f32_16x16x32_bf16 v[152:155], v[20:23], v[72:75], v[152:155]
  ds_read_b64_tr_b16 v[70:71], v6 offset:17056
  v_mfma_f32_16x16x32_bf16 v[148:151], v[16:19], v[72:75], v[148:151]
  s_add_u32 s50, s26, 0
  s_add_u32 m0, s24, 0
  v_mfma_f32_16x16x32_bf16 v[144:147], v[12:15], v[72:75], v[144:147]
  buffer_load_dwordx4 v1, s[8:11], s50 offen lds
  v_mfma_f32_16x16x32_bf16 v[160:163], v[76:79], v[12:15], v[160:163]
  ds_read_b64_tr_b16 v[72:73], v6 offset:6336
  v_lshlrev_b32 v10, 16, v76
  v_and_b32 v11, s79, v76
  v_mfma_f32_16x16x32_bf16 v[164:167], v[76:79], v[16:19], v[164:167]
  ds_read_b64_tr_b16 v[74:75], v6 offset:9920
  v_add_f32 v91, v91, v10
  v_add_f32 v91, v91, v11
  v_mfma_f32_16x16x32_bf16 v[168:171], v[76:79], v[20:23], v[168:171]
  s_add_u32 s50, s26, 4096
  s_add_u32 m0, s24, 1040
  v_lshlrev_b32 v10, 16, v77
  v_and_b32 v11, s79, v77
  v_mfma_f32_16x16x32_bf16 v[172:175], v[76:79], v[24:27], v[172:175]
  buffer_load_dwordx4 v1, s[8:11], s50 offen lds
  v_add_f32 v91, v91, v10
  v_add_f32 v91, v91, v11
  s_waitcnt lgkmcnt(4)
  v_mfma_f32_16x16x32_bf16 v[188:191], v[60:63], v[24:27], v[188:191]
  v_lshlrev_b32 v10, 16, v78
  v_and_b32 v11, s79, v78
  v_mfma_f32_16x16x32_bf16 v[184:187], v[60:63], v[20:23], v[184:187]
  v_add_f32 v91, v91, v10
  v_add_f32 v91, v91, v11
  v_mfma_f32_16x16x32_bf16 v[180:183], v[60:63], v[16:19], v[180:183]
  v_lshlrev_b32 v10, 16, v79
  v_and_b32 v11, s79, v79
  v_mfma_f32_16x16x32_bf16 v[176:179], v[60:63], v[12:15], v[176:179]
  v_add_f32 v91, v91, v10
  v_add_f32 v91, v91, v11
  v_mfma_f32_16x16x32_bf16 v[192:195], v[64:67], v[12:15], v[192:195]
  ds_read_b64_tr_b16 v[60:61], v7 offset:22528
  v_mfma_f32_16x16x32_bf16 v[196:199], v[64:67], v[16:19], v[196:199]
  ds_read_b64_tr_b16 v[62:63], v7 offset:23552
  v_mfma_f32_16x16x32_bf16 v[200:203], v[64:67], v[20:23], v[200:203]
  ds_read_b64_tr_b16 v[76:77], v6 offset:13504
  v_mfma_f32_16x16x32_bf16 v[204:207], v[64:67], v[24:27], v[204:207]
  ds_read_b64_tr_b16 v[78:79], v6 offset:17088
  s_waitcnt lgkmcnt(6)
  v_mfma_f32_16x16x32_bf16 v[220:223], v[68:71], v[24:27], v[220:223]
  ds_read_b64_tr_b16 v[64:65], v8 offset:22528
  v_mfma_f32_16x16x32_bf16 v[216:219], v[68:71], v[20:23], v[216:219]
  ds_read_b64_tr_b16 v[66:67], v8 offset:23552
  v_mfma_f32_16x16x32_bf16 v[212:215], v[68:71], v[16:19], v[212:215]
  v_mfma_f32_16x16x32_bf16 v[208:211], v[68:71], v[12:15], v[208:211]
  s_waitcnt lgkmcnt(6)
  v_mfma_f32_16x16x32_bf16 v[224:227], v[72:75], v[12:15], v[224:227]
  ds_read_b64_tr_b16 v[68:69], v7 offset:24576
  v_lshlrev_b32 v10, 16, v72
  v_and_b32 v11, s79, v72
  v_mfma_f32_16x16x32_bf16 v[228:231], v[72:75], v[16:19], v[228:231]
  ds_read_b64_tr_b16 v[70:71], v7 offset:25600
  v_add_f32 v92, v92, v10
  v_add_f32 v92, v92, v11
  v_mfma_f32_16x16x32_bf16 v[232:235], v[72:75], v[20:23], v[232:235]
  v_lshlrev_b32 v10, 16, v73
  v_and_b32 v11, s79, v73
  v_mfma_f32_16x16x32_bf16 v[236:239], v[72:75], v[24:27], v[236:239]
  v_add_f32 v92, v92, v10
  v_add_f32 v92, v92, v11
  s_cmp_eq_u32 s60, 2
  s_cbranch_scc0 L_nx_39
  s_call_b64 s[74:75], L_x_poll_4
L_nx_39:
  s_waitcnt lgkmcnt(4)
  v_mfma_f32_16x16x32_bf16 v[252:255], v[76:79], v[24:27], v[252:255]
  v_lshlrev_b32 v10, 16, v74
  v_and_b32 v11, s79, v74
  v_mfma_f32_16x16x32_bf16 v[248:251], v[76:79], v[20:23], v[248:251]
  v_add_f32 v92, v92, v10
  v_add_f32 v92, v92, v11
  v_mfma_f32_16x16x32_bf16 v[244:247], v[76:79], v[16:19], v[244:247]
  v_lshlrev_b32 v10, 16, v75
  v_and_b32 v11, s79, v75
  v_mfma_f32_16x16x32_bf16 v[240:243], v[76:79], v[12:15], v[240:243]
  v_add_f32 v92, v92, v10
  v_add_f32 v92, v92, v11
  s_waitcnt vmcnt(5)
  s_barrier
  v_mfma_f32_16x16x32_bf16 v[96:99], v[60:63], v[28:31], v[96:99]
  ds_read_b64_tr_b16 v[76:77], v6 offset:26752
  v_lshlrev_b32 v10, 16, v60
  v_and_b32 v11, s79, v60
  v_mfma_f32_16x16x32_bf16 v[100:103], v[60:63], v[32:35], v[100:103]
  ds_read_b64_tr_b16 v[78:79], v6 offset:30336
  v_add_f32 v90, v90, v10
  v_add_f32 v90, v90, v11
  v_mfma_f32_16x16x32_bf16 v[104:107], v[60:63], v[36:39], v[104:107]
  s_add_u32 m0, s33, 66560
  ds_read_b64_tr_b16 v[72:73], v8 offset:24576
  ds_read_b64 v[12:13], v5 offset:33280
  v_lshlrev_b32 v10, 16, v61
  v_and_b32 v11, s79, v61
  v_mfma_f32_16x16x32_bf16 v[108:111], v[60:63], v[40:43], v[108:111]
  buffer_load_dwordx4 v2, s[12:15], s27 offen lds
  s_add_u32 s27, s27, s30
  ds_read_b64_tr_b16 v[74:75], v8 offset:25600
  ds_read_b64 v[14:15], v5 offset:33312
  v_add_f32 v90, v90, v10
  v_add_f32 v90, v90, v11
  s_waitcnt lgkmcnt(8)
  v_mfma_f32_16x16x32_bf16 v[124:127], v[64:67], v[40:43], v[124:127]
  v_lshlrev_b32 v10, 16, v62
  v_and_b32 v11, s79, v62
  v_mfma_f32_16x16x32_bf16 v[120:123], v[64:67], v[36:39], v[120:123]
  v_add_f32 v90, v90, v10
  v_add_f32 v90, v90, v11
  v_mfma_f32_16x16x32_bf16 v[116:119], v[64:67], v[32:35], v[116:119]
  s_add_u32 m0, s34, 66560
  ds_read_b64 v[16:17], v5 offset:33536
  v_lshlrev_b32 v10, 16, v63
  v_and_b32 v11, s79, v63
  v_mfma_f32_16x16x32_bf16 v[112:115], v[64:67], v[28:31], v[112:115]
  buffer_load_dwordx4 v3, s[16:19], s28 offen lds
  s_add_u32 s28, s28, s31
  ds_read_b64 v[18:19], v5 offset:33568
  v_add_f32 v90, v90, v10
  v_add_f32 v90, v90, v11
  s_waitcnt lgkmcnt(8)
  v_mfma_f32_16x16x32_bf16 v[128:131], v[28:31], v[68:71], v[128:131]
  ds_read_b64_tr_b16 v[64:65], v6 offset:26784
  v_mfma_f32_16x16x32_bf16 v[132:135], v[32:35], v[68:71], v[132:135]
  ds_read_b64_tr_b16 v[66:67], v6 offset:30368
  v_mfma_f32_16x16x32_bf16 v[136:139], v[36:39], v[68:71], v[136:139]
  s_add_u32 m0, s35, 66560
  ds_read_b64_tr_b16 v[60:61], v6 offset:33920
  ds_read_b64 v[20:21], v5 offset:33792
  v_mfma_f32_16x16x32_bf16 v[140:143], v[40:43], v[68:71], v[140:143]
  buffer_load_dwordx4 v4, s[20:23], s29 offen lds
  s_add_u32 s29, s29, s32
  ds_read_b64_tr_b16 v[62:63], v6 offset:37504
  ds_read_b64 v[22:23], v5 offset:33824
  s_waitcnt lgkmcnt(9)
  v_mfma_f32_16x16x32_bf16 v[156:159], v[40:43], v[72:75], v[156:159]
  ds_read_b64_tr_b16 v[68:69], v6 offset:33952
  v_mfma_f32_16x16x32_bf16 v[152:155], v[36:39], v[72:75], v[152:155]
  ds_read_b64_tr_b16 v[70:71], v6 offset:37536
  v_mfma_f32_16x16x32_bf16 v[148:151], v[32:35], v[72:75], v[148:151]
  s_add_u32 s50, s26, 262144
  s_add_u32 m0, s24, 16640
  ds_read_b64 v[24:25], v5 offset:34048
  v_mfma_f32_16x16x32_bf16 v[144:147], v[28:31], v[72:75], v[144:147]
  buffer_load_dwordx4 v1, s[8:11], s50 offen lds
  ds_read_b64 v[26:27], v5 offset:34080
  v_mfma_f32_16x16x32_bf16 v[160:163], v[76:79], v[28:31], v[160:163]
  ds_read_b64_tr_b16 v[72:73], v6 offset:26816
  v_lshlrev_b32 v10, 16, v76
  v_and_b32 v11, s79, v76
  v_mfma_f32_16x16x32_bf16 v[164:167], v[76:79], v[32:35], v[164:167]
  ds_read_b64_tr_b16 v[74:75], v6 offset:30400
  v_add_f32 v91, v91, v10
  v_add_f32 v91, v91, v11
  v_mfma_f32_16x16x32_bf16 v[168:171], v[76:79], v[36:39], v[168:171]
  s_add_u32 s50, s26, 266240
  s_add_u32 m0, s24, 17680
  ds_read_b64 v[44:45], v5 offset:33344
  v_lshlrev_b32 v10, 16, v77
  v_and_b32 v11, s79, v77
  v_mfma_f32_16x16x32_bf16 v[172:175], v[76:79], v[40:43], v[172:175]
  buffer_load_dwordx4 v1, s[8:11], s50 offen lds
  ds_read_b64 v[46:47], v5 offset:33376
  v_add_f32 v91, v91, v10
  v_add_f32 v91, v91, v11
  s_waitcnt lgkmcnt(9)
  v_mfma_f32_16x16x32_bf16 v[188:191], v[60:63], v[40:43], v[188:191]
  v_lshlrev_b32 v10, 16, v78
  v_and_b32 v11, s79, v78
  v_mfma_f32_16x16x32_bf16 v[184:187], v[60:63], v[36:39], v[184:187]
  v_add_f32 v91, v91, v10
  v_add_f32 v91, v91, v11
  v_mfma_f32_16x16x32_bf16 v[180:183], v[60:63], v[32:35], v[180:183]
  v_lshlrev_b32 v10, 16, v79
  v_and_b32 v11, s79, v79
  v_mfma_f32_16x16x32_bf16 v[176:179], v[60:63], v[28:31], v[176:179]
  v_add_f32 v91, v91, v10
  v_add_f32 v91, v91, v11
  v_mfma_f32_16x16x32_bf16 v[192:195], v[64:67], v[28:31], v[192:195]
  ds_read_b64_tr_b16 v[60:61], v94 offset:2048
  v_mfma_f32_16x16x32_bf16 v[196:199], v[64:67], v[32:35], v[196:199]
  ds_read_b64_tr_b16 v[62:63], v94 offset:3072
  v_mfma_f32_16x16x32_bf16 v[200:203], v[64:67], v[36:39], v[200:203]
  ds_read_b64_tr_b16 v[76:77], v6 offset:33984
  ds_read_b64 v[48:49], v5 offset:33600
  v_mfma_f32_16x16x32_bf16 v[204:207], v[64:67], v[40:43], v[204:207]
  ds_read_b64_tr_b16 v[78:79], v6 offset:37568
  ds_read_b64 v[50:51], v5 offset:33632
  s_waitcnt lgkmcnt(12)
  v_mfma_f32_16x16x32_bf16 v[220:223], v[68:71], v[40:43], v[220:223]
  ds_read_b64_tr_b16 v[64:65], v95 offset:2048
  v_mfma_f32_16x16x32_bf16 v[216:219], v[68:71], v[36:39], v[216:219]
  ds_read_b64_tr_b16 v[66:67], v95 offset:3072
  v_mfma_f32_16x16x32_bf16 v[212:215], v[68:71], v[32:35], v[212:215]
  ds_read_b64 v[52:53], v5 offset:33856
  v_mfma_f32_16x16x32_bf16 v[208:211], v[68:71], v[28:31], v[208:211]
  ds_read_b64 v[54:55], v5 offset:33888
  s_waitcnt lgkmcnt(12)
  v_mfma_f32_16x16x32_bf16 v[224:227], v[72:75], v[28:31], v[224:227]
  ds_read_b64_tr_b16 v[68:69], v94 offset:4096
  v_lshlrev_b32 v10, 16, v72
  v_and_b32 v11, s79, v72
  v_mfma_f32_16x16x32_bf16 v[228:231], v[72:75], v[32:35], v[228:231]
  ds_read_b64_tr_b16 v[70:71], v94 offset:5120
  v_add_f32 v92, v92, v10
  v_add_f32 v92, v92, v11
  v_mfma_f32_16x16x32_bf16 v[232:235], v[72:75], v[36:39], v[232:235]
  ds_read_b64 v[56:57], v5 offset:34112
  v_lshlrev_b32 v10, 16, v73
  v_and_b32 v11, s79, v73
  v_mfma_f32_16x16x32_bf16 v[236:239], v[72:75], v[40:43], v[236:239]
  ds_read_b64 v[58:59], v5 offset:34144
  v_add_f32 v92, v92, v10
  v_add_f32 v92, v92, v11
  s_cmp_eq_u32 s60, 3
  s_cbranch_scc0 L_nx_40
  s_call_b64 s[74:75], L_x_wphi_4
L_nx_40:
  s_waitcnt lgkmcnt(9)
  v_mfma_f32_16x16x32_bf16 v[252:255], v[76:79], v[40:43], v[252:255]
  v_lshlrev_b32 v10, 16, v74
  v_and_b32 v11, s79, v74
  v_mfma_f32_16x16x32_bf16 v[248:251], v[76:79], v[36:39], v[248:251]
  v_add_f32 v92, v92, v10
  v_add_f32 v92, v92, v11
  v_mfma_f32_16x16x32_bf16 v[244:247], v[76:79], v[32:35], v[244:247]
  s_add_u32 s25, s25, 128
  s_cmp_ge_u32 s25, 2048
  s_cselect_b32 s26, 0x10000000, s25
  v_lshlrev_b32 v10, 16, v75
  v_and_b32 v11, s79, v75
  v_mfma_f32_16x16x32_bf16 v[240:243], v[76:79], v[28:31], v[240:243]
  v_add_f32 v92, v92, v10
  v_add_f32 v92, v92, v11
  s_waitcnt vmcnt(5) lgkmcnt(0)
  s_barrier
  v_mfma_f32_16x16x32_bf16 v[96:99], v[60:63], v[12:15], v[96:99]
  ds_read_b64_tr_b16 v[76:77], v93 offset:6272
  v_lshlrev_b32 v10, 16, v60
  v_and_b32 v11, s79, v60
  v_mfma_f32_16x16x32_bf16 v[100:103], v[60:63], v[16:19], v[100:103]
  ds_read_b64_tr_b16 v[78:79], v93 offset:9856
  v_add_f32 v90, v90, v10
  v_add_f32 v90, v90, v11
  s_cmp_eq_u32 s60, 2
  s_cbranch_scc0 L_nx_41
  s_call_b64 s[74:75], L_x_stat_4
L_nx_41:
  s_cmp_eq_u32 s60, 8
  s_cbranch_scc0 L_nx_42
  s_call_b64 s[74:75], L_x_rows_4
L_nx_42:
  v_mfma_f32_16x16x32_bf16 v[104:107], v[60:63], v[20:23], v[104:107]
  s_add_u32 m0, s33, 87040
  ds_read_b64_tr_b16 v[72:73], v95 offset:4096
  v_lshlrev_b32 v10, 16, v61
  v_and_b32 v11, s79, v61
  v_mfma_f32_16x16x32_bf16 v[108:111], v[60:63], v[24:27], v[108:111]
  buffer_load_dwordx4 v2, s[12:15], s27 offen lds
  s_add_u32 s27, s27, s30
  ds_read_b64_tr_b16 v[74:75], v95 offset:5120
  v_add_f32 v90, v90, v10
  v_add_f32 v90, v90, v11
  v_mfma_f32_16x16x32_bf16 v[124:127], v[64:67], v[24:27], v[124:127]
  v_lshlrev_b32 v10, 16, v62
  v_and_b32 v11, s79, v62
  v_mfma_f32_16x16x32_bf16 v[120:123], v[64:67], v[20:23], v[120:123]
  v_add_f32 v90, v90, v10
  v_add_f32 v90, v90, v11
  v_mfma_f32_16x16x32_bf16 v[116:119], v[64:67], v[16:19], v[116:119]
  s_add_u32 m0, s34, 87040
  v_lshlrev_b32 v10, 16, v63
  v_and_b32 v11, s79, v63
  v_mfma_f32_16x16x32_bf16 v[112:115], v[64:67], v[12:15], v[112:115]
  buffer_load_dwordx4 v3, s[16:19], s28 offen lds
  s_add_u32 s28, s28, s31
  v_add_f32 v90, v90, v10
  v_add_f32 v90, v90, v11
  v_mfma_f32_16x16x32_bf16 v[128:131], v[12:15], v[68:71], v[128:131]
  ds_read_b64_tr_b16 v[64:65], v93 offset:6304
  v_mfma_f32_16x16x32_bf16 v[132:135], v[16:19], v[68:71], v[132:135]
  ds_read_b64_tr_b16 v[66:67], v93 offset:9888
  v_mfma_f32_16x16x32_bf16 v[136:139], v[20:23], v[68:71], v[136:139]
  s_add_u32 m0, s35, 87040
  ds_read_b64_tr_b16 v[60:61], v93 offset:13440
  v_mfma_f32_16x16x32_bf16 v[140:143], v[24:27], v[68:71], v[140:143]
  buffer_load_dwordx4 v4, s[20:23], s29 offen lds
  s_add_u32 s29, s29, s32
  ds_read_b64_tr_b16 v[62:63], v93 offset:17024
  s_waitcnt lgkmcnt(4)
  v_mfma_f32_16x16x32_bf16 v[156:159], v[24:27], v[72:75], v[156:159]
  ds_read_b64_tr_b16 v[68:69], v93 offset:13472
  v_mfma_f32_16x16x32_bf16 v[152:155], v[20:23], v[72:75], v[152:155]
  ds_read_b64_tr_b16 v[70:71], v93 offset:17056
  v_mfma_f32_16x16x32_bf16 v[148:151], v[16:19], v[72:75], v[148:151]
  s_add_u32 s50, s26, 0
  s_add_u32 m0, s24, 33280
  v_mfma_f32_16x16x32_bf16 v[144:147], v[12:15], v[72:75], v[144:147]
  buffer_load_dwordx4 v1, s[8:11], s50 offen lds
  v_mfma_f32_16x16x32_bf16 v[160:163], v[76:79], v[12:15], v[160:163]
  ds_read_b64_tr_b16 v[72:73], v93 offset:6336
  v_lshlrev_b32 v10, 16, v76
  v_and_b32 v11, s79, v76
  v_mfma_f32_16x16x32_bf16 v[164:167], v[76:79], v[16:19], v[164:167]
  ds_read_b64_tr_b16 v[74:75], v93 offset:9920
  v_add_f32 v91, v91, v10
  v_add_f32 v91, v91, v11
  v_mfma_f32_16x16x32_bf16 v[168:171], v[76:79], v[20:23], v[168:171]
  s_add_u32 s50, s26, 4096
  s_add_u32 m0, s24, 34320
  v_lshlrev_b32 v10, 16, v77
  v_and_b32 v11, s79, v77
  v_mfma_f32_16x16x32_bf16 v[172:175], v[76:79], v[24:27], v[172:175]
  buffer_load_dwordx4 v1, s[8:11], s50 offen lds
  v_add_f32 v91, v91, v10
  v_add_f32 v91, v91, v11
  s_waitcnt lgkmcnt(4)
  v_mfma_f32_16x16x32_bf16 v[188:191], v[60:63], v[24:27], v[188:191]
  v_lshlrev_b32 v10, 16, v78
  v_and_b32 v11, s79, v78
  v_mfma_f32_16x16x32_bf16 v[184:187], v[60:63], v[20:23], v[184:187]
  v_add_f32 v91, v91, v10
  v_add_f32 v91, v91, v11
  v_mfma_f32_16x16x32_bf16 v[180:183], v[60:63], v[16:19], v[180:183]
  v_lshlrev_b32 v10, 16, v79
  v_and_b32 v11, s79, v79
  v_mfma_f32_16x16x32_bf16 v[176:179], v[60:63], v[12:15], v[176:179]
  v_add_f32 v91, v91, v10
  v_add_f32 v91, v91, v11
  v_mfma_f32_16x16x32_bf16 v[192:195], v[64:67], v[12:15], v[192:195]
  ds_read_b64_tr_b16 v[60:61], v94 offset:22528
  v_mfma_f32_16x16x32_bf16 v[196:199], v[64:67], v[16:19], v[196:199]
  ds_read_b64_tr_b16 v[62:63], v94 offset:23552
  v_mfma_f32_16x16x32_bf16 v[200:203], v[64:67], v[20:23], v[200:203]
  ds_read_b64_tr_b16 v[76:77], v93 offset:13504
  v_mfma_f32_16x16x32_bf16 v[204:207], v[64:67], v[24:27], v[204:207]
  ds_read_b64_tr_b16 v[78:79], v93 offset:17088
  s_waitcnt lgkmcnt(6)
  v_mfma_f32_16x16x32_bf16 v[220:223], v[68:71], v[24:27], v[220:223]
  ds_read_b64_tr_b16 v[64:65], v95 offset:22528
  v_mfma_f32_16x16x32_bf16 v[216:219], v[68:71], v[20:23], v[216:219]
  ds_read_b64_tr_b16 v[66:67], v95 offset:23552
  v_mfma_f32_16x16x32_bf16 v[212:215], v[68:71], v[16:19], v[212:215]
  v_mfma_f32_16x16x32_bf16 v[208:211], v[68:71], v[12:15], v[208:211]
  s_waitcnt lgkmcnt(6)
  v_mfma_f32_16x16x32_bf16 v[224:227], v[72:75], v[12:15], v[224:227]
  ds_read_b64_tr_b16 v[68:69], v94 offset:24576
  v_lshlrev_b32 v10, 16, v72
  v_and_b32 v11, s79, v72
  v_mfma_f32_16x16x32_bf16 v[228:231], v[72:75], v[16:19], v[228:231]
  ds_read_b64_tr_b16 v[70:71], v94 offset:25600
  v_add_f32 v92, v92, v10
  v_add_f32 v92, v92, v11
  v_mfma_f32_16x16x32_bf16 v[232:235], v[72:75], v[20:23], v[232:235]
  v_lshlrev_b32 v10, 16, v73
  v_and_b32 v11, s79, v73
  v_mfma_f32_16x16x32_bf16 v[236:239], v[72:75], v[24:27], v[236:239]
  v_add_f32 v92, v92, v10
  v_add_f32 v92, v92, v11
  s_waitcnt lgkmcnt(4)
  v_mfma_f32_16x16x32_bf16 v[252:255], v[76:79], v[24:27], v[252:255]
  v_lshlrev_b32 v10, 16, v74
  v_and_b32 v11, s79, v74
  v_mfma_f32_16x16x32_bf16 v[248:251], v[76:79], v[20:23], v[248:251]
  v_add_f32 v92, v92, v10
  v_add_f32 v92, v92, v11
  v_mfma_f32_16x16x32_bf16 v[244:247], v[76:79], v[16:19], v[244:247]
  v_lshlrev_b32 v10, 16, v75
  v_and_b32 v11, s79, v75
  v_mfma_f32_16x16x32_bf16 v[240:243], v[76:79], v[12:15], v[240:243]
  v_add_f32 v92, v92, v10
  v_add_f32 v92, v92, v11
  s_waitcnt vmcnt(5)
  s_barrier
  v_mfma_f32_16x16x32_bf16 v[96:99], v[60:63], v[44:47], v[96:99]
  ds_read_b64_tr_b16 v[76:77], v93 offset:26752
  v_lshlrev_b32 v10, 16, v60
  v_and_b32 v11, s79, v60
  v_mfma_f32_16x16x32_bf16 v[100:103], v[60:63], v[48:51], v[100:103]
  ds_read_b64_tr_b16 v[78:79], v93 offset:30336
  v_add_f32 v90, v90, v10
  v_add_f32 v90, v90, v11
  v_mfma_f32_16x16x32_bf16 v[104:107], v[60:63], v[52:55], v[104:107]
  s_add_u32 m0, s33, 107520
  ds_read_b64_tr_b16 v[72:73], v95 offset:24576
  ds_read_b64 v[12:13], v5 offset:0
  v_lshlrev_b32 v10, 16, v61
  v_and_b32 v11, s79, v61
  v_mfma_f32_16x16x32_bf16 v[108:111], v[60:63], v[56:59], v[108:111]
  buffer_load_dwordx4 v2, s[12:15], s27 offen lds
  s_add_u32 s27, s27, s30
  ds_read_b64_tr_b16 v[74:75], v95 offset:25600
  ds_read_b64 v[14:15], v5 offset:32
  v_add_f32 v90, v90, v10
  v_add_f32 v90, v90, v11
  s_waitcnt lgkmcnt(8)
  v_mfma_f32_16x16x32_bf16 v[124:127], v[64:67], v[56:59], v[124:127]
  v_lshlrev_b32 v10, 16, v62
  v_and_b32 v11, s79, v62
  v_mfma_f32_16x16x32_bf16 v[120:123], v[64:67], v[52:55], v[120:123]
  v_add_f32 v90, v90, v10
  v_add_f32 v90, v90, v11
  v_mfma_f32_16x16x32_bf16 v[116:119], v[64:67], v[48:51], v[116:119]
  s_add_u32 m0, s34, 107520
  ds_read_b64 v[16:17], v5 offset:256
  v_lshlrev_b32 v10, 16, v63
  v_and_b32 v11, s79, v63
  v_mfma_f32_16x16x32_bf16 v[112:115], v[64:67], v[44:47], v[112:115]
  buffer_load_dwordx4 v3, s[16:19], s28 offen lds
  s_add_u32 s28, s28, s31
  ds_read_b64 v[18:19], v5 offset:288
  v_add_f32 v90, v90, v10
  v_add_f32 v90, v90, v11
  s_waitcnt lgkmcnt(8)
  v_mfma_f32_16x16x32_bf16 v[128:131], v[44:47], v[68:71], v[128:131]
  ds_read_b64_tr_b16 v[64:65], v93 offset:26784
  v_mfma_f32_16x16x32_bf16 v[132:135], v[48:51], v[68:71], v[132:135]
  ds_read_b64_tr_b16 v[66:67], v93 offset:30368
  v_mfma_f32_16x16x32_bf16 v[136:139], v[52:55], v[68:71], v[136:139]
  s_add_u32 m0, s35, 107520
  ds_read_b64_tr_b16 v[60:61], v93 offset:33920
  ds_read_b64 v[20:21], v5 offset:512
  v_mfma_f32_16x16x32_bf16 v[140:143], v[56:59], v[68:71], v[140:143]
  buffer_load_dwordx4 v4, s[20:23], s29 offen lds
  s_add_u32 s29, s29, s32
  ds_read_b64_tr_b16 v[62:63], v93 offset:37504
  ds_read_b64 v[22:23], v5 offset:544
  s_waitcnt lgkmcnt(9)
  v_mfma_f32_16x16x32_bf16 v[156:159], v[56:59], v[72:75], v[156:159]
  ds_read_b64_tr_b16 v[68:69], v93 offset:33952
  v_mfma_f32_16x16x32_bf16 v[152:155], v[52:55], v[72:75], v[152:155]
  ds_read_b64_tr_b16 v[70:71], v93 offset:37536
  v_mfma_f32_16x16x32_bf16 v[148:151], v[48:51], v[72:75], v[148:151]
  s_add_u32 s50, s26, 262144
  s_add_u32 m0, s24, 49920
  ds_read_b64 v[24:25], v5 offset:768
  v_mfma_f32_16x16x32_bf16 v[144:147], v[44:47], v[72:75], v[144:147]
  buffer_load_dwordx4 v1, s[8:11], s50 offen lds
  ds_read_b64 v[26:27], v5 offset:800
  v_mfma_f32_16x16x32_bf16 v[160:163], v[76:79], v[44:47], v[160:163]
  ds_read_b64_tr_b16 v[72:73], v93 offset:26816
  v_lshlrev_b32 v10, 16, v76
  v_and_b32 v11, s79, v76
  v_mfma_f32_16x16x32_bf16 v[164:167], v[76:79], v[48:51], v[164:167]
  ds_read_b64_tr_b16 v[74:75], v93 offset:30400
  v_add_f32 v91, v91, v10
  v_add_f32 v91, v91, v11
  v_mfma_f32_16x16x32_bf16 v[168:171], v[76:79], v[52:55], v[168:171]
  s_add_u32 s50, s26, 266240
  s_add_u32 m0, s24, 50960
  ds_read_b64 v[28:29], v5 offset:64
  v_lshlrev_b32 v10, 16, v77
  v_and_b32 v11, s79, v77
  v_mfma_f32_16x16x32_bf16 v[172:175], v[76:79], v[56:59], v[172:175]
  buffer_load_dwordx4 v1, s[8:11], s50 offen lds
  ds_read_b64 v[30:31], v5 offset:96
  v_add_f32 v91, v91, v10
  v_add_f32 v91, v91, v11
  s_waitcnt lgkmcnt(9)
  v_mfma_f32_16x16x32_bf16 v[188:191], v[60:63], v[56:59], v[188:191]
  v_lshlrev_b32 v10, 16, v78
  v_and_b32 v11, s79, v78
  v_mfma_f32_16x16x32_bf16 v[184:187], v[60:63], v[52:55], v[184:187]
  v_add_f32 v91, v91, v10
  v_add_f32 v91, v91, v11
  v_mfma_f32_16x16x32_bf16 v[180:183], v[60:63], v[48:51], v[180:183]
  v_lshlrev_b32 v10, 16, v79
  v_and_b32 v11, s79, v79
  v_mfma_f32_16x16x32_bf16 v[176:179], v[60:63], v[44:47], v[176:179]
  v_add_f32 v91, v91, v10
  v_add_f32 v91, v91, v11
  v_mfma_f32_16x16x32_bf16 v[192:195], v[64:67], v[44:47], v[192:195]
  ds_read_b64_tr_b16 v[60:61], v7 offset:2048
  v_mfma_f32_16x16x32_bf16 v[196:199], v[64:67], v[48:51], v[196:199]
  ds_read_b64_tr_b16 v[62:63], v7 offset:3072
  v_mfma_f32_16x16x32_bf16 v[200:203], v[64:67], v[52:55], v[200:203]
  ds_read_b64_tr_b16 v[76:77], v93 offset:33984
  ds_read_b64 v[32:33], v5 offset:320
  v_mfma_f32_16x16x32_bf16 v[204:207], v[64:67], v[56:59], v[204:207]
  ds_read_b64_tr_b16 v[78:79], v93 offset:37568
  ds_read_b64 v[34:35], v5 offset:352
  s_waitcnt lgkmcnt(12)
  v_mfma_f32_16x16x32_bf16 v[220:223], v[68:71], v[56:59], v[220:223]
  ds_read_b64_tr_b16 v[64:65], v8 offset:2048
  v_mfma_f32_16x16x32_bf16 v[216:219], v[68:71], v[52:55], v[216:219]
  ds_read_b64_tr_b16 v[66:67], v8 offset:3072
  v_mfma_f32_16x16x32_bf16 v[212:215], v[68:71], v[48:51], v[212:215]
  ds_read_b64 v[36:37], v5 offset:576
  v_mfma_f32_16x16x32_bf16 v[208:211], v[68:71], v[44:47], v[208:211]
  ds_read_b64 v[38:39], v5 offset:608
  s_waitcnt lgkmcnt(12)
  v_mfma_f32_16x16x32_bf16 v[224:227], v[72:75], v[44:47], v[224:227]
  ds_read_b64_tr_b16 v[68:69], v7 offset:4096
  v_lshlrev_b32 v10, 16, v72
  v_and_b32 v11, s79, v72
  v_mfma_f32_16x16x32_bf16 v[228:231], v[72:75], v[48:51], v[228:231]
  ds_read_b64_tr_b16 v[70:71], v7 offset:5120
  v_add_f32 v92, v92, v10
  v_add_f32 v92, v92, v11
  v_mfma_f32_16x16x32_bf16 v[232:235], v[72:75], v[52:55], v[232:235]
  ds_read_b64 v[40:41], v5 offset:832
  v_lshlrev_b32 v10, 16, v73
  v_and_b32 v11, s79, v73
  v_mfma_f32_16x16x32_bf16 v[236:239], v[72:75], v[56:59], v[236:239]
  ds_read_b64 v[42:43], v5 offset:864
  v_add_f32 v92, v92, v10
  v_add_f32 v92, v92, v11
  s_waitcnt lgkmcnt(9)
  v_mfma_f32_16x16x32_bf16 v[252:255], v[76:79], v[56:59], v[252:255]
  v_lshlrev_b32 v10, 16, v74
  v_and_b32 v11, s79, v74
  v_mfma_f32_16x16x32_bf16 v[248:251], v[76:79], v[52:55], v[248:251]
  v_add_f32 v92, v92, v10
  v_add_f32 v92, v92, v11
  v_mfma_f32_16x16x32_bf16 v[244:247], v[76:79], v[48:51], v[244:247]
  s_add_u32 s25, s25, 128
  s_cmp_ge_u32 s25, 2048
  s_cselect_b32 s26, 0x10000000, s25
  v_lshlrev_b32 v10, 16, v75
  v_and_b32 v11, s79, v75
  v_mfma_f32_16x16x32_bf16 v[240:243], v[76:79], v[44:47], v[240:243]
  v_add_f32 v92, v92, v10
  v_add_f32 v92, v92, v11
  s_waitcnt vmcnt(5) lgkmcnt(0)
  s_barrier
  s_sub_u32 s60, s60, 1
  s_cmp_lt_u32 s60, 2
  s_cbranch_scc1 L_loopt4
  s_call_b64 s[74:75], L_x_cpub_4
  s_cmp_gt_u32 s60, 2
  s_cbranch_scc1 L_loopp4
L_loopt4:
  s_cmp_lg_u32 s60, 0
  s_cbranch_scc1 L_loopc4
  s_branch L_epi1
L_x_drain_4:
  s_waitcnt vmcnt(0)
  s_setpc_b64 s[74:75]
L_x_rows_4:
  s_waitcnt vmcnt(0)
  v_lshlrev_b32 v10, 16, v80
  v_and_b32 v11, s79, v80
  v_mov_b32 v88, v10
  v_mov_b32 v89, v11
  v_lshlrev_b32 v10, 16, v81
  v_and_b32 v11, s79, v81
  v_add_f32 v88, v88, v10
  v_add_f32 v89, v89, v11
  v_lshlrev_b32 v10, 16, v82
  v_and_b32 v11, s79, v82
  v_add_f32 v88, v88, v10
  v_add_f32 v89, v89, v11
  v_lshlrev_b32 v10, 16, v83
  v_and_b32 v11, s79, v83
  v_add_f32 v88, v88, v10
  v_add_f32 v89, v89, v11
  v_lshlrev_b32 v10, 16, v84
  v_and_b32 v11, s79, v84
  v_add_f32 v88, v88, v10
  v_add_f32 v89, v89, v11
  v_lshlrev_b32 v10, 16, v85
  v_and_b32 v11, s79, v85
  v_add_f32 v88, v88, v10
  v_add_f32 v89, v89, v11
  v_lshlrev_b32 v10, 16, v86
  v_and_b32 v11, s79, v86
  v_add_f32 v88, v88, v10
  v_add_f32 v89, v89, v11
  v_lshlrev_b32 v10, 16, v87
  v_and_b32 v11, s79, v87
  v_add_f32 v88, v88, v10
  v_add_f32 v89, v89, v11
  v_add_f32 v88, v88, v89
  s_nop 1
  v_add_f32_dpp v88, v88, v88 quad_perm:[1,0,3,2] row_mask:0xf bank_mask:0xf
  s_nop 1
  v_add_f32_dpp v88, v88, v88 quad_perm:[2,3,0,1] row_mask:0xf bank_mask:0xf
  s_nop 1
  v_add_f32_dpp v88, v88, v88 row_half_mirror row_mask:0xf bank_mask:0xf
  s_nop 1
  v_add_f32_dpp v88, v88, v88 row_mirror row_mask:0xf bank_mask:0xf
  v_mov_b32 v10, v88
  s_nop 1
  v_permlane16_swap_b32 v88, v10
  s_nop 0
  v_add_f32 v88, v88, v10
  v_mov_b32 v10, v88
  s_nop 1
  v_permlane32_swap_b32 v88, v10
  s_nop 0
  v_add_f32 v88, v88, v10
  v_mul_f32 v88, 0xba800000, v88
  v_lshlrev_b32 v10, 16, v80
  v_and_b32 v11, s79, v80
  v_add_f32 v10, v10, v88
  v_add_f32 v11, v11, v88
  v_mul_f32 v89, v10, v10
  v_fmac_f32 v89, v11, v11
  v_lshlrev_b32 v10, 16, v81
  v_and_b32 v11, s79, v81
  v_add_f32 v10, v10, v88
  v_add_f32 v11, v11, v88
  v_fmac_f32 v89, v10, v10
  v_fmac_f32 v89, v11, v11
  v_lshlrev_b32 v10, 16, v82
  v_and_b32 v11, s79, v82
  v_add_f32 v10, v10, v88
  v_add_f32 v11, v11, v88
  v_fmac_f32 v89, v10, v10
  v_fmac_f32 v89, v11, v11
  v_lshlrev_b32 v10, 16, v83
  v_and_b32 v11, s79, v83
  v_add_f32 v10, v10, v88
  v_add_f32 v11, v11, v88
  v_fmac_f32 v89, v10, v10
  v_fmac_f32 v89, v11, v11
  v_lshlrev_b32 v10, 16, v84
  v_and_b32 v11, s79, v84
  v_add_f32 v10, v10, v88
  v_add_f32 v11, v11, v88
  v_fmac_f32 v89, v10, v10
  v_fmac_f32 v89, v11, v11
  v_lshlrev_b32 v10, 16, v85
  v_and_b32 v11, s79, v85
  v_add_f32 v10, v10, v88
  v_add_f32 v11, v11, v88
  v_fmac_f32 v89, v10, v10
  v_fmac_f32 v89, v11, v11
  v_lshlrev_b32 v10, 16, v86
  v_and_b32 v11, s79, v86
  v_add_f32 v10, v10, v88
  v_add_f32 v11, v11, v88
  v_fmac_f32 v89, v10, v10
  v_fmac_f32 v89, v11, v11
  v_lshlrev_b32 v10, 16, v87
  v_and_b32 v11, s79, v87
  v_add_f32 v10, v10, v88
  v_add_f32 v11, v11, v88
  v_fmac_f32 v89, v10, v10
  v_fmac_f32 v89, v11, v11
  s_nop 1
  v_add_f32_dpp v89, v89, v89 quad_perm:[1,0,3,2] row_mask:0xf bank_mask:0xf
  s_nop 1
  v_add_f32_dpp v89, v89, v89 quad_perm:[2,3,0,1] row_mask:0xf bank_mask:0xf
  s_nop 1
  v_add_f32_dpp v89, v89, v89 row_half_mirror row_mask:0xf bank_mask:0xf
  s_nop 1
  v_add_f32_dpp v89, v89, v89 row_mirror row_mask:0xf bank_mask:0xf
  v_mov_b32 v10, v89
  s_nop 1
  v_permlane16_swap_b32 v89, v10
  s_nop 0
  v_add_f32 v89, v89, v10
  v_mov_b32 v10, v89
  s_nop 1
  v_permlane32_swap_b32 v89, v10
  s_nop 0
  v_add_f32 v89, v89, v10
  v_mul_f32 v89, 0x3a800000, v89
  v_cvt_pk_bf16_f32 v10, v88, v89
  v_lshlrev_b32 v80, 16, v10
  v_and_b32 v89, s79, v10
  v_add_f32 v89, 0x3727c5ac, v89
  v_cvt_pk_bf16_f32 v89, v89, v89
  v_lshlrev_b32 v89, 16, v89
  v_sqrt_f32 v89, v89
  s_lshl_b32 s51, s2, 6
  v_cvt_pk_bf16_f32 v89, v89, v89
  s_add_u32 s51, s51, 51380256
  v_lshlrev_b32 v81, 16, v89
  s_mov_b64 exec, 1
  buffer_store_dwordx2 v[80:81], v0, s[64:67], s51 offen sc1
  s_mov_b64 exec, -1
  s_setpc_b64 s[74:75]
L_x_poll_4:
  v_and_b32 v89, 0x70, v9
  v_lshlrev_b32 v89, 1, v89
  buffer_load_dword v88, v89, s[56:59], 0 offen sc1
  s_setpc_b64 s[74:75]
L_x_stat_4:
  s_waitcnt vmcnt(0)
  v_cmp_ne_u32 vcc, 32, v88
  s_nop 4
  s_cbranch_vccz L_x_stat_4_go
  s_sleep 2
  v_and_b32 v89, 0x70, v9
  v_lshlrev_b32 v89, 1, v89
  buffer_load_dword v88, v89, s[56:59], 0 offen sc1
  s_branch L_x_stat_4
L_x_stat_4_go:
  s_lshl_b32 s51, s6, 8
  s_lshl_b32 s55, s7, 5
  s_add_u32 s51, s51, s55
  s_lshl_b32 s55, s3, 2
  s_add_u32 s51, s51, s55
  s_add_u32 s51, s51, 50376704
  v_mov_b32 v88, 1
  s_mov_b64 exec, 1
  buffer_store_dword v88, v0, s[64:67], s51 offen sc1
  s_mov_b64 exec, -1
  v_and_b32 v88, 0xf0, v9
  v_lshrrev_b32 v88, 1, v88
  s_lshl_b32 s51, s7, 11
  s_add_u32 s51, s51, 51380224
  buffer_load_dwordx2 v[80:81], v88, s[64:67], s51 offen offset:0 sc1
  buffer_load_dwordx2 v[82:83], v88, s[64:67], s51 offen offset:128 sc1
  buffer_load_dwordx2 v[84:85], v88, s[64:67], s51 offen offset:256 sc1
  buffer_load_dwordx2 v[86:87], v88, s[64:67], s51 offen offset:384 sc1
  s_setpc_b64 s[74:75]
L_x_cpub_4:
  v_mov_b32 v10, v90
  v_mov_b32 v11, v91
  v_mov_b32 v88, v92
  s_nop 1
  v_permlane16_swap_b32 v90, v10
  v_permlane16_swap_b32 v91, v11
  v_permlane16_swap_b32 v92, v88
  v_add_f32 v90, v90, v10
  v_add_f32 v91, v91, v11
  v_add_f32 v92, v92, v88
  v_mov_b32 v10, v90
  v_mov_b32 v11, v91
  v_mov_b32 v88, v92
  s_nop 1
  v_permlane32_swap_b32 v90, v10
  v_permlane32_swap_b32 v91, v11
  v_permlane32_swap_b32 v92, v88
  v_add_f32 v90, v90, v10
  v_add_f32 v91, v91, v11
  v_add_f32 v92, v92, v88
  v_and_b32 v89, 0xf0, v9
  v_lshrrev_b32 v89, 2, v89
  s_mul_i32 s51, s6, 7680
  s_mul_i32 s52, s7, 1280
  s_add_u32 s51, s51, s52
  s_add_u32 s51, s51, 52429440
  s_mov_b64 exec, 0xffff
  buffer_store_dword v90, v89, s[64:67], s51 offen offset:0 sc1
  buffer_store_dword v91, v89, s[64:67], s51 offen offset:256 sc1
  buffer_store_dword v92, v89, s[64:67], s51 offen offset:512 sc1
  s_mov_b64 exec, -1
  s_nop 1
  v_mov_b32 v90, 0
  v_mov_b32 v91, 0
  v_mov_b32 v92, 0
  s_setpc_b64 s[74:75]
L_x_wphi_4:
  s_mov_b32 m0, 154112
  s_lshl_b32 s51, s6, 11
  buffer_load_dwordx4 v9, s[68:71], s51 offen lds
  buffer_load_dwordx4 v9, s[68:71], s51 offen offset:1024 lds
  s_setpc_b64 s[74:75]
L_loop5:
  s_cmp_eq_u32 s60, s61
  s_cbranch_scc1 L_loopc5
L_loopp5:
  v_mfma_f32_16x16x32_bf16 v[96:99], v[60:63], v[12:15], v[96:99]
  v_mfma_f32_16x16x32_bf16 v[100:103], v[60:63], v[16:19], v[100:103]
  s_cmp_eq_u32 s60, 6
  s_cbranch_scc0 L_nx_43
  s_call_b64 s[74:75], L_x_drain_5
L_nx_43:
  v_mfma_f32_16x16x32_bf16 v[104:107], v[60:63], v[20:23], v[104:107]
  s_add_u32 m0, s33, 128000
  v_mfma_f32_16x16x32_bf16 v[108:111], v[60:63], v[24:27], v[108:111]
  buffer_load_dwordx4 v2, s[12:15], s27 offen lds
  s_add_u32 s27, s27, s30
  v_mfma_f32_16x16x32_bf16 v[124:127], v[64:67], v[24:27], v[124:127]
  ds_read_b64_tr_b16 v[60:61], v6 offset:13440
  v_mfma_f32_16x16x32_bf16 v[120:123], v[64:67], v[20:23], v[120:123]
  ds_read_b64_tr_b16 v[62:63], v6 offset:17024
  v_mfma_f32_16x16x32_bf16 v[116:119], v[64:67], v[16:19], v[116:119]
  s_add_u32 m0, s34, 128000
  ds_read_b64_tr_b16 v[76:77], v6 offset:6272
  v_mfma_f32_16x16x32_bf16 v[112:115], v[64:67], v[12:15], v[112:115]
  buffer_load_dwordx4 v3, s[16:19], s28 offen lds
  s_add_u32 s28, s28, s31
  ds_read_b64_tr_b16 v[78:79], v6 offset:9856
  v_mfma_f32_16x16x32_bf16 v[128:131], v[12:15], v[68:71], v[128:131]
  v_mfma_f32_16x16x32_bf16 v[132:135], v[16:19], v[68:71], v[132:135]
  v_mfma_f32_16x16x32_bf16 v[136:139], v[20:23], v[68:71], v[136:139]
  s_add_u32 m0, s35, 128000
  v_mfma_f32_16x16x32_bf16 v[140:143], v[24:27], v[68:71], v[140:143]
  buffer_load_dwordx4 v4, s[20:23], s29 offen lds
  s_add_u32 s29, s29, s32
  s_waitcnt lgkmcnt(4)
  v_mfma_f32_16x16x32_bf16 v[156:159], v[24:27], v[72:75], v[156:159]
  ds_read_b64_tr_b16 v[68:69], v6 offset:13472
  v_mfma_f32_16x16x32_bf16 v[152:155], v[20:23], v[72:75], v[152:155]
  ds_read_b64_tr_b16 v[70:71], v6 offset:17056
  v_mfma_f32_16x16x32_bf16 v[148:151], v[16:19], v[72:75], v[148:151]
  s_add_u32 s50, s26, 0
  s_add_u32 m0, s24, 0
  ds_read_b64_tr_b16 v[64:65], v6 offset:6304
  v_mfma_f32_16x16x32_bf16 v[144:147], v[12:15], v[72:75], v[144:147]
  buffer_load_dwordx4 v1, s[8:11], s50 offen lds
  ds_read_b64_tr_b16 v[66:67], v6 offset:9888
  s_waitcnt lgkmcnt(4)
  v_mfma_f32_16x16x32_bf16 v[160:163], v[76:79], v[12:15], v[160:163]
  ds_read_b64_tr_b16 v[72:73], v6 offset:6336
  v_mfma_f32_16x16x32_bf16 v[164:167], v[76:79], v[16:19], v[164:167]
  ds_read_b64_tr_b16 v[74:75], v6 offset:9920
  v_mfma_f32_16x16x32_bf16 v[168:171], v[76:79], v[20:23], v[168:171]
  s_add_u32 s50, s26, 4096
  s_add_u32 m0, s24, 1040
  v_mfma_f32_16x16x32_bf16 v[172:175], v[76:79], v[24:27], v[172:175]
  buffer_load_dwordx4 v1, s[8:11], s50 offen lds
  v_mfma_f32_16x16x32_bf16 v[188:191], v[60:63], v[24:27], v[188:191]
  ds_read_b64_tr_b16 v[76:77], v6 offset:13504
  v_mfma_f32_16x16x32_bf16 v[184:187], v[60:63], v[20:23], v[184:187]
  ds_read_b64_tr_b16 v[78:79], v6 offset:17088
  v_mfma_f32_16x16x32_bf16 v[180:183], v[60:63], v[16:19], v[180:183]
  v_mfma_f32_16x16x32_bf16 v[176:179], v[60:63], v[12:15], v[176:179]
  s_waitcnt lgkmcnt(4)
  v_mfma_f32_16x16x32_bf16 v[192:195], v[64:67], v[12:15], v[192:195]
  v_mfma_f32_16x16x32_bf16 v[196:199], v[64:67], v[16:19], v[196:199]
  v_mfma_f32_16x16x32_bf16 v[200:203], v[64:67], v[20:23], v[200:203]
  v_mfma_f32_16x16x32_bf16 v[204:207], v[64:67], v[24:27], v[204:207]
  v_mfma_f32_16x16x32_bf16 v[220:223], v[68:71], v[24:27], v[220:223]
  ds_read_b64_tr_b16 v[64:65], v8 offset:22528
  v_mfma_f32_16x16x32_bf16 v[216:219], v[68:71], v[20:23], v[216:219]
  ds_read_b64_tr_b16 v[66:67], v8 offset:23552
  v_mfma_f32_16x16x32_bf16 v[212:215], v[68:71], v[16:19], v[212:215]
  ds_read_b64_tr_b16 v[60:61], v7 offset:22528
  v_mfma_f32_16x16x32_bf16 v[208:211], v[68:71], v[12:15], v[208:211]
  ds_read_b64_tr_b16 v[62:63], v7 offset:23552
  s_waitcnt lgkmcnt(6)
  v_mfma_f32_16x16x32_bf16 v[224:227], v[72:75], v[12:15], v[224:227]
  ds_read_b64_tr_b16 v[68:69], v7 offset:24576
  v_mfma_f32_16x16x32_bf16 v[228:231], v[72:75], v[16:19], v[228:231]
  ds_read_b64_tr_b16 v[70:71], v7 offset:25600
  v_mfma_f32_16x16x32_bf16 v[232:235], v[72:75], v[20:23], v[232:235]
  v_mfma_f32_16x16x32_bf16 v[236:239], v[72:75], v[24:27], v[236:239]
  s_cmp_eq_u32 s60, 2
  s_cbranch_scc0 L_nx_44
  s_call_b64 s[74:75], L_x_poll_5
L_nx_44:
  s_cmp_eq_u32 s60, 1
  s_cbranch_scc0 L_nx_45
  s_call_b64 s[74:75], L_x_cpoll_5
L_nx_45:
  s_waitcnt lgkmcnt(6)
  v_mfma_f32_16x16x32_bf16 v[252:255], v[76:79], v[24:27], v[252:255]
  ds_read_b64_tr_b16 v[72:73], v8 offset:24576
  v_mfma_f32_16x16x32_bf16 v[248:251], v[76:79], v[20:23], v[248:251]
  ds_read_b64_tr_b16 v[74:75], v8 offset:25600
  v_mfma_f32_16x16x32_bf16 v[244:247], v[76:79], v[16:19], v[244:247]
  v_mfma_f32_16x16x32_bf16 v[240:243], v[76:79], v[12:15], v[240:243]
  s_waitcnt vmcnt(5)
  s_barrier
  s_waitcnt lgkmcnt(4)
  v_mfma_f32_16x16x32_bf16 v[96:99], v[60:63], v[28:31], v[96:99]
  v_mfma_f32_16x16x32_bf16 v[100:103], v[60:63], v[32:35], v[100:103]
  v_mfma_f32_16x16x32_bf16 v[104:107], v[60:63], v[36:39], v[104:107]
  s_add_u32 m0, s33, 66560
  ds_read_b64 v[12:13], v5 offset:33280
  v_mfma_f32_16x16x32_bf16 v[108:111], v[60:63], v[40:43], v[108:111]
  buffer_load_dwordx4 v2, s[12:15], s27 offen lds
  s_add_u32 s27, s27, s30
  ds_read_b64 v[14:15], v5 offset:33312
  v_mfma_f32_16x16x32_bf16 v[124:127], v[64:67], v[40:43], v[124:127]
  ds_read_b64_tr_b16 v[60:61], v6 offset:33920
  v_mfma_f32_16x16x32_bf16 v[120:123], v[64:67], v[36:39], v[120:123]
  ds_read_b64_tr_b16 v[62:63], v6 offset:37504
  v_mfma_f32_16x16x32_bf16 v[116:119], v[64:67], v[32:35], v[116:119]
  s_add_u32 m0, s34, 66560
  ds_read_b64_tr_b16 v[76:77], v6 offset:26752
  ds_read_b64 v[16:17], v5 offset:33536
  v_mfma_f32_16x16x32_bf16 v[112:115], v[64:67], v[28:31], v[112:115]
  buffer_load_dwordx4 v3, s[16:19], s28 offen lds
  s_add_u32 s28, s28, s31
  ds_read_b64_tr_b16 v[78:79], v6 offset:30336
  ds_read_b64 v[18:19], v5 offset:33568
  s_waitcnt lgkmcnt(10)
  v_mfma_f32_16x16x32_bf16 v[128:131], v[28:31], v[68:71], v[128:131]
  v_mfma_f32_16x16x32_bf16 v[132:135], v[32:35], v[68:71], v[132:135]
  v_mfma_f32_16x16x32_bf16 v[136:139], v[36:39], v[68:71], v[136:139]
  s_add_u32 m0, s35, 66560
  ds_read_b64 v[20:21], v5 offset:33792
  v_mfma_f32_16x16x32_bf16 v[140:143], v[40:43], v[68:71], v[140:143]
  buffer_load_dwordx4 v4, s[20:23], s29 offen lds
  s_add_u32 s29, s29, s32
  ds_read_b64 v[22:23], v5 offset:33824
  s_waitcnt lgkmcnt(10)
  v_mfma_f32_16x16x32_bf16 v[156:159], v[40:43], v[72:75], v[156:159]
  ds_read_b64_tr_b16 v[68:69], v6 offset:33952
  v_mfma_f32_16x16x32_bf16 v[152:155], v[36:39], v[72:75], v[152:155]
  ds_read_b64_tr_b16 v[70:71], v6 offset:37536
  v_mfma_f32_16x16x32_bf16 v[148:151], v[32:35], v[72:75], v[148:151]
  s_add_u32 s50, s26, 262144
  s_add_u32 m0, s24, 16640
  ds_read_b64_tr_b16 v[64:65], v6 offset:26784
  ds_read_b64 v[24:25], v5 offset:34048
  v_mfma_f32_16x16x32_bf16 v[144:147], v[28:31], v[72:75], v[144:147]
  buffer_load_dwordx4 v1, s[8:11], s50 offen lds
  ds_read_b64_tr_b16 v[66:67], v6 offset:30368
  ds_read_b64 v[26:27], v5 offset:34080
  s_waitcnt lgkmcnt(9)
  v_mfma_f32_16x16x32_bf16 v[160:163], v[76:79], v[28:31], v[160:163]
  ds_read_b64_tr_b16 v[72:73], v6 offset:26816
  v_mfma_f32_16x16x32_bf16 v[164:167], v[76:79], v[32:35], v[164:167]
  ds_read_b64_tr_b16 v[74:75], v6 offset:30400
  v_mfma_f32_16x16x32_bf16 v[168:171], v[76:79], v[36:39], v[168:171]
  s_add_u32 s50, s26, 266240
  s_add_u32 m0, s24, 17680
  ds_read_b64 v[44:45], v5 offset:33344
  v_mfma_f32_16x16x32_bf16 v[172:175], v[76:79], v[40:43], v[172:175]
  buffer_load_dwordx4 v1, s[8:11], s50 offen lds
  ds_read_b64 v[46:47], v5 offset:33376
  v_mfma_f32_16x16x32_bf16 v[188:191], v[60:63], v[40:43], v[188:191]
  ds_read_b64_tr_b16 v[76:77], v6 offset:33984
  v_mfma_f32_16x16x32_bf16 v[184:187], v[60:63], v[36:39], v[184:187]
  ds_read_b64_tr_b16 v[78:79], v6 offset:37568
  v_mfma_f32_16x16x32_bf16 v[180:183], v[60:63], v[32:35], v[180:183]
  v_mfma_f32_16x16x32_bf16 v[176:179], v[60:63], v[28:31], v[176:179]
  s_waitcnt lgkmcnt(7)
  v_mfma_f32_16x16x32_bf16 v[192:195], v[64:67], v[28:31], v[192:195]
  v_mfma_f32_16x16x32_bf16 v[196:199], v[64:67], v[32:35], v[196:199]
  v_mfma_f32_16x16x32_bf16 v[200:203], v[64:67], v[36:39], v[200:203]
  ds_read_b64 v[48:49], v5 offset:33600
  v_mfma_f32_16x16x32_bf16 v[204:207], v[64:67], v[40:43], v[204:207]
  ds_read_b64 v[50:51], v5 offset:33632
  v_mfma_f32_16x16x32_bf16 v[220:223], v[68:71], v[40:43], v[220:223]
  ds_read_b64_tr_b16 v[64:65], v95 offset:2048
  v_mfma_f32_16x16x32_bf16 v[216:219], v[68:71], v[36:39], v[216:219]
  ds_read_b64_tr_b16 v[66:67], v95 offset:3072
  v_mfma_f32_16x16x32_bf16 v[212:215], v[68:71], v[32:35], v[212:215]
  ds_read_b64_tr_b16 v[60:61], v94 offset:2048
  ds_read_b64 v[52:53], v5 offset:33856
  v_mfma_f32_16x16x32_bf16 v[208:211], v[68:71], v[28:31], v[208:211]
  ds_read_b64_tr_b16 v[62:63], v94 offset:3072
  ds_read_b64 v[54:55], v5 offset:33888
  s_waitcnt lgkmcnt(12)
  v_mfma_f32_16x16x32_bf16 v[224:227], v[72:75], v[28:31], v[224:227]
  ds_read_b64_tr_b16 v[68:69], v94 offset:4096
  v_mfma_f32_16x16x32_bf16 v[228:231], v[72:75], v[32:35], v[228:231]
  ds_read_b64_tr_b16 v[70:71], v94 offset:5120
  v_mfma_f32_16x16x32_bf16 v[232:235], v[72:75], v[36:39], v[232:235]
  ds_read_b64 v[56:57], v5 offset:34112
  v_mfma_f32_16x16x32_bf16 v[236:239], v[72:75], v[40:43], v[236:239]
  ds_read_b64 v[58:59], v5 offset:34144
  s_waitcnt lgkmcnt(12)
  v_mfma_f32_16x16x32_bf16 v[252:255], v[76:79], v[40:43], v[252:255]
  ds_read_b64_tr_b16 v[72:73], v95 offset:4096
  v_mfma_f32_16x16x32_bf16 v[248:251], v[76:79], v[36:39], v[248:251]
  ds_read_b64_tr_b16 v[74:75], v95 offset:5120
  v_mfma_f32_16x16x32_bf16 v[244:247], v[76:79], v[32:35], v[244:247]
  s_add_u32 s25, s25, 128
  s_cmp_ge_u32 s25, 2048
  s_cselect_b32 s26, 0x10000000, s25
  v_mfma_f32_16x16x32_bf16 v[240:243], v[76:79], v[28:31], v[240:243]
  s_waitcnt vmcnt(5) lgkmcnt(2)
  s_barrier
  v_mfma_f32_16x16x32_bf16 v[96:99], v[60:63], v[12:15], v[96:99]
  v_mfma_f32_16x16x32_bf16 v[100:103], v[60:63], v[16:19], v[100:103]
  s_cmp_eq_u32 s60, 2
  s_cbranch_scc0 L_nx_46
  s_call_b64 s[74:75], L_x_stat_5
L_nx_46:
  s_cmp_eq_u32 s60, 8
  s_cbranch_scc0 L_nx_47
  s_call_b64 s[74:75], L_x_rows_5
L_nx_47:
  s_cmp_eq_u32 s60, 1
  s_cbranch_scc0 L_nx_48
  s_call_b64 s[74:75], L_x_cload_5
L_nx_48:
  v_mfma_f32_16x16x32_bf16 v[104:107], v[60:63], v[20:23], v[104:107]
  s_add_u32 m0, s33, 87040
  v_mfma_f32_16x16x32_bf16 v[108:111], v[60:63], v[24:27], v[108:111]
  buffer_load_dwordx4 v2, s[12:15], s27 offen lds
  s_add_u32 s27, s27, s30
  v_mfma_f32_16x16x32_bf16 v[124:127], v[64:67], v[24:27], v[124:127]
  ds_read_b64_tr_b16 v[60:61], v93 offset:13440
  v_mfma_f32_16x16x32_bf16 v[120:123], v[64:67], v[20:23], v[120:123]
  ds_read_b64_tr_b16 v[62:63], v93 offset:17024
  v_mfma_f32_16x16x32_bf16 v[116:119], v[64:67], v[16:19], v[116:119]
  s_add_u32 m0, s34, 87040
  ds_read_b64_tr_b16 v[76:77], v93 offset:6272
  v_mfma_f32_16x16x32_bf16 v[112:115], v[64:67], v[12:15], v[112:115]
  buffer_load_dwordx4 v3, s[16:19], s28 offen lds
  s_add_u32 s28, s28, s31
  ds_read_b64_tr_b16 v[78:79], v93 offset:9856
  v_mfma_f32_16x16x32_bf16 v[128:131], v[12:15], v[68:71], v[128:131]
  v_mfma_f32_16x16x32_bf16 v[132:135], v[16:19], v[68:71], v[132:135]
  v_mfma_f32_16x16x32_bf16 v[136:139], v[20:23], v[68:71], v[136:139]
  s_add_u32 m0, s35, 87040
  v_mfma_f32_16x16x32_bf16 v[140:143], v[24:27], v[68:71], v[140:143]
  buffer_load_dwordx4 v4, s[20:23], s29 offen lds
  s_add_u32 s29, s29, s32
  s_waitcnt lgkmcnt(4)
  v_mfma_f32_16x16x32_bf16 v[156:159], v[24:27], v[72:75], v[156:159]
  ds_read_b64_tr_b16 v[68:69], v93 offset:13472
  v_mfma_f32_16x16x32_bf16 v[152:155], v[20:23], v[72:75], v[152:155]
  ds_read_b64_tr_b16 v[70:71], v93 offset:17056
  v_mfma_f32_16x16x32_bf16 v[148:151], v[16:19], v[72:75], v[148:151]
  s_add_u32 s50, s26, 0
  s_add_u32 m0, s24, 33280
  ds_read_b64_tr_b16 v[64:65], v93 offset:6304
  v_mfma_f32_16x16x32_bf16 v[144:147], v[12:15], v[72:75], v[144:147]
  buffer_load_dwordx4 v1, s[8:11], s50 offen lds
  ds_read_b64_tr_b16 v[66:67], v93 offset:9888
  s_waitcnt lgkmcnt(4)
  v_mfma_f32_16x16x32_bf16 v[160:163], v[76:79], v[12:15], v[160:163]
  ds_read_b64_tr_b16 v[72:73], v93 offset:6336
  v_mfma_f32_16x16x32_bf16 v[164:167], v[76:79], v[16:19], v[164:167]
  ds_read_b64_tr_b16 v[74:75], v93 offset:9920
  v_mfma_f32_16x16x32_bf16 v[168:171], v[76:79], v[20:23], v[168:171]
  s_add_u32 s50, s26, 4096
  s_add_u32 m0, s24, 34320
  v_mfma_f32_16x16x32_bf16 v[172:175], v[76:79], v[24:27], v[172:175]
  buffer_load_dwordx4 v1, s[8:11], s50 offen lds
  v_mfma_f32_16x16x32_bf16 v[188:191], v[60:63], v[24:27], v[188:191]
  ds_read_b64_tr_b16 v[76:77], v93 offset:13504
  v_mfma_f32_16x16x32_bf16 v[184:187], v[60:63], v[20:23], v[184:187]
  ds_read_b64_tr_b16 v[78:79], v93 offset:17088
  v_mfma_f32_16x16x32_bf16 v[180:183], v[60:63], v[16:19], v[180:183]
  v_mfma_f32_16x16x32_bf16 v[176:179], v[60:63], v[12:15], v[176:179]
  s_waitcnt lgkmcnt(4)
  v_mfma_f32_16x16x32_bf16 v[192:195], v[64:67], v[12:15], v[192:195]
  v_mfma_f32_16x16x32_bf16 v[196:199], v[64:67], v[16:19], v[196:199]
  v_mfma_f32_16x16x32_bf16 v[200:203], v[64:67], v[20:23], v[200:203]
  v_mfma_f32_16x16x32_bf16 v[204:207], v[64:67], v[24:27], v[204:207]
  v_mfma_f32_16x16x32_bf16 v[220:223], v[68:71], v[24:27], v[220:223]
  ds_read_b64_tr_b16 v[64:65], v95 offset:22528
  v_mfma_f32_16x16x32_bf16 v[216:219], v[68:71], v[20:23], v[216:219]
  ds_read_b64_tr_b16 v[66:67], v95 offset:23552
  v_mfma_f32_16x16x32_bf16 v[212:215], v[68:71], v[16:19], v[212:215]
  ds_read_b64_tr_b16 v[60:61], v94 offset:22528
  v_mfma_f32_16x16x32_bf16 v[208:211], v[68:71], v[12:15], v[208:211]
  ds_read_b64_tr_b16 v[62:63], v94 offset:23552
  s_waitcnt lgkmcnt(6)
  v_mfma_f32_16x16x32_bf16 v[224:227], v[72:75], v[12:15], v[224:227]
  ds_read_b64_tr_b16 v[68:69], v94 offset:24576
  v_mfma_f32_16x16x32_bf16 v[228:231], v[72:75], v[16:19], v[228:231]
  ds_read_b64_tr_b16 v[70:71], v94 offset:25600
  v_mfma_f32_16x16x32_bf16 v[232:235], v[72:75], v[20:23], v[232:235]
  v_mfma_f32_16x16x32_bf16 v[236:239], v[72:75], v[24:27], v[236:239]
  s_waitcnt lgkmcnt(6)
  v_mfma_f32_16x16x32_bf16 v[252:255], v[76:79], v[24:27], v[252:255]
  ds_read_b64_tr_b16 v[72:73], v95 offset:24576
  v_mfma_f32_16x16x32_bf16 v[248:251], v[76:79], v[20:23], v[248:251]
  ds_read_b64_tr_b16 v[74:75], v95 offset:25600
  v_mfma_f32_16x16x32_bf16 v[244:247], v[76:79], v[16:19], v[244:247]
  v_mfma_f32_16x16x32_bf16 v[240:243], v[76:79], v[12:15], v[240:243]
  s_waitcnt vmcnt(5)
  s_barrier
  s_waitcnt lgkmcnt(4)
  v_mfma_f32_16x16x32_bf16 v[96:99], v[60:63], v[44:47], v[96:99]
  v_mfma_f32_16x16x32_bf16 v[100:103], v[60:63], v[48:51], v[100:103]
  v_mfma_f32_16x16x32_bf16 v[104:107], v[60:63], v[52:55], v[104:107]
  s_add_u32 m0, s33, 107520
  ds_read_b64 v[12:13], v5 offset:0
  v_mfma_f32_16x16x32_bf16 v[108:111], v[60:63], v[56:59], v[108:111]
  buffer_load_dwordx4 v2, s[12:15], s27 offen lds
  s_add_u32 s27, s27, s30
  ds_read_b64 v[14:15], v5 offset:32
  v_mfma_f32_16x16x32_bf16 v[124:127], v[64:67], v[56:59], v[124:127]
  ds_read_b64_tr_b16 v[60:61], v93 offset:33920
  v_mfma_f32_16x16x32_bf16 v[120:123], v[64:67], v[52:55], v[120:123]
  ds_read_b64_tr_b16 v[62:63], v93 offset:37504
  v_mfma_f32_16x16x32_bf16 v[116:119], v[64:67], v[48:51], v[116:119]
  s_add_u32 m0, s34, 107520
  ds_read_b64_tr_b16 v[76:77], v93 offset:26752
  ds_read_b64 v[16:17], v5 offset:256
  v_mfma_f32_16x16x32_bf16 v[112:115], v[64:67], v[44:47], v[112:115]
  buffer_load_dwordx4 v3, s[16:19], s28 offen lds
  s_add_u32 s28, s28, s31
  ds_read_b64_tr_b16 v[78:79], v93 offset:30336
  ds_read_b64 v[18:19], v5 offset:288
  s_waitcnt lgkmcnt(10)
  v_mfma_f32_16x16x32_bf16 v[128:131], v[44:47], v[68:71], v[128:131]
  v_mfma_f32_16x16x32_bf16 v[132:135], v[48:51], v[68:71], v[132:135]
  v_mfma_f32_16x16x32_bf16 v[136:139], v[52:55], v[68:71], v[136:139]
  s_add_u32 m0, s35, 107520
  ds_read_b64 v[20:21], v5 offset:512
  v_mfma_f32_16x16x32_bf16 v[140:143], v[56:59], v[68:71], v[140:143]
  buffer_load_dwordx4 v4, s[20:23], s29 offen lds
  s_add_u32 s29, s29, s32
  ds_read_b64 v[22:23], v5 offset:544
  s_waitcnt lgkmcnt(10)
  v_mfma_f32_16x16x32_bf16 v[156:159], v[56:59], v[72:75], v[156:159]
  ds_read_b64_tr_b16 v[68:69], v93 offset:33952
  v_mfma_f32_16x16x32_bf16 v[152:155], v[52:55], v[72:75], v[152:155]
  ds_read_b64_tr_b16 v[70:71], v93 offset:37536
  v_mfma_f32_16x16x32_bf16 v[148:151], v[48:51], v[72:75], v[148:151]
  s_add_u32 s50, s26, 262144
  s_add_u32 m0, s24, 49920
  ds_read_b64_tr_b16 v[64:65], v93 offset:26784
  ds_read_b64 v[24:25], v5 offset:768
  v_mfma_f32_16x16x32_bf16 v[144:147], v[44:47], v[72:75], v[144:147]
  buffer_load_dwordx4 v1, s[8:11], s50 offen lds
  ds_read_b64_tr_b16 v[66:67], v93 offset:30368
  ds_read_b64 v[26:27], v5 offset:800
  s_waitcnt lgkmcnt(9)
  v_mfma_f32_16x16x32_bf16 v[160:163], v[76:79], v[44:47], v[160:163]
  ds_read_b64_tr_b16 v[72:73], v93 offset:26816
  v_mfma_f32_16x16x32_bf16 v[164:167], v[76:79], v[48:51], v[164:167]
  ds_read_b64_tr_b16 v[74:75], v93 offset:30400
  v_mfma_f32_16x16x32_bf16 v[168:171], v[76:79], v[52:55], v[168:171]
  s_add_u32 s50, s26, 266240
  s_add_u32 m0, s24, 50960
  ds_read_b64 v[28:29], v5 offset:64
  v_mfma_f32_16x16x32_bf16 v[172:175], v[76:79], v[56:59], v[172:175]
  buffer_load_dwordx4 v1, s[8:11], s50 offen lds
  ds_read_b64 v[30:31], v5 offset:96
  v_mfma_f32_16x16x32_bf16 v[188:191], v[60:63], v[56:59], v[188:191]
  ds_read_b64_tr_b16 v[76:77], v93 offset:33984
  v_mfma_f32_16x16x32_bf16 v[184:187], v[60:63], v[52:55], v[184:187]
  ds_read_b64_tr_b16 v[78:79], v93 offset:37568
  v_mfma_f32_16x16x32_bf16 v[180:183], v[60:63], v[48:51], v[180:183]
  v_mfma_f32_16x16x32_bf16 v[176:179], v[60:63], v[44:47], v[176:179]
  s_waitcnt lgkmcnt(7)
  v_mfma_f32_16x16x32_bf16 v[192:195], v[64:67], v[44:47], v[192:195]
  v_mfma_f32_16x16x32_bf16 v[196:199], v[64:67], v[48:51], v[196:199]
  v_mfma_f32_16x16x32_bf16 v[200:203], v[64:67], v[52:55], v[200:203]
  ds_read_b64 v[32:33], v5 offset:320
  v_mfma_f32_16x16x32_bf16 v[204:207], v[64:67], v[56:59], v[204:207]
  ds_read_b64 v[34:35], v5 offset:352
  v_mfma_f32_16x16x32_bf16 v[220:223], v[68:71], v[56:59], v[220:223]
  ds_read_b64_tr_b16 v[64:65], v8 offset:2048
  v_mfma_f32_16x16x32_bf16 v[216:219], v[68:71], v[52:55], v[216:219]
  ds_read_b64_tr_b16 v[66:67], v8 offset:3072
  v_mfma_f32_16x16x32_bf16 v[212:215], v[68:71], v[48:51], v[212:215]
  ds_read_b64_tr_b16 v[60:61], v7 offset:2048
  ds_read_b64 v[36:37], v5 offset:576
  v_mfma_f32_16x16x32_bf16 v[208:211], v[68:71], v[44:47], v[208:211]
  ds_read_b64_tr_b16 v[62:63], v7 offset:3072
  ds_read_b64 v[38:39], v5 offset:608
  s_waitcnt lgkmcnt(12)
  v_mfma_f32_16x16x32_bf16 v[224:227], v[72:75], v[44:47], v[224:227]
  ds_read_b64_tr_b16 v[68:69], v7 offset:4096
  v_mfma_f32_16x16x32_bf16 v[228:231], v[72:75], v[48:51], v[228:231]
  ds_read_b64_tr_b16 v[70:71], v7 offset:5120
  v_mfma_f32_16x16x32_bf16 v[232:235], v[72:75], v[52:55], v[232:235]
  ds_read_b64 v[40:41], v5 offset:832
  v_mfma_f32_16x16x32_bf16 v[236:239], v[72:75], v[56:59], v[236:239]
  ds_read_b64 v[42:43], v5 offset:864
  s_waitcnt lgkmcnt(12)
  v_mfma_f32_16x16x32_bf16 v[252:255], v[76:79], v[56:59], v[252:255]
  ds_read_b64_tr_b16 v[72:73], v8 offset:4096
  v_mfma_f32_16x16x32_bf16 v[248:251], v[76:79], v[52:55], v[248:251]
  ds_read_b64_tr_b16 v[74:75], v8 offset:5120
  v_mfma_f32_16x16x32_bf16 v[244:247], v[76:79], v[48:51], v[244:247]
  s_add_u32 s25, s25, 128
  s_cmp_ge_u32 s25, 2048
  s_cselect_b32 s26, 0x10000000, s25
  v_mfma_f32_16x16x32_bf16 v[240:243], v[76:79], v[44:47], v[240:243]
  s_waitcnt vmcnt(5) lgkmcnt(2)
  s_barrier
  s_sub_u32 s60, s60, 1
  s_cmp_gt_u32 s60, 2
  s_cbranch_scc1 L_loop5
L_loopc5:
  v_mfma_f32_16x16x32_bf16 v[96:99], v[60:63], v[12:15], v[96:99]
  v_mfma_f32_16x16x32_bf16 v[100:103], v[60:63], v[16:19], v[100:103]
  s_cmp_eq_u32 s60, 6
  s_cbranch_scc0 L_nx_49
  s_call_b64 s[74:75], L_x_drain_5
L_nx_49:
  v_mfma_f32_16x16x32_bf16 v[104:107], v[60:63], v[20:23], v[104:107]
  s_add_u32 m0, s33, 128000
  v_mfma_f32_16x16x32_bf16 v[108:111], v[60:63], v[24:27], v[108:111]
  buffer_load_dwordx4 v2, s[12:15], s27 offen lds
  s_add_u32 s27, s27, s30
  v_mfma_f32_16x16x32_bf16 v[124:127], v[64:67], v[24:27], v[124:127]
  ds_read_b64_tr_b16 v[60:61], v6 offset:13440
  v_lshlrev_b32 v10, 16, v64
  v_and_b32 v11, s79, v64
  v_mfma_f32_16x16x32_bf16 v[120:123], v[64:67], v[20:23], v[120:123]
  ds_read_b64_tr_b16 v[62:63], v6 offset:17024
  v_add_f32 v90, v90, v10
  v_add_f32 v90, v90, v11
  v_mfma_f32_16x16x32_bf16 v[116:119], v[64:67], v[16:19], v[116:119]
  s_add_u32 m0, s34, 128000
  ds_read_b64_tr_b16 v[76:77], v6 offset:6272
  v_lshlrev_b32 v10, 16, v65
  v_and_b32 v11, s79, v65
  v_mfma_f32_16x16x32_bf16 v[112:115], v[64:67], v[12:15], v[112:115]
  buffer_load_dwordx4 v3, s[16:19], s28 offen lds
  s_add_u32 s28, s28, s31
  ds_read_b64_tr_b16 v[78:79], v6 offset:9856
  v_add_f32 v90, v90, v10
  v_add_f32 v90, v90, v11
  v_mfma_f32_16x16x32_bf16 v[128:131], v[12:15], v[68:71], v[128:131]
  v_lshlrev_b32 v10, 16, v66
  v_and_b32 v11, s79, v66
  v_mfma_f32_16x16x32_bf16 v[132:135], v[16:19], v[68:71], v[132:135]
  v_add_f32 v90, v90, v10
  v_add_f32 v90, v90, v11
  v_mfma_f32_16x16x32_bf16 v[136:139], v[20:23], v[68:71], v[136:139]
  s_add_u32 m0, s35, 128000
  v_lshlrev_b32 v10, 16, v67
  v_and_b32 v11, s79, v67
  v_mfma_f32_16x16x32_bf16 v[140:143], v[24:27], v[68:71], v[140:143]
  buffer_load_dwordx4 v4, s[20:23], s29 offen lds
  s_add_u32 s29, s29, s32
  v_add_f32 v90, v90, v10
  v_add_f32 v90, v90, v11
  s_waitcnt lgkmcnt(4)
  v_mfma_f32_16x16x32_bf16 v[156:159], v[24:27], v[72:75], v[156:159]
  ds_read_b64_tr_b16 v[68:69], v6 offset:13472
  v_mfma_f32_16x16x32_bf16 v[152:155], v[20:23], v[72:75], v[152:155]
  ds_read_b64_tr_b16 v[70:71], v6 offset:17056
  v_mfma_f32_16x16x32_bf16 v[148:151], v[16:19], v[72:75], v[148:151]
  s_add_u32 s50, s26, 0
  s_add_u32 m0, s24, 0
  ds_read_b64_tr_b16 v[64:65], v6 offset:6304
  v_mfma_f32_16x16x32_bf16 v[144:147], v[12:15], v[72:75], v[144:147]
  buffer_load_dwordx4 v1, s[8:11], s50 offen lds
  ds_read_b64_tr_b16 v[66:67], v6 offset:9888
  s_waitcnt lgkmcnt(4)
  v_mfma_f32_16x16x32_bf16 v[160:163], v[76:79], v[12:15], v[160:163]
  ds_read_b64_tr_b16 v[72:73], v6 offset:6336
  v_mfma_f32_16x16x32_bf16 v[164:167], v[76:79], v[16:19], v[164:167]
  ds_read_b64_tr_b16 v[74:75], v6 offset:9920
  v_mfma_f32_16x16x32_bf16 v[168:171], v[76:79], v[20:23], v[168:171]
  s_add_u32 s50, s26, 4096
  s_add_u32 m0, s24, 1040
  v_mfma_f32_16x16x32_bf16 v[172:175], v[76:79], v[24:27], v[172:175]
  buffer_load_dwordx4 v1, s[8:11], s50 offen lds
  v_mfma_f32_16x16x32_bf16 v[188:191], v[60:63], v[24:27], v[188:191]
  ds_read_b64_tr_b16 v[76:77], v6 offset:13504
  v_lshlrev_b32 v10, 16, v60
  v_and_b32 v11, s79, v60
  v_mfma_f32_16x16x32_bf16 v[184:187], v[60:63], v[20:23], v[184:187]
  ds_read_b64_tr_b16 v[78:79], v6 offset:17088
  v_add_f32 v91, v91, v10
  v_add_f32 v91, v91, v11
  v_mfma_f32_16x16x32_bf16 v[180:183], v[60:63], v[16:19], v[180:183]
  v_lshlrev_b32 v10, 16, v61
  v_and_b32 v11, s79, v61
  v_mfma_f32_16x16x32_bf16 v[176:179], v[60:63], v[12:15], v[176:179]
  v_add_f32 v91, v91, v10
  v_add_f32 v91, v91, v11
  s_waitcnt lgkmcnt(4)
  v_mfma_f32_16x16x32_bf16 v[192:195], v[64:67], v[12:15], v[192:195]
  v_lshlrev_b32 v10, 16, v62
  v_and_b32 v11, s79, v62
  v_mfma_f32_16x16x32_bf16 v[196:199], v[64:67], v[16:19], v[196:199]
  v_add_f32 v91, v91, v10
  v_add_f32 v91, v91, v11
  v_mfma_f32_16x16x32_bf16 v[200:203], v[64:67], v[20:23], v[200:203]
  v_lshlrev_b32 v10, 16, v63
  v_and_b32 v11, s79, v63
  v_mfma_f32_16x16x32_bf16 v[204:207], v[64:67], v[24:27], v[204:207]
  v_add_f32 v91, v91, v10
  v_add_f32 v91, v91, v11
  v_mfma_f32_16x16x32_bf16 v[220:223], v[68:71], v[24:27], v[220:223]
  ds_read_b64_tr_b16 v[64:65], v8 offset:22528
  v_mfma_f32_16x16x32_bf16 v[216:219], v[68:71], v[20:23], v[216:219]
  ds_read_b64_tr_b16 v[66:67], v8 offset:23552
  v_mfma_f32_16x16x32_bf16 v[212:215], v[68:71], v[16:19], v[212:215]
  ds_read_b64_tr_b16 v[60:61], v7 offset:22528
  v_mfma_f32_16x16x32_bf16 v[208:211], v[68:71], v[12:15], v[208:211]
  ds_read_b64_tr_b16 v[62:63], v7 offset:23552
  s_waitcnt lgkmcnt(6)
  v_mfma_f32_16x16x32_bf16 v[224:227], v[72:75], v[12:15], v[224:227]
  ds_read_b64_tr_b16 v[68:69], v7 offset:24576
  v_mfma_f32_16x16x32_bf16 v[228:231], v[72:75], v[16:19], v[228:231]
  ds_read_b64_tr_b16 v[70:71], v7 offset:25600
  v_mfma_f32_16x16x32_bf16 v[232:235], v[72:75], v[20:23], v[232:235]
  v_mfma_f32_16x16x32_bf16 v[236:239], v[72:75], v[24:27], v[236:239]
  s_cmp_eq_u32 s60, 2
  s_cbranch_scc0 L_nx_50
  s_call_b64 s[74:75], L_x_poll_5
L_nx_50:
  s_cmp_eq_u32 s60, 1
  s_cbranch_scc0 L_nx_51
  s_call_b64 s[74:75], L_x_cpoll_5
L_nx_51:
  s_waitcnt lgkmcnt(6)
  v_mfma_f32_16x16x32_bf16 v[252:255], v[76:79], v[24:27], v[252:255]
  ds_read_b64_tr_b16 v[72:73], v8 offset:24576
  v_lshlrev_b32 v10, 16, v76
  v_and_b32 v11, s79, v76
  v_add_f32 v92, v92, v10
  v_add_f32 v92, v92, v11
  v_mfma_f32_16x16x32_bf16 v[248:251], v[76:79], v[20:23], v[248:251]
  ds_read_b64_tr_b16 v[74:75], v8 offset:25600
  v_lshlrev_b32 v10, 16, v77
  v_and_b32 v11, s79, v77
  v_add_f32 v92, v92, v10
  v_add_f32 v92, v92, v11
  v_mfma_f32_16x16x32_bf16 v[244:247], v[76:79], v[16:19], v[244:247]
  v_lshlrev_b32 v10, 16, v78
  v_and_b32 v11, s79, v78
  v_add_f32 v92, v92, v10
  v_add_f32 v92, v92, v11
  v_mfma_f32_16x16x32_bf16 v[240:243], v[76:79], v[12:15], v[240:243]
  v_lshlrev_b32 v10, 16, v79
  v_and_b32 v11, s79, v79
  v_add_f32 v92, v92, v10
  v_add_f32 v92, v92, v11
  s_waitcnt vmcnt(5)
  s_barrier
  s_waitcnt lgkmcnt(4)
  v_mfma_f32_16x16x32_bf16 v[96:99], v[60:63], v[28:31], v[96:99]
  v_mfma_f32_16x16x32_bf16 v[100:103], v[60:63], v[32:35], v[100:103]
  v_mfma_f32_16x16x32_bf16 v[104:107], v[60:63], v[36:39], v[104:107]
  s_add_u32 m0, s33, 66560
  ds_read_b64 v[12:13], v5 offset:33280
  v_mfma_f32_16x16x32_bf16 v[108:111], v[60:63], v[40:43], v[108:111]
  buffer_load_dwordx4 v2, s[12:15], s27 offen lds
  s_add_u32 s27, s27, s30
  ds_read_b64 v[14:15], v5 offset:33312
  v_mfma_f32_16x16x32_bf16 v[124:127], v[64:67], v[40:43], v[124:127]
  ds_read_b64_tr_b16 v[60:61], v6 offset:33920
  v_lshlrev_b32 v10, 16, v64
  v_and_b32 v11, s79, v64
  v_mfma_f32_16x16x32_bf16 v[120:123], v[64:67], v[36:39], v[120:123]
  ds_read_b64_tr_b16 v[62:63], v6 offset:37504
  v_add_f32 v90, v90, v10
  v_add_f32 v90, v90, v11
  v_mfma_f32_16x16x32_bf16 v[116:119], v[64:67], v[32:35], v[116:119]
  s_add_u32 m0, s34, 66560
  ds_read_b64_tr_b16 v[76:77], v6 offset:26752
  ds_read_b64 v[16:17], v5 offset:33536
  v_lshlrev_b32 v10, 16, v65
  v_and_b32 v11, s79, v65
  v_mfma_f32_16x16x32_bf16 v[112:115], v[64:67], v[28:31], v[112:115]
  buffer_load_dwordx4 v3, s[16:19], s28 offen lds
  s_add_u32 s28, s28, s31
  ds_read_b64_tr_b16 v[78:79], v6 offset:30336
  ds_read_b64 v[18:19], v5 offset:33568
  v_add_f32 v90, v90, v10
  v_add_f32 v90, v90, v11
  s_waitcnt lgkmcnt(10)
  v_mfma_f32_16x16x32_bf16 v[128:131], v[28:31], v[68:71], v[128:131]
  v_lshlrev_b32 v10, 16, v66
  v_and_b32 v11, s79, v66
  v_mfma_f32_16x16x32_bf16 v[132:135], v[32:35], v[68:71], v[132:135]
  v_add_f32 v90, v90, v10
  v_add_f32 v90, v90, v11
  v_mfma_f32_16x16x32_bf16 v[136:139], v[36:39], v[68:71], v[136:139]
  s_add_u32 m0, s35, 66560
  ds_read_b64 v[20:21], v5 offset:33792
  v_lshlrev_b32 v10, 16, v67
  v_and_b32 v11, s79, v67
  v_mfma_f32_16x16x32_bf16 v[140:143], v[40:43], v[68:71], v[140:143]
  buffer_load_dwordx4 v4, s[20:23], s29 offen lds
  s_add_u32 s29, s29, s32
  ds_read_b64 v[22:23], v5 offset:33824
  v_add_f32 v90, v90, v10
  v_add_f32 v90, v90, v11
  s_waitcnt lgkmcnt(10)
  v_mfma_f32_16x16x32_bf16 v[156:159], v[40:43], v[72:75], v[156:159]
  ds_read_b64_tr_b16 v[68:69], v6 offset:33952
  v_mfma_f32_16x16x32_bf16 v[152:155], v[36:39], v[72:75], v[152:155]
  ds_read_b64_tr_b16 v[70:71], v6 offset:37536
  v_mfma_f32_16x16x32_bf16 v[148:151], v[32:35], v[72:75], v[148:151]
  s_add_u32 s50, s26, 262144
  s_add_u32 m0, s24, 16640
  ds_read_b64_tr_b16 v[64:65], v6 offset:26784
  ds_read_b64 v[24:25], v5 offset:34048
  v_mfma_f32_16x16x32_bf16 v[144:147], v[28:31], v[72:75], v[144:147]
  buffer_load_dwordx4 v1, s[8:11], s50 offen lds
  ds_read_b64_tr_b16 v[66:67], v6 offset:30368
  ds_read_b64 v[26:27], v5 offset:34080
  s_waitcnt lgkmcnt(9)
  v_mfma_f32_16x16x32_bf16 v[160:163], v[76:79], v[28:31], v[160:163]
  ds_read_b64_tr_b16 v[72:73], v6 offset:26816
  v_mfma_f32_16x16x32_bf16 v[164:167], v[76:79], v[32:35], v[164:167]
  ds_read_b64_tr_b16 v[74:75], v6 offset:30400
  v_mfma_f32_16x16x32_bf16 v[168:171], v[76:79], v[36:39], v[168:171]
  s_add_u32 s50, s26, 266240
  s_add_u32 m0, s24, 17680
  ds_read_b64 v[44:45], v5 offset:33344
  v_mfma_f32_16x16x32_bf16 v[172:175], v[76:79], v[40:43], v[172:175]
  buffer_load_dwordx4 v1, s[8:11], s50 offen lds
  ds_read_b64 v[46:47], v5 offset:33376
  v_mfma_f32_16x16x32_bf16 v[188:191], v[60:63], v[40:43], v[188:191]
  ds_read_b64_tr_b16 v[76:77], v6 offset:33984
  v_lshlrev_b32 v10, 16, v60
  v_and_b32 v11, s79, v60
  v_mfma_f32_16x16x32_bf16 v[184:187], v[60:63], v[36:39], v[184:187]
  ds_read_b64_tr_b16 v[78:79], v6 offset:37568
  v_add_f32 v91, v91, v10
  v_add_f32 v91, v91, v11
  v_mfma_f32_16x16x32_bf16 v[180:183], v[60:63], v[32:35], v[180:183]
  v_lshlrev_b32 v10, 16, v61
  v_and_b32 v11, s79, v61
  v_mfma_f32_16x16x32_bf16 v[176:179], v[60:63], v[28:31], v[176:179]
  v_add_f32 v91, v91, v10
  v_add_f32 v91, v91, v11
  s_waitcnt lgkmcnt(7)
  v_mfma_f32_16x16x32_bf16 v[192:195], v[64:67], v[28:31], v[192:195]
  v_lshlrev_b32 v10, 16, v62
  v_and_b32 v11, s79, v62
  v_mfma_f32_16x16x32_bf16 v[196:199], v[64:67], v[32:35], v[196:199]
  v_add_f32 v91, v91, v10
  v_add_f32 v91, v91, v11
  v_mfma_f32_16x16x32_bf16 v[200:203], v[64:67], v[36:39], v[200:203]
  ds_read_b64 v[48:49], v5 offset:33600
  v_lshlrev_b32 v10, 16, v63
  v_and_b32 v11, s79, v63
  v_mfma_f32_16x16x32_bf16 v[204:207], v[64:67], v[40:43], v[204:207]
  ds_read_b64 v[50:51], v5 offset:33632
  v_add_f32 v91, v91, v10
  v_add_f32 v91, v91, v11
  v_mfma_f32_16x16x32_bf16 v[220:223], v[68:71], v[40:43], v[220:223]
  ds_read_b64_tr_b16 v[64:65], v95 offset:2048
  v_mfma_f32_16x16x32_bf16 v[216:219], v[68:71], v[36:39], v[216:219]
  ds_read_b64_tr_b16 v[66:67], v95 offset:3072
  v_mfma_f32_16x16x32_bf16 v[212:215], v[68:71], v[32:35], v[212:215]
  ds_read_b64_tr_b16 v[60:61], v94 offset:2048
  ds_read_b64 v[52:53], v5 offset:33856
  v_mfma_f32_16x16x32_bf16 v[208:211], v[68:71], v[28:31], v[208:211]
  ds_read_b64_tr_b16 v[62:63], v94 offset:3072
  ds_read_b64 v[54:55], v5 offset:33888
  s_waitcnt lgkmcnt(12)
  v_mfma_f32_16x16x32_bf16 v[224:227], v[72:75], v[28:31], v[224:227]
  ds_read_b64_tr_b16 v[68:69], v94 offset:4096
  v_mfma_f32_16x16x32_bf16 v[228:231], v[72:75], v[32:35], v[228:231]
  ds_read_b64_tr_b16 v[70:71], v94 offset:5120
  v_mfma_f32_16x16x32_bf16 v[232:235], v[72:75], v[36:39], v[232:235]
  ds_read_b64 v[56:57], v5 offset:34112
  v_mfma_f32_16x16x32_bf16 v[236:239], v[72:75], v[40:43], v[236:239]
  ds_read_b64 v[58:59], v5 offset:34144
  s_waitcnt lgkmcnt(12)
  v_mfma_f32_16x16x32_bf16 v[252:255], v[76:79], v[40:43], v[252:255]
  ds_read_b64_tr_b16 v[72:73], v95 offset:4096
  v_lshlrev_b32 v10, 16, v76
  v_and_b32 v11, s79, v76
  v_add_f32 v92, v92, v10
  v_add_f32 v92, v92, v11
  v_mfma_f32_16x16x32_bf16 v[248:251], v[76:79], v[36:39], v[248:251]
  ds_read_b64_tr_b16 v[74:75], v95 offset:5120
  v_lshlrev_b32 v10, 16, v77
  v_and_b32 v11, s79, v77
  v_add_f32 v92, v92, v10
  v_add_f32 v92, v92, v11
  v_mfma_f32_16x16x32_bf16 v[244:247], v[76:79], v[32:35], v[244:247]
  s_add_u32 s25, s25, 128
  s_cmp_ge_u32 s25, 2048
  s_cselect_b32 s26, 0x10000000, s25
  v_lshlrev_b32 v10, 16, v78
  v_and_b32 v11, s79, v78
  v_add_f32 v92, v92, v10
  v_add_f32 v92, v92, v11
  v_mfma_f32_16x16x32_bf16 v[240:243], v[76:79], v[28:31], v[240:243]
  v_lshlrev_b32 v10, 16, v79
  v_and_b32 v11, s79, v79
  v_add_f32 v92, v92, v10
  v_add_f32 v92, v92, v11
  s_waitcnt vmcnt(5) lgkmcnt(2)
  s_barrier
  v_mfma_f32_16x16x32_bf16 v[96:99], v[60:63], v[12:15], v[96:99]
  v_mfma_f32_16x16x32_bf16 v[100:103], v[60:63], v[16:19], v[100:103]
  s_cmp_eq_u32 s60, 2
  s_cbranch_scc0 L_nx_52
  s_call_b64 s[74:75], L_x_stat_5
L_nx_52:
  s_cmp_eq_u32 s60, 8
  s_cbranch_scc0 L_nx_53
  s_call_b64 s[74:75], L_x_rows_5
L_nx_53:
  s_cmp_eq_u32 s60, 1
  s_cbranch_scc0 L_nx_54
  s_call_b64 s[74:75], L_x_cload_5
L_nx_54:
  v_mfma_f32_16x16x32_bf16 v[104:107], v[60:63], v[20:23], v[104:107]
  s_add_u32 m0, s33, 87040
  v_mfma_f32_16x16x32_bf16 v[108:111], v[60:63], v[24:27], v[108:111]
  buffer_load_dwordx4 v2, s[12:15], s27 offen lds
  s_add_u32 s27, s27, s30
  v_mfma_f32_16x16x32_bf16 v[124:127], v[64:67], v[24:27], v[124:127]
  ds_read_b64_tr_b16 v[60:61], v93 offset:13440
  v_lshlrev_b32 v10, 16, v64
  v_and_b32 v11, s79, v64
  v_mfma_f32_16x16x32_bf16 v[120:123], v[64:67], v[20:23], v[120:123]
  ds_read_b64_tr_b16 v[62:63], v93 offset:17024
  v_add_f32 v90, v90, v10
  v_add_f32 v90, v90, v11
  v_mfma_f32_16x16x32_bf16 v[116:119], v[64:67], v[16:19], v[116:119]
  s_add_u32 m0, s34, 87040
  ds_read_b64_tr_b16 v[76:77], v93 offset:6272
  v_lshlrev_b32 v10, 16, v65
  v_and_b32 v11, s79, v65
  v_mfma_f32_16x16x32_bf16 v[112:115], v[64:67], v[12:15], v[112:115]
  buffer_load_dwordx4 v3, s[16:19], s28 offen lds
  s_add_u32 s28, s28, s31
  ds_read_b64_tr_b16 v[78:79], v93 offset:9856
  v_add_f32 v90, v90, v10
  v_add_f32 v90, v90, v11
  v_mfma_f32_16x16x32_bf16 v[128:131], v[12:15], v[68:71], v[128:131]
  v_lshlrev_b32 v10, 16, v66
  v_and_b32 v11, s79, v66
  v_mfma_f32_16x16x32_bf16 v[132:135], v[16:19], v[68:71], v[132:135]
  v_add_f32 v90, v90, v10
  v_add_f32 v90, v90, v11
  v_mfma_f32_16x16x32_bf16 v[136:139], v[20:23], v[68:71], v[136:139]
  s_add_u32 m0, s35, 87040
  v_lshlrev_b32 v10, 16, v67
  v_and_b32 v11, s79, v67
  v_mfma_f32_16x16x32_bf16 v[140:143], v[24:27], v[68:71], v[140:143]
  buffer_load_dwordx4 v4, s[20:23], s29 offen lds
  s_add_u32 s29, s29, s32
  v_add_f32 v90, v90, v10
  v_add_f32 v90, v90, v11
  s_waitcnt lgkmcnt(4)
  v_mfma_f32_16x16x32_bf16 v[156:159], v[24:27], v[72:75], v[156:159]
  ds_read_b64_tr_b16 v[68:69], v93 offset:13472
  v_mfma_f32_16x16x32_bf16 v[152:155], v[20:23], v[72:75], v[152:155]
  ds_read_b64_tr_b16 v[70:71], v93 offset:17056
  v_mfma_f32_16x16x32_bf16 v[148:151], v[16:19], v[72:75], v[148:151]
  s_add_u32 s50, s26, 0
  s_add_u32 m0, s24, 33280
  ds_read_b64_tr_b16 v[64:65], v93 offset:6304
  v_mfma_f32_16x16x32_bf16 v[144:147], v[12:15], v[72:75], v[144:147]
  buffer_load_dwordx4 v1, s[8:11], s50 offen lds
  ds_read_b64_tr_b16 v[66:67], v93 offset:9888
  s_waitcnt lgkmcnt(4)
  v_mfma_f32_16x16x32_bf16 v[160:163], v[76:79], v[12:15], v[160:163]
  ds_read_b64_tr_b16 v[72:73], v93 offset:6336
  v_mfma_f32_16x16x32_bf16 v[164:167], v[76:79], v[16:19], v[164:167]
  ds_read_b64_tr_b16 v[74:75], v93 offset:9920
  v_mfma_f32_16x16x32_bf16 v[168:171], v[76:79], v[20:23], v[168:171]
  s_add_u32 s50, s26, 4096
  s_add_u32 m0, s24, 34320
  v_mfma_f32_16x16x32_bf16 v[172:175], v[76:79], v[24:27], v[172:175]
  buffer_load_dwordx4 v1, s[8:11], s50 offen lds
  v_mfma_f32_16x16x32_bf16 v[188:191], v[60:63], v[24:27], v[188:191]
  ds_read_b64_tr_b16 v[76:77], v93 offset:13504
  v_lshlrev_b32 v10, 16, v60
  v_and_b32 v11, s79, v60
  v_mfma_f32_16x16x32_bf16 v[184:187], v[60:63], v[20:23], v[184:187]
  ds_read_b64_tr_b16 v[78:79], v93 offset:17088
  v_add_f32 v91, v91, v10
  v_add_f32 v91, v91, v11
  v_mfma_f32_16x16x32_bf16 v[180:183], v[60:63], v[16:19], v[180:183]
  v_lshlrev_b32 v10, 16, v61
  v_and_b32 v11, s79, v61
  v_mfma_f32_16x16x32_bf16 v[176:179], v[60:63], v[12:15], v[176:179]
  v_add_f32 v91, v91, v10
  v_add_f32 v91, v91, v11
  s_waitcnt lgkmcnt(4)
  v_mfma_f32_16x16x32_bf16 v[192:195], v[64:67], v[12:15], v[192:195]
  v_lshlrev_b32 v10, 16, v62
  v_and_b32 v11, s79, v62
  v_mfma_f32_16x16x32_bf16 v[196:199], v[64:67], v[16:19], v[196:199]
  v_add_f32 v91, v91, v10
  v_add_f32 v91, v91, v11
  v_mfma_f32_16x16x32_bf16 v[200:203], v[64:67], v[20:23], v[200:203]
  v_lshlrev_b32 v10, 16, v63
  v_and_b32 v11, s79, v63
  v_mfma_f32_16x16x32_bf16 v[204:207], v[64:67], v[24:27], v[204:207]
  v_add_f32 v91, v91, v10
  v_add_f32 v91, v91, v11
  v_mfma_f32_16x16x32_bf16 v[220:223], v[68:71], v[24:27], v[220:223]
  ds_read_b64_tr_b16 v[64:65], v95 offset:22528
  v_mfma_f32_16x16x32_bf16 v[216:219], v[68:71], v[20:23], v[216:219]
  ds_read_b64_tr_b16 v[66:67], v95 offset:23552
  v_mfma_f32_16x16x32_bf16 v[212:215], v[68:71], v[16:19], v[212:215]
  ds_read_b64_tr_b16 v[60:61], v94 offset:22528
  v_mfma_f32_16x16x32_bf16 v[208:211], v[68:71], v[12:15], v[208:211]
  ds_read_b64_tr_b16 v[62:63], v94 offset:23552
  s_waitcnt lgkmcnt(6)
  v_mfma_f32_16x16x32_bf16 v[224:227], v[72:75], v[12:15], v[224:227]
  ds_read_b64_tr_b16 v[68:69], v94 offset:24576
  v_mfma_f32_16x16x32_bf16 v[228:231], v[72:75], v[16:19], v[228:231]
  ds_read_b64_tr_b16 v[70:71], v94 offset:25600
  v_mfma_f32_16x16x32_bf16 v[232:235], v[72:75], v[20:23], v[232:235]
  v_mfma_f32_16x16x32_bf16 v[236:239], v[72:75], v[24:27], v[236:239]
  s_waitcnt lgkmcnt(6)
  v_mfma_f32_16x16x32_bf16 v[252:255], v[76:79], v[24:27], v[252:255]
  ds_read_b64_tr_b16 v[72:73], v95 offset:24576
  v_lshlrev_b32 v10, 16, v76
  v_and_b32 v11, s79, v76
  v_add_f32 v92, v92, v10
  v_add_f32 v92, v92, v11
  v_mfma_f32_16x16x32_bf16 v[248:251], v[76:79], v[20:23], v[248:251]
  ds_read_b64_tr_b16 v[74:75], v95 offset:25600
  v_lshlrev_b32 v10, 16, v77
  v_and_b32 v11, s79, v77
  v_add_f32 v92, v92, v10
  v_add_f32 v92, v92, v11
  v_mfma_f32_16x16x32_bf16 v[244:247], v[76:79], v[16:19], v[244:247]
  v_lshlrev_b32 v10, 16, v78
  v_and_b32 v11, s79, v78
  v_add_f32 v92, v92, v10
  v_add_f32 v92, v92, v11
  v_mfma_f32_16x16x32_bf16 v[240:243], v[76:79], v[12:15], v[240:243]
  v_lshlrev_b32 v10, 16, v79
  v_and_b32 v11, s79, v79
  v_add_f32 v92, v92, v10
  v_add_f32 v92, v92, v11
  s_waitcnt vmcnt(5)
  s_barrier
  s_waitcnt lgkmcnt(4)
  v_mfma_f32_16x16x32_bf16 v[96:99], v[60:63], v[44:47], v[96:99]
  v_mfma_f32_16x16x32_bf16 v[100:103], v[60:63], v[48:51], v[100:103]
  v_mfma_f32_16x16x32_bf16 v[104:107], v[60:63], v[52:55], v[104:107]
  s_add_u32 m0, s33, 107520
  ds_read_b64 v[12:13], v5 offset:0
  v_mfma_f32_16x16x32_bf16 v[108:111], v[60:63], v[56:59], v[108:111]
  buffer_load_dwordx4 v2, s[12:15], s27 offen lds
  s_add_u32 s27, s27, s30
  ds_read_b64 v[14:15], v5 offset:32
  v_mfma_f32_16x16x32_bf16 v[124:127], v[64:67], v[56:59], v[124:127]
  ds_read_b64_tr_b16 v[60:61], v93 offset:33920
  v_lshlrev_b32 v10, 16, v64
  v_and_b32 v11, s79, v64
  v_mfma_f32_16x16x32_bf16 v[120:123], v[64:67], v[52:55], v[120:123]
  ds_read_b64_tr_b16 v[62:63], v93 offset:37504
  v_add_f32 v90, v90, v10
  v_add_f32 v90, v90, v11
  v_mfma_f32_16x16x32_bf16 v[116:119], v[64:67], v[48:51], v[116:119]
  s_add_u32 m0, s34, 107520
  ds_read_b64_tr_b16 v[76:77], v93 offset:26752
  ds_read_b64 v[16:17], v5 offset:256
  v_lshlrev_b32 v10, 16, v65
  v_and_b32 v11, s79, v65
  v_mfma_f32_16x16x32_bf16 v[112:115], v[64:67], v[44:47], v[112:115]
  buffer_load_dwordx4 v3, s[16:19], s28 offen lds
  s_add_u32 s28, s28, s31
  ds_read_b64_tr_b16 v[78:79], v93 offset:30336
  ds_read_b64 v[18:19], v5 offset:288
  v_add_f32 v90, v90, v10
  v_add_f32 v90, v90, v11
  s_waitcnt lgkmcnt(10)
  v_mfma_f32_16x16x32_bf16 v[128:131], v[44:47], v[68:71], v[128:131]
  v_lshlrev_b32 v10, 16, v66
  v_and_b32 v11, s79, v66
  v_mfma_f32_16x16x32_bf16 v[132:135], v[48:51], v[68:71], v[132:135]
  v_add_f32 v90, v90, v10
  v_add_f32 v90, v90, v11
  v_mfma_f32_16x16x32_bf16 v[136:139], v[52:55], v[68:71], v[136:139]
  s_add_u32 m0, s35, 107520
  ds_read_b64 v[20:21], v5 offset:512
  v_lshlrev_b32 v10, 16, v67
  v_and_b32 v11, s79, v67
  v_mfma_f32_16x16x32_bf16 v[140:143], v[56:59], v[68:71], v[140:143]
  buffer_load_dwordx4 v4, s[20:23], s29 offen lds
  s_add_u32 s29, s29, s32
  ds_read_b64 v[22:23], v5 offset:544
  v_add_f32 v90, v90, v10
  v_add_f32 v90, v90, v11
  s_waitcnt lgkmcnt(10)
  v_mfma_f32_16x16x32_bf16 v[156:159], v[56:59], v[72:75], v[156:159]
  ds_read_b64_tr_b16 v[68:69], v93 offset:33952
  v_mfma_f32_16x16x32_bf16 v[152:155], v[52:55], v[72:75], v[152:155]
  ds_read_b64_tr_b16 v[70:71], v93 offset:37536
  v_mfma_f32_16x16x32_bf16 v[148:151], v[48:51], v[72:75], v[148:151]
  s_add_u32 s50, s26, 262144
  s_add_u32 m0, s24, 49920
  ds_read_b64_tr_b16 v[64:65], v93 offset:26784
  ds_read_b64 v[24:25], v5 offset:768
  v_mfma_f32_16x16x32_bf16 v[144:147], v[44:47], v[72:75], v[144:147]
  buffer_load_dwordx4 v1, s[8:11], s50 offen lds
  ds_read_b64_tr_b16 v[66:67], v93 offset:30368
  ds_read_b64 v[26:27], v5 offset:800
  s_waitcnt lgkmcnt(9)
  v_mfma_f32_16x16x32_bf16 v[160:163], v[76:79], v[44:47], v[160:163]
  ds_read_b64_tr_b16 v[72:73], v93 offset:26816
  v_mfma_f32_16x16x32_bf16 v[164:167], v[76:79], v[48:51], v[164:167]
  ds_read_b64_tr_b16 v[74:75], v93 offset:30400
  v_mfma_f32_16x16x32_bf16 v[168:171], v[76:79], v[52:55], v[168:171]
  s_add_u32 s50, s26, 266240
  s_add_u32 m0, s24, 50960
  ds_read_b64 v[28:29], v5 offset:64
  v_mfma_f32_16x16x32_bf16 v[172:175], v[76:79], v[56:59], v[172:175]
  buffer_load_dwordx4 v1, s[8:11], s50 offen lds
  ds_read_b64 v[30:31], v5 offset:96
  v_mfma_f32_16x16x32_bf16 v[188:191], v[60:63], v[56:59], v[188:191]
  ds_read_b64_tr_b16 v[76:77], v93 offset:33984
  v_lshlrev_b32 v10, 16, v60
  v_and_b32 v11, s79, v60
  v_mfma_f32_16x16x32_bf16 v[184:187], v[60:63], v[52:55], v[184:187]
  ds_read_b64_tr_b16 v[78:79], v93 offset:37568
  v_add_f32 v91, v91, v10
  v_add_f32 v91, v91, v11
  v_mfma_f32_16x16x32_bf16 v[180:183], v[60:63], v[48:51], v[180:183]
  v_lshlrev_b32 v10, 16, v61
  v_and_b32 v11, s79, v61
  v_mfma_f32_16x16x32_bf16 v[176:179], v[60:63], v[44:47], v[176:179]
  v_add_f32 v91, v91, v10
  v_add_f32 v91, v91, v11
  s_waitcnt lgkmcnt(7)
  v_mfma_f32_16x16x32_bf16 v[192:195], v[64:67], v[44:47], v[192:195]
  v_lshlrev_b32 v10, 16, v62
  v_and_b32 v11, s79, v62
  v_mfma_f32_16x16x32_bf16 v[196:199], v[64:67], v[48:51], v[196:199]
  v_add_f32 v91, v91, v10
  v_add_f32 v91, v91, v11
  v_mfma_f32_16x16x32_bf16 v[200:203], v[64:67], v[52:55], v[200:203]
  ds_read_b64 v[32:33], v5 offset:320
  v_lshlrev_b32 v10, 16, v63
  v_and_b32 v11, s79, v63
  v_mfma_f32_16x16x32_bf16 v[204:207], v[64:67], v[56:59], v[204:207]
  ds_read_b64 v[34:35], v5 offset:352
  v_add_f32 v91, v91, v10
  v_add_f32 v91, v91, v11
  v_mfma_f32_16x16x32_bf16 v[220:223], v[68:71], v[56:59], v[220:223]
  ds_read_b64_tr_b16 v[64:65], v8 offset:2048
  v_mfma_f32_16x16x32_bf16 v[216:219], v[68:71], v[52:55], v[216:219]
  ds_read_b64_tr_b16 v[66:67], v8 offset:3072
  v_mfma_f32_16x16x32_bf16 v[212:215], v[68:71], v[48:51], v[212:215]
  ds_read_b64_tr_b16 v[60:61], v7 offset:2048
  ds_read_b64 v[36:37], v5 offset:576
  v_mfma_f32_16x16x32_bf16 v[208:211], v[68:71], v[44:47], v[208:211]
  ds_read_b64_tr_b16 v[62:63], v7 offset:3072
  ds_read_b64 v[38:39], v5 offset:608
  s_waitcnt lgkmcnt(12)
  v_mfma_f32_16x16x32_bf16 v[224:227], v[72:75], v[44:47], v[224:227]
  ds_read_b64_tr_b16 v[68:69], v7 offset:4096
  v_mfma_f32_16x16x32_bf16 v[228:231], v[72:75], v[48:51], v[228:231]
  ds_read_b64_tr_b16 v[70:71], v7 offset:5120
  v_mfma_f32_16x16x32_bf16 v[232:235], v[72:75], v[52:55], v[232:235]
  ds_read_b64 v[40:41], v5 offset:832
  v_mfma_f32_16x16x32_bf16 v[236:239], v[72:75], v[56:59], v[236:239]
  ds_read_b64 v[42:43], v5 offset:864
  s_waitcnt lgkmcnt(12)
  v_mfma_f32_16x16x32_bf16 v[252:255], v[76:79], v[56:59], v[252:255]
  ds_read_b64_tr_b16 v[72:73], v8 offset:4096
  v_lshlrev_b32 v10, 16, v76
  v_and_b32 v11, s79, v76
  v_add_f32 v92, v92, v10
  v_add_f32 v92, v92, v11
  v_mfma_f32_16x16x32_bf16 v[248:251], v[76:79], v[52:55], v[248:251]
  ds_read_b64_tr_b16 v[74:75], v8 offset:5120
  v_lshlrev_b32 v10, 16, v77
  v_and_b32 v11, s79, v77
  v_add_f32 v92, v92, v10
  v_add_f32 v92, v92, v11
  v_mfma_f32_16x16x32_bf16 v[244:247], v[76:79], v[48:51], v[244:247]
  s_add_u32 s25, s25, 128
  s_cmp_ge_u32 s25, 2048
  s_cselect_b32 s26, 0x10000000, s25
  v_lshlrev_b32 v10, 16, v78
  v_and_b32 v11, s79, v78
  v_add_f32 v92, v92, v10
  v_add_f32 v92, v92, v11
  v_mfma_f32_16x16x32_bf16 v[240:243], v[76:79], v[44:47], v[240:243]
  v_lshlrev_b32 v10, 16, v79
  v_and_b32 v11, s79, v79
  v_add_f32 v92, v92, v10
  v_add_f32 v92, v92, v11
  s_waitcnt vmcnt(5) lgkmcnt(2)
  s_barrier
  s_sub_u32 s60, s60, 1
  s_cmp_lt_u32 s60, 2
  s_cbranch_scc1 L_loopt5
  s_call_b64 s[74:75], L_x_cpub_5
  s_cmp_gt_u32 s60, 2
  s_cbranch_scc1 L_loopp5
L_loopt5:
  s_cmp_lg_u32 s60, 0
  s_cbranch_scc1 L_loopc5
  s_branch L_epi1
L_x_drain_5:
  s_waitcnt vmcnt(0)
  s_setpc_b64 s[74:75]
L_x_rows_5:
  s_waitcnt vmcnt(0)
  v_lshlrev_b32 v10, 16, v80
  v_and_b32 v11, s79, v80
  v_mov_b32 v88, v10
  v_mov_b32 v89, v11
  v_lshlrev_b32 v10, 16, v81
  v_and_b32 v11, s79, v81
  v_add_f32 v88, v88, v10
  v_add_f32 v89, v89, v11
  v_lshlrev_b32 v10, 16, v82
  v_and_b32 v11, s79, v82
  v_add_f32 v88, v88, v10
  v_add_f32 v89, v89, v11
  v_lshlrev_b32 v10, 16, v83
  v_and_b32 v11, s79, v83
  v_add_f32 v88, v88, v10
  v_add_f32 v89, v89, v11
  v_lshlrev_b32 v10, 16, v84
  v_and_b32 v11, s79, v84
  v_add_f32 v88, v88, v10
  v_add_f32 v89, v89, v11
  v_lshlrev_b32 v10, 16, v85
  v_and_b32 v11, s79, v85
  v_add_f32 v88, v88, v10
  v_add_f32 v89, v89, v11
  v_lshlrev_b32 v10, 16, v86
  v_and_b32 v11, s79, v86
  v_add_f32 v88, v88, v10
  v_add_f32 v89, v89, v11
  v_lshlrev_b32 v10, 16, v87
  v_and_b32 v11, s79, v87
  v_add_f32 v88, v88, v10
  v_add_f32 v89, v89, v11
  v_add_f32 v88, v88, v89
  s_nop 1
  v_add_f32_dpp v88, v88, v88 quad_perm:[1,0,3,2] row_mask:0xf bank_mask:0xf
  s_nop 1
  v_add_f32_dpp v88, v88, v88 quad_perm:[2,3,0,1] row_mask:0xf bank_mask:0xf
  s_nop 1
  v_add_f32_dpp v88, v88, v88 row_half_mirror row_mask:0xf bank_mask:0xf
  s_nop 1
  v_add_f32_dpp v88, v88, v88 row_mirror row_mask:0xf bank_mask:0xf
  v_mov_b32 v10, v88
  s_nop 1
  v_permlane16_swap_b32 v88, v10
  s_nop 0
  v_add_f32 v88, v88, v10
  v_mov_b32 v10, v88
  s_nop 1
  v_permlane32_swap_b32 v88, v10
  s_nop 0
  v_add_f32 v88, v88, v10
  v_mul_f32 v88, 0xba800000, v88
  v_lshlrev_b32 v10, 16, v80
  v_and_b32 v11, s79, v80
  v_add_f32 v10, v10, v88
  v_add_f32 v11, v11, v88
  v_mul_f32 v89, v10, v10
  v_fmac_f32 v89, v11, v11
  v_lshlrev_b32 v10, 16, v81
  v_and_b32 v11, s79, v81
  v_add_f32 v10, v10, v88
  v_add_f32 v11, v11, v88
  v_fmac_f32 v89, v10, v10
  v_fmac_f32 v89, v11, v11
  v_lshlrev_b32 v10, 16, v82
  v_and_b32 v11, s79, v82
  v_add_f32 v10, v10, v88
  v_add_f32 v11, v11, v88
  v_fmac_f32 v89, v10, v10
  v_fmac_f32 v89, v11, v11
  v_lshlrev_b32 v10, 16, v83
  v_and_b32 v11, s79, v83
  v_add_f32 v10, v10, v88
  v_add_f32 v11, v11, v88
  v_fmac_f32 v89, v10, v10
  v_fmac_f32 v89, v11, v11
  v_lshlrev_b32 v10, 16, v84
  v_and_b32 v11, s79, v84
  v_add_f32 v10, v10, v88
  v_add_f32 v11, v11, v88
  v_fmac_f32 v89, v10, v10
  v_fmac_f32 v89, v11, v11
  v_lshlrev_b32 v10, 16, v85
  v_and_b32 v11, s79, v85
  v_add_f32 v10, v10, v88
  v_add_f32 v11, v11, v88
  v_fmac_f32 v89, v10, v10
  v_fmac_f32 v89, v11, v11
  v_lshlrev_b32 v10, 16, v86
  v_and_b32 v11, s79, v86
  v_add_f32 v10, v10, v88
  v_add_f32 v11, v11, v88
  v_fmac_f32 v89, v10, v10
  v_fmac_f32 v89, v11, v11
  v_lshlrev_b32 v10, 16, v87
  v_and_b32 v11, s79, v87
  v_add_f32 v10, v10, v88
  v_add_f32 v11, v11, v88
  v_fmac_f32 v89, v10, v10
  v_fmac_f32 v89, v11, v11
  s_nop 1
  v_add_f32_dpp v89, v89, v89 quad_perm:[1,0,3,2] row_mask:0xf bank_mask:0xf
  s_nop 1
  v_add_f32_dpp v89, v89, v89 quad_perm:[2,3,0,1] row_mask:0xf bank_mask:0xf
  s_nop 1
  v_add_f32_dpp v89, v89, v89 row_half_mirror row_mask:0xf bank_mask:0xf
  s_nop 1
  v_add_f32_dpp v89, v89, v89 row_mirror row_mask:0xf bank_mask:0xf
  v_mov_b32 v10, v89
  s_nop 1
  v_permlane16_swap_b32 v89, v10
  s_nop 0
  v_add_f32 v89, v89, v10
  v_mov_b32 v10, v89
  s_nop 1
  v_permlane32_swap_b32 v89, v10
  s_nop 0
  v_add_f32 v89, v89, v10
  v_mul_f32 v89, 0x3a800000, v89
  v_cvt_pk_bf16_f32 v10, v88, v89
  v_lshlrev_b32 v80, 16, v10
  v_and_b32 v89, s79, v10
  v_add_f32 v89, 0x3727c5ac, v89
  v_cvt_pk_bf16_f32 v89, v89, v89
  v_lshlrev_b32 v89, 16, v89
  v_sqrt_f32 v89, v89
  s_lshl_b32 s51, s2, 6
  v_cvt_pk_bf16_f32 v89, v89, v89
  s_add_u32 s51, s51, 51380264
  v_lshlrev_b32 v81, 16, v89
  s_mov_b64 exec, 1
  buffer_store_dwordx2 v[80:81], v0, s[64:67], s51 offen sc1
  s_mov_b64 exec, -1
  s_setpc_b64 s[74:75]
L_x_poll_5:
  v_and_b32 v89, 0x70, v9
  v_lshlrev_b32 v89, 1, v89
  buffer_load_dword v88, v89, s[56:59], 0 offen sc1
  s_setpc_b64 s[74:75]
L_x_stat_5:
  s_waitcnt vmcnt(0)
  v_cmp_ne_u32 vcc, 32, v88
  s_nop 4
  s_cbranch_vccz L_x_stat_5_go
  s_sleep 2
  v_and_b32 v89, 0x70, v9
  v_lshlrev_b32 v89, 1, v89
  buffer_load_dword v88, v89, s[56:59], 0 offen sc1
  s_branch L_x_stat_5
L_x_stat_5_go:
  s_lshl_b32 s51, s6, 8
  s_lshl_b32 s55, s7, 5
  s_add_u32 s51, s51, s55
  s_lshl_b32 s55, s3, 2
  s_add_u32 s51, s51, s55
  s_add_u32 s51, s51, 50376704
  v_mov_b32 v88, 1
  s_mov_b64 exec, 1
  buffer_store_dword v88, v0, s[64:67], s51 offen sc1
  s_mov_b64 exec, -1
  v_and_b32 v88, 0xf0, v9
  v_lshrrev_b32 v88, 1, v88
  s_lshl_b32 s51, s7, 11
  s_add_u32 s51, s51, 51380736
  buffer_load_dwordx2 v[80:81], v88, s[64:67], s51 offen offset:0 sc1
  buffer_load_dwordx2 v[82:83], v88, s[64:67], s51 offen offset:128 sc1
  buffer_load_dwordx2 v[84:85], v88, s[64:67], s51 offen offset:256 sc1
  buffer_load_dwordx2 v[86:87], v88, s[64:67], s51 offen offset:384 sc1
  s_setpc_b64 s[74:75]
L_x_cpub_5:
  v_mov_b32 v10, v90
  v_mov_b32 v11, v91
  v_mov_b32 v88, v92
  s_nop 1
  v_permlane16_swap_b32 v90, v10
  v_permlane16_swap_b32 v91, v11
  v_permlane16_swap_b32 v92, v88
  v_add_f32 v90, v90, v10
  v_add_f32 v91, v91, v11
  v_add_f32 v92, v92, v88
  v_mov_b32 v10, v90
  v_mov_b32 v11, v91
  v_mov_b32 v88, v92
  s_nop 1
  v_permlane32_swap_b32 v90, v10
  v_permlane32_swap_b32 v91, v11
  v_permlane32_swap_b32 v92, v88
  v_add_f32 v90, v90, v10
  v_add_f32 v91, v91, v11
  v_add_f32 v92, v92, v88
  v_and_b32 v89, 0xf0, v9
  v_lshrrev_b32 v89, 2, v89
  s_mul_i32 s51, s6, 7680
  s_mul_i32 s52, s7, 1280
  s_add_u32 s51, s51, s52
  s_add_u32 s51, s51, 52429504
  s_mov_b64 exec, 0xffff
  buffer_store_dword v90, v89, s[64:67], s51 offen offset:0 sc1
  buffer_store_dword v91, v89, s[64:67], s51 offen offset:256 sc1
  buffer_store_dword v92, v89, s[64:67], s51 offen offset:512 sc1
  s_mov_b64 exec, -1
  s_nop 1
  v_mov_b32 v90, 0
  v_mov_b32 v91, 0
  v_mov_b32 v92, 0
  s_setpc_b64 s[74:75]
L_x_cpoll_5:
  v_lshrrev_b32 v89, 2, v9
  s_lshl_b32 s51, s6, 8
  s_add_u32 s51, s51, 50376704
  buffer_load_dword v88, v89, s[64:67], s51 offen sc1
  s_setpc_b64 s[74:75]
L_x_cload_5:
  s_waitcnt vmcnt(0)
  v_cmp_ne_u32 vcc, 1, v88
  s_nop 4
  s_cbranch_vccz L_x_cload_go
  s_sleep 1
  v_lshrrev_b32 v89, 2, v9
  s_lshl_b32 s51, s6, 8
  s_add_u32 s51, s51, 50376704
  buffer_load_dword v88, v89, s[64:67], s51 offen sc1
  s_branch L_x_cload_5
L_x_cload_go:
  s_mul_i32 s51, s6, 7680
  s_add_u32 s51, s51, 52428800
  s_mov_b32 m0, 156160
  s_nop 0
  buffer_load_dwordx4 v9, s[64:67], s51 offen offset:0 sc1 lds
  buffer_load_dwordx4 v9, s[64:67], s51 offen offset:1024 sc1 lds
  buffer_load_dwordx4 v9, s[64:67], s51 offen offset:2048 sc1 lds
  buffer_load_dwordx4 v9, s[64:67], s51 offen offset:3072 sc1 lds
  s_add_u32 s51, s51, 4096
  s_mov_b32 m0, 160256
  s_nop 0
  buffer_load_dwordx4 v9, s[64:67], s51 offen offset:0 sc1 lds
  buffer_load_dwordx4 v9, s[64:67], s51 offen offset:1024 sc1 lds
  buffer_load_dwordx4 v9, s[64:67], s51 offen offset:2048 sc1 lds
  buffer_load_dwordx4 v9, s[64:67], s51 offen offset:3072 sc1 lds
  s_add_u32 s51, s51, 4096
  s_setpc_b64 s[74:75]
L_loop6:
  s_cmp_eq_u32 s60, s61
  s_cbranch_scc1 L_loopc6
L_loopp6:
  v_mfma_f32_16x16x32_bf16 v[96:99], v[60:63], v[12:15], v[96:99]
  ds_read_b64_tr_b16 v[76:77], v6 offset:6272
  v_mfma_f32_16x16x32_bf16 v[100:103], v[60:63], v[16:19], v[100:103]
  ds_read_b64_tr_b16 v[78:79], v6 offset:9856
  s_cmp_eq_u32 s60, 6
  s_cbranch_scc0 L_nx_55
  s_call_b64 s[74:75], L_x_drain_6
L_nx_55:
  v_mfma_f32_16x16x32_bf16 v[104:107], v[60:63], v[20:23], v[104:107]
  s_add_u32 m0, s33, 128000
  v_mfma_f32_16x16x32_bf16 v[108:111], v[60:63], v[24:27], v[108:111]
  buffer_load_dwordx4 v2, s[12:15], s27 offen lds
  s_add_u32 s27, s27, s30
  v_mfma_f32_16x16x32_bf16 v[124:127], v[64:67], v[24:27], v[124:127]
  ds_read_b64_tr_b16 v[60:61], v6 offset:13440
  v_mfma_f32_16x16x32_bf16 v[120:123], v[64:67], v[20:23], v[120:123]
  ds_read_b64_tr_b16 v[62:63], v6 offset:17024
  v_mfma_f32_16x16x32_bf16 v[116:119], v[64:67], v[16:19], v[116:119]
  s_add_u32 m0, s34, 128000
  v_mfma_f32_16x16x32_bf16 v[112:115], v[64:67], v[12:15], v[112:115]
  buffer_load_dwordx4 v3, s[16:19], s28 offen lds
  s_add_u32 s28, s28, s31
  v_mfma_f32_16x16x32_bf16 v[128:131], v[12:15], v[68:71], v[128:131]
  ds_read_b64_tr_b16 v[64:65], v6 offset:6304
  v_mfma_f32_16x16x32_bf16 v[132:135], v[16:19], v[68:71], v[132:135]
  ds_read_b64_tr_b16 v[66:67], v6 offset:9888
  v_mfma_f32_16x16x32_bf16 v[136:139], v[20:23], v[68:71], v[136:139]
  s_add_u32 s50, s26, 0
  s_add_u32 m0, s24, 0
  v_mfma_f32_16x16x32_bf16 v[140:143], v[24:27], v[68:71], v[140:143]
  buffer_load_dwordx4 v1, s[8:11], s50 offen lds
  s_waitcnt lgkmcnt(6)
  v_mfma_f32_16x16x32_bf16 v[156:159], v[24:27], v[72:75], v[156:159]
  v_mfma_f32_16x16x32_bf16 v[152:155], v[20:23], v[72:75], v[152:155]
  v_mfma_f32_16x16x32_bf16 v[148:151], v[16:19], v[72:75], v[148:151]
  s_add_u32 s50, s26, 4096
  s_add_u32 m0, s24, 1040
  v_mfma_f32_16x16x32_bf16 v[144:147], v[12:15], v[72:75], v[144:147]
  buffer_load_dwordx4 v1, s[8:11], s50 offen lds
  s_waitcnt lgkmcnt(4)
  v_mfma_f32_16x16x32_bf16 v[160:163], v[76:79], v[12:15], v[160:163]
  ds_read_b64_tr_b16 v[72:73], v6 offset:6336
  v_mfma_f32_16x16x32_bf16 v[164:167], v[76:79], v[16:19], v[164:167]
  ds_read_b64_tr_b16 v[74:75], v6 offset:9920
  v_mfma_f32_16x16x32_bf16 v[168:171], v[76:79], v[20:23], v[168:171]
  s_add_u32 s50, s26, 8192
  s_add_u32 m0, s24, 2080
  ds_read_b64_tr_b16 v[68:69], v6 offset:13472
  v_mfma_f32_16x16x32_bf16 v[172:175], v[76:79], v[24:27], v[172:175]
  buffer_load_dwordx4 v1, s[8:11], s50 offen lds
  ds_read_b64_tr_b16 v[70:71], v6 offset:17056
  s_waitcnt lgkmcnt(6)
  v_mfma_f32_16x16x32_bf16 v[188:191], v[60:63], v[24:27], v[188:191]
  ds_read_b64_tr_b16 v[76:77], v6 offset:13504
  v_mfma_f32_16x16x32_bf16 v[184:187], v[60:63], v[20:23], v[184:187]
  ds_read_b64_tr_b16 v[78:79], v6 offset:17088
  v_mfma_f32_16x16x32_bf16 v[180:183], v[60:63], v[16:19], v[180:183]
  s_add_u32 s50, s26, 12288
  s_add_u32 m0, s24, 3120
  v_mfma_f32_16x16x32_bf16 v[176:179], v[60:63], v[12:15], v[176:179]
  buffer_load_dwordx4 v1, s[8:11], s50 offen lds
  s_waitcnt lgkmcnt(6)
  v_mfma_f32_16x16x32_bf16 v[192:195], v[64:67], v[12:15], v[192:195]
  ds_read_b64_tr_b16 v[60:61], v7 offset:22528
  v_mfma_f32_16x16x32_bf16 v[196:199], v[64:67], v[16:19], v[196:199]
  ds_read_b64_tr_b16 v[62:63], v7 offset:23552
  v_mfma_f32_16x16x32_bf16 v[200:203], v[64:67], v[20:23], v[200:203]
  v_mfma_f32_16x16x32_bf16 v[204:207], v[64:67], v[24:27], v[204:207]
  s_waitcnt lgkmcnt(4)
  v_mfma_f32_16x16x32_bf16 v[220:223], v[68:71], v[24:27], v[220:223]
  v_mfma_f32_16x16x32_bf16 v[216:219], v[68:71], v[20:23], v[216:219]
  v_mfma_f32_16x16x32_bf16 v[212:215], v[68:71], v[16:19], v[212:215]
  v_mfma_f32_16x16x32_bf16 v[208:211], v[68:71], v[12:15], v[208:211]
  v_mfma_f32_16x16x32_bf16 v[224:227], v[72:75], v[12:15], v[224:227]
  ds_read_b64_tr_b16 v[68:69], v7 offset:24576
  v_mfma_f32_16x16x32_bf16 v[228:231], v[72:75], v[16:19], v[228:231]
  ds_read_b64_tr_b16 v[70:71], v7 offset:25600
  v_mfma_f32_16x16x32_bf16 v[232:235], v[72:75], v[20:23], v[232:235]
  ds_read_b64_tr_b16 v[64:65], v8 offset:22528
  v_mfma_f32_16x16x32_bf16 v[236:239], v[72:75], v[24:27], v[236:239]
  ds_read_b64_tr_b16 v[66:67], v8 offset:23552
  s_cmp_eq_u32 s60, 2
  s_cbranch_scc0 L_nx_56
  s_call_b64 s[74:75], L_x_poll_6
L_nx_56:
  s_waitcnt lgkmcnt(6)
  v_mfma_f32_16x16x32_bf16 v[252:255], v[76:79], v[24:27], v[252:255]
  ds_read_b64_tr_b16 v[72:73], v8 offset:24576
  v_mfma_f32_16x16x32_bf16 v[248:251], v[76:79], v[20:23], v[248:251]
  ds_read_b64_tr_b16 v[74:75], v8 offset:25600
  v_mfma_f32_16x16x32_bf16 v[244:247], v[76:79], v[16:19], v[244:247]
  v_mfma_f32_16x16x32_bf16 v[240:243], v[76:79], v[12:15], v[240:243]
  s_waitcnt vmcnt(6)
  s_barrier
  s_waitcnt lgkmcnt(6)
  v_mfma_f32_16x16x32_bf16 v[96:99], v[60:63], v[28:31], v[96:99]
  ds_read_b64_tr_b16 v[76:77], v6 offset:26752
  v_mfma_f32_16x16x32_bf16 v[100:103], v[60:63], v[32:35], v[100:103]
  ds_read_b64_tr_b16 v[78:79], v6 offset:30336
  v_mfma_f32_16x16x32_bf16 v[104:107], v[60:63], v[36:39], v[104:107]
  s_add_u32 m0, s33, 66560
  ds_read_b64 v[12:13], v5 offset:33280
  v_mfma_f32_16x16x32_bf16 v[108:111], v[60:63], v[40:43], v[108:111]
  buffer_load_dwordx4 v2, s[12:15], s27 offen lds
  s_add_u32 s27, s27, s30
  ds_read_b64 v[14:15], v5 offset:33312
  s_waitcnt lgkmcnt(6)
  v_mfma_f32_16x16x32_bf16 v[124:127], v[64:67], v[40:43], v[124:127]
  ds_read_b64_tr_b16 v[60:61], v6 offset:33920
  v_mfma_f32_16x16x32_bf16 v[120:123], v[64:67], v[36:39], v[120:123]
  ds_read_b64_tr_b16 v[62:63], v6 offset:37504
  v_mfma_f32_16x16x32_bf16 v[116:119], v[64:67], v[32:35], v[116:119]
  s_add_u32 m0, s34, 66560
  ds_read_b64 v[16:17], v5 offset:33536
  v_mfma_f32_16x16x32_bf16 v[112:115], v[64:67], v[28:31], v[112:115]
  buffer_load_dwordx4 v3, s[16:19], s28 offen lds
  s_add_u32 s28, s28, s31
  ds_read_b64 v[18:19], v5 offset:33568
  v_mfma_f32_16x16x32_bf16 v[128:131], v[28:31], v[68:71], v[128:131]
  ds_read_b64_tr_b16 v[64:65], v6 offset:26784
  v_mfma_f32_16x16x32_bf16 v[132:135], v[32:35], v[68:71], v[132:135]
  ds_read_b64_tr_b16 v[66:67], v6 offset:30368
  v_mfma_f32_16x16x32_bf16 v[136:139], v[36:39], v[68:71], v[136:139]
  s_add_u32 s50, s26, 262144
  s_add_u32 m0, s24, 16640
  ds_read_b64 v[20:21], v5 offset:33792
  v_mfma_f32_16x16x32_bf16 v[140:143], v[40:43], v[68:71], v[140:143]
  buffer_load_dwordx4 v1, s[8:11], s50 offen lds
  ds_read_b64 v[22:23], v5 offset:33824
  s_waitcnt lgkmcnt(12)
  v_mfma_f32_16x16x32_bf16 v[156:159], v[40:43], v[72:75], v[156:159]
  v_mfma_f32_16x16x32_bf16 v[152:155], v[36:39], v[72:75], v[152:155]
  v_mfma_f32_16x16x32_bf16 v[148:151], v[32:35], v[72:75], v[148:151]
  s_add_u32 s50, s26, 266240
  s_add_u32 m0, s24, 17680
  ds_read_b64 v[24:25], v5 offset:34048
  v_mfma_f32_16x16x32_bf16 v[144:147], v[28:31], v[72:75], v[144:147]
  buffer_load_dwordx4 v1, s[8:11], s50 offen lds
  ds_read_b64 v[26:27], v5 offset:34080
  s_waitcnt lgkmcnt(12)
  v_mfma_f32_16x16x32_bf16 v[160:163], v[76:79], v[28:31], v[160:163]
  ds_read_b64_tr_b16 v[72:73], v6 offset:26816
  v_mfma_f32_16x16x32_bf16 v[164:167], v[76:79], v[32:35], v[164:167]
  ds_read_b64_tr_b16 v[74:75], v6 offset:30400
  v_mfma_f32_16x16x32_bf16 v[168:171], v[76:79], v[36:39], v[168:171]
  s_add_u32 s50, s26, 270336
  s_add_u32 m0, s24, 18720
  ds_read_b64_tr_b16 v[68:69], v6 offset:33952
  ds_read_b64 v[44:45], v5 offset:33344
  v_mfma_f32_16x16x32_bf16 v[172:175], v[76:79], v[40:43], v[172:175]
  buffer_load_dwordx4 v1, s[8:11], s50 offen lds
  ds_read_b64_tr_b16 v[70:71], v6 offset:37536
  ds_read_b64 v[46:47], v5 offset:33376
  s_waitcnt lgkmcnt(14)
  v_mfma_f32_16x16x32_bf16 v[188:191], v[60:63], v[40:43], v[188:191]
  ds_read_b64_tr_b16 v[76:77], v6 offset:33984
  v_mfma_f32_16x16x32_bf16 v[184:187], v[60:63], v[36:39], v[184:187]
  ds_read_b64_tr_b16 v[78:79], v6 offset:37568
  v_mfma_f32_16x16x32_bf16 v[180:183], v[60:63], v[32:35], v[180:183]
  s_add_u32 s50, s26, 274432
  s_add_u32 m0, s24, 19760
  v_mfma_f32_16x16x32_bf16 v[176:179], v[60:63], v[28:31], v[176:179]
  buffer_load_dwordx4 v1, s[8:11], s50 offen lds
  s_waitcnt lgkmcnt(12)
  v_mfma_f32_16x16x32_bf16 v[192:195], v[64:67], v[28:31], v[192:195]
  ds_read_b64_tr_b16 v[60:61], v94 offset:2048
  v_mfma_f32_16x16x32_bf16 v[196:199], v[64:67], v[32:35], v[196:199]
  ds_read_b64_tr_b16 v[62:63], v94 offset:3072
  v_mfma_f32_16x16x32_bf16 v[200:203], v[64:67], v[36:39], v[200:203]
  ds_read_b64 v[48:49], v5 offset:33600
  v_mfma_f32_16x16x32_bf16 v[204:207], v[64:67], v[40:43], v[204:207]
  ds_read_b64 v[50:51], v5 offset:33632
  s_waitcnt lgkmcnt(7)
  v_mfma_f32_16x16x32_bf16 v[220:223], v[68:71], v[40:43], v[220:223]
  v_mfma_f32_16x16x32_bf16 v[216:219], v[68:71], v[36:39], v[216:219]
  v_mfma_f32_16x16x32_bf16 v[212:215], v[68:71], v[32:35], v[212:215]
  ds_read_b64 v[52:53], v5 offset:33856
  v_mfma_f32_16x16x32_bf16 v[208:211], v[68:71], v[28:31], v[208:211]
  ds_read_b64 v[54:55], v5 offset:33888
  v_mfma_f32_16x16x32_bf16 v[224:227], v[72:75], v[28:31], v[224:227]
  ds_read_b64_tr_b16 v[68:69], v94 offset:4096
  v_mfma_f32_16x16x32_bf16 v[228:231], v[72:75], v[32:35], v[228:231]
  ds_read_b64_tr_b16 v[70:71], v94 offset:5120
  v_mfma_f32_16x16x32_bf16 v[232:235], v[72:75], v[36:39], v[232:235]
  ds_read_b64_tr_b16 v[64:65], v95 offset:2048
  ds_read_b64 v[56:57], v5 offset:34112
  v_mfma_f32_16x16x32_bf16 v[236:239], v[72:75], v[40:43], v[236:239]
  ds_read_b64_tr_b16 v[66:67], v95 offset:3072
  ds_read_b64 v[58:59], v5 offset:34144
  s_waitcnt lgkmcnt(12)
  v_mfma_f32_16x16x32_bf16 v[252:255], v[76:79], v[40:43], v[252:255]
  ds_read_b64_tr_b16 v[72:73], v95 offset:4096
  v_mfma_f32_16x16x32_bf16 v[248:251], v[76:79], v[36:39], v[248:251]
  ds_read_b64_tr_b16 v[74:75], v95 offset:5120
  v_mfma_f32_16x16x32_bf16 v[244:247], v[76:79], v[32:35], v[244:247]
  s_add_u32 s25, s25, 128
  s_cmp_ge_u32 s25, 2048
  s_cselect_b32 s26, 0x10000000, s25
  v_mfma_f32_16x16x32_bf16 v[240:243], v[76:79], v[28:31], v[240:243]
  s_waitcnt vmcnt(6) lgkmcnt(2)
  s_barrier
  v_mfma_f32_16x16x32_bf16 v[96:99], v[60:63], v[12:15], v[96:99]
  ds_read_b64_tr_b16 v[76:77], v93 offset:6272
  v_mfma_f32_16x16x32_bf16 v[100:103], v[60:63], v[16:19], v[100:103]
  ds_read_b64_tr_b16 v[78:79], v93 offset:9856
  s_cmp_eq_u32 s60, 2
  s_cbranch_scc0 L_nx_57
  s_call_b64 s[74:75], L_x_stat_6
L_nx_57:
  s_cmp_eq_u32 s60, 8
  s_cbranch_scc0 L_nx_58
  s_call_b64 s[74:75], L_x_rows_6
L_nx_58:
  v_mfma_f32_16x16x32_bf16 v[104:107], v[60:63], v[20:23], v[104:107]
  s_add_u32 m0, s33, 87040
  v_mfma_f32_16x16x32_bf16 v[108:111], v[60:63], v[24:27], v[108:111]
  buffer_load_dwordx4 v2, s[12:15], s27 offen lds
  s_add_u32 s27, s27, s30
  v_mfma_f32_16x16x32_bf16 v[124:127], v[64:67], v[24:27], v[124:127]
  ds_read_b64_tr_b16 v[60:61], v93 offset:13440
  v_mfma_f32_16x16x32_bf16 v[120:123], v[64:67], v[20:23], v[120:123]
  ds_read_b64_tr_b16 v[62:63], v93 offset:17024
  v_mfma_f32_16x16x32_bf16 v[116:119], v[64:67], v[16:19], v[116:119]
  s_add_u32 m0, s34, 87040
  v_mfma_f32_16x16x32_bf16 v[112:115], v[64:67], v[12:15], v[112:115]
  buffer_load_dwordx4 v3, s[16:19], s28 offen lds
  s_add_u32 s28, s28, s31
  v_mfma_f32_16x16x32_bf16 v[128:131], v[12:15], v[68:71], v[128:131]
  ds_read_b64_tr_b16 v[64:65], v93 offset:6304
  v_mfma_f32_16x16x32_bf16 v[132:135], v[16:19], v[68:71], v[132:135]
  ds_read_b64_tr_b16 v[66:67], v93 offset:9888
  v_mfma_f32_16x16x32_bf16 v[136:139], v[20:23], v[68:71], v[136:139]
  s_add_u32 s50, s26, 0
  s_add_u32 m0, s24, 33280
  v_mfma_f32_16x16x32_bf16 v[140:143], v[24:27], v[68:71], v[140:143]
  buffer_load_dwordx4 v1, s[8:11], s50 offen lds
  s_waitcnt lgkmcnt(6)
  v_mfma_f32_16x16x32_bf16 v[156:159], v[24:27], v[72:75], v[156:159]
  v_mfma_f32_16x16x32_bf16 v[152:155], v[20:23], v[72:75], v[152:155]
  v_mfma_f32_16x16x32_bf16 v[148:151], v[16:19], v[72:75], v[148:151]
  s_add_u32 s50, s26, 4096
  s_add_u32 m0, s24, 34320
  v_mfma_f32_16x16x32_bf16 v[144:147], v[12:15], v[72:75], v[144:147]
  buffer_load_dwordx4 v1, s[8:11], s50 offen lds
  s_waitcnt lgkmcnt(4)
  v_mfma_f32_16x16x32_bf16 v[160:163], v[76:79], v[12:15], v[160:163]
  ds_read_b64_tr_b16 v[72:73], v93 offset:6336
  v_mfma_f32_16x16x32_bf16 v[164:167], v[76:79], v[16:19], v[164:167]
  ds_read_b64_tr_b16 v[74:75], v93 offset:9920
  v_mfma_f32_16x16x32_bf16 v[168:171], v[76:79], v[20:23], v[168:171]
  s_add_u32 s50, s26, 8192
  s_add_u32 m0, s24, 35360
  ds_read_b64_tr_b16 v[68:69], v93 offset:13472
  v_mfma_f32_16x16x32_bf16 v[172:175], v[76:79], v[24:27], v[172:175]
  buffer_load_dwordx4 v1, s[8:11], s50 offen lds
  ds_read_b64_tr_b16 v[70:71], v93 offset:17056
  s_waitcnt lgkmcnt(6)
  v_mfma_f32_16x16x32_bf16 v[188:191], v[60:63], v[24:27], v[188:191]
  ds_read_b64_tr_b16 v[76:77], v93 offset:13504
  v_mfma_f32_16x16x32_bf16 v[184:187], v[60:63], v[20:23], v[184:187]
  ds_read_b64_tr_b16 v[78:79], v93 offset:17088
  v_mfma_f32_16x16x32_bf16 v[180:183], v[60:63], v[16:19], v[180:183]
  s_add_u32 s50, s26, 12288
  s_add_u32 m0, s24, 36400
  v_mfma_f32_16x16x32_bf16 v[176:179], v[60:63], v[12:15], v[176:179]
  buffer_load_dwordx4 v1, s[8:11], s50 offen lds
  s_waitcnt lgkmcnt(6)
  v_mfma_f32_16x16x32_bf16 v[192:195], v[64:67], v[12:15], v[192:195]
  ds_read_b64_tr_b16 v[60:61], v94 offset:22528
  v_mfma_f32_16x16x32_bf16 v[196:199], v[64:67], v[16:19], v[196:199]
  ds_read_b64_tr_b16 v[62:63], v94 offset:23552
  v_mfma_f32_16x16x32_bf16 v[200:203], v[64:67], v[20:23], v[200:203]
  v_mfma_f32_16x16x32_bf16 v[204:207], v[64:67], v[24:27], v[204:207]
  s_waitcnt lgkmcnt(4)
  v_mfma_f32_16x16x32_bf16 v[220:223], v[68:71], v[24:27], v[220:223]
  v_mfma_f32_16x16x32_bf16 v[216:219], v[68:71], v[20:23], v[216:219]
  v_mfma_f32_16x16x32_bf16 v[212:215], v[68:71], v[16:19], v[212:215]
  v_mfma_f32_16x16x32_bf16 v[208:211], v[68:71], v[12:15], v[208:211]
  v_mfma_f32_16x16x32_bf16 v[224:227], v[72:75], v[12:15], v[224:227]
  ds_read_b64_tr_b16 v[68:69], v94 offset:24576
  v_mfma_f32_16x16x32_bf16 v[228:231], v[72:75], v[16:19], v[228:231]
  ds_read_b64_tr_b16 v[70:71], v94 offset:25600
  v_mfma_f32_16x16x32_bf16 v[232:235], v[72:75], v[20:23], v[232:235]
  ds_read_b64_tr_b16 v[64:65], v95 offset:22528
  v_mfma_f32_16x16x32_bf16 v[236:239], v[72:75], v[24:27], v[236:239]
  ds_read_b64_tr_b16 v[66:67], v95 offset:23552
  s_waitcnt lgkmcnt(6)
  v_mfma_f32_16x16x32_bf16 v[252:255], v[76:79], v[24:27], v[252:255]
  ds_read_b64_tr_b16 v[72:73], v95 offset:24576
  v_mfma_f32_16x16x32_bf16 v[248:251], v[76:79], v[20:23], v[248:251]
  ds_read_b64_tr_b16 v[74:75], v95 offset:25600
  v_mfma_f32_16x16x32_bf16 v[244:247], v[76:79], v[16:19], v[244:247]
  v_mfma_f32_16x16x32_bf16 v[240:243], v[76:79], v[12:15], v[240:243]
  s_waitcnt vmcnt(6)
  s_barrier
  s_waitcnt lgkmcnt(6)
  v_mfma_f32_16x16x32_bf16 v[96:99], v[60:63], v[44:47], v[96:99]
  ds_read_b64_tr_b16 v[76:77], v93 offset:26752
  v_mfma_f32_16x16x32_bf16 v[100:103], v[60:63], v[48:51], v[100:103]
  ds_read_b64_tr_b16 v[78:79], v93 offset:30336
  v_mfma_f32_16x16x32_bf16 v[104:107], v[60:63], v[52:55], v[104:107]
  s_add_u32 m0, s33, 107520
  ds_read_b64 v[12:13], v5 offset:0
  v_mfma_f32_16x16x32_bf16 v[108:111], v[60:63], v[56:59], v[108:111]
  buffer_load_dwordx4 v2, s[12:15], s27 offen lds
  s_add_u32 s27, s27, s30
  ds_read_b64 v[14:15], v5 offset:32
  s_waitcnt lgkmcnt(6)
  v_mfma_f32_16x16x32_bf16 v[124:127], v[64:67], v[56:59], v[124:127]
  ds_read_b64_tr_b16 v[60:61], v93 offset:33920
  v_mfma_f32_16x16x32_bf16 v[120:123], v[64:67], v[52:55], v[120:123]
  ds_read_b64_tr_b16 v[62:63], v93 offset:37504
  v_mfma_f32_16x16x32_bf16 v[116:119], v[64:67], v[48:51], v[116:119]
  s_add_u32 m0, s34, 107520
  ds_read_b64 v[16:17], v5 offset:256
  v_mfma_f32_16x16x32_bf16 v[112:115], v[64:67], v[44:47], v[112:115]
  buffer_load_dwordx4 v3, s[16:19], s28 offen lds
  s_add_u32 s28, s28, s31
  ds_read_b64 v[18:19], v5 offset:288
  v_mfma_f32_16x16x32_bf16 v[128:131], v[44:47], v[68:71], v[128:131]
  ds_read_b64_tr_b16 v[64:65], v93 offset:26784
  v_mfma_f32_16x16x32_bf16 v[132:135], v[48:51], v[68:71], v[132:135]
  ds_read_b64_tr_b16 v[66:67], v93 offset:30368
  v_mfma_f32_16x16x32_bf16 v[136:139], v[52:55], v[68:71], v[136:139]
  s_add_u32 s50, s26, 262144
  s_add_u32 m0, s24, 49920
  ds_read_b64 v[20:21], v5 offset:512
  v_mfma_f32_16x16x32_bf16 v[140:143], v[56:59], v[68:71], v[140:143]
  buffer_load_dwordx4 v1, s[8:11], s50 offen lds
  ds_read_b64 v[22:23], v5 offset:544
  s_waitcnt lgkmcnt(12)
  v_mfma_f32_16x16x32_bf16 v[156:159], v[56:59], v[72:75], v[156:159]
  v_mfma_f32_16x16x32_bf16 v[152:155], v[52:55], v[72:75], v[152:155]
  v_mfma_f32_16x16x32_bf16 v[148:151], v[48:51], v[72:75], v[148:151]
  s_add_u32 s50, s26, 266240
  s_add_u32 m0, s24, 50960
  ds_read_b64 v[24:25], v5 offset:768
  v_mfma_f32_16x16x32_bf16 v[144:147], v[44:47], v[72:75], v[144:147]
  buffer_load_dwordx4 v1, s[8:11], s50 offen lds
  ds_read_b64 v[26:27], v5 offset:800
  s_waitcnt lgkmcnt(12)
  v_mfma_f32_16x16x32_bf16 v[160:163], v[76:79], v[44:47], v[160:163]
  ds_read_b64_tr_b16 v[72:73], v93 offset:26816
  v_mfma_f32_16x16x32_bf16 v[164:167], v[76:79], v[48:51], v[164:167]
  ds_read_b64_tr_b16 v[74:75], v93 offset:30400
  v_mfma_f32_16x16x32_bf16 v[168:171], v[76:79], v[52:55], v[168:171]
  s_add_u32 s50, s26, 270336
  s_add_u32 m0, s24, 52000
  ds_read_b64_tr_b16 v[68:69], v93 offset:33952
  ds_read_b64 v[28:29], v5 offset:64
  v_mfma_f32_16x16x32_bf16 v[172:175], v[76:79], v[56:59], v[172:175]
  buffer_load_dwordx4 v1, s[8:11], s50 offen lds
  ds_read_b64_tr_b16 v[70:71], v93 offset:37536
  ds_read_b64 v[30:31], v5 offset:96
  s_waitcnt lgkmcnt(14)
  v_mfma_f32_16x16x32_bf16 v[188:191], v[60:63], v[56:59], v[188:191]
  ds_read_b64_tr_b16 v[76:77], v93 offset:33984
  v_mfma_f32_16x16x32_bf16 v[184:187], v[60:63], v[52:55], v[184:187]
  ds_read_b64_tr_b16 v[78:79], v93 offset:37568
  v_mfma_f32_16x16x32_bf16 v[180:183], v[60:63], v[48:51], v[180:183]
  s_add_u32 s50, s26, 274432
  s_add_u32 m0, s24, 53040
  v_mfma_f32_16x16x32_bf16 v[176:179], v[60:63], v[44:47], v[176:179]
  buffer_load_dwordx4 v1, s[8:11], s50 offen lds
  s_waitcnt lgkmcnt(12)
  v_mfma_f32_16x16x32_bf16 v[192:195], v[64:67], v[44:47], v[192:195]
  ds_read_b64_tr_b16 v[60:61], v7 offset:2048
  v_mfma_f32_16x16x32_bf16 v[196:199], v[64:67], v[48:51], v[196:199]
  ds_read_b64_tr_b16 v[62:63], v7 offset:3072
  v_mfma_f32_16x16x32_bf16 v[200:203], v[64:67], v[52:55], v[200:203]
  ds_read_b64 v[32:33], v5 offset:320
  v_mfma_f32_16x16x32_bf16 v[204:207], v[64:67], v[56:59], v[204:207]
  ds_read_b64 v[34:35], v5 offset:352
  s_waitcnt lgkmcnt(7)
  v_mfma_f32_16x16x32_bf16 v[220:223], v[68:71], v[56:59], v[220:223]
  v_mfma_f32_16x16x32_bf16 v[216:219], v[68:71], v[52:55], v[216:219]
  v_mfma_f32_16x16x32_bf16 v[212:215], v[68:71], v[48:51], v[212:215]
  ds_read_b64 v[36:37], v5 offset:576
  v_mfma_f32_16x16x32_bf16 v[208:211], v[68:71], v[44:47], v[208:211]
  ds_read_b64 v[38:39], v5 offset:608
  v_mfma_f32_16x16x32_bf16 v[224:227], v[72:75], v[44:47], v[224:227]
  ds_read_b64_tr_b16 v[68:69], v7 offset:4096
  v_mfma_f32_16x16x32_bf16 v[228:231], v[72:75], v[48:51], v[228:231]
  ds_read_b64_tr_b16 v[70:71], v7 offset:5120
  v_mfma_f32_16x16x32_bf16 v[232:235], v[72:75], v[52:55], v[232:235]
  ds_read_b64_tr_b16 v[64:65], v8 offset:2048
  ds_read_b64 v[40:41], v5 offset:832
  v_mfma_f32_16x16x32_bf16 v[236:239], v[72:75], v[56:59], v[236:239]
  ds_read_b64_tr_b16 v[66:67], v8 offset:3072
  ds_read_b64 v[42:43], v5 offset:864
  s_waitcnt lgkmcnt(12)
  v_mfma_f32_16x16x32_bf16 v[252:255], v[76:79], v[56:59], v[252:255]
  ds_read_b64_tr_b16 v[72:73], v8 offset:4096
  v_mfma_f32_16x16x32_bf16 v[248:251], v[76:79], v[52:55], v[248:251]
  ds_read_b64_tr_b16 v[74:75], v8 offset:5120
  v_mfma_f32_16x16x32_bf16 v[244:247], v[76:79], v[48:51], v[244:247]
  s_add_u32 s25, s25, 128
  s_cmp_ge_u32 s25, 2048
  s_cselect_b32 s26, 0x10000000, s25
  v_mfma_f32_16x16x32_bf16 v[240:243], v[76:79], v[44:47], v[240:243]
  s_waitcnt vmcnt(6) lgkmcnt(2)
  s_barrier
  s_sub_u32 s60, s60, 1
  s_cmp_gt_u32 s60, 2
  s_cbranch_scc1 L_loop6
L_loopc6:
  v_mfma_f32_16x16x32_bf16 v[96:99], v[60:63], v[12:15], v[96:99]
  ds_read_b64_tr_b16 v[76:77], v6 offset:6272
  v_mfma_f32_16x16x32_bf16 v[100:103], v[60:63], v[16:19], v[100:103]
  ds_read_b64_tr_b16 v[78:79], v6 offset:9856
  s_cmp_eq_u32 s60, 6
  s_cbranch_scc0 L_nx_59
  s_call_b64 s[74:75], L_x_drain_6
L_nx_59:
  v_mfma_f32_16x16x32_bf16 v[104:107], v[60:63], v[20:23], v[104:107]
  s_add_u32 m0, s33, 128000
  v_mfma_f32_16x16x32_bf16 v[108:111], v[60:63], v[24:27], v[108:111]
  buffer_load_dwordx4 v2, s[12:15], s27 offen lds
  s_add_u32 s27, s27, s30
  v_mfma_f32_16x16x32_bf16 v[124:127], v[64:67], v[24:27], v[124:127]
  ds_read_b64_tr_b16 v[60:61], v6 offset:13440
  v_mfma_f32_16x16x32_bf16 v[120:123], v[64:67], v[20:23], v[120:123]
  ds_read_b64_tr_b16 v[62:63], v6 offset:17024
  v_mfma_f32_16x16x32_bf16 v[116:119], v[64:67], v[16:19], v[116:119]
  s_add_u32 m0, s34, 128000
  v_mfma_f32_16x16x32_bf16 v[112:115], v[64:67], v[12:15], v[112:115]
  buffer_load_dwordx4 v3, s[16:19], s28 offen lds
  s_add_u32 s28, s28, s31
  v_mfma_f32_16x16x32_bf16 v[128:131], v[12:15], v[68:71], v[128:131]
  ds_read_b64_tr_b16 v[64:65], v6 offset:6304
  v_lshlrev_b32 v10, 16, v68
  v_and_b32 v11, s79, v68
  v_mfma_f32_16x16x32_bf16 v[132:135], v[16:19], v[68:71], v[132:135]
  ds_read_b64_tr_b16 v[66:67], v6 offset:9888
  v_add_f32 v90, v90, v10
  v_add_f32 v90, v90, v11
  v_mfma_f32_16x16x32_bf16 v[136:139], v[20:23], v[68:71], v[136:139]
  s_add_u32 s50, s26, 0
  s_add_u32 m0, s24, 0
  v_lshlrev_b32 v10, 16, v69
  v_and_b32 v11, s79, v69
  v_mfma_f32_16x16x32_bf16 v[140:143], v[24:27], v[68:71], v[140:143]
  buffer_load_dwordx4 v1, s[8:11], s50 offen lds
  v_add_f32 v90, v90, v10
  v_add_f32 v90, v90, v11
  s_waitcnt lgkmcnt(6)
  v_mfma_f32_16x16x32_bf16 v[156:159], v[24:27], v[72:75], v[156:159]
  v_lshlrev_b32 v10, 16, v70
  v_and_b32 v11, s79, v70
  v_mfma_f32_16x16x32_bf16 v[152:155], v[20:23], v[72:75], v[152:155]
  v_add_f32 v90, v90, v10
  v_add_f32 v90, v90, v11
  v_mfma_f32_16x16x32_bf16 v[148:151], v[16:19], v[72:75], v[148:151]
  s_add_u32 s50, s26, 4096
  s_add_u32 m0, s24, 1040
  v_lshlrev_b32 v10, 16, v71
  v_and_b32 v11, s79, v71
  v_mfma_f32_16x16x32_bf16 v[144:147], v[12:15], v[72:75], v[144:147]
  buffer_load_dwordx4 v1, s[8:11], s50 offen lds
  v_add_f32 v90, v90, v10
  v_add_f32 v90, v90, v11
  s_waitcnt lgkmcnt(4)
  v_mfma_f32_16x16x32_bf16 v[160:163], v[76:79], v[12:15], v[160:163]
  ds_read_b64_tr_b16 v[72:73], v6 offset:6336
  v_mfma_f32_16x16x32_bf16 v[164:167], v[76:79], v[16:19], v[164:167]
  ds_read_b64_tr_b16 v[74:75], v6 offset:9920
  v_mfma_f32_16x16x32_bf16 v[168:171], v[76:79], v[20:23], v[168:171]
  s_add_u32 s50, s26, 8192
  s_add_u32 m0, s24, 2080
  ds_read_b64_tr_b16 v[68:69], v6 offset:13472
  v_mfma_f32_16x16x32_bf16 v[172:175], v[76:79], v[24:27], v[172:175]
  buffer_load_dwordx4 v1, s[8:11], s50 offen lds
  ds_read_b64_tr_b16 v[70:71], v6 offset:17056
  s_waitcnt lgkmcnt(6)
  v_mfma_f32_16x16x32_bf16 v[188:191], v[60:63], v[24:27], v[188:191]
  ds_read_b64_tr_b16 v[76:77], v6 offset:13504
  v_mfma_f32_16x16x32_bf16 v[184:187], v[60:63], v[20:23], v[184:187]
  ds_read_b64_tr_b16 v[78:79], v6 offset:17088
  v_mfma_f32_16x16x32_bf16 v[180:183], v[60:63], v[16:19], v[180:183]
  s_add_u32 s50, s26, 12288
  s_add_u32 m0, s24, 3120
  v_mfma_f32_16x16x32_bf16 v[176:179], v[60:63], v[12:15], v[176:179]
  buffer_load_dwordx4 v1, s[8:11], s50 offen lds
  s_waitcnt lgkmcnt(6)
  v_mfma_f32_16x16x32_bf16 v[192:195], v[64:67], v[12:15], v[192:195]
  ds_read_b64_tr_b16 v[60:61], v7 offset:22528
  v_lshlrev_b32 v10, 16, v64
  v_and_b32 v11, s79, v64
  v_mfma_f32_16x16x32_bf16 v[196:199], v[64:67], v[16:19], v[196:199]
  ds_read_b64_tr_b16 v[62:63], v7 offset:23552
  v_add_f32 v91, v91, v10
  v_add_f32 v91, v91, v11
  v_mfma_f32_16x16x32_bf16 v[200:203], v[64:67], v[20:23], v[200:203]
  v_lshlrev_b32 v10, 16, v65
  v_and_b32 v11, s79, v65
  v_mfma_f32_16x16x32_bf16 v[204:207], v[64:67], v[24:27], v[204:207]
  v_add_f32 v91, v91, v10
  v_add_f32 v91, v91, v11
  s_waitcnt lgkmcnt(4)
  v_mfma_f32_16x16x32_bf16 v[220:223], v[68:71], v[24:27], v[220:223]
  v_lshlrev_b32 v10, 16, v66
  v_and_b32 v11, s79, v66
  v_mfma_f32_16x16x32_bf16 v[216:219], v[68:71], v[20:23], v[216:219]
  v_add_f32 v91, v91, v10
  v_add_f32 v91, v91, v11
  v_mfma_f32_16x16x32_bf16 v[212:215], v[68:71], v[16:19], v[212:215]
  v_lshlrev_b32 v10, 16, v67
  v_and_b32 v11, s79, v67
  v_mfma_f32_16x16x32_bf16 v[208:211], v[68:71], v[12:15], v[208:211]
  v_add_f32 v91, v91, v10
  v_add_f32 v91, v91, v11
  v_mfma_f32_16x16x32_bf16 v[224:227], v[72:75], v[12:15], v[224:227]
  ds_read_b64_tr_b16 v[68:69], v7 offset:24576
  v_mfma_f32_16x16x32_bf16 v[228:231], v[72:75], v[16:19], v[228:231]
  ds_read_b64_tr_b16 v[70:71], v7 offset:25600
  v_mfma_f32_16x16x32_bf16 v[232:235], v[72:75], v[20:23], v[232:235]
  ds_read_b64_tr_b16 v[64:65], v8 offset:22528
  v_mfma_f32_16x16x32_bf16 v[236:239], v[72:75], v[24:27], v[236:239]
  ds_read_b64_tr_b16 v[66:67], v8 offset:23552
  s_cmp_eq_u32 s60, 2
  s_cbranch_scc0 L_nx_60
  s_call_b64 s[74:75], L_x_poll_6
L_nx_60:
  s_waitcnt lgkmcnt(6)
  v_mfma_f32_16x16x32_bf16 v[252:255], v[76:79], v[24:27], v[252:255]
  ds_read_b64_tr_b16 v[72:73], v8 offset:24576
  v_mfma_f32_16x16x32_bf16 v[248:251], v[76:79], v[20:23], v[248:251]
  ds_read_b64_tr_b16 v[74:75], v8 offset:25600
  v_mfma_f32_16x16x32_bf16 v[244:247], v[76:79], v[16:19], v[244:247]
  v_mfma_f32_16x16x32_bf16 v[240:243], v[76:79], v[12:15], v[240:243]
  s_waitcnt vmcnt(6)
  s_barrier
  s_waitcnt lgkmcnt(6)
  v_mfma_f32_16x16x32_bf16 v[96:99], v[60:63], v[28:31], v[96:99]
  ds_read_b64_tr_b16 v[76:77], v6 offset:26752
  v_mfma_f32_16x16x32_bf16 v[100:103], v[60:63], v[32:35], v[100:103]
  ds_read_b64_tr_b16 v[78:79], v6 offset:30336
  v_mfma_f32_16x16x32_bf16 v[104:107], v[60:63], v[36:39], v[104:107]
  s_add_u32 m0, s33, 66560
  ds_read_b64 v[12:13], v5 offset:33280
  v_mfma_f32_16x16x32_bf16 v[108:111], v[60:63], v[40:43], v[108:111]
  buffer_load_dwordx4 v2, s[12:15], s27 offen lds
  s_add_u32 s27, s27, s30
  ds_read_b64 v[14:15], v5 offset:33312
  s_waitcnt lgkmcnt(6)
  v_mfma_f32_16x16x32_bf16 v[124:127], v[64:67], v[40:43], v[124:127]
  ds_read_b64_tr_b16 v[60:61], v6 offset:33920
  v_mfma_f32_16x16x32_bf16 v[120:123], v[64:67], v[36:39], v[120:123]
  ds_read_b64_tr_b16 v[62:63], v6 offset:37504
  v_mfma_f32_16x16x32_bf16 v[116:119], v[64:67], v[32:35], v[116:119]
  s_add_u32 m0, s34, 66560
  ds_read_b64 v[16:17], v5 offset:33536
  v_mfma_f32_16x16x32_bf16 v[112:115], v[64:67], v[28:31], v[112:115]
  buffer_load_dwordx4 v3, s[16:19], s28 offen lds
  s_add_u32 s28, s28, s31
  ds_read_b64 v[18:19], v5 offset:33568
  v_mfma_f32_16x16x32_bf16 v[128:131], v[28:31], v[68:71], v[128:131]
  ds_read_b64_tr_b16 v[64:65], v6 offset:26784
  v_lshlrev_b32 v10, 16, v68
  v_and_b32 v11, s79, v68
  v_mfma_f32_16x16x32_bf16 v[132:135], v[32:35], v[68:71], v[132:135]
  ds_read_b64_tr_b16 v[66:67], v6 offset:30368
  v_add_f32 v90, v90, v10
  v_add_f32 v90, v90, v11
  v_mfma_f32_16x16x32_bf16 v[136:139], v[36:39], v[68:71], v[136:139]
  s_add_u32 s50, s26, 262144
  s_add_u32 m0, s24, 16640
  ds_read_b64 v[20:21], v5 offset:33792
  v_lshlrev_b32 v10, 16, v69
  v_and_b32 v11, s79, v69
  v_mfma_f32_16x16x32_bf16 v[140:143], v[40:43], v[68:71], v[140:143]
  buffer_load_dwordx4 v1, s[8:11], s50 offen lds
  ds_read_b64 v[22:23], v5 offset:33824
  v_add_f32 v90, v90, v10
  v_add_f32 v90, v90, v11
  s_waitcnt lgkmcnt(12)
  v_mfma_f32_16x16x32_bf16 v[156:159], v[40:43], v[72:75], v[156:159]
  v_lshlrev_b32 v10, 16, v70
  v_and_b32 v11, s79, v70
  v_mfma_f32_16x16x32_bf16 v[152:155], v[36:39], v[72:75], v[152:155]
  v_add_f32 v90, v90, v10
  v_add_f32 v90, v90, v11
  v_mfma_f32_16x16x32_bf16 v[148:151], v[32:35], v[72:75], v[148:151]
  s_add_u32 s50, s26, 266240
  s_add_u32 m0, s24, 17680
  ds_read_b64 v[24:25], v5 offset:34048
  v_lshlrev_b32 v10, 16, v71
  v_and_b32 v11, s79, v71
  v_mfma_f32_16x16x32_bf16 v[144:147], v[28:31], v[72:75], v[144:147]
  buffer_load_dwordx4 v1, s[8:11], s50 offen lds
  ds_read_b64 v[26:27], v5 offset:34080
  v_add_f32 v90, v90, v10
  v_add_f32 v90, v90, v11
  s_waitcnt lgkmcnt(12)
  v_mfma_f32_16x16x32_bf16 v[160:163], v[76:79], v[28:31], v[160:163]
  ds_read_b64_tr_b16 v[72:73], v6 offset:26816
  v_mfma_f32_16x16x32_bf16 v[164:167], v[76:79], v[32:35], v[164:167]
  ds_read_b64_tr_b16 v[74:75], v6 offset:30400
  v_mfma_f32_16x16x32_bf16 v[168:171], v[76:79], v[36:39], v[168:171]
  s_add_u32 s50, s26, 270336
  s_add_u32 m0, s24, 18720
  ds_read_b64_tr_b16 v[68:69], v6 offset:33952
  ds_read_b64 v[44:45], v5 offset:33344
  v_mfma_f32_16x16x32_bf16 v[172:175], v[76:79], v[40:43], v[172:175]
  buffer_load_dwordx4 v1, s[8:11], s50 offen lds
  ds_read_b64_tr_b16 v[70:71], v6 offset:37536
  ds_read_b64 v[46:47], v5 offset:33376
  s_waitcnt lgkmcnt(14)
  v_mfma_f32_16x16x32_bf16 v[188:191], v[60:63], v[40:43], v[188:191]
  ds_read_b64_tr_b16 v[76:77], v6 offset:33984
  v_mfma_f32_16x16x32_bf16 v[184:187], v[60:63], v[36:39], v[184:187]
  ds_read_b64_tr_b16 v[78:79], v6 offset:37568
  v_mfma_f32_16x16x32_bf16 v[180:183], v[60:63], v[32:35], v[180:183]
  s_add_u32 s50, s26, 274432
  s_add_u32 m0, s24, 19760
  v_mfma_f32_16x16x32_bf16 v[176:179], v[60:63], v[28:31], v[176:179]
  buffer_load_dwordx4 v1, s[8:11], s50 offen lds
  s_waitcnt lgkmcnt(12)
  v_mfma_f32_16x16x32_bf16 v[192:195], v[64:67], v[28:31], v[192:195]
  ds_read_b64_tr_b16 v[60:61], v94 offset:2048
  v_lshlrev_b32 v10, 16, v64
  v_and_b32 v11, s79, v64
  v_mfma_f32_16x16x32_bf16 v[196:199], v[64:67], v[32:35], v[196:199]
  ds_read_b64_tr_b16 v[62:63], v94 offset:3072
  v_add_f32 v91, v91, v10
  v_add_f32 v91, v91, v11
  v_mfma_f32_16x16x32_bf16 v[200:203], v[64:67], v[36:39], v[200:203]
  ds_read_b64 v[48:49], v5 offset:33600
  v_lshlrev_b32 v10, 16, v65
  v_and_b32 v11, s79, v65
  v_mfma_f32_16x16x32_bf16 v[204:207], v[64:67], v[40:43], v[204:207]
  ds_read_b64 v[50:51], v5 offset:33632
  v_add_f32 v91, v91, v10
  v_add_f32 v91, v91, v11
  s_waitcnt lgkmcnt(7)
  v_mfma_f32_16x16x32_bf16 v[220:223], v[68:71], v[40:43], v[220:223]
  v_lshlrev_b32 v10, 16, v66
  v_and_b32 v11, s79, v66
  v_mfma_f32_16x16x32_bf16 v[216:219], v[68:71], v[36:39], v[216:219]
  v_add_f32 v91, v91, v10
  v_add_f32 v91, v91, v11
  v_mfma_f32_16x16x32_bf16 v[212:215], v[68:71], v[32:35], v[212:215]
  ds_read_b64 v[52:53], v5 offset:33856
  v_lshlrev_b32 v10, 16, v67
  v_and_b32 v11, s79, v67
  v_mfma_f32_16x16x32_bf16 v[208:211], v[68:71], v[28:31], v[208:211]
  ds_read_b64 v[54:55], v5 offset:33888
  v_add_f32 v91, v91, v10
  v_add_f32 v91, v91, v11
  v_mfma_f32_16x16x32_bf16 v[224:227], v[72:75], v[28:31], v[224:227]
  ds_read_b64_tr_b16 v[68:69], v94 offset:4096
  v_mfma_f32_16x16x32_bf16 v[228:231], v[72:75], v[32:35], v[228:231]
  ds_read_b64_tr_b16 v[70:71], v94 offset:5120
  v_mfma_f32_16x16x32_bf16 v[232:235], v[72:75], v[36:39], v[232:235]
  ds_read_b64_tr_b16 v[64:65], v95 offset:2048
  ds_read_b64 v[56:57], v5 offset:34112
  v_mfma_f32_16x16x32_bf16 v[236:239], v[72:75], v[40:43], v[236:239]
  ds_read_b64_tr_b16 v[66:67], v95 offset:3072
  ds_read_b64 v[58:59], v5 offset:34144
  s_waitcnt lgkmcnt(12)
  v_mfma_f32_16x16x32_bf16 v[252:255], v[76:79], v[40:43], v[252:255]
  ds_read_b64_tr_b16 v[72:73], v95 offset:4096
  v_mfma_f32_16x16x32_bf16 v[248:251], v[76:79], v[36:39], v[248:251]
  ds_read_b64_tr_b16 v[74:75], v95 offset:5120
  v_mfma_f32_16x16x32_bf16 v[244:247], v[76:79], v[32:35], v[244:247]
  s_add_u32 s25, s25, 128
  s_cmp_ge_u32 s25, 2048
  s_cselect_b32 s26, 0x10000000, s25
  v_mfma_f32_16x16x32_bf16 v[240:243], v[76:79], v[28:31], v[240:243]
  s_waitcnt vmcnt(6) lgkmcnt(2)
  s_barrier
  v_mfma_f32_16x16x32_bf16 v[96:99], v[60:63], v[12:15], v[96:99]
  ds_read_b64_tr_b16 v[76:77], v93 offset:6272
  v_mfma_f32_16x16x32_bf16 v[100:103], v[60:63], v[16:19], v[100:103]
  ds_read_b64_tr_b16 v[78:79], v93 offset:9856
  s_cmp_eq_u32 s60, 2
  s_cbranch_scc0 L_nx_61
  s_call_b64 s[74:75], L_x_stat_6
L_nx_61:
  s_cmp_eq_u32 s60, 8
  s_cbranch_scc0 L_nx_62
  s_call_b64 s[74:75], L_x_rows_6
L_nx_62:
  v_mfma_f32_16x16x32_bf16 v[104:107], v[60:63], v[20:23], v[104:107]
  s_add_u32 m0, s33, 87040
  v_mfma_f32_16x16x32_bf16 v[108:111], v[60:63], v[24:27], v[108:111]
  buffer_load_dwordx4 v2, s[12:15], s27 offen lds
  s_add_u32 s27, s27, s30
  v_mfma_f32_16x16x32_bf16 v[124:127], v[64:67], v[24:27], v[124:127]
  ds_read_b64_tr_b16 v[60:61], v93 offset:13440
  v_mfma_f32_16x16x32_bf16 v[120:123], v[64:67], v[20:23], v[120:123]
  ds_read_b64_tr_b16 v[62:63], v93 offset:17024
  v_mfma_f32_16x16x32_bf16 v[116:119], v[64:67], v[16:19], v[116:119]
  s_add_u32 m0, s34, 87040
  v_mfma_f32_16x16x32_bf16 v[112:115], v[64:67], v[12:15], v[112:115]
  buffer_load_dwordx4 v3, s[16:19], s28 offen lds
  s_add_u32 s28, s28, s31
  v_mfma_f32_16x16x32_bf16 v[128:131], v[12:15], v[68:71], v[128:131]
  ds_read_b64_tr_b16 v[64:65], v93 offset:6304
  v_lshlrev_b32 v10, 16, v68
  v_and_b32 v11, s79, v68
  v_mfma_f32_16x16x32_bf16 v[132:135], v[16:19], v[68:71], v[132:135]
  ds_read_b64_tr_b16 v[66:67], v93 offset:9888
  v_add_f32 v90, v90, v10
  v_add_f32 v90, v90, v11
  v_mfma_f32_16x16x32_bf16 v[136:139], v[20:23], v[68:71], v[136:139]
  s_add_u32 s50, s26, 0
  s_add_u32 m0, s24, 33280
  v_lshlrev_b32 v10, 16, v69
  v_and_b32 v11, s79, v69
  v_mfma_f32_16x16x32_bf16 v[140:143], v[24:27], v[68:71], v[140:143]
  buffer_load_dwordx4 v1, s[8:11], s50 offen lds
  v_add_f32 v90, v90, v10
  v_add_f32 v90, v90, v11
  s_waitcnt lgkmcnt(6)
  v_mfma_f32_16x16x32_bf16 v[156:159], v[24:27], v[72:75], v[156:159]
  v_lshlrev_b32 v10, 16, v70
  v_and_b32 v11, s79, v70
  v_mfma_f32_16x16x32_bf16 v[152:155], v[20:23], v[72:75], v[152:155]
  v_add_f32 v90, v90, v10
  v_add_f32 v90, v90, v11
  v_mfma_f32_16x16x32_bf16 v[148:151], v[16:19], v[72:75], v[148:151]
  s_add_u32 s50, s26, 4096
  s_add_u32 m0, s24, 34320
  v_lshlrev_b32 v10, 16, v71
  v_and_b32 v11, s79, v71
  v_mfma_f32_16x16x32_bf16 v[144:147], v[12:15], v[72:75], v[144:147]
  buffer_load_dwordx4 v1, s[8:11], s50 offen lds
  v_add_f32 v90, v90, v10
  v_add_f32 v90, v90, v11
  s_waitcnt lgkmcnt(4)
  v_mfma_f32_16x16x32_bf16 v[160:163], v[76:79], v[12:15], v[160:163]
  ds_read_b64_tr_b16 v[72:73], v93 offset:6336
  v_mfma_f32_16x16x32_bf16 v[164:167], v[76:79], v[16:19], v[164:167]
  ds_read_b64_tr_b16 v[74:75], v93 offset:9920
  v_mfma_f32_16x16x32_bf16 v[168:171], v[76:79], v[20:23], v[168:171]
  s_add_u32 s50, s26, 8192
  s_add_u32 m0, s24, 35360
  ds_read_b64_tr_b16 v[68:69], v93 offset:13472
  v_mfma_f32_16x16x32_bf16 v[172:175], v[76:79], v[24:27], v[172:175]
  buffer_load_dwordx4 v1, s[8:11], s50 offen lds
  ds_read_b64_tr_b16 v[70:71], v93 offset:17056
  s_waitcnt lgkmcnt(6)
  v_mfma_f32_16x16x32_bf16 v[188:191], v[60:63], v[24:27], v[188:191]
  ds_read_b64_tr_b16 v[76:77], v93 offset:13504
  v_mfma_f32_16x16x32_bf16 v[184:187], v[60:63], v[20:23], v[184:187]
  ds_read_b64_tr_b16 v[78:79], v93 offset:17088
  v_mfma_f32_16x16x32_bf16 v[180:183], v[60:63], v[16:19], v[180:183]
  s_add_u32 s50, s26, 12288
  s_add_u32 m0, s24, 36400
  v_mfma_f32_16x16x32_bf16 v[176:179], v[60:63], v[12:15], v[176:179]
  buffer_load_dwordx4 v1, s[8:11], s50 offen lds
  s_waitcnt lgkmcnt(6)
  v_mfma_f32_16x16x32_bf16 v[192:195], v[64:67], v[12:15], v[192:195]
  ds_read_b64_tr_b16 v[60:61], v94 offset:22528
  v_lshlrev_b32 v10, 16, v64
  v_and_b32 v11, s79, v64
  v_mfma_f32_16x16x32_bf16 v[196:199], v[64:67], v[16:19], v[196:199]
  ds_read_b64_tr_b16 v[62:63], v94 offset:23552
  v_add_f32 v91, v91, v10
  v_add_f32 v91, v91, v11
  v_mfma_f32_16x16x32_bf16 v[200:203], v[64:67], v[20:23], v[200:203]
  v_lshlrev_b32 v10, 16, v65
  v_and_b32 v11, s79, v65
  v_mfma_f32_16x16x32_bf16 v[204:207], v[64:67], v[24:27], v[204:207]
  v_add_f32 v91, v91, v10
  v_add_f32 v91, v91, v11
  s_waitcnt lgkmcnt(4)
  v_mfma_f32_16x16x32_bf16 v[220:223], v[68:71], v[24:27], v[220:223]
  v_lshlrev_b32 v10, 16, v66
  v_and_b32 v11, s79, v66
  v_mfma_f32_16x16x32_bf16 v[216:219], v[68:71], v[20:23], v[216:219]
  v_add_f32 v91, v91, v10
  v_add_f32 v91, v91, v11
  v_mfma_f32_16x16x32_bf16 v[212:215], v[68:71], v[16:19], v[212:215]
  v_lshlrev_b32 v10, 16, v67
  v_and_b32 v11, s79, v67
  v_mfma_f32_16x16x32_bf16 v[208:211], v[68:71], v[12:15], v[208:211]
  v_add_f32 v91, v91, v10
  v_add_f32 v91, v91, v11
  v_mfma_f32_16x16x32_bf16 v[224:227], v[72:75], v[12:15], v[224:227]
  ds_read_b64_tr_b16 v[68:69], v94 offset:24576
  v_mfma_f32_16x16x32_bf16 v[228:231], v[72:75], v[16:19], v[228:231]
  ds_read_b64_tr_b16 v[70:71], v94 offset:25600
  v_mfma_f32_16x16x32_bf16 v[232:235], v[72:75], v[20:23], v[232:235]
  ds_read_b64_tr_b16 v[64:65], v95 offset:22528
  v_mfma_f32_16x16x32_bf16 v[236:239], v[72:75], v[24:27], v[236:239]
  ds_read_b64_tr_b16 v[66:67], v95 offset:23552
  s_waitcnt lgkmcnt(6)
  v_mfma_f32_16x16x32_bf16 v[252:255], v[76:79], v[24:27], v[252:255]
  ds_read_b64_tr_b16 v[72:73], v95 offset:24576
  v_mfma_f32_16x16x32_bf16 v[248:251], v[76:79], v[20:23], v[248:251]
  ds_read_b64_tr_b16 v[74:75], v95 offset:25600
  v_mfma_f32_16x16x32_bf16 v[244:247], v[76:79], v[16:19], v[244:247]
  v_mfma_f32_16x16x32_bf16 v[240:243], v[76:79], v[12:15], v[240:243]
  s_waitcnt vmcnt(6)
  s_barrier
  s_waitcnt lgkmcnt(6)
  v_mfma_f32_16x16x32_bf16 v[96:99], v[60:63], v[44:47], v[96:99]
  ds_read_b64_tr_b16 v[76:77], v93 offset:26752
  v_mfma_f32_16x16x32_bf16 v[100:103], v[60:63], v[48:51], v[100:103]
  ds_read_b64_tr_b16 v[78:79], v93 offset:30336
  v_mfma_f32_16x16x32_bf16 v[104:107], v[60:63], v[52:55], v[104:107]
  s_add_u32 m0, s33, 107520
  ds_read_b64 v[12:13], v5 offset:0
  v_mfma_f32_16x16x32_bf16 v[108:111], v[60:63], v[56:59], v[108:111]
  buffer_load_dwordx4 v2, s[12:15], s27 offen lds
  s_add_u32 s27, s27, s30
  ds_read_b64 v[14:15], v5 offset:32
  s_waitcnt lgkmcnt(6)
  v_mfma_f32_16x16x32_bf16 v[124:127], v[64:67], v[56:59], v[124:127]
  ds_read_b64_tr_b16 v[60:61], v93 offset:33920
  v_mfma_f32_16x16x32_bf16 v[120:123], v[64:67], v[52:55], v[120:123]
  ds_read_b64_tr_b16 v[62:63], v93 offset:37504
  v_mfma_f32_16x16x32_bf16 v[116:119], v[64:67], v[48:51], v[116:119]
  s_add_u32 m0, s34, 107520
  ds_read_b64 v[16:17], v5 offset:256
  v_mfma_f32_16x16x32_bf16 v[112:115], v[64:67], v[44:47], v[112:115]
  buffer_load_dwordx4 v3, s[16:19], s28 offen lds
  s_add_u32 s28, s28, s31
  ds_read_b64 v[18:19], v5 offset:288
  v_mfma_f32_16x16x32_bf16 v[128:131], v[44:47], v[68:71], v[128:131]
  ds_read_b64_tr_b16 v[64:65], v93 offset:26784
  v_lshlrev_b32 v10, 16, v68
  v_and_b32 v11, s79, v68
  v_mfma_f32_16x16x32_bf16 v[132:135], v[48:51], v[68:71], v[132:135]
  ds_read_b64_tr_b16 v[66:67], v93 offset:30368
  v_add_f32 v90, v90, v10
  v_add_f32 v90, v90, v11
  v_mfma_f32_16x16x32_bf16 v[136:139], v[52:55], v[68:71], v[136:139]
  s_add_u32 s50, s26, 262144
  s_add_u32 m0, s24, 49920
  ds_read_b64 v[20:21], v5 offset:512
  v_lshlrev_b32 v10, 16, v69
  v_and_b32 v11, s79, v69
  v_mfma_f32_16x16x32_bf16 v[140:143], v[56:59], v[68:71], v[140:143]
  buffer_load_dwordx4 v1, s[8:11], s50 offen lds
  ds_read_b64 v[22:23], v5 offset:544
  v_add_f32 v90, v90, v10
  v_add_f32 v90, v90, v11
  s_waitcnt lgkmcnt(12)
  v_mfma_f32_16x16x32_bf16 v[156:159], v[56:59], v[72:75], v[156:159]
  v_lshlrev_b32 v10, 16, v70
  v_and_b32 v11, s79, v70
  v_mfma_f32_16x16x32_bf16 v[152:155], v[52:55], v[72:75], v[152:155]
  v_add_f32 v90, v90, v10
  v_add_f32 v90, v90, v11
  v_mfma_f32_16x16x32_bf16 v[148:151], v[48:51], v[72:75], v[148:151]
  s_add_u32 s50, s26, 266240
  s_add_u32 m0, s24, 50960
  ds_read_b64 v[24:25], v5 offset:768
  v_lshlrev_b32 v10, 16, v71
  v_and_b32 v11, s79, v71
  v_mfma_f32_16x16x32_bf16 v[144:147], v[44:47], v[72:75], v[144:147]
  buffer_load_dwordx4 v1, s[8:11], s50 offen lds
  ds_read_b64 v[26:27], v5 offset:800
  v_add_f32 v90, v90, v10
  v_add_f32 v90, v90, v11
  s_waitcnt lgkmcnt(12)
  v_mfma_f32_16x16x32_bf16 v[160:163], v[76:79], v[44:47], v[160:163]
  ds_read_b64_tr_b16 v[72:73], v93 offset:26816
  v_mfma_f32_16x16x32_bf16 v[164:167], v[76:79], v[48:51], v[164:167]
  ds_read_b64_tr_b16 v[74:75], v93 offset:30400
  v_mfma_f32_16x16x32_bf16 v[168:171], v[76:79], v[52:55], v[168:171]
  s_add_u32 s50, s26, 270336
  s_add_u32 m0, s24, 52000
  ds_read_b64_tr_b16 v[68:69], v93 offset:33952
  ds_read_b64 v[28:29], v5 offset:64
  v_mfma_f32_16x16x32_bf16 v[172:175], v[76:79], v[56:59], v[172:175]
  buffer_load_dwordx4 v1, s[8:11], s50 offen lds
  ds_read_b64_tr_b16 v[70:71], v93 offset:37536
  ds_read_b64 v[30:31], v5 offset:96
  s_waitcnt lgkmcnt(14)
  v_mfma_f32_16x16x32_bf16 v[188:191], v[60:63], v[56:59], v[188:191]
  ds_read_b64_tr_b16 v[76:77], v93 offset:33984
  v_mfma_f32_16x16x32_bf16 v[184:187], v[60:63], v[52:55], v[184:187]
  ds_read_b64_tr_b16 v[78:79], v93 offset:37568
  v_mfma_f32_16x16x32_bf16 v[180:183], v[60:63], v[48:51], v[180:183]
  s_add_u32 s50, s26, 274432
  s_add_u32 m0, s24, 53040
  v_mfma_f32_16x16x32_bf16 v[176:179], v[60:63], v[44:47], v[176:179]
  buffer_load_dwordx4 v1, s[8:11], s50 offen lds
  s_waitcnt lgkmcnt(12)
  v_mfma_f32_16x16x32_bf16 v[192:195], v[64:67], v[44:47], v[192:195]
  ds_read_b64_tr_b16 v[60:61], v7 offset:2048
  v_lshlrev_b32 v10, 16, v64
  v_and_b32 v11, s79, v64
  v_mfma_f32_16x16x32_bf16 v[196:199], v[64:67], v[48:51], v[196:199]
  ds_read_b64_tr_b16 v[62:63], v7 offset:3072
  v_add_f32 v91, v91, v10
  v_add_f32 v91, v91, v11
  v_mfma_f32_16x16x32_bf16 v[200:203], v[64:67], v[52:55], v[200:203]
  ds_read_b64 v[32:33], v5 offset:320
  v_lshlrev_b32 v10, 16, v65
  v_and_b32 v11, s79, v65
  v_mfma_f32_16x16x32_bf16 v[204:207], v[64:67], v[56:59], v[204:207]
  ds_read_b64 v[34:35], v5 offset:352
  v_add_f32 v91, v91, v10
  v_add_f32 v91, v91, v11
  s_waitcnt lgkmcnt(7)
  v_mfma_f32_16x16x32_bf16 v[220:223], v[68:71], v[56:59], v[220:223]
  v_lshlrev_b32 v10, 16, v66
  v_and_b32 v11, s79, v66
  v_mfma_f32_16x16x32_bf16 v[216:219], v[68:71], v[52:55], v[216:219]
  v_add_f32 v91, v91, v10
  v_add_f32 v91, v91, v11
  v_mfma_f32_16x16x32_bf16 v[212:215], v[68:71], v[48:51], v[212:215]
  ds_read_b64 v[36:37], v5 offset:576
  v_lshlrev_b32 v10, 16, v67
  v_and_b32 v11, s79, v67
  v_mfma_f32_16x16x32_bf16 v[208:211], v[68:71], v[44:47], v[208:211]
  ds_read_b64 v[38:39], v5 offset:608
  v_add_f32 v91, v91, v10
  v_add_f32 v91, v91, v11
  v_mfma_f32_16x16x32_bf16 v[224:227], v[72:75], v[44:47], v[224:227]
  ds_read_b64_tr_b16 v[68:69], v7 offset:4096
  v_mfma_f32_16x16x32_bf16 v[228:231], v[72:75], v[48:51], v[228:231]
  ds_read_b64_tr_b16 v[70:71], v7 offset:5120
  v_mfma_f32_16x16x32_bf16 v[232:235], v[72:75], v[52:55], v[232:235]
  ds_read_b64_tr_b16 v[64:65], v8 offset:2048
  ds_read_b64 v[40:41], v5 offset:832
  v_mfma_f32_16x16x32_bf16 v[236:239], v[72:75], v[56:59], v[236:239]
  ds_read_b64_tr_b16 v[66:67], v8 offset:3072
  ds_read_b64 v[42:43], v5 offset:864
  s_waitcnt lgkmcnt(12)
  v_mfma_f32_16x16x32_bf16 v[252:255], v[76:79], v[56:59], v[252:255]
  ds_read_b64_tr_b16 v[72:73], v8 offset:4096
  v_mfma_f32_16x16x32_bf16 v[248:251], v[76:79], v[52:55], v[248:251]
  ds_read_b64_tr_b16 v[74:75], v8 offset:5120
  v_mfma_f32_16x16x32_bf16 v[244:247], v[76:79], v[48:51], v[244:247]
  s_add_u32 s25, s25, 128
  s_cmp_ge_u32 s25, 2048
  s_cselect_b32 s26, 0x10000000, s25
  v_mfma_f32_16x16x32_bf16 v[240:243], v[76:79], v[44:47], v[240:243]
  s_waitcnt vmcnt(6) lgkmcnt(2)
  s_barrier
  s_sub_u32 s60, s60, 1
  s_cmp_lt_u32 s60, 2
  s_cbranch_scc1 L_loopt6
  s_call_b64 s[74:75], L_x_cpub_6
  s_cmp_gt_u32 s60, 2
  s_cbranch_scc1 L_loopp6
L_loopt6:
  s_cmp_lg_u32 s60, 0
  s_cbranch_scc1 L_loopc6
  s_branch L_epi1
L_x_drain_6:
  s_waitcnt vmcnt(0)
  s_setpc_b64 s[74:75]
L_x_rows_6:
  s_waitcnt vmcnt(0)
  v_lshlrev_b32 v10, 16, v80
  v_and_b32 v11, s79, v80
  v_mov_b32 v88, v10
  v_mov_b32 v89, v11
  v_lshlrev_b32 v10, 16, v81
  v_and_b32 v11, s79, v81
  v_add_f32 v88, v88, v10
  v_add_f32 v89, v89, v11
  v_lshlrev_b32 v10, 16, v82
  v_and_b32 v11, s79, v82
  v_add_f32 v88, v88, v10
  v_add_f32 v89, v89, v11
  v_lshlrev_b32 v10, 16, v83
  v_and_b32 v11, s79, v83
  v_add_f32 v88, v88, v10
  v_add_f32 v89, v89, v11
  v_lshlrev_b32 v10, 16, v84
  v_and_b32 v11, s79, v84
  v_add_f32 v88, v88, v10
  v_add_f32 v89, v89, v11
  v_lshlrev_b32 v10, 16, v85
  v_and_b32 v11, s79, v85
  v_add_f32 v88, v88, v10
  v_add_f32 v89, v89, v11
  v_lshlrev_b32 v10, 16, v86
  v_and_b32 v11, s79, v86
  v_add_f32 v88, v88, v10
  v_add_f32 v89, v89, v11
  v_lshlrev_b32 v10, 16, v87
  v_and_b32 v11, s79, v87
  v_add_f32 v88, v88, v10
  v_add_f32 v89, v89, v11
  v_add_f32 v88, v88, v89
  s_nop 1
  v_add_f32_dpp v88, v88, v88 quad_perm:[1,0,3,2] row_mask:0xf bank_mask:0xf
  s_nop 1
  v_add_f32_dpp v88, v88, v88 quad_perm:[2,3,0,1] row_mask:0xf bank_mask:0xf
  s_nop 1
  v_add_f32_dpp v88, v88, v88 row_half_mirror row_mask:0xf bank_mask:0xf
  s_nop 1
  v_add_f32_dpp v88, v88, v88 row_mirror row_mask:0xf bank_mask:0xf
  v_mov_b32 v10, v88
  s_nop 1
  v_permlane16_swap_b32 v88, v10
  s_nop 0
  v_add_f32 v88, v88, v10
  v_mov_b32 v10, v88
  s_nop 1
  v_permlane32_swap_b32 v88, v10
  s_nop 0
  v_add_f32 v88, v88, v10
  v_mul_f32 v88, 0xba800000, v88
  v_lshlrev_b32 v10, 16, v80
  v_and_b32 v11, s79, v80
  v_add_f32 v10, v10, v88
  v_add_f32 v11, v11, v88
  v_mul_f32 v89, v10, v10
  v_fmac_f32 v89, v11, v11
  v_lshlrev_b32 v10, 16, v81
  v_and_b32 v11, s79, v81
  v_add_f32 v10, v10, v88
  v_add_f32 v11, v11, v88
  v_fmac_f32 v89, v10, v10
  v_fmac_f32 v89, v11, v11
  v_lshlrev_b32 v10, 16, v82
  v_and_b32 v11, s79, v82
  v_add_f32 v10, v10, v88
  v_add_f32 v11, v11, v88
  v_fmac_f32 v89, v10, v10
  v_fmac_f32 v89, v11, v11
  v_lshlrev_b32 v10, 16, v83
  v_and_b32 v11, s79, v83
  v_add_f32 v10, v10, v88
  v_add_f32 v11, v11, v88
  v_fmac_f32 v89, v10, v10
  v_fmac_f32 v89, v11, v11
  v_lshlrev_b32 v10, 16, v84
  v_and_b32 v11, s79, v84
  v_add_f32 v10, v10, v88
  v_add_f32 v11, v11, v88
  v_fmac_f32 v89, v10, v10
  v_fmac_f32 v89, v11, v11
  v_lshlrev_b32 v10, 16, v85
  v_and_b32 v11, s79, v85
  v_add_f32 v10, v10, v88
  v_add_f32 v11, v11, v88
  v_fmac_f32 v89, v10, v10
  v_fmac_f32 v89, v11, v11
  v_lshlrev_b32 v10, 16, v86
  v_and_b32 v11, s79, v86
  v_add_f32 v10, v10, v88
  v_add_f32 v11, v11, v88
  v_fmac_f32 v89, v10, v10
  v_fmac_f32 v89, v11, v11
  v_lshlrev_b32 v10, 16, v87
  v_and_b32 v11, s79, v87
  v_add_f32 v10, v10, v88
  v_add_f32 v11, v11, v88
  v_fmac_f32 v89, v10, v10
  v_fmac_f32 v89, v11, v11
  s_nop 1
  v_add_f32_dpp v89, v89, v89 quad_perm:[1,0,3,2] row_mask:0xf bank_mask:0xf
  s_nop 1
  v_add_f32_dpp v89, v89, v89 quad_perm:[2,3,0,1] row_mask:0xf bank_mask:0xf
  s_nop 1
  v_add_f32_dpp v89, v89, v89 row_half_mirror row_mask:0xf bank_mask:0xf
  s_nop 1
  v_add_f32_dpp v89, v89, v89 row_mirror row_mask:0xf bank_mask:0xf
  v_mov_b32 v10, v89
  s_nop 1
  v_permlane16_swap_b32 v89, v10
  s_nop 0
  v_add_f32 v89, v89, v10
  v_mov_b32 v10, v89
  s_nop 1
  v_permlane32_swap_b32 v89, v10
  s_nop 0
  v_add_f32 v89, v89, v10
  v_mul_f32 v89, 0x3a800000, v89
  v_cvt_pk_bf16_f32 v10, v88, v89
  v_lshlrev_b32 v80, 16, v10
  v_and_b32 v89, s79, v10
  v_add_f32 v89, 0x3727c5ac, v89
  v_cvt_pk_bf16_f32 v89, v89, v89
  v_lshlrev_b32 v89, 16, v89
  v_sqrt_f32 v89, v89
  s_lshl_b32 s51, s2, 6
  v_cvt_pk_bf16_f32 v89, v89, v89
  s_add_u32 s51, s51, 51380272
  v_lshlrev_b32 v81, 16, v89
  s_mov_b64 exec, 1
  buffer_store_dwordx2 v[80:81], v0, s[64:67], s51 offen sc1
  s_mov_b64 exec, -1
  s_setpc_b64 s[74:75]
L_x_poll_6:
  v_and_b32 v89, 0x70, v9
  v_lshlrev_b32 v89, 1, v89
  buffer_load_dword v88, v89, s[56:59], 0 offen sc1
  s_setpc_b64 s[74:75]
L_x_stat_6:
  s_waitcnt vmcnt(0)
  v_cmp_ne_u32 vcc, 32, v88
  s_nop 4
  s_cbranch_vccz L_x_stat_6_go
  s_sleep 2
  v_and_b32 v89, 0x70, v9
  v_lshlrev_b32 v89, 1, v89
  buffer_load_dword v88, v89, s[56:59], 0 offen sc1
  s_branch L_x_stat_6
L_x_stat_6_go:
  s_lshl_b32 s51, s6, 8
  s_lshl_b32 s55, s7, 5
  s_add_u32 s51, s51, s55
  s_lshl_b32 s55, s3, 2
  s_add_u32 s51, s51, s55
  s_add_u32 s51, s51, 50376704
  v_mov_b32 v88, 1
  s_mov_b64 exec, 1
  buffer_store_dword v88, v0, s[64:67], s51 offen sc1
  s_mov_b64 exec, -1
  v_and_b32 v88, 0xf0, v9
  v_lshrrev_b32 v88, 1, v88
  s_lshl_b32 s51, s7, 11
  s_add_u32 s51, s51, 51381248
  buffer_load_dwordx2 v[80:81], v88, s[64:67], s51 offen offset:0 sc1
  buffer_load_dwordx2 v[82:83], v88, s[64:67], s51 offen offset:128 sc1
  buffer_load_dwordx2 v[84:85], v88, s[64:67], s51 offen offset:256 sc1
  buffer_load_dwordx2 v[86:87], v88, s[64:67], s51 offen offset:384 sc1
  s_setpc_b64 s[74:75]
L_x_cpub_6:
  v_mov_b32 v10, v90
  v_mov_b32 v11, v91
  v_mov_b32 v88, v92
  s_nop 1
  v_permlane16_swap_b32 v90, v10
  v_permlane16_swap_b32 v91, v11
  v_permlane16_swap_b32 v92, v88
  v_add_f32 v90, v90, v10
  v_add_f32 v91, v91, v11
  v_add_f32 v92, v92, v88
  v_mov_b32 v10, v90
  v_mov_b32 v11, v91
  v_mov_b32 v88, v92
  s_nop 1
  v_permlane32_swap_b32 v90, v10
  v_permlane32_swap_b32 v91, v11
  v_permlane32_swap_b32 v92, v88
  v_add_f32 v90, v90, v10
  v_add_f32 v91, v91, v11
  v_add_f32 v92, v92, v88
  v_and_b32 v89, 0xf0, v9
  v_lshrrev_b32 v89, 2, v89
  s_mul_i32 s51, s6, 7680
  s_mul_i32 s52, s7, 1280
  s_add_u32 s51, s51, s52
  s_add_u32 s51, s51, 52429568
  s_mov_b64 exec, 0xffff
  buffer_store_dword v90, v89, s[64:67], s51 offen offset:0 sc1
  buffer_store_dword v91, v89, s[64:67], s51 offen offset:256 sc1
  s_mov_b64 exec, -1
  s_nop 1
  v_mov_b32 v90, 0
  v_mov_b32 v91, 0
  v_mov_b32 v92, 0
  s_setpc_b64 s[74:75]
L_loop7:
  s_cmp_eq_u32 s60, s61
  s_cbranch_scc1 L_loopc7
L_loopp7:
  v_mfma_f32_16x16x32_bf16 v[96:99], v[60:63], v[12:15], v[96:99]
  ds_read_b64_tr_b16 v[76:77], v6 offset:6272
  v_mfma_f32_16x16x32_bf16 v[100:103], v[60:63], v[16:19], v[100:103]
  ds_read_b64_tr_b16 v[78:79], v6 offset:9856
  v_mfma_f32_16x16x32_bf16 v[104:107], v[60:63], v[20:23], v[104:107]
  v_mfma_f32_16x16x32_bf16 v[108:111], v[60:63], v[24:27], v[108:111]
  buffer_load_dword v1, v2, s[12:15], s27 offen
  s_add_u32 s27, s27, s30
  v_mfma_f32_16x16x32_bf16 v[124:127], v[64:67], v[24:27], v[124:127]
  ds_read_b64_tr_b16 v[60:61], v6 offset:13440
  v_mfma_f32_16x16x32_bf16 v[120:123], v[64:67], v[20:23], v[120:123]
  ds_read_b64_tr_b16 v[62:63], v6 offset:17024
  v_mfma_f32_16x16x32_bf16 v[116:119], v[64:67], v[16:19], v[116:119]
  v_mfma_f32_16x16x32_bf16 v[112:115], v[64:67], v[12:15], v[112:115]
  buffer_load_dword v1, v3, s[16:19], s28 offen
  s_add_u32 s28, s28, s31
  s_waitcnt lgkmcnt(4)
  v_mfma_f32_16x16x32_bf16 v[128:131], v[12:15], v[68:71], v[128:131]
  ds_read_b64_tr_b16 v[64:65], v6 offset:6304
  v_mfma_f32_16x16x32_bf16 v[132:135], v[16:19], v[68:71], v[132:135]
  ds_read_b64_tr_b16 v[66:67], v6 offset:9888
  v_mfma_f32_16x16x32_bf16 v[136:139], v[20:23], v[68:71], v[136:139]
  v_mfma_f32_16x16x32_bf16 v[140:143], v[24:27], v[68:71], v[140:143]
  buffer_load_dword v1, v4, s[20:23], s29 offen
  s_add_u32 s29, s29, s32
  v_mfma_f32_16x16x32_bf16 v[156:159], v[24:27], v[72:75], v[156:159]
  ds_read_b64_tr_b16 v[68:69], v6 offset:13472
  v_mfma_f32_16x16x32_bf16 v[152:155], v[20:23], v[72:75], v[152:155]
  ds_read_b64_tr_b16 v[70:71], v6 offset:17056
  v_mfma_f32_16x16x32_bf16 v[148:151], v[16:19], v[72:75], v[148:151]
  v_mfma_f32_16x16x32_bf16 v[144:147], v[12:15], v[72:75], v[144:147]
  s_waitcnt lgkmcnt(6)
  v_mfma_f32_16x16x32_bf16 v[160:163], v[76:79], v[12:15], v[160:163]
  v_mfma_f32_16x16x32_bf16 v[164:167], v[76:79], v[16:19], v[164:167]
  v_mfma_f32_16x16x32_bf16 v[168:171], v[76:79], v[20:23], v[168:171]
  v_mfma_f32_16x16x32_bf16 v[172:175], v[76:79], v[24:27], v[172:175]
  s_waitcnt lgkmcnt(4)
  v_mfma_f32_16x16x32_bf16 v[188:191], v[60:63], v[24:27], v[188:191]
  ds_read_b64_tr_b16 v[76:77], v6 offset:13504
  v_mfma_f32_16x16x32_bf16 v[184:187], v[60:63], v[20:23], v[184:187]
  ds_read_b64_tr_b16 v[78:79], v6 offset:17088
  v_mfma_f32_16x16x32_bf16 v[180:183], v[60:63], v[16:19], v[180:183]
  ds_read_b64_tr_b16 v[72:73], v6 offset:6336
  v_mfma_f32_16x16x32_bf16 v[176:179], v[60:63], v[12:15], v[176:179]
  ds_read_b64_tr_b16 v[74:75], v6 offset:9920
  s_waitcnt lgkmcnt(6)
  v_mfma_f32_16x16x32_bf16 v[192:195], v[64:67], v[12:15], v[192:195]
  ds_read_b64_tr_b16 v[60:61], v7 offset:22528
  v_mfma_f32_16x16x32_bf16 v[196:199], v[64:67], v[16:19], v[196:199]
  ds_read_b64_tr_b16 v[62:63], v7 offset:23552
  v_mfma_f32_16x16x32_bf16 v[200:203], v[64:67], v[20:23], v[200:203]
  v_mfma_f32_16x16x32_bf16 v[204:207], v[64:67], v[24:27], v[204:207]
  s_waitcnt lgkmcnt(6)
  v_mfma_f32_16x16x32_bf16 v[220:223], v[68:71], v[24:27], v[220:223]
  ds_read_b64_tr_b16 v[64:65], v8 offset:22528
  v_mfma_f32_16x16x32_bf16 v[216:219], v[68:71], v[20:23], v[216:219]
  ds_read_b64_tr_b16 v[66:67], v8 offset:23552
  v_mfma_f32_16x16x32_bf16 v[212:215], v[68:71], v[16:19], v[212:215]
  v_mfma_f32_16x16x32_bf16 v[208:211], v[68:71], v[12:15], v[208:211]
  s_waitcnt lgkmcnt(4)
  v_mfma_f32_16x16x32_bf16 v[224:227], v[72:75], v[12:15], v[224:227]
  v_mfma_f32_16x16x32_bf16 v[228:231], v[72:75], v[16:19], v[228:231]
  v_mfma_f32_16x16x32_bf16 v[232:235], v[72:75], v[20:23], v[232:235]
  v_mfma_f32_16x16x32_bf16 v[236:239], v[72:75], v[24:27], v[236:239]
  s_cmp_eq_u32 s60, 2
  s_cbranch_scc0 L_nx_63
  s_call_b64 s[74:75], L_x_poll_7
L_nx_63:
  s_cmp_eq_u32 s60, 4
  s_cbranch_scc0 L_nx_64
  s_call_b64 s[74:75], L_x_sig_7
L_nx_64:
  v_mfma_f32_16x16x32_bf16 v[252:255], v[76:79], v[24:27], v[252:255]
  ds_read_b64_tr_b16 v[72:73], v8 offset:24576
  v_mfma_f32_16x16x32_bf16 v[248:251], v[76:79], v[20:23], v[248:251]
  ds_read_b64_tr_b16 v[74:75], v8 offset:25600
  v_mfma_f32_16x16x32_bf16 v[244:247], v[76:79], v[16:19], v[244:247]
  ds_read_b64_tr_b16 v[68:69], v7 offset:24576
  v_mfma_f32_16x16x32_bf16 v[240:243], v[76:79], v[12:15], v[240:243]
  ds_read_b64_tr_b16 v[70:71], v7 offset:25600
  s_barrier
  s_waitcnt lgkmcnt(6)
  v_mfma_f32_16x16x32_bf16 v[96:99], v[60:63], v[28:31], v[96:99]
  ds_read_b64_tr_b16 v[76:77], v6 offset:26752
  v_mfma_f32_16x16x32_bf16 v[100:103], v[60:63], v[32:35], v[100:103]
  ds_read_b64_tr_b16 v[78:79], v6 offset:30336
  v_mfma_f32_16x16x32_bf16 v[104:107], v[60:63], v[36:39], v[104:107]
  ds_read_b64 v[12:13], v5 offset:33280
  v_mfma_f32_16x16x32_bf16 v[108:111], v[60:63], v[40:43], v[108:111]
  ds_read_b64 v[14:15], v5 offset:33312
  buffer_load_dword v1, v2, s[12:15], s27 offen
  s_add_u32 s27, s27, s30
  s_waitcnt lgkmcnt(8)
  v_mfma_f32_16x16x32_bf16 v[124:127], v[64:67], v[40:43], v[124:127]
  ds_read_b64_tr_b16 v[60:61], v6 offset:33920
  v_mfma_f32_16x16x32_bf16 v[120:123], v[64:67], v[36:39], v[120:123]
  ds_read_b64_tr_b16 v[62:63], v6 offset:37504
  v_mfma_f32_16x16x32_bf16 v[116:119], v[64:67], v[32:35], v[116:119]
  ds_read_b64 v[16:17], v5 offset:33536
  v_mfma_f32_16x16x32_bf16 v[112:115], v[64:67], v[28:31], v[112:115]
  ds_read_b64 v[18:19], v5 offset:33568
  buffer_load_dword v1, v3, s[16:19], s28 offen
  s_add_u32 s28, s28, s31
  s_waitcnt lgkmcnt(8)
  v_mfma_f32_16x16x32_bf16 v[128:131], v[28:31], v[68:71], v[128:131]
  ds_read_b64_tr_b16 v[64:65], v6 offset:26784
  v_mfma_f32_16x16x32_bf16 v[132:135], v[32:35], v[68:71], v[132:135]
  ds_read_b64_tr_b16 v[66:67], v6 offset:30368
  v_mfma_f32_16x16x32_bf16 v[136:139], v[36:39], v[68:71], v[136:139]
  ds_read_b64 v[20:21], v5 offset:33792
  v_mfma_f32_16x16x32_bf16 v[140:143], v[40:43], v[68:71], v[140:143]
  ds_read_b64 v[22:23], v5 offset:33824
  buffer_load_dword v1, v4, s[20:23], s29 offen
  s_add_u32 s29, s29, s32
  v_mfma_f32_16x16x32_bf16 v[156:159], v[40:43], v[72:75], v[156:159]
  ds_read_b64_tr_b16 v[68:69], v6 offset:33952
  v_mfma_f32_16x16x32_bf16 v[152:155], v[36:39], v[72:75], v[152:155]
  ds_read_b64_tr_b16 v[70:71], v6 offset:37536
  v_mfma_f32_16x16x32_bf16 v[148:151], v[32:35], v[72:75], v[148:151]
  ds_read_b64 v[24:25], v5 offset:34048
  v_mfma_f32_16x16x32_bf16 v[144:147], v[28:31], v[72:75], v[144:147]
  ds_read_b64 v[26:27], v5 offset:34080
  s_waitcnt lgkmcnt(14)
  v_mfma_f32_16x16x32_bf16 v[160:163], v[76:79], v[28:31], v[160:163]
  v_mfma_f32_16x16x32_bf16 v[164:167], v[76:79], v[32:35], v[164:167]
  v_mfma_f32_16x16x32_bf16 v[168:171], v[76:79], v[36:39], v[168:171]
  ds_read_b64 v[44:45], v5 offset:33344
  v_mfma_f32_16x16x32_bf16 v[172:175], v[76:79], v[40:43], v[172:175]
  ds_read_b64 v[46:47], v5 offset:33376
  s_waitcnt lgkmcnt(12)
  v_mfma_f32_16x16x32_bf16 v[188:191], v[60:63], v[40:43], v[188:191]
  ds_read_b64_tr_b16 v[76:77], v6 offset:33984
  v_mfma_f32_16x16x32_bf16 v[184:187], v[60:63], v[36:39], v[184:187]
  ds_read_b64_tr_b16 v[78:79], v6 offset:37568
  v_mfma_f32_16x16x32_bf16 v[180:183], v[60:63], v[32:35], v[180:183]
  ds_read_b64_tr_b16 v[72:73], v6 offset:26816
  v_mfma_f32_16x16x32_bf16 v[176:179], v[60:63], v[28:31], v[176:179]
  ds_read_b64_tr_b16 v[74:75], v6 offset:30400
  s_waitcnt lgkmcnt(12)
  v_mfma_f32_16x16x32_bf16 v[192:195], v[64:67], v[28:31], v[192:195]
  ds_read_b64_tr_b16 v[60:61], v94 offset:2048
  v_mfma_f32_16x16x32_bf16 v[196:199], v[64:67], v[32:35], v[196:199]
  ds_read_b64_tr_b16 v[62:63], v94 offset:3072
  v_mfma_f32_16x16x32_bf16 v[200:203], v[64:67], v[36:39], v[200:203]
  ds_read_b64 v[48:49], v5 offset:33600
  v_mfma_f32_16x16x32_bf16 v[204:207], v[64:67], v[40:43], v[204:207]
  ds_read_b64 v[50:51], v5 offset:33632
  s_waitcnt lgkmcnt(12)
  v_mfma_f32_16x16x32_bf16 v[220:223], v[68:71], v[40:43], v[220:223]
  ds_read_b64_tr_b16 v[64:65], v95 offset:2048
  v_mfma_f32_16x16x32_bf16 v[216:219], v[68:71], v[36:39], v[216:219]
  ds_read_b64_tr_b16 v[66:67], v95 offset:3072
  v_mfma_f32_16x16x32_bf16 v[212:215], v[68:71], v[32:35], v[212:215]
  ds_read_b64 v[52:53], v5 offset:33856
  v_mfma_f32_16x16x32_bf16 v[208:211], v[68:71], v[28:31], v[208:211]
  ds_read_b64 v[54:55], v5 offset:33888
  s_waitcnt lgkmcnt(8)
  v_mfma_f32_16x16x32_bf16 v[224:227], v[72:75], v[28:31], v[224:227]
  v_mfma_f32_16x16x32_bf16 v[228:231], v[72:75], v[32:35], v[228:231]
  v_mfma_f32_16x16x32_bf16 v[232:235], v[72:75], v[36:39], v[232:235]
  ds_read_b64 v[56:57], v5 offset:34112
  v_mfma_f32_16x16x32_bf16 v[236:239], v[72:75], v[40:43], v[236:239]
  ds_read_b64 v[58:59], v5 offset:34144
  v_mfma_f32_16x16x32_bf16 v[252:255], v[76:79], v[40:43], v[252:255]
  ds_read_b64_tr_b16 v[72:73], v95 offset:4096
  v_mfma_f32_16x16x32_bf16 v[248:251], v[76:79], v[36:39], v[248:251]
  ds_read_b64_tr_b16 v[74:75], v95 offset:5120
  v_mfma_f32_16x16x32_bf16 v[244:247], v[76:79], v[32:35], v[244:247]
  ds_read_b64_tr_b16 v[68:69], v94 offset:4096
  v_mfma_f32_16x16x32_bf16 v[240:243], v[76:79], v[28:31], v[240:243]
  ds_read_b64_tr_b16 v[70:71], v94 offset:5120
  s_waitcnt lgkmcnt(4)
  s_barrier
  v_mfma_f32_16x16x32_bf16 v[96:99], v[60:63], v[12:15], v[96:99]
  ds_read_b64_tr_b16 v[76:77], v93 offset:6272
  v_mfma_f32_16x16x32_bf16 v[100:103], v[60:63], v[16:19], v[100:103]
  ds_read_b64_tr_b16 v[78:79], v93 offset:9856
  s_cmp_eq_u32 s60, 2
  s_cbranch_scc0 L_nx_65
  s_call_b64 s[74:75], L_x_stat_7
L_nx_65:
  s_cmp_eq_u32 s60, 8
  s_cbranch_scc0 L_nx_66
  s_call_b64 s[74:75], L_x_rows_7
L_nx_66:
  v_mfma_f32_16x16x32_bf16 v[104:107], v[60:63], v[20:23], v[104:107]
  v_mfma_f32_16x16x32_bf16 v[108:111], v[60:63], v[24:27], v[108:111]
  buffer_load_dword v1, v2, s[12:15], s27 offen
  s_add_u32 s27, s27, s30
  v_mfma_f32_16x16x32_bf16 v[124:127], v[64:67], v[24:27], v[124:127]
  ds_read_b64_tr_b16 v[60:61], v93 offset:13440
  v_mfma_f32_16x16x32_bf16 v[120:123], v[64:67], v[20:23], v[120:123]
  ds_read_b64_tr_b16 v[62:63], v93 offset:17024
  v_mfma_f32_16x16x32_bf16 v[116:119], v[64:67], v[16:19], v[116:119]
  v_mfma_f32_16x16x32_bf16 v[112:115], v[64:67], v[12:15], v[112:115]
  buffer_load_dword v1, v3, s[16:19], s28 offen
  s_add_u32 s28, s28, s31
  s_waitcnt lgkmcnt(4)
  v_mfma_f32_16x16x32_bf16 v[128:131], v[12:15], v[68:71], v[128:131]
  ds_read_b64_tr_b16 v[64:65], v93 offset:6304
  v_mfma_f32_16x16x32_bf16 v[132:135], v[16:19], v[68:71], v[132:135]
  ds_read_b64_tr_b16 v[66:67], v93 offset:9888
  v_mfma_f32_16x16x32_bf16 v[136:139], v[20:23], v[68:71], v[136:139]
  v_mfma_f32_16x16x32_bf16 v[140:143], v[24:27], v[68:71], v[140:143]
  buffer_load_dword v1, v4, s[20:23], s29 offen
  s_add_u32 s29, s29, s32
  v_mfma_f32_16x16x32_bf16 v[156:159], v[24:27], v[72:75], v[156:159]
  ds_read_b64_tr_b16 v[68:69], v93 offset:13472
  v_mfma_f32_16x16x32_bf16 v[152:155], v[20:23], v[72:75], v[152:155]
  ds_read_b64_tr_b16 v[70:71], v93 offset:17056
  v_mfma_f32_16x16x32_bf16 v[148:151], v[16:19], v[72:75], v[148:151]
  v_mfma_f32_16x16x32_bf16 v[144:147], v[12:15], v[72:75], v[144:147]
  s_waitcnt lgkmcnt(6)
  v_mfma_f32_16x16x32_bf16 v[160:163], v[76:79], v[12:15], v[160:163]
  v_mfma_f32_16x16x32_bf16 v[164:167], v[76:79], v[16:19], v[164:167]
  v_mfma_f32_16x16x32_bf16 v[168:171], v[76:79], v[20:23], v[168:171]
  v_mfma_f32_16x16x32_bf16 v[172:175], v[76:79], v[24:27], v[172:175]
  s_waitcnt lgkmcnt(4)
  v_mfma_f32_16x16x32_bf16 v[188:191], v[60:63], v[24:27], v[188:191]
  ds_read_b64_tr_b16 v[76:77], v93 offset:13504
  v_mfma_f32_16x16x32_bf16 v[184:187], v[60:63], v[20:23], v[184:187]
  ds_read_b64_tr_b16 v[78:79], v93 offset:17088
  v_mfma_f32_16x16x32_bf16 v[180:183], v[60:63], v[16:19], v[180:183]
  ds_read_b64_tr_b16 v[72:73], v93 offset:6336
  v_mfma_f32_16x16x32_bf16 v[176:179], v[60:63], v[12:15], v[176:179]
  ds_read_b64_tr_b16 v[74:75], v93 offset:9920
  s_waitcnt lgkmcnt(6)
  v_mfma_f32_16x16x32_bf16 v[192:195], v[64:67], v[12:15], v[192:195]
  ds_read_b64_tr_b16 v[60:61], v94 offset:22528
  v_mfma_f32_16x16x32_bf16 v[196:199], v[64:67], v[16:19], v[196:199]
  ds_read_b64_tr_b16 v[62:63], v94 offset:23552
  v_mfma_f32_16x16x32_bf16 v[200:203], v[64:67], v[20:23], v[200:203]
  v_mfma_f32_16x16x32_bf16 v[204:207], v[64:67], v[24:27], v[204:207]
  s_waitcnt lgkmcnt(6)
  v_mfma_f32_16x16x32_bf16 v[220:223], v[68:71], v[24:27], v[220:223]
  ds_read_b64_tr_b16 v[64:65], v95 offset:22528
  v_mfma_f32_16x16x32_bf16 v[216:219], v[68:71], v[20:23], v[216:219]
  ds_read_b64_tr_b16 v[66:67], v95 offset:23552
  v_mfma_f32_16x16x32_bf16 v[212:215], v[68:71], v[16:19], v[212:215]
  v_mfma_f32_16x16x32_bf16 v[208:211], v[68:71], v[12:15], v[208:211]
  s_waitcnt lgkmcnt(4)
  v_mfma_f32_16x16x32_bf16 v[224:227], v[72:75], v[12:15], v[224:227]
  v_mfma_f32_16x16x32_bf16 v[228:231], v[72:75], v[16:19], v[228:231]
  v_mfma_f32_16x16x32_bf16 v[232:235], v[72:75], v[20:23], v[232:235]
  v_mfma_f32_16x16x32_bf16 v[236:239], v[72:75], v[24:27], v[236:239]
  v_mfma_f32_16x16x32_bf16 v[252:255], v[76:79], v[24:27], v[252:255]
  ds_read_b64_tr_b16 v[72:73], v95 offset:24576
  v_mfma_f32_16x16x32_bf16 v[248:251], v[76:79], v[20:23], v[248:251]
  ds_read_b64_tr_b16 v[74:75], v95 offset:25600
  v_mfma_f32_16x16x32_bf16 v[244:247], v[76:79], v[16:19], v[244:247]
  ds_read_b64_tr_b16 v[68:69], v94 offset:24576
  v_mfma_f32_16x16x32_bf16 v[240:243], v[76:79], v[12:15], v[240:243]
  ds_read_b64_tr_b16 v[70:71], v94 offset:25600
  s_barrier
  s_waitcnt lgkmcnt(6)
  v_mfma_f32_16x16x32_bf16 v[96:99], v[60:63], v[44:47], v[96:99]
  ds_read_b64_tr_b16 v[76:77], v93 offset:26752
  v_mfma_f32_16x16x32_bf16 v[100:103], v[60:63], v[48:51], v[100:103]
  ds_read_b64_tr_b16 v[78:79], v93 offset:30336
  s_cmp_eq_u32 s60, 5
  s_cbranch_scc0 L_nx_67
  s_call_b64 s[74:75], L_x_drain_7
L_nx_67:
  v_mfma_f32_16x16x32_bf16 v[104:107], v[60:63], v[52:55], v[104:107]
  ds_read_b64 v[12:13], v5 offset:0
  v_mfma_f32_16x16x32_bf16 v[108:111], v[60:63], v[56:59], v[108:111]
  ds_read_b64 v[14:15], v5 offset:32
  buffer_load_dword v1, v2, s[12:15], s27 offen
  s_add_u32 s27, s27, s30
  s_waitcnt lgkmcnt(8)
  v_mfma_f32_16x16x32_bf16 v[124:127], v[64:67], v[56:59], v[124:127]
  ds_read_b64_tr_b16 v[60:61], v93 offset:33920
  v_mfma_f32_16x16x32_bf16 v[120:123], v[64:67], v[52:55], v[120:123]
  ds_read_b64_tr_b16 v[62:63], v93 offset:37504
  v_mfma_f32_16x16x32_bf16 v[116:119], v[64:67], v[48:51], v[116:119]
  ds_read_b64 v[16:17], v5 offset:256
  v_mfma_f32_16x16x32_bf16 v[112:115], v[64:67], v[44:47], v[112:115]
  ds_read_b64 v[18:19], v5 offset:288
  buffer_load_dword v1, v3, s[16:19], s28 offen
  s_add_u32 s28, s28, s31
  s_waitcnt lgkmcnt(8)
  v_mfma_f32_16x16x32_bf16 v[128:131], v[44:47], v[68:71], v[128:131]
  ds_read_b64_tr_b16 v[64:65], v93 offset:26784
  v_mfma_f32_16x16x32_bf16 v[132:135], v[48:51], v[68:71], v[132:135]
  ds_read_b64_tr_b16 v[66:67], v93 offset:30368
  v_mfma_f32_16x16x32_bf16 v[136:139], v[52:55], v[68:71], v[136:139]
  ds_read_b64 v[20:21], v5 offset:512
  v_mfma_f32_16x16x32_bf16 v[140:143], v[56:59], v[68:71], v[140:143]
  ds_read_b64 v[22:23], v5 offset:544
  buffer_load_dword v1, v4, s[20:23], s29 offen
  s_add_u32 s29, s29, s32
  v_mfma_f32_16x16x32_bf16 v[156:159], v[56:59], v[72:75], v[156:159]
  ds_read_b64_tr_b16 v[68:69], v93 offset:33952
  v_mfma_f32_16x16x32_bf16 v[152:155], v[52:55], v[72:75], v[152:155]
  ds_read_b64_tr_b16 v[70:71], v93 offset:37536
  v_mfma_f32_16x16x32_bf16 v[148:151], v[48:51], v[72:75], v[148:151]
  ds_read_b64 v[24:25], v5 offset:768
  v_mfma_f32_16x16x32_bf16 v[144:147], v[44:47], v[72:75], v[144:147]
  ds_read_b64 v[26:27], v5 offset:800
  s_waitcnt lgkmcnt(14)
  v_mfma_f32_16x16x32_bf16 v[160:163], v[76:79], v[44:47], v[160:163]
  v_mfma_f32_16x16x32_bf16 v[164:167], v[76:79], v[48:51], v[164:167]
  v_mfma_f32_16x16x32_bf16 v[168:171], v[76:79], v[52:55], v[168:171]
  ds_read_b64 v[28:29], v5 offset:64
  v_mfma_f32_16x16x32_bf16 v[172:175], v[76:79], v[56:59], v[172:175]
  ds_read_b64 v[30:31], v5 offset:96
  s_waitcnt lgkmcnt(12)
  v_mfma_f32_16x16x32_bf16 v[188:191], v[60:63], v[56:59], v[188:191]
  ds_read_b64_tr_b16 v[76:77], v93 offset:33984
  v_mfma_f32_16x16x32_bf16 v[184:187], v[60:63], v[52:55], v[184:187]
  ds_read_b64_tr_b16 v[78:79], v93 offset:37568
  v_mfma_f32_16x16x32_bf16 v[180:183], v[60:63], v[48:51], v[180:183]
  ds_read_b64_tr_b16 v[72:73], v93 offset:26816
  v_mfma_f32_16x16x32_bf16 v[176:179], v[60:63], v[44:47], v[176:179]
  ds_read_b64_tr_b16 v[74:75], v93 offset:30400
  s_waitcnt lgkmcnt(12)
  v_mfma_f32_16x16x32_bf16 v[192:195], v[64:67], v[44:47], v[192:195]
  ds_read_b64_tr_b16 v[60:61], v7 offset:2048
  v_mfma_f32_16x16x32_bf16 v[196:199], v[64:67], v[48:51], v[196:199]
  ds_read_b64_tr_b16 v[62:63], v7 offset:3072
  v_mfma_f32_16x16x32_bf16 v[200:203], v[64:67], v[52:55], v[200:203]
  ds_read_b64 v[32:33], v5 offset:320
  v_mfma_f32_16x16x32_bf16 v[204:207], v[64:67], v[56:59], v[204:207]
  ds_read_b64 v[34:35], v5 offset:352
  s_waitcnt lgkmcnt(12)
  v_mfma_f32_16x16x32_bf16 v[220:223], v[68:71], v[56:59], v[220:223]
  ds_read_b64_tr_b16 v[64:65], v8 offset:2048
  v_mfma_f32_16x16x32_bf16 v[216:219], v[68:71], v[52:55], v[216:219]
  ds_read_b64_tr_b16 v[66:67], v8 offset:3072
  v_mfma_f32_16x16x32_bf16 v[212:215], v[68:71], v[48:51], v[212:215]
  ds_read_b64 v[36:37], v5 offset:576
  v_mfma_f32_16x16x32_bf16 v[208:211], v[68:71], v[44:47], v[208:211]
  ds_read_b64 v[38:39], v5 offset:608
  s_waitcnt lgkmcnt(8)
  v_mfma_f32_16x16x32_bf16 v[224:227], v[72:75], v[44:47], v[224:227]
  v_mfma_f32_16x16x32_bf16 v[228:231], v[72:75], v[48:51], v[228:231]
  v_mfma_f32_16x16x32_bf16 v[232:235], v[72:75], v[52:55], v[232:235]
  ds_read_b64 v[40:41], v5 offset:832
  v_mfma_f32_16x16x32_bf16 v[236:239], v[72:75], v[56:59], v[236:239]
  ds_read_b64 v[42:43], v5 offset:864
  s_cmp_eq_u32 s60, 2
  s_cbranch_scc0 L_nx_68
  s_call_b64 s[74:75], L_x_pfc_7
L_nx_68:
  v_mfma_f32_16x16x32_bf16 v[252:255], v[76:79], v[56:59], v[252:255]
  ds_read_b64_tr_b16 v[72:73], v8 offset:4096
  v_mfma_f32_16x16x32_bf16 v[248:251], v[76:79], v[52:55], v[248:251]
  ds_read_b64_tr_b16 v[74:75], v8 offset:5120
  v_mfma_f32_16x16x32_bf16 v[244:247], v[76:79], v[48:51], v[244:247]
  ds_read_b64_tr_b16 v[68:69], v7 offset:4096
  v_mfma_f32_16x16x32_bf16 v[240:243], v[76:79], v[44:47], v[240:243]
  ds_read_b64_tr_b16 v[70:71], v7 offset:5120
  s_waitcnt lgkmcnt(4)
  s_barrier
  s_sub_u32 s60, s60, 1
  s_cmp_gt_u32 s60, 2
  s_cbranch_scc1 L_loop7
L_loopc7:
  v_mfma_f32_16x16x32_bf16 v[96:99], v[60:63], v[12:15], v[96:99]
  ds_read_b64_tr_b16 v[76:77], v6 offset:6272
  v_mfma_f32_16x16x32_bf16 v[100:103], v[60:63], v[16:19], v[100:103]
  ds_read_b64_tr_b16 v[78:79], v6 offset:9856
  v_mfma_f32_16x16x32_bf16 v[104:107], v[60:63], v[20:23], v[104:107]
  v_mfma_f32_16x16x32_bf16 v[108:111], v[60:63], v[24:27], v[108:111]
  buffer_load_dword v1, v2, s[12:15], s27 offen
  s_add_u32 s27, s27, s30
  v_mfma_f32_16x16x32_bf16 v[124:127], v[64:67], v[24:27], v[124:127]
  ds_read_b64_tr_b16 v[60:61], v6 offset:13440
  v_mfma_f32_16x16x32_bf16 v[120:123], v[64:67], v[20:23], v[120:123]
  ds_read_b64_tr_b16 v[62:63], v6 offset:17024
  v_mfma_f32_16x16x32_bf16 v[116:119], v[64:67], v[16:19], v[116:119]
  v_mfma_f32_16x16x32_bf16 v[112:115], v[64:67], v[12:15], v[112:115]
  buffer_load_dword v1, v3, s[16:19], s28 offen
  s_add_u32 s28, s28, s31
  s_waitcnt lgkmcnt(4)
  v_mfma_f32_16x16x32_bf16 v[128:131], v[12:15], v[68:71], v[128:131]
  ds_read_b64_tr_b16 v[64:65], v6 offset:6304
  v_mfma_f32_16x16x32_bf16 v[132:135], v[16:19], v[68:71], v[132:135]
  ds_read_b64_tr_b16 v[66:67], v6 offset:9888
  v_mfma_f32_16x16x32_bf16 v[136:139], v[20:23], v[68:71], v[136:139]
  v_mfma_f32_16x16x32_bf16 v[140:143], v[24:27], v[68:71], v[140:143]
  buffer_load_dword v1, v4, s[20:23], s29 offen
  s_add_u32 s29, s29, s32
  v_mfma_f32_16x16x32_bf16 v[156:159], v[24:27], v[72:75], v[156:159]
  ds_read_b64_tr_b16 v[68:69], v6 offset:13472
  v_lshlrev_b32 v10, 16, v72
  v_and_b32 v11, s79, v72
  v_mfma_f32_16x16x32_bf16 v[152:155], v[20:23], v[72:75], v[152:155]
  ds_read_b64_tr_b16 v[70:71], v6 offset:17056
  v_add_f32 v90, v90, v10
  v_add_f32 v90, v90, v11
  v_mfma_f32_16x16x32_bf16 v[148:151], v[16:19], v[72:75], v[148:151]
  v_lshlrev_b32 v10, 16, v73
  v_and_b32 v11, s79, v73
  v_mfma_f32_16x16x32_bf16 v[144:147], v[12:15], v[72:75], v[144:147]
  v_add_f32 v90, v90, v10
  v_add_f32 v90, v90, v11
  s_waitcnt lgkmcnt(6)
  v_mfma_f32_16x16x32_bf16 v[160:163], v[76:79], v[12:15], v[160:163]
  v_lshlrev_b32 v10, 16, v74
  v_and_b32 v11, s79, v74
  v_mfma_f32_16x16x32_bf16 v[164:167], v[76:79], v[16:19], v[164:167]
  v_add_f32 v90, v90, v10
  v_add_f32 v90, v90, v11
  v_mfma_f32_16x16x32_bf16 v[168:171], v[76:79], v[20:23], v[168:171]
  v_lshlrev_b32 v10, 16, v75
  v_and_b32 v11, s79, v75
  v_mfma_f32_16x16x32_bf16 v[172:175], v[76:79], v[24:27], v[172:175]
  v_add_f32 v90, v90, v10
  v_add_f32 v90, v90, v11
  s_waitcnt lgkmcnt(4)
  v_mfma_f32_16x16x32_bf16 v[188:191], v[60:63], v[24:27], v[188:191]
  ds_read_b64_tr_b16 v[76:77], v6 offset:13504
  v_mfma_f32_16x16x32_bf16 v[184:187], v[60:63], v[20:23], v[184:187]
  ds_read_b64_tr_b16 v[78:79], v6 offset:17088
  v_mfma_f32_16x16x32_bf16 v[180:183], v[60:63], v[16:19], v[180:183]
  ds_read_b64_tr_b16 v[72:73], v6 offset:6336
  v_mfma_f32_16x16x32_bf16 v[176:179], v[60:63], v[12:15], v[176:179]
  ds_read_b64_tr_b16 v[74:75], v6 offset:9920
  s_waitcnt lgkmcnt(6)
  v_mfma_f32_16x16x32_bf16 v[192:195], v[64:67], v[12:15], v[192:195]
  ds_read_b64_tr_b16 v[60:61], v7 offset:22528
  v_mfma_f32_16x16x32_bf16 v[196:199], v[64:67], v[16:19], v[196:199]
  ds_read_b64_tr_b16 v[62:63], v7 offset:23552
  v_mfma_f32_16x16x32_bf16 v[200:203], v[64:67], v[20:23], v[200:203]
  v_mfma_f32_16x16x32_bf16 v[204:207], v[64:67], v[24:27], v[204:207]
  s_waitcnt lgkmcnt(6)
  v_mfma_f32_16x16x32_bf16 v[220:223], v[68:71], v[24:27], v[220:223]
  ds_read_b64_tr_b16 v[64:65], v8 offset:22528
  v_lshlrev_b32 v10, 16, v68
  v_and_b32 v11, s79, v68
  v_mfma_f32_16x16x32_bf16 v[216:219], v[68:71], v[20:23], v[216:219]
  ds_read_b64_tr_b16 v[66:67], v8 offset:23552
  v_add_f32 v91, v91, v10
  v_add_f32 v91, v91, v11
  v_mfma_f32_16x16x32_bf16 v[212:215], v[68:71], v[16:19], v[212:215]
  v_lshlrev_b32 v10, 16, v69
  v_and_b32 v11, s79, v69
  v_mfma_f32_16x16x32_bf16 v[208:211], v[68:71], v[12:15], v[208:211]
  v_add_f32 v91, v91, v10
  v_add_f32 v91, v91, v11
  s_waitcnt lgkmcnt(4)
  v_mfma_f32_16x16x32_bf16 v[224:227], v[72:75], v[12:15], v[224:227]
  v_lshlrev_b32 v10, 16, v70
  v_and_b32 v11, s79, v70
  v_mfma_f32_16x16x32_bf16 v[228:231], v[72:75], v[16:19], v[228:231]
  v_add_f32 v91, v91, v10
  v_add_f32 v91, v91, v11
  v_mfma_f32_16x16x32_bf16 v[232:235], v[72:75], v[20:23], v[232:235]
  v_lshlrev_b32 v10, 16, v71
  v_and_b32 v11, s79, v71
  v_mfma_f32_16x16x32_bf16 v[236:239], v[72:75], v[24:27], v[236:239]
  v_add_f32 v91, v91, v10
  v_add_f32 v91, v91, v11
  s_cmp_eq_u32 s60, 2
  s_cbranch_scc0 L_nx_69
  s_call_b64 s[74:75], L_x_poll_7
L_nx_69:
  s_cmp_eq_u32 s60, 4
  s_cbranch_scc0 L_nx_70
  s_call_b64 s[74:75], L_x_sig_7
L_nx_70:
  v_mfma_f32_16x16x32_bf16 v[252:255], v[76:79], v[24:27], v[252:255]
  ds_read_b64_tr_b16 v[72:73], v8 offset:24576
  v_mfma_f32_16x16x32_bf16 v[248:251], v[76:79], v[20:23], v[248:251]
  ds_read_b64_tr_b16 v[74:75], v8 offset:25600
  v_mfma_f32_16x16x32_bf16 v[244:247], v[76:79], v[16:19], v[244:247]
  ds_read_b64_tr_b16 v[68:69], v7 offset:24576
  v_mfma_f32_16x16x32_bf16 v[240:243], v[76:79], v[12:15], v[240:243]
  ds_read_b64_tr_b16 v[70:71], v7 offset:25600
  s_barrier
  s_waitcnt lgkmcnt(6)
  v_mfma_f32_16x16x32_bf16 v[96:99], v[60:63], v[28:31], v[96:99]
  ds_read_b64_tr_b16 v[76:77], v6 offset:26752
  v_mfma_f32_16x16x32_bf16 v[100:103], v[60:63], v[32:35], v[100:103]
  ds_read_b64_tr_b16 v[78:79], v6 offset:30336
  v_mfma_f32_16x16x32_bf16 v[104:107], v[60:63], v[36:39], v[104:107]
  ds_read_b64 v[12:13], v5 offset:33280
  v_mfma_f32_16x16x32_bf16 v[108:111], v[60:63], v[40:43], v[108:111]
  ds_read_b64 v[14:15], v5 offset:33312
  buffer_load_dword v1, v2, s[12:15], s27 offen
  s_add_u32 s27, s27, s30
  s_waitcnt lgkmcnt(8)
  v_mfma_f32_16x16x32_bf16 v[124:127], v[64:67], v[40:43], v[124:127]
  ds_read_b64_tr_b16 v[60:61], v6 offset:33920
  v_mfma_f32_16x16x32_bf16 v[120:123], v[64:67], v[36:39], v[120:123]
  ds_read_b64_tr_b16 v[62:63], v6 offset:37504
  v_mfma_f32_16x16x32_bf16 v[116:119], v[64:67], v[32:35], v[116:119]
  ds_read_b64 v[16:17], v5 offset:33536
  v_mfma_f32_16x16x32_bf16 v[112:115], v[64:67], v[28:31], v[112:115]
  ds_read_b64 v[18:19], v5 offset:33568
  buffer_load_dword v1, v3, s[16:19], s28 offen
  s_add_u32 s28, s28, s31
  s_waitcnt lgkmcnt(8)
  v_mfma_f32_16x16x32_bf16 v[128:131], v[28:31], v[68:71], v[128:131]
  ds_read_b64_tr_b16 v[64:65], v6 offset:26784
  v_mfma_f32_16x16x32_bf16 v[132:135], v[32:35], v[68:71], v[132:135]
  ds_read_b64_tr_b16 v[66:67], v6 offset:30368
  v_mfma_f32_16x16x32_bf16 v[136:139], v[36:39], v[68:71], v[136:139]
  ds_read_b64 v[20:21], v5 offset:33792
  v_mfma_f32_16x16x32_bf16 v[140:143], v[40:43], v[68:71], v[140:143]
  ds_read_b64 v[22:23], v5 offset:33824
  buffer_load_dword v1, v4, s[20:23], s29 offen
  s_add_u32 s29, s29, s32
  v_mfma_f32_16x16x32_bf16 v[156:159], v[40:43], v[72:75], v[156:159]
  ds_read_b64_tr_b16 v[68:69], v6 offset:33952
  v_lshlrev_b32 v10, 16, v72
  v_and_b32 v11, s79, v72
  v_mfma_f32_16x16x32_bf16 v[152:155], v[36:39], v[72:75], v[152:155]
  ds_read_b64_tr_b16 v[70:71], v6 offset:37536
  v_add_f32 v90, v90, v10
  v_add_f32 v90, v90, v11
  v_mfma_f32_16x16x32_bf16 v[148:151], v[32:35], v[72:75], v[148:151]
  ds_read_b64 v[24:25], v5 offset:34048
  v_lshlrev_b32 v10, 16, v73
  v_and_b32 v11, s79, v73
  v_mfma_f32_16x16x32_bf16 v[144:147], v[28:31], v[72:75], v[144:147]
  ds_read_b64 v[26:27], v5 offset:34080
  v_add_f32 v90, v90, v10
  v_add_f32 v90, v90, v11
  s_waitcnt lgkmcnt(14)
  v_mfma_f32_16x16x32_bf16 v[160:163], v[76:79], v[28:31], v[160:163]
  v_lshlrev_b32 v10, 16, v74
  v_and_b32 v11, s79, v74
  v_mfma_f32_16x16x32_bf16 v[164:167], v[76:79], v[32:35], v[164:167]
  v_add_f32 v90, v90, v10
  v_add_f32 v90, v90, v11
  v_mfma_f32_16x16x32_bf16 v[168:171], v[76:79], v[36:39], v[168:171]
  ds_read_b64 v[44:45], v5 offset:33344
  v_lshlrev_b32 v10, 16, v75
  v_and_b32 v11, s79, v75
  v_mfma_f32_16x16x32_bf16 v[172:175], v[76:79], v[40:43], v[172:175]
  ds_read_b64 v[46:47], v5 offset:33376
  v_add_f32 v90, v90, v10
  v_add_f32 v90, v90, v11
  s_waitcnt lgkmcnt(12)
  v_mfma_f32_16x16x32_bf16 v[188:191], v[60:63], v[40:43], v[188:191]
  ds_read_b64_tr_b16 v[76:77], v6 offset:33984
  v_mfma_f32_16x16x32_bf16 v[184:187], v[60:63], v[36:39], v[184:187]
  ds_read_b64_tr_b16 v[78:79], v6 offset:37568
  v_mfma_f32_16x16x32_bf16 v[180:183], v[60:63], v[32:35], v[180:183]
  ds_read_b64_tr_b16 v[72:73], v6 offset:26816
  v_mfma_f32_16x16x32_bf16 v[176:179], v[60:63], v[28:31], v[176:179]
  ds_read_b64_tr_b16 v[74:75], v6 offset:30400
  s_waitcnt lgkmcnt(12)
  v_mfma_f32_16x16x32_bf16 v[192:195], v[64:67], v[28:31], v[192:195]
  ds_read_b64_tr_b16 v[60:61], v94 offset:2048
  v_mfma_f32_16x16x32_bf16 v[196:199], v[64:67], v[32:35], v[196:199]
  ds_read_b64_tr_b16 v[62:63], v94 offset:3072
  v_mfma_f32_16x16x32_bf16 v[200:203], v[64:67], v[36:39], v[200:203]
  ds_read_b64 v[48:49], v5 offset:33600
  v_mfma_f32_16x16x32_bf16 v[204:207], v[64:67], v[40:43], v[204:207]
  ds_read_b64 v[50:51], v5 offset:33632
  s_waitcnt lgkmcnt(12)
  v_mfma_f32_16x16x32_bf16 v[220:223], v[68:71], v[40:43], v[220:223]
  ds_read_b64_tr_b16 v[64:65], v95 offset:2048
  v_lshlrev_b32 v10, 16, v68
  v_and_b32 v11, s79, v68
  v_mfma_f32_16x16x32_bf16 v[216:219], v[68:71], v[36:39], v[216:219]
  ds_read_b64_tr_b16 v[66:67], v95 offset:3072
  v_add_f32 v91, v91, v10
  v_add_f32 v91, v91, v11
  v_mfma_f32_16x16x32_bf16 v[212:215], v[68:71], v[32:35], v[212:215]
  ds_read_b64 v[52:53], v5 offset:33856
  v_lshlrev_b32 v10, 16, v69
  v_and_b32 v11, s79, v69
  v_mfma_f32_16x16x32_bf16 v[208:211], v[68:71], v[28:31], v[208:211]
  ds_read_b64 v[54:55], v5 offset:33888
  v_add_f32 v91, v91, v10
  v_add_f32 v91, v91, v11
  s_waitcnt lgkmcnt(8)
  v_mfma_f32_16x16x32_bf16 v[224:227], v[72:75], v[28:31], v[224:227]
  v_lshlrev_b32 v10, 16, v70
  v_and_b32 v11, s79, v70
  v_mfma_f32_16x16x32_bf16 v[228:231], v[72:75], v[32:35], v[228:231]
  v_add_f32 v91, v91, v10
  v_add_f32 v91, v91, v11
  v_mfma_f32_16x16x32_bf16 v[232:235], v[72:75], v[36:39], v[232:235]
  ds_read_b64 v[56:57], v5 offset:34112
  v_lshlrev_b32 v10, 16, v71
  v_and_b32 v11, s79, v71
  v_mfma_f32_16x16x32_bf16 v[236:239], v[72:75], v[40:43], v[236:239]
  ds_read_b64 v[58:59], v5 offset:34144
  v_add_f32 v91, v91, v10
  v_add_f32 v91, v91, v11
  v_mfma_f32_16x16x32_bf16 v[252:255], v[76:79], v[40:43], v[252:255]
  ds_read_b64_tr_b16 v[72:73], v95 offset:4096
  v_mfma_f32_16x16x32_bf16 v[248:251], v[76:79], v[36:39], v[248:251]
  ds_read_b64_tr_b16 v[74:75], v95 offset:5120
  v_mfma_f32_16x16x32_bf16 v[244:247], v[76:79], v[32:35], v[244:247]
  ds_read_b64_tr_b16 v[68:69], v94 offset:4096
  v_mfma_f32_16x16x32_bf16 v[240:243], v[76:79], v[28:31], v[240:243]
  ds_read_b64_tr_b16 v[70:71], v94 offset:5120
  s_waitcnt lgkmcnt(4)
  s_barrier
  v_mfma_f32_16x16x32_bf16 v[96:99], v[60:63], v[12:15], v[96:99]
  ds_read_b64_tr_b16 v[76:77], v93 offset:6272
  v_mfma_f32_16x16x32_bf16 v[100:103], v[60:63], v[16:19], v[100:103]
  ds_read_b64_tr_b16 v[78:79], v93 offset:9856
  s_cmp_eq_u32 s60, 2
  s_cbranch_scc0 L_nx_71
  s_call_b64 s[74:75], L_x_stat_7
L_nx_71:
  s_cmp_eq_u32 s60, 8
  s_cbranch_scc0 L_nx_72
  s_call_b64 s[74:75], L_x_rows_7
L_nx_72:
  v_mfma_f32_16x16x32_bf16 v[104:107], v[60:63], v[20:23], v[104:107]
  v_mfma_f32_16x16x32_bf16 v[108:111], v[60:63], v[24:27], v[108:111]
  buffer_load_dword v1, v2, s[12:15], s27 offen
  s_add_u32 s27, s27, s30
  v_mfma_f32_16x16x32_bf16 v[124:127], v[64:67], v[24:27], v[124:127]
  ds_read_b64_tr_b16 v[60:61], v93 offset:13440
  v_mfma_f32_16x16x32_bf16 v[120:123], v[64:67], v[20:23], v[120:123]
  ds_read_b64_tr_b16 v[62:63], v93 offset:17024
  v_mfma_f32_16x16x32_bf16 v[116:119], v[64:67], v[16:19], v[116:119]
  v_mfma_f32_16x16x32_bf16 v[112:115], v[64:67], v[12:15], v[112:115]
  buffer_load_dword v1, v3, s[16:19], s28 offen
  s_add_u32 s28, s28, s31
  s_waitcnt lgkmcnt(4)
  v_mfma_f32_16x16x32_bf16 v[128:131], v[12:15], v[68:71], v[128:131]
  ds_read_b64_tr_b16 v[64:65], v93 offset:6304
  v_mfma_f32_16x16x32_bf16 v[132:135], v[16:19], v[68:71], v[132:135]
  ds_read_b64_tr_b16 v[66:67], v93 offset:9888
  v_mfma_f32_16x16x32_bf16 v[136:139], v[20:23], v[68:71], v[136:139]
  v_mfma_f32_16x16x32_bf16 v[140:143], v[24:27], v[68:71], v[140:143]
  buffer_load_dword v1, v4, s[20:23], s29 offen
  s_add_u32 s29, s29, s32
  v_mfma_f32_16x16x32_bf16 v[156:159], v[24:27], v[72:75], v[156:159]
  ds_read_b64_tr_b16 v[68:69], v93 offset:13472
  v_lshlrev_b32 v10, 16, v72
  v_and_b32 v11, s79, v72
  v_mfma_f32_16x16x32_bf16 v[152:155], v[20:23], v[72:75], v[152:155]
  ds_read_b64_tr_b16 v[70:71], v93 offset:17056
  v_add_f32 v90, v90, v10
  v_add_f32 v90, v90, v11
  v_mfma_f32_16x16x32_bf16 v[148:151], v[16:19], v[72:75], v[148:151]
  v_lshlrev_b32 v10, 16, v73
  v_and_b32 v11, s79, v73
  v_mfma_f32_16x16x32_bf16 v[144:147], v[12:15], v[72:75], v[144:147]
  v_add_f32 v90, v90, v10
  v_add_f32 v90, v90, v11
  s_waitcnt lgkmcnt(6)
  v_mfma_f32_16x16x32_bf16 v[160:163], v[76:79], v[12:15], v[160:163]
  v_lshlrev_b32 v10, 16, v74
  v_and_b32 v11, s79, v74
  v_mfma_f32_16x16x32_bf16 v[164:167], v[76:79], v[16:19], v[164:167]
  v_add_f32 v90, v90, v10
  v_add_f32 v90, v90, v11
  v_mfma_f32_16x16x32_bf16 v[168:171], v[76:79], v[20:23], v[168:171]
  v_lshlrev_b32 v10, 16, v75
  v_and_b32 v11, s79, v75
  v_mfma_f32_16x16x32_bf16 v[172:175], v[76:79], v[24:27], v[172:175]
  v_add_f32 v90, v90, v10
  v_add_f32 v90, v90, v11
  s_waitcnt lgkmcnt(4)
  v_mfma_f32_16x16x32_bf16 v[188:191], v[60:63], v[24:27], v[188:191]
  ds_read_b64_tr_b16 v[76:77], v93 offset:13504
  v_mfma_f32_16x16x32_bf16 v[184:187], v[60:63], v[20:23], v[184:187]
  ds_read_b64_tr_b16 v[78:79], v93 offset:17088
  v_mfma_f32_16x16x32_bf16 v[180:183], v[60:63], v[16:19], v[180:183]
  ds_read_b64_tr_b16 v[72:73], v93 offset:6336
  v_mfma_f32_16x16x32_bf16 v[176:179], v[60:63], v[12:15], v[176:179]
  ds_read_b64_tr_b16 v[74:75], v93 offset:9920
  s_waitcnt lgkmcnt(6)
  v_mfma_f32_16x16x32_bf16 v[192:195], v[64:67], v[12:15], v[192:195]
  ds_read_b64_tr_b16 v[60:61], v94 offset:22528
  v_mfma_f32_16x16x32_bf16 v[196:199], v[64:67], v[16:19], v[196:199]
  ds_read_b64_tr_b16 v[62:63], v94 offset:23552
  v_mfma_f32_16x16x32_bf16 v[200:203], v[64:67], v[20:23], v[200:203]
  v_mfma_f32_16x16x32_bf16 v[204:207], v[64:67], v[24:27], v[204:207]
  s_waitcnt lgkmcnt(6)
  v_mfma_f32_16x16x32_bf16 v[220:223], v[68:71], v[24:27], v[220:223]
  ds_read_b64_tr_b16 v[64:65], v95 offset:22528
  v_lshlrev_b32 v10, 16, v68
  v_and_b32 v11, s79, v68
  v_mfma_f32_16x16x32_bf16 v[216:219], v[68:71], v[20:23], v[216:219]
  ds_read_b64_tr_b16 v[66:67], v95 offset:23552
  v_add_f32 v91, v91, v10
  v_add_f32 v91, v91, v11
  v_mfma_f32_16x16x32_bf16 v[212:215], v[68:71], v[16:19], v[212:215]
  v_lshlrev_b32 v10, 16, v69
  v_and_b32 v11, s79, v69
  v_mfma_f32_16x16x32_bf16 v[208:211], v[68:71], v[12:15], v[208:211]
  v_add_f32 v91, v91, v10
  v_add_f32 v91, v91, v11
  s_waitcnt lgkmcnt(4)
  v_mfma_f32_16x16x32_bf16 v[224:227], v[72:75], v[12:15], v[224:227]
  v_lshlrev_b32 v10, 16, v70
  v_and_b32 v11, s79, v70
  v_mfma_f32_16x16x32_bf16 v[228:231], v[72:75], v[16:19], v[228:231]
  v_add_f32 v91, v91, v10
  v_add_f32 v91, v91, v11
  v_mfma_f32_16x16x32_bf16 v[232:235], v[72:75], v[20:23], v[232:235]
  v_lshlrev_b32 v10, 16, v71
  v_and_b32 v11, s79, v71
  v_mfma_f32_16x16x32_bf16 v[236:239], v[72:75], v[24:27], v[236:239]
  v_add_f32 v91, v91, v10
  v_add_f32 v91, v91, v11
  v_mfma_f32_16x16x32_bf16 v[252:255], v[76:79], v[24:27], v[252:255]
  ds_read_b64_tr_b16 v[72:73], v95 offset:24576
  v_mfma_f32_16x16x32_bf16 v[248:251], v[76:79], v[20:23], v[248:251]
  ds_read_b64_tr_b16 v[74:75], v95 offset:25600
  v_mfma_f32_16x16x32_bf16 v[244:247], v[76:79], v[16:19], v[244:247]
  ds_read_b64_tr_b16 v[68:69], v94 offset:24576
  v_mfma_f32_16x16x32_bf16 v[240:243], v[76:79], v[12:15], v[240:243]
  ds_read_b64_tr_b16 v[70:71], v94 offset:25600
  s_barrier
  s_waitcnt lgkmcnt(6)
  v_mfma_f32_16x16x32_bf16 v[96:99], v[60:63], v[44:47], v[96:99]
  ds_read_b64_tr_b16 v[76:77], v93 offset:26752
  v_mfma_f32_16x16x32_bf16 v[100:103], v[60:63], v[48:51], v[100:103]
  ds_read_b64_tr_b16 v[78:79], v93 offset:30336
  s_cmp_eq_u32 s60, 5
  s_cbranch_scc0 L_nx_73
  s_call_b64 s[74:75], L_x_drain_7
L_nx_73:
  v_mfma_f32_16x16x32_bf16 v[104:107], v[60:63], v[52:55], v[104:107]
  ds_read_b64 v[12:13], v5 offset:0
  v_mfma_f32_16x16x32_bf16 v[108:111], v[60:63], v[56:59], v[108:111]
  ds_read_b64 v[14:15], v5 offset:32
  buffer_load_dword v1, v2, s[12:15], s27 offen
  s_add_u32 s27, s27, s30
  s_waitcnt lgkmcnt(8)
  v_mfma_f32_16x16x32_bf16 v[124:127], v[64:67], v[56:59], v[124:127]
  ds_read_b64_tr_b16 v[60:61], v93 offset:33920
  v_mfma_f32_16x16x32_bf16 v[120:123], v[64:67], v[52:55], v[120:123]
  ds_read_b64_tr_b16 v[62:63], v93 offset:37504
  v_mfma_f32_16x16x32_bf16 v[116:119], v[64:67], v[48:51], v[116:119]
  ds_read_b64 v[16:17], v5 offset:256
  v_mfma_f32_16x16x32_bf16 v[112:115], v[64:67], v[44:47], v[112:115]
  ds_read_b64 v[18:19], v5 offset:288
  buffer_load_dword v1, v3, s[16:19], s28 offen
  s_add_u32 s28, s28, s31
  s_waitcnt lgkmcnt(8)
  v_mfma_f32_16x16x32_bf16 v[128:131], v[44:47], v[68:71], v[128:131]
  ds_read_b64_tr_b16 v[64:65], v93 offset:26784
  v_mfma_f32_16x16x32_bf16 v[132:135], v[48:51], v[68:71], v[132:135]
  ds_read_b64_tr_b16 v[66:67], v93 offset:30368
  v_mfma_f32_16x16x32_bf16 v[136:139], v[52:55], v[68:71], v[136:139]
  ds_read_b64 v[20:21], v5 offset:512
  v_mfma_f32_16x16x32_bf16 v[140:143], v[56:59], v[68:71], v[140:143]
  ds_read_b64 v[22:23], v5 offset:544
  buffer_load_dword v1, v4, s[20:23], s29 offen
  s_add_u32 s29, s29, s32
  v_mfma_f32_16x16x32_bf16 v[156:159], v[56:59], v[72:75], v[156:159]
  ds_read_b64_tr_b16 v[68:69], v93 offset:33952
  v_lshlrev_b32 v10, 16, v72
  v_and_b32 v11, s79, v72
  v_mfma_f32_16x16x32_bf16 v[152:155], v[52:55], v[72:75], v[152:155]
  ds_read_b64_tr_b16 v[70:71], v93 offset:37536
  v_add_f32 v90, v90, v10
  v_add_f32 v90, v90, v11
  v_mfma_f32_16x16x32_bf16 v[148:151], v[48:51], v[72:75], v[148:151]
  ds_read_b64 v[24:25], v5 offset:768
  v_lshlrev_b32 v10, 16, v73
  v_and_b32 v11, s79, v73
  v_mfma_f32_16x16x32_bf16 v[144:147], v[44:47], v[72:75], v[144:147]
  ds_read_b64 v[26:27], v5 offset:800
  v_add_f32 v90, v90, v10
  v_add_f32 v90, v90, v11
  s_waitcnt lgkmcnt(14)
  v_mfma_f32_16x16x32_bf16 v[160:163], v[76:79], v[44:47], v[160:163]
  v_lshlrev_b32 v10, 16, v74
  v_and_b32 v11, s79, v74
  v_mfma_f32_16x16x32_bf16 v[164:167], v[76:79], v[48:51], v[164:167]
  v_add_f32 v90, v90, v10
  v_add_f32 v90, v90, v11
  v_mfma_f32_16x16x32_bf16 v[168:171], v[76:79], v[52:55], v[168:171]
  ds_read_b64 v[28:29], v5 offset:64
  v_lshlrev_b32 v10, 16, v75
  v_and_b32 v11, s79, v75
  v_mfma_f32_16x16x32_bf16 v[172:175], v[76:79], v[56:59], v[172:175]
  ds_read_b64 v[30:31], v5 offset:96
  v_add_f32 v90, v90, v10
  v_add_f32 v90, v90, v11
  s_waitcnt lgkmcnt(12)
  v_mfma_f32_16x16x32_bf16 v[188:191], v[60:63], v[56:59], v[188:191]
  ds_read_b64_tr_b16 v[76:77], v93 offset:33984
  v_mfma_f32_16x16x32_bf16 v[184:187], v[60:63], v[52:55], v[184:187]
  ds_read_b64_tr_b16 v[78:79], v93 offset:37568
  v_mfma_f32_16x16x32_bf16 v[180:183], v[60:63], v[48:51], v[180:183]
  ds_read_b64_tr_b16 v[72:73], v93 offset:26816
  v_mfma_f32_16x16x32_bf16 v[176:179], v[60:63], v[44:47], v[176:179]
  ds_read_b64_tr_b16 v[74:75], v93 offset:30400
  s_waitcnt lgkmcnt(12)
  v_mfma_f32_16x16x32_bf16 v[192:195], v[64:67], v[44:47], v[192:195]
  ds_read_b64_tr_b16 v[60:61], v7 offset:2048
  v_mfma_f32_16x16x32_bf16 v[196:199], v[64:67], v[48:51], v[196:199]
  ds_read_b64_tr_b16 v[62:63], v7 offset:3072
  v_mfma_f32_16x16x32_bf16 v[200:203], v[64:67], v[52:55], v[200:203]
  ds_read_b64 v[32:33], v5 offset:320
  v_mfma_f32_16x16x32_bf16 v[204:207], v[64:67], v[56:59], v[204:207]
  ds_read_b64 v[34:35], v5 offset:352
  s_waitcnt lgkmcnt(12)
  v_mfma_f32_16x16x32_bf16 v[220:223], v[68:71], v[56:59], v[220:223]
  ds_read_b64_tr_b16 v[64:65], v8 offset:2048
  v_lshlrev_b32 v10, 16, v68
  v_and_b32 v11, s79, v68
  v_mfma_f32_16x16x32_bf16 v[216:219], v[68:71], v[52:55], v[216:219]
  ds_read_b64_tr_b16 v[66:67], v8 offset:3072
  v_add_f32 v91, v91, v10
  v_add_f32 v91, v91, v11
  v_mfma_f32_16x16x32_bf16 v[212:215], v[68:71], v[48:51], v[212:215]
  ds_read_b64 v[36:37], v5 offset:576
  v_lshlrev_b32 v10, 16, v69
  v_and_b32 v11, s79, v69
  v_mfma_f32_16x16x32_bf16 v[208:211], v[68:71], v[44:47], v[208:211]
  ds_read_b64 v[38:39], v5 offset:608
  v_add_f32 v91, v91, v10
  v_add_f32 v91, v91, v11
  s_waitcnt lgkmcnt(8)
  v_mfma_f32_16x16x32_bf16 v[224:227], v[72:75], v[44:47], v[224:227]
  v_lshlrev_b32 v10, 16, v70
  v_and_b32 v11, s79, v70
  v_mfma_f32_16x16x32_bf16 v[228:231], v[72:75], v[48:51], v[228:231]
  v_add_f32 v91, v91, v10
  v_add_f32 v91, v91, v11
  v_mfma_f32_16x16x32_bf16 v[232:235], v[72:75], v[52:55], v[232:235]
  ds_read_b64 v[40:41], v5 offset:832
  v_lshlrev_b32 v10, 16, v71
  v_and_b32 v11, s79, v71
  v_mfma_f32_16x16x32_bf16 v[236:239], v[72:75], v[56:59], v[236:239]
  ds_read_b64 v[42:43], v5 offset:864
  v_add_f32 v91, v91, v10
  v_add_f32 v91, v91, v11
  s_cmp_eq_u32 s60, 2
  s_cbranch_scc0 L_nx_74
  s_call_b64 s[74:75], L_x_pfc_7
L_nx_74:
  v_mfma_f32_16x16x32_bf16 v[252:255], v[76:79], v[56:59], v[252:255]
  ds_read_b64_tr_b16 v[72:73], v8 offset:4096
  v_mfma_f32_16x16x32_bf16 v[248:251], v[76:79], v[52:55], v[248:251]
  ds_read_b64_tr_b16 v[74:75], v8 offset:5120
  v_mfma_f32_16x16x32_bf16 v[244:247], v[76:79], v[48:51], v[244:247]
  ds_read_b64_tr_b16 v[68:69], v7 offset:4096
  v_mfma_f32_16x16x32_bf16 v[240:243], v[76:79], v[44:47], v[240:243]
  ds_read_b64_tr_b16 v[70:71], v7 offset:5120
  s_waitcnt lgkmcnt(4)
  s_barrier
  s_sub_u32 s60, s60, 1
  s_cmp_lt_u32 s60, 2
  s_cbranch_scc1 L_loopt7
  s_call_b64 s[74:75], L_x_cpub_7
  s_cmp_gt_u32 s60, 2
  s_cbranch_scc1 L_loopp7
L_loopt7:
  s_cmp_lg_u32 s60, 0
  s_cbranch_scc1 L_loopc7
  s_branch L_epi1
L_x_drain_7:
  s_waitcnt vmcnt(0)
  s_setpc_b64 s[74:75]
L_x_rows_7:
  s_waitcnt vmcnt(6)
  v_lshlrev_b32 v10, 16, v80
  v_and_b32 v11, s79, v80
  v_mov_b32 v88, v10
  v_mov_b32 v89, v11
  v_lshlrev_b32 v10, 16, v81
  v_and_b32 v11, s79, v81
  v_add_f32 v88, v88, v10
  v_add_f32 v89, v89, v11
  v_lshlrev_b32 v10, 16, v82
  v_and_b32 v11, s79, v82
  v_add_f32 v88, v88, v10
  v_add_f32 v89, v89, v11
  v_lshlrev_b32 v10, 16, v83
  v_and_b32 v11, s79, v83
  v_add_f32 v88, v88, v10
  v_add_f32 v89, v89, v11
  v_lshlrev_b32 v10, 16, v84
  v_and_b32 v11, s79, v84
  v_add_f32 v88, v88, v10
  v_add_f32 v89, v89, v11
  v_lshlrev_b32 v10, 16, v85
  v_and_b32 v11, s79, v85
  v_add_f32 v88, v88, v10
  v_add_f32 v89, v89, v11
  v_lshlrev_b32 v10, 16, v86
  v_and_b32 v11, s79, v86
  v_add_f32 v88, v88, v10
  v_add_f32 v89, v89, v11
  v_lshlrev_b32 v10, 16, v87
  v_and_b32 v11, s79, v87
  v_add_f32 v88, v88, v10
  v_add_f32 v89, v89, v11
  v_add_f32 v88, v88, v89
  s_nop 1
  v_add_f32_dpp v88, v88, v88 quad_perm:[1,0,3,2] row_mask:0xf bank_mask:0xf
  s_nop 1
  v_add_f32_dpp v88, v88, v88 quad_perm:[2,3,0,1] row_mask:0xf bank_mask:0xf
  s_nop 1
  v_add_f32_dpp v88, v88, v88 row_half_mirror row_mask:0xf bank_mask:0xf
  s_nop 1
  v_add_f32_dpp v88, v88, v88 row_mirror row_mask:0xf bank_mask:0xf
  v_mov_b32 v10, v88
  s_nop 1
  v_permlane16_swap_b32 v88, v10
  s_nop 0
  v_add_f32 v88, v88, v10
  v_mov_b32 v10, v88
  s_nop 1
  v_permlane32_swap_b32 v88, v10
  s_nop 0
  v_add_f32 v88, v88, v10
  v_mul_f32 v88, 0xba800000, v88
  v_lshlrev_b32 v10, 16, v80
  v_and_b32 v11, s79, v80
  v_add_f32 v10, v10, v88
  v_add_f32 v11, v11, v88
  v_mul_f32 v89, v10, v10
  v_fmac_f32 v89, v11, v11
  v_lshlrev_b32 v10, 16, v81
  v_and_b32 v11, s79, v81
  v_add_f32 v10, v10, v88
  v_add_f32 v11, v11, v88
  v_fmac_f32 v89, v10, v10
  v_fmac_f32 v89, v11, v11
  v_lshlrev_b32 v10, 16, v82
  v_and_b32 v11, s79, v82
  v_add_f32 v10, v10, v88
  v_add_f32 v11, v11, v88
  v_fmac_f32 v89, v10, v10
  v_fmac_f32 v89, v11, v11
  v_lshlrev_b32 v10, 16, v83
  v_and_b32 v11, s79, v83
  v_add_f32 v10, v10, v88
  v_add_f32 v11, v11, v88
  v_fmac_f32 v89, v10, v10
  v_fmac_f32 v89, v11, v11
  v_lshlrev_b32 v10, 16, v84
  v_and_b32 v11, s79, v84
  v_add_f32 v10, v10, v88
  v_add_f32 v11, v11, v88
  v_fmac_f32 v89, v10, v10
  v_fmac_f32 v89, v11, v11
  v_lshlrev_b32 v10, 16, v85
  v_and_b32 v11, s79, v85
  v_add_f32 v10, v10, v88
  v_add_f32 v11, v11, v88
  v_fmac_f32 v89, v10, v10
  v_fmac_f32 v89, v11, v11
  v_lshlrev_b32 v10, 16, v86
  v_and_b32 v11, s79, v86
  v_add_f32 v10, v10, v88
  v_add_f32 v11, v11, v88
  v_fmac_f32 v89, v10, v10
  v_fmac_f32 v89, v11, v11
  v_lshlrev_b32 v10, 16, v87
  v_and_b32 v11, s79, v87
  v_add_f32 v10, v10, v88
  v_add_f32 v11, v11, v88
  v_fmac_f32 v89, v10, v10
  v_fmac_f32 v89, v11, v11
  s_nop 1
  v_add_f32_dpp v89, v89, v89 quad_perm:[1,0,3,2] row_mask:0xf bank_mask:0xf
  s_nop 1
  v_add_f32_dpp v89, v89, v89 quad_perm:[2,3,0,1] row_mask:0xf bank_mask:0xf
  s_nop 1
  v_add_f32_dpp v89, v89, v89 row_half_mirror row_mask:0xf bank_mask:0xf
  s_nop 1
  v_add_f32_dpp v89, v89, v89 row_mirror row_mask:0xf bank_mask:0xf
  v_mov_b32 v10, v89
  s_nop 1
  v_permlane16_swap_b32 v89, v10
  s_nop 0
  v_add_f32 v89, v89, v10
  v_mov_b32 v10, v89
  s_nop 1
  v_permlane32_swap_b32 v89, v10
  s_nop 0
  v_add_f32 v89, v89, v10
  v_mul_f32 v89, 0x3a800000, v89
  v_cvt_pk_bf16_f32 v10, v88, v89
  v_lshlrev_b32 v80, 16, v10
  v_and_b32 v89, s79, v10
  v_add_f32 v89, 0x3727c5ac, v89
  v_cvt_pk_bf16_f32 v89, v89, v89
  v_lshlrev_b32 v89, 16, v89
  v_sqrt_f32 v89, v89
  s_lshl_b32 s51, s2, 6
  v_cvt_pk_bf16_f32 v89, v89, v89
  s_add_u32 s51, s51, 51380280
  v_lshlrev_b32 v81, 16, v89
  s_mov_b64 exec, 1
  buffer_store_dwordx2 v[80:81], v0, s[64:67], s51 offen sc1
  s_mov_b64 exec, -1
  s_setpc_b64 s[74:75]
L_x_poll_7:
  v_and_b32 v89, 0x70, v9
  v_lshlrev_b32 v89, 1, v89
  buffer_load_dword v88, v89, s[56:59], 0 offen sc1
  s_setpc_b64 s[74:75]
L_x_stat_7:
  s_waitcnt vmcnt(0)
  v_cmp_ne_u32 vcc, 32, v88
  s_nop 4
  s_cbranch_vccz L_x_stat_7_go
  s_sleep 2
  v_and_b32 v89, 0x70, v9
  v_lshlrev_b32 v89, 1, v89
  buffer_load_dword v88, v89, s[56:59], 0 offen sc1
  s_branch L_x_stat_7
L_x_stat_7_go:
  s_lshl_b32 s51, s6, 8
  s_lshl_b32 s55, s7, 5
  s_add_u32 s51, s51, s55
  s_lshl_b32 s55, s3, 2
  s_add_u32 s51, s51, s55
  s_add_u32 s51, s51, 50376704
  v_mov_b32 v88, 1
  s_mov_b64 exec, 1
  buffer_store_dword v88, v0, s[64:67], s51 offen sc1
  s_mov_b64 exec, -1
  v_and_b32 v88, 0xf0, v9
  v_lshrrev_b32 v88, 1, v88
  s_lshl_b32 s51, s7, 11
  s_add_u32 s51, s51, 51381760
  buffer_load_dwordx2 v[80:81], v88, s[64:67], s51 offen offset:0 sc1
  buffer_load_dwordx2 v[82:83], v88, s[64:67], s51 offen offset:128 sc1
  buffer_load_dwordx2 v[84:85], v88, s[64:67], s51 offen offset:256 sc1
  buffer_load_dwordx2 v[86:87], v88, s[64:67], s51 offen offset:384 sc1
  s_setpc_b64 s[74:75]
L_x_cpub_7:
  v_mov_b32 v10, v90
  v_mov_b32 v11, v91
  v_mov_b32 v88, v92
  s_nop 1
  v_permlane16_swap_b32 v90, v10
  v_permlane16_swap_b32 v91, v11
  v_permlane16_swap_b32 v92, v88
  v_add_f32 v90, v90, v10
  v_add_f32 v91, v91, v11
  v_add_f32 v92, v92, v88
  v_mov_b32 v10, v90
  v_mov_b32 v11, v91
  v_mov_b32 v88, v92
  s_nop 1
  v_permlane32_swap_b32 v90, v10
  v_permlane32_swap_b32 v91, v11
  v_permlane32_swap_b32 v92, v88
  v_add_f32 v90, v90, v10
  v_add_f32 v91, v91, v11
  v_add_f32 v92, v92, v88
  v_and_b32 v89, 0xf0, v9
  v_lshrrev_b32 v89, 2, v89
  s_mul_i32 s51, s6, 7680
  s_mul_i32 s52, s7, 1280
  s_add_u32 s51, s51, s52
  s_add_u32 s51, s51, 52429632
  s_mov_b64 exec, 0xffff
  buffer_store_dword v90, v89, s[64:67], s51 offen offset:0 sc1
  buffer_store_dword v91, v89, s[64:67], s51 offen offset:256 sc1
  s_mov_b64 exec, -1
  s_nop 1
  v_mov_b32 v90, 0
  v_mov_b32 v91, 0
  v_mov_b32 v92, 0
  s_setpc_b64 s[74:75]
L_x_sig_7:
  s_lshr_b32 s51, s2, 5
  s_lshl_b32 s51, s51, 5
  v_mov_b32 v88, 1
  s_mov_b64 exec, 1
  buffer_atomic_add v88, v0, s[56:59], s51 offen sc1
  s_mov_b64 exec, -1
  s_mov_b32 s12, s100
  s_and_b32 s13, s101, 0xffff
  s_add_u32 s51, s2, 1
  s_mul_i32 s14, s51, 28672
  s_mov_b32 s16, s100
  s_and_b32 s17, s101, 0xffff
  s_add_u32 s51, s2, 1
  s_mul_i32 s18, s51, 28672
  s_mov_b32 s20, s42
  s_and_b32 s21, s43, 0xffff
  s_lshl_b32 s22, s51, 13
  v_lshrrev_b32 v2, 4, v9
  v_and_b32 v4, 7, v2
  v_lshlrev_b32 v4, 7, v4
  v_min_u32 v2, 13, v2
  v_lshlrev_b32 v2, 7, v2
  v_mov_b32 v3, v2
  s_mul_i32 s27, s2, 28672
  s_add_u32 s28, s27, 1792
  s_lshl_b32 s29, s2, 13
  s_mov_b32 s30, 3584
  s_mov_b32 s31, 3584
  s_mov_b32 s32, 1024
  s_setpc_b64 s[74:75]
L_x_pfc_7:
  s_getpc_b64 s[96:97]
L_pc_ref:
  s_sub_u32 s96, s96, L_pc_ref - fused_kernel
  s_subb_u32 s97, s97, 0
  s_and_b32 s97, s97, 0xffff
  s_mov_b32 s98, L_done - fused_kernel
  s_mov_b32 s99, 0x00020000
  v_lshrrev_b32 v88, 4, v9
  v_min_u32 v88, 23, v88
  v_lshlrev_b32 v88, 7, v88
  s_lshr_b32 s51, s2, 3
  s_mul_i32 s51, s51, 3072
  buffer_load_dword v1, v88, s[96:99], s51 offen
  s_setpc_b64 s[74:75]
L_epi1:
  s_waitcnt vmcnt(0) lgkmcnt(0)
  v_lshrrev_b32 v54, 8, v9
  v_lshlrev_b32 v52, 4, v54
  v_and_b32 v55, 0xf0, v9
  v_lshrrev_b32 v12, 2, v55
  v_lshrrev_b32 v56, 6, v55
  v_lshl_add_u32 v56, v54, 2, v56
  v_lshlrev_b32 v56, 6, v56
  v_and_b32 v57, 12, v12
  v_lshl_add_u32 v56, v57, 1, v56
  v_add_u32 v56, 154112, v56
  v_mul_u32_u24 v13, 1280, v54
  s_lshl_b32 s50, s4, 6
  s_add_u32 s50, s50, 156800
  v_add3_u32 v13, v13, v12, s50
  v_cmp_gt_u32 vcc, 2, v54
  ds_read_b32 v16, v13 offset:0
  ds_read_b32 v17, v13 offset:5120
  ds_read_b32 v18, v13 offset:256
  ds_read_b32 v19, v13 offset:5376
  ds_read_b32 v20, v13 offset:512
  ds_read_b32 v21, v13 offset:5632
  s_waitcnt lgkmcnt(0)
  v_cndmask_b32 v17, 0, v17, vcc
  v_add_f32 v90, v90, v16
  v_add_f32 v90, v90, v17
  v_cndmask_b32 v19, 0, v19, vcc
  v_add_f32 v91, v91, v18
  v_add_f32 v91, v91, v19
  v_cndmask_b32 v21, 0, v21, vcc
  v_add_f32 v92, v92, v20
  v_add_f32 v92, v92, v21
  v_mov_b32 v13, v90
  v_mov_b32 v14, v91
  v_mov_b32 v15, v92
  s_nop 1
  v_permlane16_swap_b32 v90, v13
  v_permlane16_swap_b32 v91, v14
  v_permlane16_swap_b32 v92, v15
  v_add_f32 v90, v90, v13
  v_add_f32 v91, v91, v14
  v_add_f32 v92, v92, v15
  v_mov_b32 v13, v90
  v_mov_b32 v14, v91
  v_mov_b32 v15, v92
  s_nop 1
  v_permlane32_swap_b32 v90, v13
  v_permlane32_swap_b32 v91, v14
  v_permlane32_swap_b32 v92, v15
  v_add_f32 v90, v90, v13
  v_add_f32 v91, v91, v14
  v_add_f32 v92, v92, v15
  s_lshl_b32 s50, s4, 6
  s_add_u32 s50, s50, 149120
  v_add_u32 v13, s50, v12
  ds_write_b32 v13, v90
  ds_write_b32 v13, v91 offset:256
  s_cmp_lt_u32 s4, 2
  s_cselect_b32 s50, s50, 149248
  v_add_u32 v14, s50, v12
  ds_write_b32 v14, v92 offset:512
  v_rcp_f32 v2, v81
  v_rcp_f32 v3, v83
  v_rcp_f32 v4, v85
  v_rcp_f32 v5, v87
  s_nop 0
  v_mul_f32 v0, s72, v2
  v_mul_f32 v1, s72, v3
  v_mul_f32 v10, s72, v4
  v_mul_f32 v11, s72, v5
  s_lshl_b32 s50, s3, 9
  s_add_u32 s50, s50, 150016
  v_lshl_add_u32 v15, v12, 1, s50
  v_mov_b32 v16, v80
  v_mov_b32 v17, v2
  ds_write_b64 v15, v[16:17] offset:0
  v_mov_b32 v18, v82
  v_mov_b32 v19, v3
  ds_write_b64 v15, v[18:19] offset:128
  v_mov_b32 v20, v84
  v_mov_b32 v21, v4
  ds_write_b64 v15, v[20:21] offset:256
  v_mov_b32 v22, v86
  v_mov_b32 v23, v5
  ds_write_b64 v15, v[22:23] offset:384
  v_lshl_add_u32 v55, v52, 1, s50
  v_add_u32 v54, 149120, v12
  v_add_u32 v52, 149120, v52
  s_lshl_b32 s54, s4, 13
  s_add_u32 s54, s54, 102400
  v_add_u32 v53, s54, v9
  s_lshl_b32 s50, s7, 14
  s_lshl_b32 s55, s4, 12
  s_add_u32 s50, s50, s55
  s_add_u32 s50, s50, 8388608
  s_mul_i32 s51, s6, 393216
  s_add_u32 s51, s51, s50
  s_waitcnt lgkmcnt(0)
  s_barrier
  ds_read_b128 v[28:31], v52 offset:256
  ds_read_b128 v[32:35], v52 offset:320
  ds_read_b128 v[36:39], v52 offset:384
  ds_read_b128 v[40:43], v52 offset:448
  ds_read_b128 v[12:15], v52 offset:0
  ds_read_b128 v[16:19], v52 offset:64
  ds_read_b128 v[44:47], v52 offset:512
  ds_read_b128 v[48:51], v52 offset:576
  ds_read_b32 v20, v54 offset:128
  ds_read_b32 v21, v54 offset:192
  s_add_u32 s51, s51, 262144
  s_waitcnt lgkmcnt(6)
  v_fma_f32 v192, v36, v80, v192
  v_fma_f32 v193, v37, v80, v193
  v_fma_f32 v194, v38, v80, v194
  v_fma_f32 v195, v39, v80, v195
  v_fma_f32 v208, v40, v80, v208
  v_fma_f32 v209, v41, v80, v209
  v_fma_f32 v210, v42, v80, v210
  v_fma_f32 v211, v43, v80, v211
  v_mul_f32 v76, v192, v0
  v_mul_f32 v77, v193, v0
  v_mul_f32 v78, v194, v0
  v_mul_f32 v79, v195, v0
  v_exp_f32 v76, v76
  v_exp_f32 v77, v77
  v_exp_f32 v78, v78
  v_exp_f32 v79, v79
  v_fma_f32 v76, v76, v81, v81
  v_fma_f32 v77, v77, v81, v81
  v_fma_f32 v78, v78, v81, v81
  v_fma_f32 v79, v79, v81, v81
  v_rcp_f32 v76, v76
  v_rcp_f32 v77, v77
  v_rcp_f32 v78, v78
  v_rcp_f32 v79, v79
  v_mul_f32 v76, v76, v208
  v_mul_f32 v77, v77, v209
  v_mul_f32 v78, v78, v210
  v_mul_f32 v79, v79, v211
  v_cvt_pk_bf16_f32 v192, v76, v77
  v_cvt_pk_bf16_f32 v193, v78, v79
  v_fma_f32 v160, v28, v80, v160
  v_fma_f32 v161, v29, v80, v161
  v_fma_f32 v162, v30, v80, v162
  v_fma_f32 v163, v31, v80, v163
  v_fma_f32 v176, v32, v80, v176
  v_fma_f32 v177, v33, v80, v177
  v_fma_f32 v178, v34, v80, v178
  v_fma_f32 v179, v35, v80, v179
  v_mul_f32 v72, v160, v0
  v_mul_f32 v73, v161, v0
  v_mul_f32 v74, v162, v0
  v_mul_f32 v75, v163, v0
  v_exp_f32 v72, v72
  v_exp_f32 v73, v73
  v_exp_f32 v74, v74
  v_exp_f32 v75, v75
  v_fma_f32 v72, v72, v81, v81
  v_fma_f32 v73, v73, v81, v81
  v_fma_f32 v74, v74, v81, v81
  v_fma_f32 v75, v75, v81, v81
  v_rcp_f32 v72, v72
  v_rcp_f32 v73, v73
  v_rcp_f32 v74, v74
  v_rcp_f32 v75, v75
  v_mul_f32 v72, v72, v176
  v_mul_f32 v73, v73, v177
  v_mul_f32 v74, v74, v178
  v_mul_f32 v75, v75, v179
  v_cvt_pk_bf16_f32 v160, v72, v73
  v_cvt_pk_bf16_f32 v161, v74, v75
  v_mov_b32 v162, v192
  v_mov_b32 v163, v193
  buffer_store_dwordx4 v[160:163], v9, s[64:67], s51 offen offset:0 sc1
  v_fma_f32 v196, v36, v82, v196
  v_fma_f32 v197, v37, v82, v197
  v_fma_f32 v198, v38, v82, v198
  v_fma_f32 v199, v39, v82, v199
  v_fma_f32 v212, v40, v82, v212
  v_fma_f32 v213, v41, v82, v213
  v_fma_f32 v214, v42, v82, v214
  v_fma_f32 v215, v43, v82, v215
  v_mul_f32 v76, v196, v1
  v_mul_f32 v77, v197, v1
  v_mul_f32 v78, v198, v1
  v_mul_f32 v79, v199, v1
  v_exp_f32 v76, v76
  v_exp_f32 v77, v77
  v_exp_f32 v78, v78
  v_exp_f32 v79, v79
  v_fma_f32 v76, v76, v83, v83
  v_fma_f32 v77, v77, v83, v83
  v_fma_f32 v78, v78, v83, v83
  v_fma_f32 v79, v79, v83, v83
  v_rcp_f32 v76, v76
  v_rcp_f32 v77, v77
  v_rcp_f32 v78, v78
  v_rcp_f32 v79, v79
  v_mul_f32 v76, v76, v212
  v_mul_f32 v77, v77, v213
  v_mul_f32 v78, v78, v214
  v_mul_f32 v79, v79, v215
  v_cvt_pk_bf16_f32 v196, v76, v77
  v_cvt_pk_bf16_f32 v197, v78, v79
  v_fma_f32 v164, v28, v82, v164
  v_fma_f32 v165, v29, v82, v165
  v_fma_f32 v166, v30, v82, v166
  v_fma_f32 v167, v31, v82, v167
  v_fma_f32 v180, v32, v82, v180
  v_fma_f32 v181, v33, v82, v181
  v_fma_f32 v182, v34, v82, v182
  v_fma_f32 v183, v35, v82, v183
  v_mul_f32 v72, v164, v1
  v_mul_f32 v73, v165, v1
  v_mul_f32 v74, v166, v1
  v_mul_f32 v75, v167, v1
  v_exp_f32 v72, v72
  v_exp_f32 v73, v73
  v_exp_f32 v74, v74
  v_exp_f32 v75, v75
  v_fma_f32 v72, v72, v83, v83
  v_fma_f32 v73, v73, v83, v83
  v_fma_f32 v74, v74, v83, v83
  v_fma_f32 v75, v75, v83, v83
  v_rcp_f32 v72, v72
  v_rcp_f32 v73, v73
  v_rcp_f32 v74, v74
  v_rcp_f32 v75, v75
  v_mul_f32 v72, v72, v180
  v_mul_f32 v73, v73, v181
  v_mul_f32 v74, v74, v182
  v_mul_f32 v75, v75, v183
  v_cvt_pk_bf16_f32 v164, v72, v73
  v_cvt_pk_bf16_f32 v165, v74, v75
  v_mov_b32 v166, v196
  v_mov_b32 v167, v197
  buffer_store_dwordx4 v[164:167], v9, s[64:67], s51 offen offset:1024 sc1
  v_fma_f32 v200, v36, v84, v200
  v_fma_f32 v201, v37, v84, v201
  v_fma_f32 v202, v38, v84, v202
  v_fma_f32 v203, v39, v84, v203
  v_fma_f32 v216, v40, v84, v216
  v_fma_f32 v217, v41, v84, v217
  v_fma_f32 v218, v42, v84, v218
  v_fma_f32 v219, v43, v84, v219
  v_mul_f32 v76, v200, v10
  v_mul_f32 v77, v201, v10
  v_mul_f32 v78, v202, v10
  v_mul_f32 v79, v203, v10
  v_exp_f32 v76, v76
  v_exp_f32 v77, v77
  v_exp_f32 v78, v78
  v_exp_f32 v79, v79
  v_fma_f32 v76, v76, v85, v85
  v_fma_f32 v77, v77, v85, v85
  v_fma_f32 v78, v78, v85, v85
  v_fma_f32 v79, v79, v85, v85
  v_rcp_f32 v76, v76
  v_rcp_f32 v77, v77
  v_rcp_f32 v78, v78
  v_rcp_f32 v79, v79
  v_mul_f32 v76, v76, v216
  v_mul_f32 v77, v77, v217
  v_mul_f32 v78, v78, v218
  v_mul_f32 v79, v79, v219
  v_cvt_pk_bf16_f32 v200, v76, v77
  v_cvt_pk_bf16_f32 v201, v78, v79
  v_fma_f32 v168, v28, v84, v168
  v_fma_f32 v169, v29, v84, v169
  v_fma_f32 v170, v30, v84, v170
  v_fma_f32 v171, v31, v84, v171
  v_fma_f32 v184, v32, v84, v184
  v_fma_f32 v185, v33, v84, v185
  v_fma_f32 v186, v34, v84, v186
  v_fma_f32 v187, v35, v84, v187
  v_mul_f32 v72, v168, v10
  v_mul_f32 v73, v169, v10
  v_mul_f32 v74, v170, v10
  v_mul_f32 v75, v171, v10
  v_exp_f32 v72, v72
  v_exp_f32 v73, v73
  v_exp_f32 v74, v74
  v_exp_f32 v75, v75
  v_fma_f32 v72, v72, v85, v85
  v_fma_f32 v73, v73, v85, v85
  v_fma_f32 v74, v74, v85, v85
  v_fma_f32 v75, v75, v85, v85
  v_rcp_f32 v72, v72
  v_rcp_f32 v73, v73
  v_rcp_f32 v74, v74
  v_rcp_f32 v75, v75
  v_mul_f32 v72, v72, v184
  v_mul_f32 v73, v73, v185
  v_mul_f32 v74, v74, v186
  v_mul_f32 v75, v75, v187
  v_cvt_pk_bf16_f32 v168, v72, v73
  v_cvt_pk_bf16_f32 v169, v74, v75
  v_mov_b32 v170, v200
  v_mov_b32 v171, v201
  buffer_store_dwordx4 v[168:171], v9, s[64:67], s51 offen offset:2048 sc1
  v_fma_f32 v204, v36, v86, v204
  v_fma_f32 v205, v37, v86, v205
  v_fma_f32 v206, v38, v86, v206
  v_fma_f32 v207, v39, v86, v207
  v_fma_f32 v220, v40, v86, v220
  v_fma_f32 v221, v41, v86, v221
  v_fma_f32 v222, v42, v86, v222
  v_fma_f32 v223, v43, v86, v223
  v_mul_f32 v76, v204, v11
  v_mul_f32 v77, v205, v11
  v_mul_f32 v78, v206, v11
  v_mul_f32 v79, v207, v11
  v_exp_f32 v76, v76
  v_exp_f32 v77, v77
  v_exp_f32 v78, v78
  v_exp_f32 v79, v79
  v_fma_f32 v76, v76, v87, v87
  v_fma_f32 v77, v77, v87, v87
  v_fma_f32 v78, v78, v87, v87
  v_fma_f32 v79, v79, v87, v87
  v_rcp_f32 v76, v76
  v_rcp_f32 v77, v77
  v_rcp_f32 v78, v78
  v_rcp_f32 v79, v79
  v_mul_f32 v76, v76, v220
  v_mul_f32 v77, v77, v221
  v_mul_f32 v78, v78, v222
  v_mul_f32 v79, v79, v223
  v_cvt_pk_bf16_f32 v204, v76, v77
  v_cvt_pk_bf16_f32 v205, v78, v79
  v_fma_f32 v172, v28, v86, v172
  v_fma_f32 v173, v29, v86, v173
  v_fma_f32 v174, v30, v86, v174
  v_fma_f32 v175, v31, v86, v175
  v_fma_f32 v188, v32, v86, v188
  v_fma_f32 v189, v33, v86, v189
  v_fma_f32 v190, v34, v86, v190
  v_fma_f32 v191, v35, v86, v191
  v_mul_f32 v72, v172, v11
  v_mul_f32 v73, v173, v11
  v_mul_f32 v74, v174, v11
  v_mul_f32 v75, v175, v11
  v_exp_f32 v72, v72
  v_exp_f32 v73, v73
  v_exp_f32 v74, v74
  v_exp_f32 v75, v75
  v_fma_f32 v72, v72, v87, v87
  v_fma_f32 v73, v73, v87, v87
  v_fma_f32 v74, v74, v87, v87
  v_fma_f32 v75, v75, v87, v87
  v_rcp_f32 v72, v72
  v_rcp_f32 v73, v73
  v_rcp_f32 v74, v74
  v_rcp_f32 v75, v75
  v_mul_f32 v72, v72, v188
  v_mul_f32 v73, v73, v189
  v_mul_f32 v74, v74, v190
  v_mul_f32 v75, v75, v191
  v_cvt_pk_bf16_f32 v172, v72, v73
  v_cvt_pk_bf16_f32 v173, v74, v75
  v_mov_b32 v174, v204
  v_mov_b32 v175, v205
  buffer_store_dwordx4 v[172:175], v9, s[64:67], s51 offen offset:3072 sc1
  s_waitcnt lgkmcnt(4)
  v_fma_f32 v104, v12, v84, v104
  v_fma_f32 v105, v13, v84, v105
  v_fma_f32 v106, v14, v84, v106
  v_fma_f32 v107, v15, v84, v107
  v_mul_f32 v104, v104, v4
  v_mul_f32 v105, v105, v4
  v_mul_f32 v106, v106, v4
  v_mul_f32 v107, v107, v4
  v_cvt_pk_bf16_f32 v104, v104, v105
  v_cvt_pk_bf16_f32 v105, v106, v107
  v_fma_f32 v120, v16, v84, v120
  v_fma_f32 v121, v17, v84, v121
  v_fma_f32 v122, v18, v84, v122
  v_fma_f32 v123, v19, v84, v123
  v_mul_f32 v120, v120, v4
  v_mul_f32 v121, v121, v4
  v_mul_f32 v122, v122, v4
  v_mul_f32 v123, v123, v4
  v_cvt_pk_bf16_f32 v106, v120, v121
  v_cvt_pk_bf16_f32 v107, v122, v123
  v_fma_f32 v108, v12, v86, v108
  v_fma_f32 v109, v13, v86, v109
  v_fma_f32 v110, v14, v86, v110
  v_fma_f32 v111, v15, v86, v111
  v_mul_f32 v108, v108, v5
  v_mul_f32 v109, v109, v5
  v_mul_f32 v110, v110, v5
  v_mul_f32 v111, v111, v5
  v_cvt_pk_bf16_f32 v108, v108, v109
  v_cvt_pk_bf16_f32 v109, v110, v111
  v_fma_f32 v124, v16, v86, v124
  v_fma_f32 v125, v17, v86, v125
  v_fma_f32 v126, v18, v86, v126
  v_fma_f32 v127, v19, v86, v127
  v_mul_f32 v124, v124, v5
  v_mul_f32 v125, v125, v5
  v_mul_f32 v126, v126, v5
  v_mul_f32 v127, v127, v5
  v_cvt_pk_bf16_f32 v110, v124, v125
  v_cvt_pk_bf16_f32 v111, v126, v127
  v_fma_f32 v96, v12, v80, v96
  v_fma_f32 v97, v13, v80, v97
  v_fma_f32 v98, v14, v80, v98
  v_fma_f32 v99, v15, v80, v99
  v_mul_f32 v96, v96, v2
  v_mul_f32 v97, v97, v2
  v_mul_f32 v98, v98, v2
  v_mul_f32 v99, v99, v2
  v_cvt_pk_bf16_f32 v96, v96, v97
  v_cvt_pk_bf16_f32 v97, v98, v99
  v_fma_f32 v112, v16, v80, v112
  v_fma_f32 v113, v17, v80, v113
  v_fma_f32 v114, v18, v80, v114
  v_fma_f32 v115, v19, v80, v115
  v_mul_f32 v112, v112, v2
  v_mul_f32 v113, v113, v2
  v_mul_f32 v114, v114, v2
  v_mul_f32 v115, v115, v2
  v_cvt_pk_bf16_f32 v98, v112, v113
  v_cvt_pk_bf16_f32 v99, v114, v115
  v_fma_f32 v100, v12, v82, v100
  v_fma_f32 v101, v13, v82, v101
  v_fma_f32 v102, v14, v82, v102
  v_fma_f32 v103, v15, v82, v103
  v_mul_f32 v100, v100, v3
  v_mul_f32 v101, v101, v3
  v_mul_f32 v102, v102, v3
  v_mul_f32 v103, v103, v3
  v_cvt_pk_bf16_f32 v100, v100, v101
  v_cvt_pk_bf16_f32 v101, v102, v103
  v_fma_f32 v116, v16, v82, v116
  v_fma_f32 v117, v17, v82, v117
  v_fma_f32 v118, v18, v82, v118
  v_fma_f32 v119, v19, v82, v119
  v_mul_f32 v116, v116, v3
  v_mul_f32 v117, v117, v3
  v_mul_f32 v118, v118, v3
  v_mul_f32 v119, v119, v3
  v_cvt_pk_bf16_f32 v102, v116, v117
  v_cvt_pk_bf16_f32 v103, v118, v119
  ds_write_b128 v53, v[104:107]
  ds_write_b128 v53, v[108:111] offset:1024
  ds_write_b128 v53, v[100:103] offset:4096
  ds_read_b128 v[112:115], v55 offset:256
  ds_read_b128 v[116:119], v55 offset:272
  ds_read_b128 v[120:123], v55 offset:384
  ds_read_b128 v[124:127], v55 offset:400
  s_waitcnt lgkmcnt(2)
  v_fma_f32 v136, v20, v112, v136
  v_fma_f32 v137, v20, v114, v137
  v_fma_f32 v138, v20, v116, v138
  v_fma_f32 v139, v20, v118, v139
  v_mul_f32 v136, v136, v113
  v_mul_f32 v137, v137, v115
  v_mul_f32 v138, v138, v117
  v_mul_f32 v139, v139, v119
  v_cvt_pk_bf16_f32 v136, v136, v137
  v_cvt_pk_bf16_f32 v137, v138, v139
  v_fma_f32 v152, v21, v112, v152
  v_fma_f32 v153, v21, v114, v153
  v_fma_f32 v154, v21, v116, v154
  v_fma_f32 v155, v21, v118, v155
  v_mul_f32 v152, v152, v113
  v_mul_f32 v153, v153, v115
  v_mul_f32 v154, v154, v117
  v_mul_f32 v155, v155, v119
  v_cvt_pk_bf16_f32 v152, v152, v153
  v_cvt_pk_bf16_f32 v153, v154, v155
  s_waitcnt lgkmcnt(0)
  v_fma_f32 v140, v20, v120, v140
  v_fma_f32 v141, v20, v122, v141
  v_fma_f32 v142, v20, v124, v142
  v_fma_f32 v143, v20, v126, v143
  v_mul_f32 v140, v140, v121
  v_mul_f32 v141, v141, v123
  v_mul_f32 v142, v142, v125
  v_mul_f32 v143, v143, v127
  v_cvt_pk_bf16_f32 v138, v140, v141
  v_cvt_pk_bf16_f32 v139, v142, v143
  v_fma_f32 v156, v21, v120, v156
  v_fma_f32 v157, v21, v122, v157
  v_fma_f32 v158, v21, v124, v158
  v_fma_f32 v159, v21, v126, v159
  v_mul_f32 v156, v156, v121
  v_mul_f32 v157, v157, v123
  v_mul_f32 v158, v158, v125
  v_mul_f32 v159, v159, v127
  v_cvt_pk_bf16_f32 v154, v156, v157
  v_cvt_pk_bf16_f32 v155, v158, v159
  s_nop 0
  ds_write_b128 v53, v[136:139] offset:2048
  ds_write_b128 v53, v[152:155] offset:3072
  ds_read_b128 v[112:115], v55 offset:0
  ds_read_b128 v[116:119], v55 offset:16
  ds_read_b128 v[120:123], v55 offset:128
  ds_read_b128 v[124:127], v55 offset:144
  s_waitcnt lgkmcnt(2)
  v_fma_f32 v128, v20, v112, v128
  v_fma_f32 v129, v20, v114, v129
  v_fma_f32 v130, v20, v116, v130
  v_fma_f32 v131, v20, v118, v131
  v_mul_f32 v128, v128, v113
  v_mul_f32 v129, v129, v115
  v_mul_f32 v130, v130, v117
  v_mul_f32 v131, v131, v119
  v_cvt_pk_bf16_f32 v128, v128, v129
  v_cvt_pk_bf16_f32 v129, v130, v131
  v_fma_f32 v144, v21, v112, v144
  v_fma_f32 v145, v21, v114, v145
  v_fma_f32 v146, v21, v116, v146
  v_fma_f32 v147, v21, v118, v147
  v_mul_f32 v144, v144, v113
  v_mul_f32 v145, v145, v115
  v_mul_f32 v146, v146, v117
  v_mul_f32 v147, v147, v119
  v_cvt_pk_bf16_f32 v144, v144, v145
  v_cvt_pk_bf16_f32 v145, v146, v147
  s_waitcnt lgkmcnt(0)
  v_fma_f32 v132, v20, v120, v132
  v_fma_f32 v133, v20, v122, v133
  v_fma_f32 v134, v20, v124, v134
  v_fma_f32 v135, v20, v126, v135
  v_mul_f32 v132, v132, v121
  v_mul_f32 v133, v133, v123
  v_mul_f32 v134, v134, v125
  v_mul_f32 v135, v135, v127
  v_cvt_pk_bf16_f32 v130, v132, v133
  v_cvt_pk_bf16_f32 v131, v134, v135
  v_fma_f32 v148, v21, v120, v148
  v_fma_f32 v149, v21, v122, v149
  v_fma_f32 v150, v21, v124, v150
  v_fma_f32 v151, v21, v126, v151
  v_mul_f32 v148, v148, v121
  v_mul_f32 v149, v149, v123
  v_mul_f32 v150, v150, v125
  v_mul_f32 v151, v151, v127
  v_cvt_pk_bf16_f32 v146, v148, v149
  v_cvt_pk_bf16_f32 v147, v150, v151
  s_nop 0
  ds_write_b128 v53, v[128:131] offset:5120
  ds_write_b128 v53, v[144:147] offset:6144
  s_waitcnt lgkmcnt(0)
  s_barrier
  s_lshl_b32 s53, s7, 11
  s_lshl_b32 s55, s3, 7
  s_add_u32 s53, s53, s55
  s_lshl_b32 s55, s6, 2
  s_add_u32 s53, s53, s55
  s_add_u32 s53, s53, 50331648
  v_mov_b32 v58, 1
  v_mov_b32 v59, 0
  s_waitcnt vmcnt(0)
  s_mov_b64 exec, 1
  buffer_store_dword v58, v59, s[64:67], s53 offen sc1
  s_mov_b64 exec, -1
  s_lshr_b32 s52, s6, 1
  s_add_u32 s52, s52, 96
  s_lshl_b32 s52, s52, 17
  s_add_u32 s52, s52, s50
  s_and_b32 s53, s6, 1
  s_lshl_b32 s53, s53, 3
  s_add_u32 s52, s52, s53
  v_fma_f32 v224, v44, v80, v224
  v_fma_f32 v225, v45, v80, v225
  v_fma_f32 v226, v46, v80, v226
  v_fma_f32 v227, v47, v80, v227
  v_fma_f32 v240, v48, v80, v240
  v_fma_f32 v241, v49, v80, v241
  v_fma_f32 v242, v50, v80, v242
  v_fma_f32 v243, v51, v80, v243
  v_mul_f32 v72, v224, v0
  v_mul_f32 v73, v225, v0
  v_mul_f32 v74, v226, v0
  v_mul_f32 v75, v227, v0
  v_exp_f32 v72, v72
  v_exp_f32 v73, v73
  v_exp_f32 v74, v74
  v_exp_f32 v75, v75
  v_fma_f32 v72, v72, v81, v81
  v_fma_f32 v73, v73, v81, v81
  v_fma_f32 v74, v74, v81, v81
  v_fma_f32 v75, v75, v81, v81
  v_rcp_f32 v72, v72
  v_rcp_f32 v73, v73
  v_rcp_f32 v74, v74
  v_rcp_f32 v75, v75
  v_mul_f32 v72, v72, v240
  v_mul_f32 v73, v73, v241
  v_mul_f32 v74, v74, v242
  v_mul_f32 v75, v75, v243
  v_cvt_pk_bf16_f32 v224, v72, v73
  v_cvt_pk_bf16_f32 v225, v74, v75
  buffer_store_dwordx2 v[224:225], v9, s[64:67], s52 offen offset:0 sc1
  v_fma_f32 v228, v44, v82, v228
  v_fma_f32 v229, v45, v82, v229
  v_fma_f32 v230, v46, v82, v230
  v_fma_f32 v231, v47, v82, v231
  v_fma_f32 v244, v48, v82, v244
  v_fma_f32 v245, v49, v82, v245
  v_fma_f32 v246, v50, v82, v246
  v_fma_f32 v247, v51, v82, v247
  v_mul_f32 v76, v228, v1
  v_mul_f32 v77, v229, v1
  v_mul_f32 v78, v230, v1
  v_mul_f32 v79, v231, v1
  v_exp_f32 v76, v76
  v_exp_f32 v77, v77
  v_exp_f32 v78, v78
  v_exp_f32 v79, v79
  v_fma_f32 v76, v76, v83, v83
  v_fma_f32 v77, v77, v83, v83
  v_fma_f32 v78, v78, v83, v83
  v_fma_f32 v79, v79, v83, v83
  v_rcp_f32 v76, v76
  v_rcp_f32 v77, v77
  v_rcp_f32 v78, v78
  v_rcp_f32 v79, v79
  v_mul_f32 v76, v76, v244
  v_mul_f32 v77, v77, v245
  v_mul_f32 v78, v78, v246
  v_mul_f32 v79, v79, v247
  v_cvt_pk_bf16_f32 v228, v76, v77
  v_cvt_pk_bf16_f32 v229, v78, v79
  buffer_store_dwordx2 v[228:229], v9, s[64:67], s52 offen offset:1024 sc1
  v_fma_f32 v232, v44, v84, v232
  v_fma_f32 v233, v45, v84, v233
  v_fma_f32 v234, v46, v84, v234
  v_fma_f32 v235, v47, v84, v235
  v_fma_f32 v248, v48, v84, v248
  v_fma_f32 v249, v49, v84, v249
  v_fma_f32 v250, v50, v84, v250
  v_fma_f32 v251, v51, v84, v251
  v_mul_f32 v72, v232, v10
  v_mul_f32 v73, v233, v10
  v_mul_f32 v74, v234, v10
  v_mul_f32 v75, v235, v10
  v_exp_f32 v72, v72
  v_exp_f32 v73, v73
  v_exp_f32 v74, v74
  v_exp_f32 v75, v75
  v_fma_f32 v72, v72, v85, v85
  v_fma_f32 v73, v73, v85, v85
  v_fma_f32 v74, v74, v85, v85
  v_fma_f32 v75, v75, v85, v85
  v_rcp_f32 v72, v72
  v_rcp_f32 v73, v73
  v_rcp_f32 v74, v74
  v_rcp_f32 v75, v75
  v_mul_f32 v72, v72, v248
  v_mul_f32 v73, v73, v249
  v_mul_f32 v74, v74, v250
  v_mul_f32 v75, v75, v251
  v_cvt_pk_bf16_f32 v232, v72, v73
  v_cvt_pk_bf16_f32 v233, v74, v75
  buffer_store_dwordx2 v[232:233], v9, s[64:67], s52 offen offset:2048 sc1
  v_fma_f32 v236, v44, v86, v236
  v_fma_f32 v237, v45, v86, v237
  v_fma_f32 v238, v46, v86, v238
  v_fma_f32 v239, v47, v86, v239
  v_fma_f32 v252, v48, v86, v252
  v_fma_f32 v253, v49, v86, v253
  v_fma_f32 v254, v50, v86, v254
  v_fma_f32 v255, v51, v86, v255
  v_mul_f32 v76, v236, v11
  v_mul_f32 v77, v237, v11
  v_mul_f32 v78, v238, v11
  v_mul_f32 v79, v239, v11
  v_exp_f32 v76, v76
  v_exp_f32 v77, v77
  v_exp_f32 v78, v78
  v_exp_f32 v79, v79
  v_fma_f32 v76, v76, v87, v87
  v_fma_f32 v77, v77, v87, v87
  v_fma_f32 v78, v78, v87, v87
  v_fma_f32 v79, v79, v87, v87
  v_rcp_f32 v76, v76
  v_rcp_f32 v77, v77
  v_rcp_f32 v78, v78
  v_rcp_f32 v79, v79
  v_mul_f32 v76, v76, v252
  v_mul_f32 v77, v77, v253
  v_mul_f32 v78, v78, v254
  v_mul_f32 v79, v79, v255
  v_cvt_pk_bf16_f32 v236, v76, v77
  v_cvt_pk_bf16_f32 v237, v78, v79
  buffer_store_dwordx2 v[236:237], v9, s[64:67], s52 offen offset:3072 sc1
  v_mov_b32 v20, v128
  v_mov_b32 v21, v129
  v_mov_b32 v22, v130
  v_mov_b32 v23, v131
  v_mov_b32 v24, v144
  v_mov_b32 v25, v145
  v_mov_b32 v26, v146
  v_mov_b32 v27, v147
  ds_read_b64_tr_b16 v[88:89], v56 offset:0
  ds_read_b64_tr_b16 v[90:91], v56 offset:1024
  ds_read_b64_tr_b16 v[92:93], v56 offset:32
  ds_read_b64_tr_b16 v[94:95], v56 offset:1056
  s_waitcnt lgkmcnt(0)
  v_lshrrev_b32 v232, 4, v9
  v_lshrrev_b32 v233, 4, v232
  v_and_b32 v232, 15, v232
  v_lshrrev_b32 v234, 2, v232
  v_and_b32 v235, 3, v232
  v_cmp_eq_u32 vcc, v234, v233
  v_and_b32 v236, 1, v235
  v_lshlrev_b32 v236, 4, v236
  v_mov_b32 v237, 0x3f80
  v_lshlrev_b32 v237, v236, v237
  v_cndmask_b32 v237, 0, v237, vcc
  v_cmp_gt_u32 vcc, 2, v235
  v_mov_b32 v204, 0
  v_mov_b32 v205, 0
  v_cndmask_b32 v206, 0, v237, vcc
  v_cndmask_b32 v207, v237, 0, vcc
  v_mov_b32 v208, 0
  v_mov_b32 v209, 0
  v_mov_b32 v212, s78
  v_mov_b32 v213, s78
  v_mov_b32 v214, s78
  v_mov_b32 v215, s78
  v_mfma_f32_16x16x32_bf16 v[224:227], v[88:91], v[96:99], 0
  v_mfma_f32_16x16x32_bf16 v[228:231], v[92:95], v[96:99], 0
  s_nop 7
  v_max3_f32 v232, v224, v225, v226
  v_min3_f32 v233, v224, v225, v226
  v_max3_f32 v232, v232, v227, v228
  v_min3_f32 v233, v233, v227, v228
  v_max3_f32 v232, v232, v229, v230
  v_min3_f32 v233, v233, v229, v230
  v_max_f32 v232, v232, v231
  v_min_f32 v233, v233, v231
  v_mov_b32 v234, v232
  v_mov_b32 v235, v233
  s_nop 1
  v_permlane16_swap_b32 v232, v234
  v_permlane16_swap_b32 v233, v235
  v_max_f32 v232, v232, v234
  v_min_f32 v233, v233, v235
  v_mov_b32 v234, v232
  v_mov_b32 v235, v233
  s_nop 1
  v_permlane32_swap_b32 v232, v234
  v_permlane32_swap_b32 v233, v235
  v_max_f32 v232, v232, v234
  v_min_f32 v233, v233, v235
  v_mul_f32 v232, s72, v232
  v_mul_f32 v233, s73, v233
  v_fma_f32 v236, v224, s73, v232
  v_fma_f32 v244, v224, s72, v233
  v_fma_f32 v237, v225, s73, v232
  v_fma_f32 v245, v225, s72, v233
  v_fma_f32 v238, v226, s73, v232
  v_fma_f32 v246, v226, s72, v233
  v_fma_f32 v239, v227, s73, v232
  v_fma_f32 v247, v227, s72, v233
  v_fma_f32 v240, v228, s73, v232
  v_fma_f32 v248, v228, s72, v233
  v_fma_f32 v241, v229, s73, v232
  v_fma_f32 v249, v229, s72, v233
  v_fma_f32 v242, v230, s73, v232
  v_fma_f32 v250, v230, s72, v233
  v_fma_f32 v243, v231, s73, v232
  v_fma_f32 v251, v231, s72, v233
  v_exp_f32 v236, v236
  v_exp_f32 v244, v244
  v_exp_f32 v237, v237
  v_exp_f32 v245, v245
  v_exp_f32 v238, v238
  v_exp_f32 v246, v246
  v_exp_f32 v239, v239
  v_exp_f32 v247, v247
  v_exp_f32 v240, v240
  v_exp_f32 v248, v248
  v_exp_f32 v241, v241
  v_exp_f32 v249, v249
  v_exp_f32 v242, v242
  v_exp_f32 v250, v250
  v_exp_f32 v243, v243
  v_exp_f32 v251, v251
  v_add_f32 v252, v236, v237
  v_add_f32 v253, v244, v245
  v_add_f32 v252, v252, v238
  v_add_f32 v253, v253, v246
  v_add_f32 v252, v252, v239
  v_add_f32 v253, v253, v247
  v_add_f32 v252, v252, v240
  v_add_f32 v253, v253, v248
  v_add_f32 v252, v252, v241
  v_add_f32 v253, v253, v249
  v_add_f32 v252, v252, v242
  v_add_f32 v253, v253, v250
  v_add_f32 v252, v252, v243
  v_add_f32 v253, v253, v251
  v_mov_b32 v234, v252
  v_mov_b32 v235, v253
  s_nop 1
  v_permlane16_swap_b32 v252, v234
  v_permlane16_swap_b32 v253, v235
  v_add_f32 v252, v252, v234
  v_add_f32 v253, v253, v235
  v_mov_b32 v234, v252
  v_mov_b32 v235, v253
  s_nop 1
  v_permlane32_swap_b32 v252, v234
  v_permlane32_swap_b32 v253, v235
  v_add_f32 v252, v252, v234
  v_add_f32 v253, v253, v235
  v_rcp_f32 v252, v252
  v_rcp_f32 v253, v253
  s_nop 0
  v_mul_f32 v236, v236, v252
  v_mul_f32 v244, v244, v253
  v_mul_f32 v237, v237, v252
  v_mul_f32 v245, v245, v253
  v_mul_f32 v238, v238, v252
  v_mul_f32 v246, v246, v253
  v_mul_f32 v239, v239, v252
  v_mul_f32 v247, v247, v253
  v_mul_f32 v240, v240, v252
  v_mul_f32 v248, v248, v253
  v_mul_f32 v241, v241, v252
  v_mul_f32 v249, v249, v253
  v_mul_f32 v242, v242, v252
  v_mul_f32 v250, v250, v253
  v_mul_f32 v243, v243, v252
  v_mul_f32 v251, v251, v253
  v_cvt_pk_bf16_f32 v216, v236, v237
  v_cvt_pk_bf16_f32 v220, v244, v245
  v_cvt_pk_bf16_f32 v217, v238, v239
  v_cvt_pk_bf16_f32 v221, v246, v247
  v_cvt_pk_bf16_f32 v218, v240, v241
  v_cvt_pk_bf16_f32 v222, v248, v249
  v_cvt_pk_bf16_f32 v219, v242, v243
  v_cvt_pk_bf16_f32 v223, v250, v251
  s_nop 1
  v_mfma_f32_16x16x32_bf16 v[172:175], v[216:219], v[206:209], 0
  v_mfma_f32_16x16x32_bf16 v[176:179], v[216:219], v[204:207], 0
  v_mfma_f32_16x16x32_bf16 v[180:183], v[220:223], v[206:209], 0
  v_mfma_f32_16x16x32_bf16 v[184:187], v[220:223], v[204:207], 0
  v_mov_b32 v226, 0
  v_mov_b32 v227, 0
  v_mov_b32 v230, 0
  v_mov_b32 v231, 0
  v_mov_b32 v234, 0
  v_mov_b32 v235, 0
  v_mov_b32 v238, 0
  v_mov_b32 v239, 0
  v_cvt_pk_bf16_f32 v224, v172, v173
  v_cvt_pk_bf16_f32 v225, v174, v175
  v_cvt_pk_bf16_f32 v228, v176, v177
  v_cvt_pk_bf16_f32 v229, v178, v179
  v_cvt_pk_bf16_f32 v232, v180, v181
  v_cvt_pk_bf16_f32 v233, v182, v183
  v_cvt_pk_bf16_f32 v236, v184, v185
  v_cvt_pk_bf16_f32 v237, v186, v187
  s_nop 1
  v_mfma_f32_16x16x32_bf16 v[124:127], v[224:227], v[20:23], 0
  v_mfma_f32_16x16x32_bf16 v[128:131], v[224:227], v[24:27], 0
  v_mfma_f32_16x16x32_bf16 v[132:135], v[224:227], v[212:215], 0
  v_mfma_f32_16x16x32_bf16 v[136:139], v[228:231], v[20:23], 0
  v_mfma_f32_16x16x32_bf16 v[140:143], v[228:231], v[24:27], 0
  v_mfma_f32_16x16x32_bf16 v[144:147], v[228:231], v[212:215], 0
  v_mfma_f32_16x16x32_bf16 v[148:151], v[232:235], v[20:23], 0
  v_mfma_f32_16x16x32_bf16 v[152:155], v[232:235], v[24:27], 0
  v_mfma_f32_16x16x32_bf16 v[156:159], v[232:235], v[212:215], 0
  v_mfma_f32_16x16x32_bf16 v[160:163], v[236:239], v[20:23], 0
  v_mfma_f32_16x16x32_bf16 v[164:167], v[236:239], v[24:27], 0
  v_mfma_f32_16x16x32_bf16 v[168:171], v[236:239], v[212:215], 0
  s_nop 7
  s_mul_i32 s51, s3, 12288
  v_add_u32 v20, s51, v9
  ds_write_b128 v20, v[124:127] offset:0
  ds_write_b128 v20, v[128:131] offset:1024
  ds_write_b128 v20, v[132:135] offset:2048
  ds_write_b128 v20, v[136:139] offset:3072
  ds_write_b128 v20, v[140:143] offset:4096
  ds_write_b128 v20, v[144:147] offset:5120
  ds_write_b128 v20, v[148:151] offset:6144
  ds_write_b128 v20, v[152:155] offset:7168
  ds_write_b128 v20, v[156:159] offset:8192
  ds_write_b128 v20, v[160:163] offset:9216
  ds_write_b128 v20, v[164:167] offset:10240
  ds_write_b128 v20, v[168:171] offset:11264
  s_waitcnt lgkmcnt(0)
  s_barrier
  s_lshr_b32 s50, s3, 1
  s_mul_i32 s50, s50, 3
  s_and_b32 s51, s3, 1
  s_add_u32 s50, s50, s51
  s_lshl_b32 s50, s50, 10
  v_add_u32 v20, s50, v9
  v_add_u32 v22, 49152, v20
  ds_read_b128 v[124:127], v20 offset:0
  ds_read_b128 v[128:131], v20 offset:12288
  ds_read_b128 v[132:135], v20 offset:24576
  ds_read_b128 v[136:139], v20 offset:36864
  ds_read_b128 v[140:143], v22 offset:0
  ds_read_b128 v[144:147], v22 offset:12288
  ds_read_b128 v[148:151], v22 offset:24576
  ds_read_b128 v[152:155], v22 offset:36864
  s_lshl_b32 s50, s6, 3
  s_add_u32 s50, s50, s7
  s_mul_i32 s50, s50, 8448
  s_add_u32 s50, s50, 29360128
  s_lshl_b32 s51, s3, 10
  s_add_u32 s51, s51, s50
  s_waitcnt lgkmcnt(0)
  v_add_f32 v124, v124, v140
  v_add_f32 v125, v125, v141
  v_add_f32 v126, v126, v142
  v_add_f32 v127, v127, v143
  v_add_f32 v128, v128, v144
  v_add_f32 v129, v129, v145
  v_add_f32 v130, v130, v146
  v_add_f32 v131, v131, v147
  v_add_f32 v132, v132, v148
  v_add_f32 v133, v133, v149
  v_add_f32 v134, v134, v150
  v_add_f32 v135, v135, v151
  v_add_f32 v136, v136, v152
  v_add_f32 v137, v137, v153
  v_add_f32 v138, v138, v154
  v_add_f32 v139, v139, v155
  v_add_f32 v124, v124, v132
  v_add_f32 v125, v125, v133
  v_add_f32 v126, v126, v134
  v_add_f32 v127, v127, v135
  v_add_f32 v128, v128, v136
  v_add_f32 v129, v129, v137
  v_add_f32 v130, v130, v138
  v_add_f32 v131, v131, v139
  v_add_f32 v124, v124, v128
  v_add_f32 v125, v125, v129
  v_add_f32 v126, v126, v130
  v_add_f32 v127, v127, v131
  buffer_store_dwordx4 v[124:127], v9, s[64:67], s51 offen sc1
  s_branch L_p2_cons
L_p2_cons:
  v_mov_b32 v4, v9
  v_lshrrev_b32 v3, 4, v4
  v_lshrrev_b32 v5, 4, v3
  v_and_b32 v6, 15, v3
  v_lshlrev_b32 v12, 2, v3
  v_mov_b32 v13, 0
  v_mov_b32 v14, 1
  s_and_b32 s50, s2, 7
  s_lshr_b32 s51, s2, 3
  s_and_b32 s20, s50, 1
  s_lshr_b32 s21, s50, 1
  s_lshl_b32 s21, s21, 2
  s_and_b32 s50, s51, 3
  s_add_u32 s21, s21, s50
  s_lshr_b32 s22, s51, 2
  s_lshl_b32 s23, s21, 3
  s_add_u32 s23, s23, s22
  s_cmp_eq_u32 s20, 1
  s_cselect_b32 s60, 34, 38
  s_barrier
  s_mov_b32 s16, s48
  s_and_b32 s17, s49, 0xffff
  s_mov_b32 s18, 4194304
  s_mov_b32 s19, 0x00020000
  v_mov_b32 v158, v12
  s_and_b32 s26, s4, 1
  s_lshr_b32 s27, s4, 1
  s_lshl_b32 s50, s26, 12
  v_add_u32 v1, s50, v4
  v_and_b32 v7, 1, v5
  v_lshrrev_b32 v8, 2, v6
  v_lshl_add_u32 v7, v7, 2, v8
  v_mul_u32_u24 v7, 1056, v7
  v_lshrrev_b32 v8, 1, v5
  v_lshl_add_u32 v7, v8, 8, v7
  v_and_b32 v8, 3, v6
  v_lshl_add_u32 v7, v8, 3, v7
  s_lshl_b32 s50, s27, 7
  s_add_u32 s50, s50, 8192
  v_add_u32 v2, s50, v7
  s_lshl_b32 s50, s21, 7
  s_lshl_b32 s55, s26, 6
  s_add_u32 s50, s50, s55
  s_add_u32 s50, s50, 0
  v_add_u32 v7, s50, v6
  v_lshlrev_b32 v7, 11, v7
  s_lshl_b32 s50, s22, 8
  s_lshl_b32 s55, s27, 7
  s_add_u32 s50, s50, s55
  s_add_u32 s50, s50, 0
  v_add_u32 v7, s50, v7
  s_mov_b32 s61, 32768
  s_mov_b32 s62, 65536
  s_mov_b32 s63, 98304
  v_mov_b32 v72, 0
  v_mov_b32 v73, 0
  v_mov_b32 v74, 0
  v_mov_b32 v75, 0
  v_mov_b32 v76, 0
  v_mov_b32 v77, 0
  v_mov_b32 v78, 0
  v_mov_b32 v79, 0
  v_mov_b32 v80, 0
  v_mov_b32 v81, 0
  v_mov_b32 v82, 0
  v_mov_b32 v83, 0
  v_mov_b32 v84, 0
  v_mov_b32 v85, 0
  v_mov_b32 v86, 0
  v_mov_b32 v87, 0
  v_mov_b32 v88, 0
  v_mov_b32 v89, 0
  v_mov_b32 v90, 0
  v_mov_b32 v91, 0
  v_mov_b32 v92, 0
  v_mov_b32 v93, 0
  v_mov_b32 v94, 0
  v_mov_b32 v95, 0
  v_mov_b32 v96, 0
  v_mov_b32 v97, 0
  v_mov_b32 v98, 0
  v_mov_b32 v99, 0
  v_mov_b32 v100, 0
  v_mov_b32 v101, 0
  v_mov_b32 v102, 0
  v_mov_b32 v103, 0
  v_mov_b32 v104, 0
  v_mov_b32 v105, 0
  v_mov_b32 v106, 0
  v_mov_b32 v107, 0
  v_mov_b32 v108, 0
  v_mov_b32 v109, 0
  v_mov_b32 v110, 0
  v_mov_b32 v111, 0
  v_mov_b32 v112, 0
  v_mov_b32 v113, 0
  v_mov_b32 v114, 0
  v_mov_b32 v115, 0
  v_mov_b32 v116, 0
  v_mov_b32 v117, 0
  v_mov_b32 v118, 0
  v_mov_b32 v119, 0
  v_mov_b32 v120, 0
  v_mov_b32 v121, 0
  v_mov_b32 v122, 0
  v_mov_b32 v123, 0
  v_mov_b32 v124, 0
  v_mov_b32 v125, 0
  v_mov_b32 v126, 0
  v_mov_b32 v127, 0
  v_mov_b32 v128, 0
  v_mov_b32 v129, 0
  v_mov_b32 v130, 0
  v_mov_b32 v131, 0
  v_mov_b32 v132, 0
  v_mov_b32 v133, 0
  v_mov_b32 v134, 0
  v_mov_b32 v135, 0
  s_mov_b32 s24, 0
  s_lshl_b32 s50, s7, 11
  s_lshl_b32 s55, s3, 7
  s_add_u32 s50, s50, s55
  s_lshl_b32 s55, s6, 2
  s_add_u32 s50, s50, s55
  s_add_u32 s50, s50, 50332672
  s_lshl_b32 s51, s6, 8
  s_lshl_b32 s55, s7, 5
  s_add_u32 s51, s51, s55
  s_lshl_b32 s55, s3, 2
  s_add_u32 s51, s51, s55
  s_add_u32 s51, s51, 50348032
  s_waitcnt vmcnt(0)
  s_mov_b64 exec, 1
  buffer_store_dword v14, v13, s[64:67], s50 offen sc1
  buffer_store_dword v14, v13, s[64:67], s51 offen sc1
  s_mov_b64 exec, -1
  s_lshl_b32 s56, s6, 8
  s_add_u32 s56, s56, 50348032
  v_lshlrev_b32 v156, 4, v5
  s_mul_i32 s50, s6, 67584
  s_add_u32 s50, s50, 29360128
  s_lshl_b32 s33, s4, 11
  s_add_u32 s33, s33, s50
  s_lshl_b32 s34, s4, 6
  s_add_u32 s34, s34, s50
  s_add_u32 s34, s34, 8192
  s_barrier
  ds_read_b128 v[8:11], v1 offset:0
  ds_read_b64_tr_b16 v[40:41], v2 offset:0
  ds_read_b64_tr_b16 v[42:43], v2 offset:512
  ds_read_b128 v[12:15], v1 offset:1024
  ds_read_b64_tr_b16 v[44:45], v2 offset:32
  ds_read_b64_tr_b16 v[46:47], v2 offset:544
  ds_read_b128 v[16:19], v1 offset:2048
  ds_read_b64_tr_b16 v[48:49], v2 offset:64
  ds_read_b64_tr_b16 v[50:51], v2 offset:576
  ds_read_b128 v[20:23], v1 offset:3072
  ds_read_b64_tr_b16 v[52:53], v2 offset:96
  ds_read_b64_tr_b16 v[54:55], v2 offset:608
  s_add_u32 s24, s24, 1
  s_cmp_eq_u32 s24, 9
  s_cselect_b32 s24, 0, s24
  s_mov_b32 s25, 16640
  s_cselect_b32 s25, 4294834176, s25
  v_add_u32 v1, s25, v1
  v_add_u32 v2, s25, v2
  s_waitcnt lgkmcnt(0)
  v_mfma_f32_16x16x32_bf16 v[72:75], v[40:43], v[8:11], v[72:75]
  ds_read_b128 v[24:27], v1 offset:0
  v_mfma_f32_16x16x32_bf16 v[76:79], v[40:43], v[12:15], v[76:79]
  ds_read_b64_tr_b16 v[56:57], v2 offset:0
  v_mfma_f32_16x16x32_bf16 v[80:83], v[40:43], v[16:19], v[80:83]
  ds_read_b64_tr_b16 v[58:59], v2 offset:512
  v_mfma_f32_16x16x32_bf16 v[84:87], v[40:43], v[20:23], v[84:87]
  ds_read_b128 v[28:31], v1 offset:1024
  v_mfma_f32_16x16x32_bf16 v[100:103], v[44:47], v[20:23], v[100:103]
  ds_read_b64_tr_b16 v[60:61], v2 offset:32
  v_mfma_f32_16x16x32_bf16 v[96:99], v[44:47], v[16:19], v[96:99]
  ds_read_b64_tr_b16 v[62:63], v2 offset:544
  v_mfma_f32_16x16x32_bf16 v[92:95], v[44:47], v[12:15], v[92:95]
  ds_read_b128 v[32:35], v1 offset:2048
  v_mfma_f32_16x16x32_bf16 v[88:91], v[44:47], v[8:11], v[88:91]
  ds_read_b64_tr_b16 v[64:65], v2 offset:64
  v_mfma_f32_16x16x32_bf16 v[104:107], v[48:51], v[8:11], v[104:107]
  ds_read_b64_tr_b16 v[66:67], v2 offset:576
  v_mfma_f32_16x16x32_bf16 v[108:111], v[48:51], v[12:15], v[108:111]
  ds_read_b128 v[36:39], v1 offset:3072
  v_mfma_f32_16x16x32_bf16 v[112:115], v[48:51], v[16:19], v[112:115]
  ds_read_b64_tr_b16 v[68:69], v2 offset:96
  v_mfma_f32_16x16x32_bf16 v[116:119], v[48:51], v[20:23], v[116:119]
  ds_read_b64_tr_b16 v[70:71], v2 offset:608
  v_mfma_f32_16x16x32_bf16 v[132:135], v[52:55], v[20:23], v[132:135]
  s_add_u32 s24, s24, 1
  s_cmp_eq_u32 s24, 9
  s_cselect_b32 s24, 0, s24
  s_mov_b32 s25, 16640
  s_cselect_b32 s25, 4294834176, s25
  v_mfma_f32_16x16x32_bf16 v[128:131], v[52:55], v[16:19], v[128:131]
  v_add_u32 v1, s25, v1
  v_add_u32 v2, s25, v2
  v_mfma_f32_16x16x32_bf16 v[124:127], v[52:55], v[12:15], v[124:127]
  v_mfma_f32_16x16x32_bf16 v[120:123], v[52:55], v[8:11], v[120:123]
  s_waitcnt lgkmcnt(0)
  v_mfma_f32_16x16x32_bf16 v[72:75], v[56:59], v[24:27], v[72:75]
  ds_read_b128 v[8:11], v1 offset:0
  v_mfma_f32_16x16x32_bf16 v[76:79], v[56:59], v[28:31], v[76:79]
  ds_read_b64_tr_b16 v[40:41], v2 offset:0
  v_mfma_f32_16x16x32_bf16 v[80:83], v[56:59], v[32:35], v[80:83]
  ds_read_b64_tr_b16 v[42:43], v2 offset:512
  v_mfma_f32_16x16x32_bf16 v[84:87], v[56:59], v[36:39], v[84:87]
  ds_read_b128 v[12:15], v1 offset:1024
  v_mfma_f32_16x16x32_bf16 v[100:103], v[60:63], v[36:39], v[100:103]
  ds_read_b64_tr_b16 v[44:45], v2 offset:32
  v_mfma_f32_16x16x32_bf16 v[96:99], v[60:63], v[32:35], v[96:99]
  ds_read_b64_tr_b16 v[46:47], v2 offset:544
  v_mfma_f32_16x16x32_bf16 v[92:95], v[60:63], v[28:31], v[92:95]
  ds_read_b128 v[16:19], v1 offset:2048
  v_mfma_f32_16x16x32_bf16 v[88:91], v[60:63], v[24:27], v[88:91]
  ds_read_b64_tr_b16 v[48:49], v2 offset:64
  v_mfma_f32_16x16x32_bf16 v[104:107], v[64:67], v[24:27], v[104:107]
  ds_read_b64_tr_b16 v[50:51], v2 offset:576
  v_mfma_f32_16x16x32_bf16 v[108:111], v[64:67], v[28:31], v[108:111]
  ds_read_b128 v[20:23], v1 offset:3072
  v_mfma_f32_16x16x32_bf16 v[112:115], v[64:67], v[32:35], v[112:115]
  ds_read_b64_tr_b16 v[52:53], v2 offset:96
  v_mfma_f32_16x16x32_bf16 v[116:119], v[64:67], v[36:39], v[116:119]
  ds_read_b64_tr_b16 v[54:55], v2 offset:608
  v_mfma_f32_16x16x32_bf16 v[132:135], v[68:71], v[36:39], v[132:135]
  s_add_u32 s24, s24, 1
  s_cmp_eq_u32 s24, 9
  s_cselect_b32 s24, 0, s24
  s_mov_b32 s25, 16640
  s_cselect_b32 s25, 4294834176, s25
  v_mfma_f32_16x16x32_bf16 v[128:131], v[68:71], v[32:35], v[128:131]
  v_add_u32 v1, s25, v1
  v_add_u32 v2, s25, v2
  v_mfma_f32_16x16x32_bf16 v[124:127], v[68:71], v[28:31], v[124:127]
  v_mfma_f32_16x16x32_bf16 v[120:123], v[68:71], v[24:27], v[120:123]
  buffer_load_dword v159, v158, s[64:67], s56 offen sc1
  s_barrier
  s_waitcnt lgkmcnt(0)
  v_mfma_f32_16x16x32_bf16 v[72:75], v[40:43], v[8:11], v[72:75]
  ds_read_b128 v[24:27], v1 offset:0
  v_mfma_f32_16x16x32_bf16 v[76:79], v[40:43], v[12:15], v[76:79]
  ds_read_b64_tr_b16 v[56:57], v2 offset:0
  v_mfma_f32_16x16x32_bf16 v[80:83], v[40:43], v[16:19], v[80:83]
  ds_read_b64_tr_b16 v[58:59], v2 offset:512
  v_mfma_f32_16x16x32_bf16 v[84:87], v[40:43], v[20:23], v[84:87]
  ds_read_b128 v[28:31], v1 offset:1024
  v_mfma_f32_16x16x32_bf16 v[100:103], v[44:47], v[20:23], v[100:103]
  ds_read_b64_tr_b16 v[60:61], v2 offset:32
  v_mfma_f32_16x16x32_bf16 v[96:99], v[44:47], v[16:19], v[96:99]
  ds_read_b64_tr_b16 v[62:63], v2 offset:544
  v_mfma_f32_16x16x32_bf16 v[92:95], v[44:47], v[12:15], v[92:95]
  ds_read_b128 v[32:35], v1 offset:2048
  v_mfma_f32_16x16x32_bf16 v[88:91], v[44:47], v[8:11], v[88:91]
  ds_read_b64_tr_b16 v[64:65], v2 offset:64
  v_mfma_f32_16x16x32_bf16 v[104:107], v[48:51], v[8:11], v[104:107]
  ds_read_b64_tr_b16 v[66:67], v2 offset:576
  v_mfma_f32_16x16x32_bf16 v[108:111], v[48:51], v[12:15], v[108:111]
  ds_read_b128 v[36:39], v1 offset:3072
  v_mfma_f32_16x16x32_bf16 v[112:115], v[48:51], v[16:19], v[112:115]
  ds_read_b64_tr_b16 v[68:69], v2 offset:96
  v_mfma_f32_16x16x32_bf16 v[116:119], v[48:51], v[20:23], v[116:119]
  ds_read_b64_tr_b16 v[70:71], v2 offset:608
  v_mfma_f32_16x16x32_bf16 v[132:135], v[52:55], v[20:23], v[132:135]
  s_add_u32 s24, s24, 1
  s_cmp_eq_u32 s24, 9
  s_cselect_b32 s24, 0, s24
  s_mov_b32 s25, 16640
  s_cselect_b32 s25, 4294834176, s25
  v_mfma_f32_16x16x32_bf16 v[128:131], v[52:55], v[16:19], v[128:131]
  v_add_u32 v1, s25, v1
  v_add_u32 v2, s25, v2
  v_mfma_f32_16x16x32_bf16 v[124:127], v[52:55], v[12:15], v[124:127]
  v_mfma_f32_16x16x32_bf16 v[120:123], v[52:55], v[8:11], v[120:123]
  s_waitcnt lgkmcnt(0)
  v_mfma_f32_16x16x32_bf16 v[72:75], v[56:59], v[24:27], v[72:75]
  ds_read_b128 v[8:11], v1 offset:0
  v_mfma_f32_16x16x32_bf16 v[76:79], v[56:59], v[28:31], v[76:79]
  ds_read_b64_tr_b16 v[40:41], v2 offset:0
  v_mfma_f32_16x16x32_bf16 v[80:83], v[56:59], v[32:35], v[80:83]
  ds_read_b64_tr_b16 v[42:43], v2 offset:512
  v_mfma_f32_16x16x32_bf16 v[84:87], v[56:59], v[36:39], v[84:87]
  ds_read_b128 v[12:15], v1 offset:1024
  v_mfma_f32_16x16x32_bf16 v[100:103], v[60:63], v[36:39], v[100:103]
  ds_read_b64_tr_b16 v[44:45], v2 offset:32
  v_mfma_f32_16x16x32_bf16 v[96:99], v[60:63], v[32:35], v[96:99]
  ds_read_b64_tr_b16 v[46:47], v2 offset:544
  v_mfma_f32_16x16x32_bf16 v[92:95], v[60:63], v[28:31], v[92:95]
  ds_read_b128 v[16:19], v1 offset:2048
  v_mfma_f32_16x16x32_bf16 v[88:91], v[60:63], v[24:27], v[88:91]
  ds_read_b64_tr_b16 v[48:49], v2 offset:64
  v_mfma_f32_16x16x32_bf16 v[104:107], v[64:67], v[24:27], v[104:107]
  ds_read_b64_tr_b16 v[50:51], v2 offset:576
  v_mfma_f32_16x16x32_bf16 v[108:111], v[64:67], v[28:31], v[108:111]
  ds_read_b128 v[20:23], v1 offset:3072
  v_mfma_f32_16x16x32_bf16 v[112:115], v[64:67], v[32:35], v[112:115]
  ds_read_b64_tr_b16 v[52:53], v2 offset:96
  v_mfma_f32_16x16x32_bf16 v[116:119], v[64:67], v[36:39], v[116:119]
  ds_read_b64_tr_b16 v[54:55], v2 offset:608
  v_mfma_f32_16x16x32_bf16 v[132:135], v[68:71], v[36:39], v[132:135]
  s_add_u32 s24, s24, 1
  s_cmp_eq_u32 s24, 9
  s_cselect_b32 s24, 0, s24
  s_mov_b32 s25, 16640
  s_cselect_b32 s25, 4294834176, s25
  v_mfma_f32_16x16x32_bf16 v[128:131], v[68:71], v[32:35], v[128:131]
  v_add_u32 v1, s25, v1
  v_add_u32 v2, s25, v2
  v_mfma_f32_16x16x32_bf16 v[124:127], v[68:71], v[28:31], v[124:127]
  v_mfma_f32_16x16x32_bf16 v[120:123], v[68:71], v[24:27], v[120:123]
L_p2_ck:
  s_waitcnt vmcnt(0)
  v_cmp_ne_u32 vcc, 1, v159
  s_nop 4
  s_cbranch_vccz L_p2_ck_ok
  s_sleep 1
  buffer_load_dword v159, v158, s[64:67], s56 offen sc1
  s_branch L_p2_ck
L_p2_ck_ok:
  s_barrier
  s_waitcnt lgkmcnt(0)
  v_mfma_f32_16x16x32_bf16 v[72:75], v[40:43], v[8:11], v[72:75]
  ds_read_b128 v[24:27], v1 offset:0
  buffer_load_dwordx4 v[160:163], v4, s[64:67], s33 offen sc1
  v_mfma_f32_16x16x32_bf16 v[76:79], v[40:43], v[12:15], v[76:79]
  ds_read_b64_tr_b16 v[56:57], v2 offset:0
  v_mfma_f32_16x16x32_bf16 v[80:83], v[40:43], v[16:19], v[80:83]
  ds_read_b64_tr_b16 v[58:59], v2 offset:512
  buffer_load_dwordx4 v[192:195], v4, s[64:67], s33 offen offset:1024 sc1
  s_add_u32 s33, s33, 8448
  v_mfma_f32_16x16x32_bf16 v[84:87], v[40:43], v[20:23], v[84:87]
  ds_read_b128 v[28:31], v1 offset:1024
  v_mfma_f32_16x16x32_bf16 v[100:103], v[44:47], v[20:23], v[100:103]
  ds_read_b64_tr_b16 v[60:61], v2 offset:32
  v_mfma_f32_16x16x32_bf16 v[96:99], v[44:47], v[16:19], v[96:99]
  ds_read_b64_tr_b16 v[62:63], v2 offset:544
  buffer_load_dwordx4 v[224:227], v156, s[64:67], s34 offen sc1
  s_add_u32 s34, s34, 8448
  v_mfma_f32_16x16x32_bf16 v[92:95], v[44:47], v[12:15], v[92:95]
  ds_read_b128 v[32:35], v1 offset:2048
  v_mfma_f32_16x16x32_bf16 v[88:91], v[44:47], v[8:11], v[88:91]
  ds_read_b64_tr_b16 v[64:65], v2 offset:64
  v_mfma_f32_16x16x32_bf16 v[104:107], v[48:51], v[8:11], v[104:107]
  ds_read_b64_tr_b16 v[66:67], v2 offset:576
  buffer_load_dwordx4 v[164:167], v4, s[64:67], s33 offen sc1
  v_mfma_f32_16x16x32_bf16 v[108:111], v[48:51], v[12:15], v[108:111]
  ds_read_b128 v[36:39], v1 offset:3072
  v_mfma_f32_16x16x32_bf16 v[112:115], v[48:51], v[16:19], v[112:115]
  ds_read_b64_tr_b16 v[68:69], v2 offset:96
  buffer_load_dwordx4 v[196:199], v4, s[64:67], s33 offen offset:1024 sc1
  s_add_u32 s33, s33, 8448
  v_mfma_f32_16x16x32_bf16 v[116:119], v[48:51], v[20:23], v[116:119]
  ds_read_b64_tr_b16 v[70:71], v2 offset:608
  v_mfma_f32_16x16x32_bf16 v[132:135], v[52:55], v[20:23], v[132:135]
  s_add_u32 s24, s24, 1
  s_cmp_eq_u32 s24, 9
  s_cselect_b32 s24, 0, s24
  s_mov_b32 s25, 16640
  s_cselect_b32 s25, 4294834176, s25
  v_mfma_f32_16x16x32_bf16 v[128:131], v[52:55], v[16:19], v[128:131]
  v_add_u32 v1, s25, v1
  v_add_u32 v2, s25, v2
  buffer_load_dwordx4 v[228:231], v156, s[64:67], s34 offen sc1
  s_add_u32 s34, s34, 8448
  v_mfma_f32_16x16x32_bf16 v[124:127], v[52:55], v[12:15], v[124:127]
  v_mfma_f32_16x16x32_bf16 v[120:123], v[52:55], v[8:11], v[120:123]
  s_waitcnt lgkmcnt(0)
  v_mfma_f32_16x16x32_bf16 v[72:75], v[56:59], v[24:27], v[72:75]
  ds_read_b128 v[8:11], v1 offset:0
  buffer_load_dwordx4 v[168:171], v4, s[64:67], s33 offen sc1
  v_mfma_f32_16x16x32_bf16 v[76:79], v[56:59], v[28:31], v[76:79]
  ds_read_b64_tr_b16 v[40:41], v2 offset:0
  v_mfma_f32_16x16x32_bf16 v[80:83], v[56:59], v[32:35], v[80:83]
  ds_read_b64_tr_b16 v[42:43], v2 offset:512
  buffer_load_dwordx4 v[200:203], v4, s[64:67], s33 offen offset:1024 sc1
  s_add_u32 s33, s33, 8448
  v_mfma_f32_16x16x32_bf16 v[84:87], v[56:59], v[36:39], v[84:87]
  ds_read_b128 v[12:15], v1 offset:1024
  v_mfma_f32_16x16x32_bf16 v[100:103], v[60:63], v[36:39], v[100:103]
  ds_read_b64_tr_b16 v[44:45], v2 offset:32
  v_mfma_f32_16x16x32_bf16 v[96:99], v[60:63], v[32:35], v[96:99]
  ds_read_b64_tr_b16 v[46:47], v2 offset:544
  buffer_load_dwordx4 v[232:235], v156, s[64:67], s34 offen sc1
  s_add_u32 s34, s34, 8448
  v_mfma_f32_16x16x32_bf16 v[92:95], v[60:63], v[28:31], v[92:95]
  ds_read_b128 v[16:19], v1 offset:2048
  v_mfma_f32_16x16x32_bf16 v[88:91], v[60:63], v[24:27], v[88:91]
  ds_read_b64_tr_b16 v[48:49], v2 offset:64
  v_mfma_f32_16x16x32_bf16 v[104:107], v[64:67], v[24:27], v[104:107]
  ds_read_b64_tr_b16 v[50:51], v2 offset:576
  buffer_load_dwordx4 v[172:175], v4, s[64:67], s33 offen sc1
  v_mfma_f32_16x16x32_bf16 v[108:111], v[64:67], v[28:31], v[108:111]
  ds_read_b128 v[20:23], v1 offset:3072
  v_mfma_f32_16x16x32_bf16 v[112:115], v[64:67], v[32:35], v[112:115]
  ds_read_b64_tr_b16 v[52:53], v2 offset:96
  buffer_load_dwordx4 v[204:207], v4, s[64:67], s33 offen offset:1024 sc1
  s_add_u32 s33, s33, 8448
  v_mfma_f32_16x16x32_bf16 v[116:119], v[64:67], v[36:39], v[116:119]
  ds_read_b64_tr_b16 v[54:55], v2 offset:608
  v_mfma_f32_16x16x32_bf16 v[132:135], v[68:71], v[36:39], v[132:135]
  s_add_u32 s24, s24, 1
  s_cmp_eq_u32 s24, 9
  s_cselect_b32 s24, 0, s24
  s_mov_b32 s25, 16640
  s_cselect_b32 s25, 4294834176, s25
  v_mfma_f32_16x16x32_bf16 v[128:131], v[68:71], v[32:35], v[128:131]
  v_add_u32 v1, s25, v1
  v_add_u32 v2, s25, v2
  buffer_load_dwordx4 v[236:239], v156, s[64:67], s34 offen sc1
  s_add_u32 s34, s34, 8448
  v_mfma_f32_16x16x32_bf16 v[124:127], v[68:71], v[28:31], v[124:127]
  v_mfma_f32_16x16x32_bf16 v[120:123], v[68:71], v[24:27], v[120:123]
  s_barrier
  s_waitcnt lgkmcnt(0)
  v_mfma_f32_16x16x32_bf16 v[72:75], v[40:43], v[8:11], v[72:75]
  ds_read_b128 v[24:27], v1 offset:0
  buffer_load_dwordx4 v[176:179], v4, s[64:67], s33 offen sc1
  v_mfma_f32_16x16x32_bf16 v[76:79], v[40:43], v[12:15], v[76:79]
  ds_read_b64_tr_b16 v[56:57], v2 offset:0
  v_mfma_f32_16x16x32_bf16 v[80:83], v[40:43], v[16:19], v[80:83]
  ds_read_b64_tr_b16 v[58:59], v2 offset:512
  buffer_load_dwordx4 v[208:211], v4, s[64:67], s33 offen offset:1024 sc1
  s_add_u32 s33, s33, 8448
  v_mfma_f32_16x16x32_bf16 v[84:87], v[40:43], v[20:23], v[84:87]
  ds_read_b128 v[28:31], v1 offset:1024
  v_mfma_f32_16x16x32_bf16 v[100:103], v[44:47], v[20:23], v[100:103]
  ds_read_b64_tr_b16 v[60:61], v2 offset:32
  v_mfma_f32_16x16x32_bf16 v[96:99], v[44:47], v[16:19], v[96:99]
  ds_read_b64_tr_b16 v[62:63], v2 offset:544
  buffer_load_dwordx4 v[240:243], v156, s[64:67], s34 offen sc1
  s_add_u32 s34, s34, 8448
  v_mfma_f32_16x16x32_bf16 v[92:95], v[44:47], v[12:15], v[92:95]
  ds_read_b128 v[32:35], v1 offset:2048
  v_mfma_f32_16x16x32_bf16 v[88:91], v[44:47], v[8:11], v[88:91]
  ds_read_b64_tr_b16 v[64:65], v2 offset:64
  v_mfma_f32_16x16x32_bf16 v[104:107], v[48:51], v[8:11], v[104:107]
  ds_read_b64_tr_b16 v[66:67], v2 offset:576
  buffer_load_dwordx4 v[180:183], v4, s[64:67], s33 offen sc1
  v_mfma_f32_16x16x32_bf16 v[108:111], v[48:51], v[12:15], v[108:111]
  ds_read_b128 v[36:39], v1 offset:3072
  v_mfma_f32_16x16x32_bf16 v[112:115], v[48:51], v[16:19], v[112:115]
  ds_read_b64_tr_b16 v[68:69], v2 offset:96
  buffer_load_dwordx4 v[212:215], v4, s[64:67], s33 offen offset:1024 sc1
  s_add_u32 s33, s33, 8448
  v_mfma_f32_16x16x32_bf16 v[116:119], v[48:51], v[20:23], v[116:119]
  ds_read_b64_tr_b16 v[70:71], v2 offset:608
  v_mfma_f32_16x16x32_bf16 v[132:135], v[52:55], v[20:23], v[132:135]
  s_add_u32 s24, s24, 1
  s_cmp_eq_u32 s24, 9
  s_cselect_b32 s24, 0, s24
  s_mov_b32 s25, 16640
  s_cselect_b32 s25, 4294834176, s25
  v_mfma_f32_16x16x32_bf16 v[128:131], v[52:55], v[16:19], v[128:131]
  v_add_u32 v1, s25, v1
  v_add_u32 v2, s25, v2
  buffer_load_dwordx4 v[244:247], v156, s[64:67], s34 offen sc1
  s_add_u32 s34, s34, 8448
  v_mfma_f32_16x16x32_bf16 v[124:127], v[52:55], v[12:15], v[124:127]
  v_mfma_f32_16x16x32_bf16 v[120:123], v[52:55], v[8:11], v[120:123]
  s_waitcnt lgkmcnt(0)
  v_mfma_f32_16x16x32_bf16 v[72:75], v[56:59], v[24:27], v[72:75]
  ds_read_b128 v[8:11], v1 offset:0
  buffer_load_dwordx4 v[184:187], v4, s[64:67], s33 offen sc1
  v_mfma_f32_16x16x32_bf16 v[76:79], v[56:59], v[28:31], v[76:79]
  ds_read_b64_tr_b16 v[40:41], v2 offset:0
  v_mfma_f32_16x16x32_bf16 v[80:83], v[56:59], v[32:35], v[80:83]
  ds_read_b64_tr_b16 v[42:43], v2 offset:512
  buffer_load_dwordx4 v[216:219], v4, s[64:67], s33 offen offset:1024 sc1
  s_add_u32 s33, s33, 8448
  v_mfma_f32_16x16x32_bf16 v[84:87], v[56:59], v[36:39], v[84:87]
  ds_read_b128 v[12:15], v1 offset:1024
  v_mfma_f32_16x16x32_bf16 v[100:103], v[60:63], v[36:39], v[100:103]
  ds_read_b64_tr_b16 v[44:45], v2 offset:32
  v_mfma_f32_16x16x32_bf16 v[96:99], v[60:63], v[32:35], v[96:99]
  ds_read_b64_tr_b16 v[46:47], v2 offset:544
  buffer_load_dwordx4 v[248:251], v156, s[64:67], s34 offen sc1
  s_add_u32 s34, s34, 8448
  v_mfma_f32_16x16x32_bf16 v[92:95], v[60:63], v[28:31], v[92:95]
  ds_read_b128 v[16:19], v1 offset:2048
  v_mfma_f32_16x16x32_bf16 v[88:91], v[60:63], v[24:27], v[88:91]
  ds_read_b64_tr_b16 v[48:49], v2 offset:64
  v_mfma_f32_16x16x32_bf16 v[104:107], v[64:67], v[24:27], v[104:107]
  ds_read_b64_tr_b16 v[50:51], v2 offset:576
  buffer_load_dwordx4 v[188:191], v4, s[64:67], s33 offen sc1
  v_mfma_f32_16x16x32_bf16 v[108:111], v[64:67], v[28:31], v[108:111]
  ds_read_b128 v[20:23], v1 offset:3072
  v_mfma_f32_16x16x32_bf16 v[112:115], v[64:67], v[32:35], v[112:115]
  ds_read_b64_tr_b16 v[52:53], v2 offset:96
  buffer_load_dwordx4 v[220:223], v4, s[64:67], s33 offen offset:1024 sc1
  s_add_u32 s33, s33, 8448
  v_mfma_f32_16x16x32_bf16 v[116:119], v[64:67], v[36:39], v[116:119]
  ds_read_b64_tr_b16 v[54:55], v2 offset:608
  v_mfma_f32_16x16x32_bf16 v[132:135], v[68:71], v[36:39], v[132:135]
  s_add_u32 s24, s24, 1
  s_cmp_eq_u32 s24, 9
  s_cselect_b32 s24, 0, s24
  s_mov_b32 s25, 16640
  s_cselect_b32 s25, 4294834176, s25
  v_mfma_f32_16x16x32_bf16 v[128:131], v[68:71], v[32:35], v[128:131]
  v_add_u32 v1, s25, v1
  v_add_u32 v2, s25, v2
  buffer_load_dwordx4 v[252:255], v156, s[64:67], s34 offen sc1
  s_add_u32 s34, s34, 8448
  v_mfma_f32_16x16x32_bf16 v[124:127], v[68:71], v[28:31], v[124:127]
  v_mfma_f32_16x16x32_bf16 v[120:123], v[68:71], v[24:27], v[120:123]
  s_barrier
  s_waitcnt lgkmcnt(0)
  v_mfma_f32_16x16x32_bf16 v[72:75], v[40:43], v[8:11], v[72:75]
  ds_read_b128 v[24:27], v1 offset:0
  v_mfma_f32_16x16x32_bf16 v[76:79], v[40:43], v[12:15], v[76:79]
  ds_read_b64_tr_b16 v[56:57], v2 offset:0
  v_mfma_f32_16x16x32_bf16 v[80:83], v[40:43], v[16:19], v[80:83]
  ds_read_b64_tr_b16 v[58:59], v2 offset:512
  v_mfma_f32_16x16x32_bf16 v[84:87], v[40:43], v[20:23], v[84:87]
  ds_read_b128 v[28:31], v1 offset:1024
  v_mfma_f32_16x16x32_bf16 v[100:103], v[44:47], v[20:23], v[100:103]
  ds_read_b64_tr_b16 v[60:61], v2 offset:32
  v_mfma_f32_16x16x32_bf16 v[96:99], v[44:47], v[16:19], v[96:99]
  ds_read_b64_tr_b16 v[62:63], v2 offset:544
  v_mfma_f32_16x16x32_bf16 v[92:95], v[44:47], v[12:15], v[92:95]
  ds_read_b128 v[32:35], v1 offset:2048
  v_mfma_f32_16x16x32_bf16 v[88:91], v[44:47], v[8:11], v[88:91]
  ds_read_b64_tr_b16 v[64:65], v2 offset:64
  v_mfma_f32_16x16x32_bf16 v[104:107], v[48:51], v[8:11], v[104:107]
  ds_read_b64_tr_b16 v[66:67], v2 offset:576
  v_mfma_f32_16x16x32_bf16 v[108:111], v[48:51], v[12:15], v[108:111]
  ds_read_b128 v[36:39], v1 offset:3072
  v_mfma_f32_16x16x32_bf16 v[112:115], v[48:51], v[16:19], v[112:115]
  ds_read_b64_tr_b16 v[68:69], v2 offset:96
  v_mfma_f32_16x16x32_bf16 v[116:119], v[48:51], v[20:23], v[116:119]
  ds_read_b64_tr_b16 v[70:71], v2 offset:608
  v_mfma_f32_16x16x32_bf16 v[132:135], v[52:55], v[20:23], v[132:135]
  s_add_u32 s24, s24, 1
  s_cmp_eq_u32 s24, 9
  s_cselect_b32 s24, 0, s24
  s_mov_b32 s25, 16640
  s_cselect_b32 s25, 4294834176, s25
  v_mfma_f32_16x16x32_bf16 v[128:131], v[52:55], v[16:19], v[128:131]
  v_add_u32 v1, s25, v1
  v_add_u32 v2, s25, v2
  v_mfma_f32_16x16x32_bf16 v[124:127], v[52:55], v[12:15], v[124:127]
  v_mfma_f32_16x16x32_bf16 v[120:123], v[52:55], v[8:11], v[120:123]
  s_waitcnt lgkmcnt(0)
  v_mfma_f32_16x16x32_bf16 v[72:75], v[56:59], v[24:27], v[72:75]
  ds_read_b128 v[8:11], v1 offset:0
  v_mfma_f32_16x16x32_bf16 v[76:79], v[56:59], v[28:31], v[76:79]
  ds_read_b64_tr_b16 v[40:41], v2 offset:0
  v_mfma_f32_16x16x32_bf16 v[80:83], v[56:59], v[32:35], v[80:83]
  ds_read_b64_tr_b16 v[42:43], v2 offset:512
  v_mfma_f32_16x16x32_bf16 v[84:87], v[56:59], v[36:39], v[84:87]
  ds_read_b128 v[12:15], v1 offset:1024
  v_mfma_f32_16x16x32_bf16 v[100:103], v[60:63], v[36:39], v[100:103]
  ds_read_b64_tr_b16 v[44:45], v2 offset:32
  v_mfma_f32_16x16x32_bf16 v[96:99], v[60:63], v[32:35], v[96:99]
  ds_read_b64_tr_b16 v[46:47], v2 offset:544
  v_mfma_f32_16x16x32_bf16 v[92:95], v[60:63], v[28:31], v[92:95]
  ds_read_b128 v[16:19], v1 offset:2048
  v_mfma_f32_16x16x32_bf16 v[88:91], v[60:63], v[24:27], v[88:91]
  ds_read_b64_tr_b16 v[48:49], v2 offset:64
  v_mfma_f32_16x16x32_bf16 v[104:107], v[64:67], v[24:27], v[104:107]
  ds_read_b64_tr_b16 v[50:51], v2 offset:576
  v_mfma_f32_16x16x32_bf16 v[108:111], v[64:67], v[28:31], v[108:111]
  ds_read_b128 v[20:23], v1 offset:3072
  v_mfma_f32_16x16x32_bf16 v[112:115], v[64:67], v[32:35], v[112:115]
  ds_read_b64_tr_b16 v[52:53], v2 offset:96
  v_mfma_f32_16x16x32_bf16 v[116:119], v[64:67], v[36:39], v[116:119]
  ds_read_b64_tr_b16 v[54:55], v2 offset:608
  v_mfma_f32_16x16x32_bf16 v[132:135], v[68:71], v[36:39], v[132:135]
  s_add_u32 s24, s24, 1
  s_cmp_eq_u32 s24, 9
  s_cselect_b32 s24, 0, s24
  s_mov_b32 s25, 16640
  s_cselect_b32 s25, 4294834176, s25
  v_mfma_f32_16x16x32_bf16 v[128:131], v[68:71], v[32:35], v[128:131]
  v_add_u32 v1, s25, v1
  v_add_u32 v2, s25, v2
  v_mfma_f32_16x16x32_bf16 v[124:127], v[68:71], v[28:31], v[124:127]
  v_mfma_f32_16x16x32_bf16 v[120:123], v[68:71], v[24:27], v[120:123]
  s_barrier
  s_waitcnt vmcnt(0)
  s_waitcnt lgkmcnt(0)
  v_mfma_f32_16x16x32_bf16 v[72:75], v[40:43], v[8:11], v[72:75]
  ds_read_b128 v[24:27], v1 offset:0
  v_add_f32 v160, v160, v176
  v_add_f32 v161, v161, v177
  v_mfma_f32_16x16x32_bf16 v[76:79], v[40:43], v[12:15], v[76:79]
  ds_read_b64_tr_b16 v[56:57], v2 offset:0
  v_add_f32 v162, v162, v178
  v_mfma_f32_16x16x32_bf16 v[80:83], v[40:43], v[16:19], v[80:83]
  ds_read_b64_tr_b16 v[58:59], v2 offset:512
  v_add_f32 v163, v163, v179
  v_add_f32 v164, v164, v180
  v_mfma_f32_16x16x32_bf16 v[84:87], v[40:43], v[20:23], v[84:87]
  ds_read_b128 v[28:31], v1 offset:1024
  v_add_f32 v165, v165, v181
  v_mfma_f32_16x16x32_bf16 v[100:103], v[44:47], v[20:23], v[100:103]
  ds_read_b64_tr_b16 v[60:61], v2 offset:32
  v_add_f32 v166, v166, v182
  v_add_f32 v167, v167, v183
  v_mfma_f32_16x16x32_bf16 v[96:99], v[44:47], v[16:19], v[96:99]
  ds_read_b64_tr_b16 v[62:63], v2 offset:544
  v_add_f32 v168, v168, v184
  v_mfma_f32_16x16x32_bf16 v[92:95], v[44:47], v[12:15], v[92:95]
  ds_read_b128 v[32:35], v1 offset:2048
  v_add_f32 v169, v169, v185
  v_add_f32 v170, v170, v186
  v_mfma_f32_16x16x32_bf16 v[88:91], v[44:47], v[8:11], v[88:91]
  ds_read_b64_tr_b16 v[64:65], v2 offset:64
  v_add_f32 v171, v171, v187
  v_mfma_f32_16x16x32_bf16 v[104:107], v[48:51], v[8:11], v[104:107]
  ds_read_b64_tr_b16 v[66:67], v2 offset:576
  v_add_f32 v172, v172, v188
  v_add_f32 v173, v173, v189
  v_mfma_f32_16x16x32_bf16 v[108:111], v[48:51], v[12:15], v[108:111]
  ds_read_b128 v[36:39], v1 offset:3072
  v_add_f32 v174, v174, v190
  v_mfma_f32_16x16x32_bf16 v[112:115], v[48:51], v[16:19], v[112:115]
  ds_read_b64_tr_b16 v[68:69], v2 offset:96
  v_add_f32 v175, v175, v191
  v_add_f32 v192, v192, v208
  v_mfma_f32_16x16x32_bf16 v[116:119], v[48:51], v[20:23], v[116:119]
  ds_read_b64_tr_b16 v[70:71], v2 offset:608
  v_add_f32 v193, v193, v209
  v_mfma_f32_16x16x32_bf16 v[132:135], v[52:55], v[20:23], v[132:135]
  s_add_u32 s24, s24, 1
  s_cmp_eq_u32 s24, 9
  s_cselect_b32 s24, 0, s24
  s_mov_b32 s25, 16640
  s_cselect_b32 s25, 4294834176, s25
  v_add_f32 v194, v194, v210
  v_add_f32 v195, v195, v211
  v_mfma_f32_16x16x32_bf16 v[128:131], v[52:55], v[16:19], v[128:131]
  v_add_u32 v1, s25, v1
  v_add_u32 v2, s25, v2
  v_add_f32 v196, v196, v212
  v_mfma_f32_16x16x32_bf16 v[124:127], v[52:55], v[12:15], v[124:127]
  v_add_f32 v197, v197, v213
  v_add_f32 v198, v198, v214
  v_mfma_f32_16x16x32_bf16 v[120:123], v[52:55], v[8:11], v[120:123]
  v_add_f32 v199, v199, v215
  s_waitcnt lgkmcnt(0)
  v_mfma_f32_16x16x32_bf16 v[72:75], v[56:59], v[24:27], v[72:75]
  ds_read_b128 v[8:11], v1 offset:0
  v_add_f32 v200, v200, v216
  v_add_f32 v201, v201, v217
  v_mfma_f32_16x16x32_bf16 v[76:79], v[56:59], v[28:31], v[76:79]
  ds_read_b64_tr_b16 v[40:41], v2 offset:0
  v_add_f32 v202, v202, v218
  v_mfma_f32_16x16x32_bf16 v[80:83], v[56:59], v[32:35], v[80:83]
  ds_read_b64_tr_b16 v[42:43], v2 offset:512
  v_add_f32 v203, v203, v219
  v_add_f32 v204, v204, v220
  v_mfma_f32_16x16x32_bf16 v[84:87], v[56:59], v[36:39], v[84:87]
  ds_read_b128 v[12:15], v1 offset:1024
  v_add_f32 v205, v205, v221
  v_mfma_f32_16x16x32_bf16 v[100:103], v[60:63], v[36:39], v[100:103]
  ds_read_b64_tr_b16 v[44:45], v2 offset:32
  v_add_f32 v206, v206, v222
  v_add_f32 v207, v207, v223
  v_mfma_f32_16x16x32_bf16 v[96:99], v[60:63], v[32:35], v[96:99]
  ds_read_b64_tr_b16 v[46:47], v2 offset:544
  v_add_f32 v224, v224, v240
  v_mfma_f32_16x16x32_bf16 v[92:95], v[60:63], v[28:31], v[92:95]
  ds_read_b128 v[16:19], v1 offset:2048
  v_add_f32 v225, v225, v241
  v_add_f32 v226, v226, v242
  v_mfma_f32_16x16x32_bf16 v[88:91], v[60:63], v[24:27], v[88:91]
  ds_read_b64_tr_b16 v[48:49], v2 offset:64
  v_add_f32 v227, v227, v243
  v_mfma_f32_16x16x32_bf16 v[104:107], v[64:67], v[24:27], v[104:107]
  ds_read_b64_tr_b16 v[50:51], v2 offset:576
  v_add_f32 v228, v228, v244
  v_add_f32 v229, v229, v245
  v_mfma_f32_16x16x32_bf16 v[108:111], v[64:67], v[28:31], v[108:111]
  ds_read_b128 v[20:23], v1 offset:3072
  v_add_f32 v230, v230, v246
  v_mfma_f32_16x16x32_bf16 v[112:115], v[64:67], v[32:35], v[112:115]
  ds_read_b64_tr_b16 v[52:53], v2 offset:96
  v_add_f32 v231, v231, v247
  v_add_f32 v232, v232, v248
  v_mfma_f32_16x16x32_bf16 v[116:119], v[64:67], v[36:39], v[116:119]
  ds_read_b64_tr_b16 v[54:55], v2 offset:608
  v_add_f32 v233, v233, v249
  v_mfma_f32_16x16x32_bf16 v[132:135], v[68:71], v[36:39], v[132:135]
  s_add_u32 s24, s24, 1
  s_cmp_eq_u32 s24, 9
  s_cselect_b32 s24, 0, s24
  s_mov_b32 s25, 16640
  s_cselect_b32 s25, 4294834176, s25
  v_add_f32 v234, v234, v250
  v_add_f32 v235, v235, v251
  v_mfma_f32_16x16x32_bf16 v[128:131], v[68:71], v[32:35], v[128:131]
  v_add_u32 v1, s25, v1
  v_add_u32 v2, s25, v2
  v_add_f32 v236, v236, v252
  v_mfma_f32_16x16x32_bf16 v[124:127], v[68:71], v[28:31], v[124:127]
  v_add_f32 v237, v237, v253
  v_add_f32 v238, v238, v254
  v_mfma_f32_16x16x32_bf16 v[120:123], v[68:71], v[24:27], v[120:123]
  v_add_f32 v239, v239, v255
  s_barrier
  s_waitcnt lgkmcnt(0)
  v_mfma_f32_16x16x32_bf16 v[72:75], v[40:43], v[8:11], v[72:75]
  ds_read_b128 v[24:27], v1 offset:0
  v_add_f32 v160, v160, v168
  v_add_f32 v161, v161, v169
  v_mfma_f32_16x16x32_bf16 v[76:79], v[40:43], v[12:15], v[76:79]
  ds_read_b64_tr_b16 v[56:57], v2 offset:0
  v_add_f32 v162, v162, v170
  v_mfma_f32_16x16x32_bf16 v[80:83], v[40:43], v[16:19], v[80:83]
  ds_read_b64_tr_b16 v[58:59], v2 offset:512
  v_add_f32 v163, v163, v171
  v_mfma_f32_16x16x32_bf16 v[84:87], v[40:43], v[20:23], v[84:87]
  ds_read_b128 v[28:31], v1 offset:1024
  v_add_f32 v164, v164, v172
  v_add_f32 v165, v165, v173
  v_mfma_f32_16x16x32_bf16 v[100:103], v[44:47], v[20:23], v[100:103]
  ds_read_b64_tr_b16 v[60:61], v2 offset:32
  v_add_f32 v166, v166, v174
  v_mfma_f32_16x16x32_bf16 v[96:99], v[44:47], v[16:19], v[96:99]
  ds_read_b64_tr_b16 v[62:63], v2 offset:544
  v_add_f32 v167, v167, v175
  v_mfma_f32_16x16x32_bf16 v[92:95], v[44:47], v[12:15], v[92:95]
  ds_read_b128 v[32:35], v1 offset:2048
  v_add_f32 v192, v192, v200
  v_add_f32 v193, v193, v201
  v_mfma_f32_16x16x32_bf16 v[88:91], v[44:47], v[8:11], v[88:91]
  ds_read_b64_tr_b16 v[64:65], v2 offset:64
  v_add_f32 v194, v194, v202
  v_mfma_f32_16x16x32_bf16 v[104:107], v[48:51], v[8:11], v[104:107]
  ds_read_b64_tr_b16 v[66:67], v2 offset:576
  v_add_f32 v195, v195, v203
  v_mfma_f32_16x16x32_bf16 v[108:111], v[48:51], v[12:15], v[108:111]
  ds_read_b128 v[36:39], v1 offset:3072
  v_add_f32 v196, v196, v204
  v_add_f32 v197, v197, v205
  v_mfma_f32_16x16x32_bf16 v[112:115], v[48:51], v[16:19], v[112:115]
  ds_read_b64_tr_b16 v[68:69], v2 offset:96
  v_add_f32 v198, v198, v206
  v_mfma_f32_16x16x32_bf16 v[116:119], v[48:51], v[20:23], v[116:119]
  ds_read_b64_tr_b16 v[70:71], v2 offset:608
  v_add_f32 v199, v199, v207
  v_mfma_f32_16x16x32_bf16 v[132:135], v[52:55], v[20:23], v[132:135]
  s_add_u32 s24, s24, 1
  s_cmp_eq_u32 s24, 9
  s_cselect_b32 s24, 0, s24
  s_mov_b32 s25, 16640
  s_cselect_b32 s25, 4294834176, s25
  v_add_f32 v224, v224, v232
  v_add_f32 v225, v225, v233
  v_mfma_f32_16x16x32_bf16 v[128:131], v[52:55], v[16:19], v[128:131]
  v_add_u32 v1, s25, v1
  v_add_u32 v2, s25, v2
  v_add_f32 v226, v226, v234
  v_mfma_f32_16x16x32_bf16 v[124:127], v[52:55], v[12:15], v[124:127]
  v_add_f32 v227, v227, v235
  v_mfma_f32_16x16x32_bf16 v[120:123], v[52:55], v[8:11], v[120:123]
  v_add_f32 v228, v228, v236
  s_waitcnt lgkmcnt(0)
  v_mfma_f32_16x16x32_bf16 v[72:75], v[56:59], v[24:27], v[72:75]
  ds_read_b128 v[8:11], v1 offset:0
  v_add_f32 v229, v229, v237
  v_add_f32 v230, v230, v238
  v_mfma_f32_16x16x32_bf16 v[76:79], v[56:59], v[28:31], v[76:79]
  ds_read_b64_tr_b16 v[40:41], v2 offset:0
  v_add_f32 v231, v231, v239
  v_mfma_f32_16x16x32_bf16 v[80:83], v[56:59], v[32:35], v[80:83]
  ds_read_b64_tr_b16 v[42:43], v2 offset:512
  v_add_f32 v160, v160, v164
  v_mfma_f32_16x16x32_bf16 v[84:87], v[56:59], v[36:39], v[84:87]
  ds_read_b128 v[12:15], v1 offset:1024
  v_add_f32 v161, v161, v165
  v_add_f32 v162, v162, v166
  v_mfma_f32_16x16x32_bf16 v[100:103], v[60:63], v[36:39], v[100:103]
  ds_read_b64_tr_b16 v[44:45], v2 offset:32
  v_add_f32 v163, v163, v167
  v_mfma_f32_16x16x32_bf16 v[96:99], v[60:63], v[32:35], v[96:99]
  ds_read_b64_tr_b16 v[46:47], v2 offset:544
  v_add_f32 v192, v192, v196
  v_mfma_f32_16x16x32_bf16 v[92:95], v[60:63], v[28:31], v[92:95]
  ds_read_b128 v[16:19], v1 offset:2048
  v_add_f32 v193, v193, v197
  v_add_f32 v194, v194, v198
  v_mfma_f32_16x16x32_bf16 v[88:91], v[60:63], v[24:27], v[88:91]
  ds_read_b64_tr_b16 v[48:49], v2 offset:64
  v_add_f32 v195, v195, v199
  v_mfma_f32_16x16x32_bf16 v[104:107], v[64:67], v[24:27], v[104:107]
  ds_read_b64_tr_b16 v[50:51], v2 offset:576
  v_add_f32 v224, v224, v228
  v_mfma_f32_16x16x32_bf16 v[108:111], v[64:67], v[28:31], v[108:111]
  ds_read_b128 v[20:23], v1 offset:3072
  v_add_f32 v225, v225, v229
  v_add_f32 v226, v226, v230
  v_mfma_f32_16x16x32_bf16 v[112:115], v[64:67], v[32:35], v[112:115]
  ds_read_b64_tr_b16 v[52:53], v2 offset:96
  v_add_f32 v227, v227, v231
  v_mfma_f32_16x16x32_bf16 v[116:119], v[64:67], v[36:39], v[116:119]
  ds_read_b64_tr_b16 v[54:55], v2 offset:608
  v_cvt_pk_bf16_f32 v164, v160, v161
  v_mfma_f32_16x16x32_bf16 v[132:135], v[68:71], v[36:39], v[132:135]
  s_add_u32 s24, s24, 1
  s_cmp_eq_u32 s24, 9
  s_cselect_b32 s24, 0, s24
  s_mov_b32 s25, 16640
  s_cselect_b32 s25, 4294834176, s25
  v_cvt_pk_bf16_f32 v165, v162, v163
  v_cvt_pk_bf16_f32 v166, v192, v193
  v_mfma_f32_16x16x32_bf16 v[128:131], v[68:71], v[32:35], v[128:131]
  v_add_u32 v1, s25, v1
  v_add_u32 v2, s25, v2
  v_cvt_pk_bf16_f32 v167, v194, v195
  v_mfma_f32_16x16x32_bf16 v[124:127], v[68:71], v[28:31], v[124:127]
  v_cvt_pk_bf16_f32 v168, v224, v225
  v_mfma_f32_16x16x32_bf16 v[120:123], v[68:71], v[24:27], v[120:123]
  v_cvt_pk_bf16_f32 v169, v226, v227
  s_lshl_b32 s50, s4, 10
  s_add_u32 s50, s50, 149760
  v_lshl_add_u32 v159, v158, 1, s50
  ds_write_b64 v159, v[164:165]
  ds_write_b64 v159, v[166:167] offset:512
  s_lshl_b32 s50, s4, 9
  s_add_u32 s50, s50, 153856
  v_lshl_add_u32 v157, v158, 1, s50
  ds_write_b64 v157, v[168:169]
  s_waitcnt lgkmcnt(0)
  s_barrier
  s_mov_b32 s28, 7
  s_mul_i32 s29, s20, 1000
  s_cmp_eq_u32 s3, 4
  s_cselect_b32 s31, 7, -1
L_p2_cloop:
  s_waitcnt lgkmcnt(0)
  v_mfma_f32_16x16x32_bf16 v[72:75], v[40:43], v[8:11], v[72:75]
  ds_read_b128 v[24:27], v1 offset:0
  v_mfma_f32_16x16x32_bf16 v[76:79], v[40:43], v[12:15], v[76:79]
  ds_read_b64_tr_b16 v[56:57], v2 offset:0
  v_mfma_f32_16x16x32_bf16 v[80:83], v[40:43], v[16:19], v[80:83]
  ds_read_b64_tr_b16 v[58:59], v2 offset:512
  v_mfma_f32_16x16x32_bf16 v[84:87], v[40:43], v[20:23], v[84:87]
  ds_read_b128 v[28:31], v1 offset:1024
  v_mfma_f32_16x16x32_bf16 v[100:103], v[44:47], v[20:23], v[100:103]
  ds_read_b64_tr_b16 v[60:61], v2 offset:32
  v_mfma_f32_16x16x32_bf16 v[96:99], v[44:47], v[16:19], v[96:99]
  ds_read_b64_tr_b16 v[62:63], v2 offset:544
  v_mfma_f32_16x16x32_bf16 v[92:95], v[44:47], v[12:15], v[92:95]
  ds_read_b128 v[32:35], v1 offset:2048
  v_mfma_f32_16x16x32_bf16 v[88:91], v[44:47], v[8:11], v[88:91]
  ds_read_b64_tr_b16 v[64:65], v2 offset:64
  v_mfma_f32_16x16x32_bf16 v[104:107], v[48:51], v[8:11], v[104:107]
  ds_read_b64_tr_b16 v[66:67], v2 offset:576
  v_mfma_f32_16x16x32_bf16 v[108:111], v[48:51], v[12:15], v[108:111]
  ds_read_b128 v[36:39], v1 offset:3072
  v_mfma_f32_16x16x32_bf16 v[112:115], v[48:51], v[16:19], v[112:115]
  ds_read_b64_tr_b16 v[68:69], v2 offset:96
  v_mfma_f32_16x16x32_bf16 v[116:119], v[48:51], v[20:23], v[116:119]
  ds_read_b64_tr_b16 v[70:71], v2 offset:608
  v_mfma_f32_16x16x32_bf16 v[132:135], v[52:55], v[20:23], v[132:135]
  s_add_u32 s24, s24, 1
  s_cmp_eq_u32 s24, 9
  s_cselect_b32 s24, 0, s24
  s_mov_b32 s25, 16640
  s_cselect_b32 s25, 4294834176, s25
  v_mfma_f32_16x16x32_bf16 v[128:131], v[52:55], v[16:19], v[128:131]
  v_add_u32 v1, s25, v1
  v_add_u32 v2, s25, v2
  v_mfma_f32_16x16x32_bf16 v[124:127], v[52:55], v[12:15], v[124:127]
  v_mfma_f32_16x16x32_bf16 v[120:123], v[52:55], v[8:11], v[120:123]
  s_waitcnt lgkmcnt(0)
  v_mfma_f32_16x16x32_bf16 v[72:75], v[56:59], v[24:27], v[72:75]
  ds_read_b128 v[8:11], v1 offset:0
  v_mfma_f32_16x16x32_bf16 v[76:79], v[56:59], v[28:31], v[76:79]
  ds_read_b64_tr_b16 v[40:41], v2 offset:0
  v_mfma_f32_16x16x32_bf16 v[80:83], v[56:59], v[32:35], v[80:83]
  ds_read_b64_tr_b16 v[42:43], v2 offset:512
  v_mfma_f32_16x16x32_bf16 v[84:87], v[56:59], v[36:39], v[84:87]
  ds_read_b128 v[12:15], v1 offset:1024
  v_mfma_f32_16x16x32_bf16 v[100:103], v[60:63], v[36:39], v[100:103]
  ds_read_b64_tr_b16 v[44:45], v2 offset:32
  v_mfma_f32_16x16x32_bf16 v[96:99], v[60:63], v[32:35], v[96:99]
  ds_read_b64_tr_b16 v[46:47], v2 offset:544
  v_mfma_f32_16x16x32_bf16 v[92:95], v[60:63], v[28:31], v[92:95]
  ds_read_b128 v[16:19], v1 offset:2048
  v_mfma_f32_16x16x32_bf16 v[88:91], v[60:63], v[24:27], v[88:91]
  ds_read_b64_tr_b16 v[48:49], v2 offset:64
  v_mfma_f32_16x16x32_bf16 v[104:107], v[64:67], v[24:27], v[104:107]
  ds_read_b64_tr_b16 v[50:51], v2 offset:576
  v_mfma_f32_16x16x32_bf16 v[108:111], v[64:67], v[28:31], v[108:111]
  ds_read_b128 v[20:23], v1 offset:3072
  v_mfma_f32_16x16x32_bf16 v[112:115], v[64:67], v[32:35], v[112:115]
  ds_read_b64_tr_b16 v[52:53], v2 offset:96
  v_mfma_f32_16x16x32_bf16 v[116:119], v[64:67], v[36:39], v[116:119]
  ds_read_b64_tr_b16 v[54:55], v2 offset:608
  v_mfma_f32_16x16x32_bf16 v[132:135], v[68:71], v[36:39], v[132:135]
  s_add_u32 s24, s24, 1
  s_cmp_eq_u32 s24, 9
  s_cselect_b32 s24, 0, s24
  s_mov_b32 s25, 16640
  s_cselect_b32 s25, 4294834176, s25
  v_mfma_f32_16x16x32_bf16 v[128:131], v[68:71], v[32:35], v[128:131]
  v_add_u32 v1, s25, v1
  v_add_u32 v2, s25, v2
  v_mfma_f32_16x16x32_bf16 v[124:127], v[68:71], v[28:31], v[124:127]
  v_mfma_f32_16x16x32_bf16 v[120:123], v[68:71], v[24:27], v[120:123]
  s_cmp_eq_u32 s28, s31
  s_cbranch_scc1 L_p2_cevt
L_p2_cevt_ret:
  s_add_u32 s28, s28, 1
  s_cmp_lg_u32 s28, s60
  s_barrier
  s_cbranch_scc1 L_p2_cloop
  s_waitcnt vmcnt(0) lgkmcnt(0)
  s_cmp_eq_u32 s20, 1
  s_cbranch_scc0 L_p2_fin
  s_lshl_b32 s50, s23, 15
  s_lshl_b32 s55, s4, 13
  s_add_u32 s50, s50, s55
  s_add_u32 s50, s50, 33554432
  s_nop 2
  v_cvt_pk_bf16_f32 v136, v72, v73
  v_cvt_pk_bf16_f32 v137, v74, v75
  v_cvt_pk_bf16_f32 v138, v76, v77
  v_cvt_pk_bf16_f32 v139, v78, v79
  buffer_store_dwordx4 v[136:139], v4, s[64:67], s50 offen offset:0 sc1
  v_cvt_pk_bf16_f32 v140, v80, v81
  v_cvt_pk_bf16_f32 v141, v82, v83
  v_cvt_pk_bf16_f32 v142, v84, v85
  v_cvt_pk_bf16_f32 v143, v86, v87
  buffer_store_dwordx4 v[140:143], v4, s[64:67], s50 offen offset:1024 sc1
  v_cvt_pk_bf16_f32 v144, v88, v89
  v_cvt_pk_bf16_f32 v145, v90, v91
  v_cvt_pk_bf16_f32 v146, v92, v93
  v_cvt_pk_bf16_f32 v147, v94, v95
  buffer_store_dwordx4 v[144:147], v4, s[64:67], s50 offen offset:2048 sc1
  v_cvt_pk_bf16_f32 v148, v96, v97
  v_cvt_pk_bf16_f32 v149, v98, v99
  v_cvt_pk_bf16_f32 v150, v100, v101
  v_cvt_pk_bf16_f32 v151, v102, v103
  buffer_store_dwordx4 v[148:151], v4, s[64:67], s50 offen offset:3072 sc1
  v_cvt_pk_bf16_f32 v152, v104, v105
  v_cvt_pk_bf16_f32 v153, v106, v107
  v_cvt_pk_bf16_f32 v154, v108, v109
  v_cvt_pk_bf16_f32 v155, v110, v111
  s_add_u32 s50, s50, 4096
  buffer_store_dwordx4 v[152:155], v4, s[64:67], s50 offen offset:0 sc1
  v_cvt_pk_bf16_f32 v156, v112, v113
  v_cvt_pk_bf16_f32 v157, v114, v115
  v_cvt_pk_bf16_f32 v158, v116, v117
  v_cvt_pk_bf16_f32 v159, v118, v119
  buffer_store_dwordx4 v[156:159], v4, s[64:67], s50 offen offset:1024 sc1
  v_cvt_pk_bf16_f32 v160, v120, v121
  v_cvt_pk_bf16_f32 v161, v122, v123
  v_cvt_pk_bf16_f32 v162, v124, v125
  v_cvt_pk_bf16_f32 v163, v126, v127
  buffer_store_dwordx4 v[160:163], v4, s[64:67], s50 offen offset:2048 sc1
  v_cvt_pk_bf16_f32 v164, v128, v129
  v_cvt_pk_bf16_f32 v165, v130, v131
  v_cvt_pk_bf16_f32 v166, v132, v133
  v_cvt_pk_bf16_f32 v167, v134, v135
  buffer_store_dwordx4 v[164:167], v4, s[64:67], s50 offen offset:3072 sc1
  s_lshl_b32 s50, s23, 7
  s_lshl_b32 s55, s4, 2
  s_add_u32 s50, s50, s55
  s_add_u32 s50, s50, 50360320
  v_mov_b32 v13, 0
  v_mov_b32 v14, 1
  s_waitcnt vmcnt(0)
  s_mov_b64 exec, 1
  buffer_store_dword v14, v13, s[64:67], s50 offen sc1
  s_branch L_p2_end
L_p2_fin:
  v_lshrrev_b32 v8, 2, v6
  v_mul_u32_u24 v8, 1056, v8
  v_and_b32 v9, 3, v6
  v_lshl_add_u32 v8, v9, 8, v8
  v_lshl_add_u32 v8, v5, 3, v8
  s_lshl_b32 s51, s26, 1
  s_add_u32 s51, s51, 4
  s_cmp_ge_u32 s51, 9
  s_cselect_b32 s52, 9, 0
  s_sub_u32 s51, s51, s52
  s_mul_i32 s51, s51, 16640
  s_lshl_b32 s52, s27, 7
  s_add_u32 s51, s51, s52
  v_add_u32 v1, s51, v8
  s_lshl_b32 s51, s26, 1
  s_add_u32 s51, s51, 5
  s_cmp_ge_u32 s51, 9
  s_cselect_b32 s52, 9, 0
  s_sub_u32 s51, s51, s52
  s_mul_i32 s51, s51, 16640
  s_lshl_b32 s52, s27, 7
  s_add_u32 s51, s51, s52
  v_add_u32 v2, s51, v8
  s_lshl_b32 s51, s27, 0
  s_add_u32 s51, s51, 8
  s_cmp_ge_u32 s51, 9
  s_cselect_b32 s52, 9, 0
  s_sub_u32 s51, s51, s52
  s_mul_i32 s51, s51, 16640
  v_add_u32 v3, s51, v4
  v_and_b32 v8, 1, v5
  v_lshlrev_b32 v8, 5, v8
  v_lshrrev_b32 v9, 1, v5
  v_lshl_add_u32 v8, v9, 4, v8
  v_add_u32 v7, v7, v8
  s_barrier
  s_cmp_eq_u32 s26, 1
  s_cbranch_scc1 L_p2_fin1
  ds_read_b128 v[136:139], v3 offset:0
  ds_read_b128 v[140:143], v3 offset:1024
  ds_read_b128 v[144:147], v3 offset:2048
  ds_read_b128 v[148:151], v3 offset:3072
  ds_read_b128 v[152:155], v3 offset:4096
  ds_read_b128 v[156:159], v3 offset:5120
  ds_read_b128 v[160:163], v3 offset:6144
  ds_read_b128 v[164:167], v3 offset:7168
  s_branch L_p2_fin2
L_p2_fin1:
  ds_read_b128 v[136:139], v3 offset:8192
  ds_read_b128 v[140:143], v3 offset:9248
  ds_read_b128 v[144:147], v3 offset:10304
  ds_read_b128 v[148:151], v3 offset:11360
  ds_read_b128 v[152:155], v3 offset:12416
  ds_read_b128 v[156:159], v3 offset:13472
  ds_read_b128 v[160:163], v3 offset:14528
  ds_read_b128 v[164:167], v3 offset:15584
L_p2_fin2:
  ds_read_b64 v[200:201], v1 offset:8192
  ds_read_b64 v[208:209], v1 offset:8224
  ds_read_b64 v[202:203], v1 offset:12416
  ds_read_b64 v[210:211], v1 offset:12448
  ds_read_b64 v[204:205], v2 offset:8192
  ds_read_b64 v[212:213], v2 offset:8224
  ds_read_b64 v[206:207], v2 offset:12416
  ds_read_b64 v[214:215], v2 offset:12448
  ds_read_b64 v[216:217], v1 offset:8256
  ds_read_b64 v[224:225], v1 offset:8288
  ds_read_b64 v[218:219], v1 offset:12480
  ds_read_b64 v[226:227], v1 offset:12512
  ds_read_b64 v[220:221], v2 offset:8256
  ds_read_b64 v[228:229], v2 offset:8288
  ds_read_b64 v[222:223], v2 offset:12480
  ds_read_b64 v[230:231], v2 offset:12512
  s_waitcnt lgkmcnt(15)
  v_lshlrev_b32 v8, 16, v136
  v_and_b32 v9, s79, v136
  v_lshlrev_b32 v10, 16, v137
  v_and_b32 v11, s79, v137
  v_add_f32 v72, v72, v8
  v_add_f32 v73, v73, v9
  v_add_f32 v74, v74, v10
  v_add_f32 v75, v75, v11
  v_lshlrev_b32 v8, 16, v200
  v_and_b32 v9, s79, v200
  v_lshlrev_b32 v10, 16, v201
  v_and_b32 v11, s79, v201
  v_add_f32 v72, v72, v8
  v_add_f32 v73, v73, v9
  v_add_f32 v74, v74, v10
  v_add_f32 v75, v75, v11
  v_cvt_pk_bf16_f32 v12, v72, v73
  v_cvt_pk_bf16_f32 v13, v74, v75
  s_waitcnt lgkmcnt(14)
  v_lshlrev_b32 v8, 16, v144
  v_and_b32 v9, s79, v144
  v_lshlrev_b32 v10, 16, v145
  v_and_b32 v11, s79, v145
  v_add_f32 v88, v88, v8
  v_add_f32 v89, v89, v9
  v_add_f32 v90, v90, v10
  v_add_f32 v91, v91, v11
  v_lshlrev_b32 v8, 16, v208
  v_and_b32 v9, s79, v208
  v_lshlrev_b32 v10, 16, v209
  v_and_b32 v11, s79, v209
  v_add_f32 v88, v88, v8
  v_add_f32 v89, v89, v9
  v_add_f32 v90, v90, v10
  v_add_f32 v91, v91, v11
  v_cvt_pk_bf16_f32 v14, v88, v89
  v_cvt_pk_bf16_f32 v15, v90, v91
  s_nop 1
  v_permlane16_swap_b32 v12, v14
  v_permlane16_swap_b32 v13, v15
  buffer_store_dwordx4 v[12:15], v7, s[16:19], 0 offen offset:0 sc1
  s_waitcnt lgkmcnt(13)
  v_lshlrev_b32 v8, 16, v138
  v_and_b32 v9, s79, v138
  v_lshlrev_b32 v10, 16, v139
  v_and_b32 v11, s79, v139
  v_add_f32 v76, v76, v8
  v_add_f32 v77, v77, v9
  v_add_f32 v78, v78, v10
  v_add_f32 v79, v79, v11
  v_lshlrev_b32 v8, 16, v202
  v_and_b32 v9, s79, v202
  v_lshlrev_b32 v10, 16, v203
  v_and_b32 v11, s79, v203
  v_add_f32 v76, v76, v8
  v_add_f32 v77, v77, v9
  v_add_f32 v78, v78, v10
  v_add_f32 v79, v79, v11
  v_cvt_pk_bf16_f32 v16, v76, v77
  v_cvt_pk_bf16_f32 v17, v78, v79
  s_waitcnt lgkmcnt(12)
  v_lshlrev_b32 v8, 16, v146
  v_and_b32 v9, s79, v146
  v_lshlrev_b32 v10, 16, v147
  v_and_b32 v11, s79, v147
  v_add_f32 v92, v92, v8
  v_add_f32 v93, v93, v9
  v_add_f32 v94, v94, v10
  v_add_f32 v95, v95, v11
  v_lshlrev_b32 v8, 16, v210
  v_and_b32 v9, s79, v210
  v_lshlrev_b32 v10, 16, v211
  v_and_b32 v11, s79, v211
  v_add_f32 v92, v92, v8
  v_add_f32 v93, v93, v9
  v_add_f32 v94, v94, v10
  v_add_f32 v95, v95, v11
  v_cvt_pk_bf16_f32 v18, v92, v93
  v_cvt_pk_bf16_f32 v19, v94, v95
  s_nop 1
  v_permlane16_swap_b32 v16, v18
  v_permlane16_swap_b32 v17, v19
  buffer_store_dwordx4 v[16:19], v7, s[16:19], s61 offen offset:0 sc1
  s_waitcnt lgkmcnt(11)
  v_lshlrev_b32 v8, 16, v140
  v_and_b32 v9, s79, v140
  v_lshlrev_b32 v10, 16, v141
  v_and_b32 v11, s79, v141
  v_add_f32 v80, v80, v8
  v_add_f32 v81, v81, v9
  v_add_f32 v82, v82, v10
  v_add_f32 v83, v83, v11
  v_lshlrev_b32 v8, 16, v204
  v_and_b32 v9, s79, v204
  v_lshlrev_b32 v10, 16, v205
  v_and_b32 v11, s79, v205
  v_add_f32 v80, v80, v8
  v_add_f32 v81, v81, v9
  v_add_f32 v82, v82, v10
  v_add_f32 v83, v83, v11
  v_cvt_pk_bf16_f32 v20, v80, v81
  v_cvt_pk_bf16_f32 v21, v82, v83
  s_waitcnt lgkmcnt(10)
  v_lshlrev_b32 v8, 16, v148
  v_and_b32 v9, s79, v148
  v_lshlrev_b32 v10, 16, v149
  v_and_b32 v11, s79, v149
  v_add_f32 v96, v96, v8
  v_add_f32 v97, v97, v9
  v_add_f32 v98, v98, v10
  v_add_f32 v99, v99, v11
  v_lshlrev_b32 v8, 16, v212
  v_and_b32 v9, s79, v212
  v_lshlrev_b32 v10, 16, v213
  v_and_b32 v11, s79, v213
  v_add_f32 v96, v96, v8
  v_add_f32 v97, v97, v9
  v_add_f32 v98, v98, v10
  v_add_f32 v99, v99, v11
  v_cvt_pk_bf16_f32 v22, v96, v97
  v_cvt_pk_bf16_f32 v23, v98, v99
  s_nop 1
  v_permlane16_swap_b32 v20, v22
  v_permlane16_swap_b32 v21, v23
  buffer_store_dwordx4 v[20:23], v7, s[16:19], s62 offen offset:0 sc1
  s_waitcnt lgkmcnt(9)
  v_lshlrev_b32 v8, 16, v142
  v_and_b32 v9, s79, v142
  v_lshlrev_b32 v10, 16, v143
  v_and_b32 v11, s79, v143
  v_add_f32 v84, v84, v8
  v_add_f32 v85, v85, v9
  v_add_f32 v86, v86, v10
  v_add_f32 v87, v87, v11
  v_lshlrev_b32 v8, 16, v206
  v_and_b32 v9, s79, v206
  v_lshlrev_b32 v10, 16, v207
  v_and_b32 v11, s79, v207
  v_add_f32 v84, v84, v8
  v_add_f32 v85, v85, v9
  v_add_f32 v86, v86, v10
  v_add_f32 v87, v87, v11
  v_cvt_pk_bf16_f32 v24, v84, v85
  v_cvt_pk_bf16_f32 v25, v86, v87
  s_waitcnt lgkmcnt(8)
  v_lshlrev_b32 v8, 16, v150
  v_and_b32 v9, s79, v150
  v_lshlrev_b32 v10, 16, v151
  v_and_b32 v11, s79, v151
  v_add_f32 v100, v100, v8
  v_add_f32 v101, v101, v9
  v_add_f32 v102, v102, v10
  v_add_f32 v103, v103, v11
  v_lshlrev_b32 v8, 16, v214
  v_and_b32 v9, s79, v214
  v_lshlrev_b32 v10, 16, v215
  v_and_b32 v11, s79, v215
  v_add_f32 v100, v100, v8
  v_add_f32 v101, v101, v9
  v_add_f32 v102, v102, v10
  v_add_f32 v103, v103, v11
  v_cvt_pk_bf16_f32 v26, v100, v101
  v_cvt_pk_bf16_f32 v27, v102, v103
  s_nop 1
  v_permlane16_swap_b32 v24, v26
  v_permlane16_swap_b32 v25, v27
  buffer_store_dwordx4 v[24:27], v7, s[16:19], s63 offen offset:0 sc1
  s_waitcnt lgkmcnt(7)
  v_lshlrev_b32 v8, 16, v152
  v_and_b32 v9, s79, v152
  v_lshlrev_b32 v10, 16, v153
  v_and_b32 v11, s79, v153
  v_add_f32 v104, v104, v8
  v_add_f32 v105, v105, v9
  v_add_f32 v106, v106, v10
  v_add_f32 v107, v107, v11
  v_lshlrev_b32 v8, 16, v216
  v_and_b32 v9, s79, v216
  v_lshlrev_b32 v10, 16, v217
  v_and_b32 v11, s79, v217
  v_add_f32 v104, v104, v8
  v_add_f32 v105, v105, v9
  v_add_f32 v106, v106, v10
  v_add_f32 v107, v107, v11
  v_cvt_pk_bf16_f32 v28, v104, v105
  v_cvt_pk_bf16_f32 v29, v106, v107
  s_waitcnt lgkmcnt(6)
  v_lshlrev_b32 v8, 16, v160
  v_and_b32 v9, s79, v160
  v_lshlrev_b32 v10, 16, v161
  v_and_b32 v11, s79, v161
  v_add_f32 v120, v120, v8
  v_add_f32 v121, v121, v9
  v_add_f32 v122, v122, v10
  v_add_f32 v123, v123, v11
  v_lshlrev_b32 v8, 16, v224
  v_and_b32 v9, s79, v224
  v_lshlrev_b32 v10, 16, v225
  v_and_b32 v11, s79, v225
  v_add_f32 v120, v120, v8
  v_add_f32 v121, v121, v9
  v_add_f32 v122, v122, v10
  v_add_f32 v123, v123, v11
  v_cvt_pk_bf16_f32 v30, v120, v121
  v_cvt_pk_bf16_f32 v31, v122, v123
  s_nop 1
  v_permlane16_swap_b32 v28, v30
  v_permlane16_swap_b32 v29, v31
  buffer_store_dwordx4 v[28:31], v7, s[16:19], 0 offen offset:64 sc1
  s_waitcnt lgkmcnt(5)
  v_lshlrev_b32 v8, 16, v154
  v_and_b32 v9, s79, v154
  v_lshlrev_b32 v10, 16, v155
  v_and_b32 v11, s79, v155
  v_add_f32 v108, v108, v8
  v_add_f32 v109, v109, v9
  v_add_f32 v110, v110, v10
  v_add_f32 v111, v111, v11
  v_lshlrev_b32 v8, 16, v218
  v_and_b32 v9, s79, v218
  v_lshlrev_b32 v10, 16, v219
  v_and_b32 v11, s79, v219
  v_add_f32 v108, v108, v8
  v_add_f32 v109, v109, v9
  v_add_f32 v110, v110, v10
  v_add_f32 v111, v111, v11
  v_cvt_pk_bf16_f32 v32, v108, v109
  v_cvt_pk_bf16_f32 v33, v110, v111
  s_waitcnt lgkmcnt(4)
  v_lshlrev_b32 v8, 16, v162
  v_and_b32 v9, s79, v162
  v_lshlrev_b32 v10, 16, v163
  v_and_b32 v11, s79, v163
  v_add_f32 v124, v124, v8
  v_add_f32 v125, v125, v9
  v_add_f32 v126, v126, v10
  v_add_f32 v127, v127, v11
  v_lshlrev_b32 v8, 16, v226
  v_and_b32 v9, s79, v226
  v_lshlrev_b32 v10, 16, v227
  v_and_b32 v11, s79, v227
  v_add_f32 v124, v124, v8
  v_add_f32 v125, v125, v9
  v_add_f32 v126, v126, v10
  v_add_f32 v127, v127, v11
  v_cvt_pk_bf16_f32 v34, v124, v125
  v_cvt_pk_bf16_f32 v35, v126, v127
  s_nop 1
  v_permlane16_swap_b32 v32, v34
  v_permlane16_swap_b32 v33, v35
  buffer_store_dwordx4 v[32:35], v7, s[16:19], s61 offen offset:64 sc1
  s_waitcnt lgkmcnt(3)
  v_lshlrev_b32 v8, 16, v156
  v_and_b32 v9, s79, v156
  v_lshlrev_b32 v10, 16, v157
  v_and_b32 v11, s79, v157
  v_add_f32 v112, v112, v8
  v_add_f32 v113, v113, v9
  v_add_f32 v114, v114, v10
  v_add_f32 v115, v115, v11
  v_lshlrev_b32 v8, 16, v220
  v_and_b32 v9, s79, v220
  v_lshlrev_b32 v10, 16, v221
  v_and_b32 v11, s79, v221
  v_add_f32 v112, v112, v8
  v_add_f32 v113, v113, v9
  v_add_f32 v114, v114, v10
  v_add_f32 v115, v115, v11
  v_cvt_pk_bf16_f32 v36, v112, v113
  v_cvt_pk_bf16_f32 v37, v114, v115
  s_waitcnt lgkmcnt(2)
  v_lshlrev_b32 v8, 16, v164
  v_and_b32 v9, s79, v164
  v_lshlrev_b32 v10, 16, v165
  v_and_b32 v11, s79, v165
  v_add_f32 v128, v128, v8
  v_add_f32 v129, v129, v9
  v_add_f32 v130, v130, v10
  v_add_f32 v131, v131, v11
  v_lshlrev_b32 v8, 16, v228
  v_and_b32 v9, s79, v228
  v_lshlrev_b32 v10, 16, v229
  v_and_b32 v11, s79, v229
  v_add_f32 v128, v128, v8
  v_add_f32 v129, v129, v9
  v_add_f32 v130, v130, v10
  v_add_f32 v131, v131, v11
  v_cvt_pk_bf16_f32 v38, v128, v129
  v_cvt_pk_bf16_f32 v39, v130, v131
  s_nop 1
  v_permlane16_swap_b32 v36, v38
  v_permlane16_swap_b32 v37, v39
  buffer_store_dwordx4 v[36:39], v7, s[16:19], s62 offen offset:64 sc1
  s_waitcnt lgkmcnt(1)
  v_lshlrev_b32 v8, 16, v158
  v_and_b32 v9, s79, v158
  v_lshlrev_b32 v10, 16, v159
  v_and_b32 v11, s79, v159
  v_add_f32 v116, v116, v8
  v_add_f32 v117, v117, v9
  v_add_f32 v118, v118, v10
  v_add_f32 v119, v119, v11
  v_lshlrev_b32 v8, 16, v222
  v_and_b32 v9, s79, v222
  v_lshlrev_b32 v10, 16, v223
  v_and_b32 v11, s79, v223
  v_add_f32 v116, v116, v8
  v_add_f32 v117, v117, v9
  v_add_f32 v118, v118, v10
  v_add_f32 v119, v119, v11
  v_cvt_pk_bf16_f32 v40, v116, v117
  v_cvt_pk_bf16_f32 v41, v118, v119
  s_waitcnt lgkmcnt(0)
  v_lshlrev_b32 v8, 16, v166
  v_and_b32 v9, s79, v166
  v_lshlrev_b32 v10, 16, v167
  v_and_b32 v11, s79, v167
  v_add_f32 v132, v132, v8
  v_add_f32 v133, v133, v9
  v_add_f32 v134, v134, v10
  v_add_f32 v135, v135, v11
  v_lshlrev_b32 v8, 16, v230
  v_and_b32 v9, s79, v230
  v_lshlrev_b32 v10, 16, v231
  v_and_b32 v11, s79, v231
  v_add_f32 v132, v132, v8
  v_add_f32 v133, v133, v9
  v_add_f32 v134, v134, v10
  v_add_f32 v135, v135, v11
  v_cvt_pk_bf16_f32 v42, v132, v133
  v_cvt_pk_bf16_f32 v43, v134, v135
  s_nop 1
  v_permlane16_swap_b32 v40, v42
  v_permlane16_swap_b32 v41, v43
  buffer_store_dwordx4 v[40:43], v7, s[16:19], s63 offen offset:64 sc1
  s_branch L_p2_end
L_p2_cevt:
  s_add_u32 s50, s28, s29
  s_cmp_eq_u32 s50, 9
  s_cbranch_scc1 L_p2_cev1
  s_cmp_eq_u32 s50, 15
  s_cbranch_scc1 L_p2_cev2
  s_cmp_eq_u32 s50, 17
  s_cbranch_scc1 L_p2_cev3
  s_cmp_eq_u32 s50, 33
  s_cbranch_scc1 L_p2_cev4
  s_cmp_eq_u32 s50, 35
  s_cbranch_scc1 L_p2_cev5
  s_cmp_eq_u32 s50, 1007
  s_cbranch_scc1 L_p2_cev6
  s_cmp_eq_u32 s50, 1009
  s_cbranch_scc1 L_p2_cev7
  s_cmp_eq_u32 s50, 1011
  s_cbranch_scc1 L_p2_cev8
L_p2_cev0:
  s_lshr_b32 s56, s21, 1
  s_lshl_b32 s56, s56, 11
  s_and_b32 s57, s21, 1
  s_lshl_b32 s57, s57, 8
  s_add_u32 s56, s56, s57
  s_add_u32 s56, s56, 50333184
  buffer_load_dword v159, v158, s[64:67], s56 offen sc1
  s_mov_b32 s31, 9
  s_branch L_p2_cevt_ret
L_p2_cev1:
L_p2_cc_75:
  s_waitcnt vmcnt(0)
  v_cmp_ne_u32 vcc, 1, v159
  s_nop 4
  s_cbranch_vccz L_p2_cc_75_ok
  s_sleep 1
  buffer_load_dword v159, v158, s[64:67], s56 offen sc1
  s_branch L_p2_cc_75
L_p2_cc_75_ok:
  s_mov_b32 s31, 15
  s_branch L_p2_cevt_ret
L_p2_cev2:
  s_lshl_b32 s56, s21, 8
  s_add_u32 s56, s56, 50356224
  buffer_load_dword v159, v158, s[64:67], s56 offen sc1
  s_mov_b32 s31, 17
  s_branch L_p2_cevt_ret
L_p2_cev3:
L_p2_cc_76:
  s_waitcnt vmcnt(0)
  v_cmp_ne_u32 vcc, 1, v159
  s_nop 4
  s_cbranch_vccz L_p2_cc_76_ok
  s_sleep 1
  buffer_load_dword v159, v158, s[64:67], s56 offen sc1
  s_branch L_p2_cc_76
L_p2_cc_76_ok:
  s_mov_b32 s31, 33
  s_branch L_p2_cevt_ret
L_p2_cev4:
  s_lshl_b32 s56, s23, 7
  s_add_u32 s56, s56, 50360320
  v_and_b32 v157, 12, v158
  buffer_load_dword v159, v157, s[64:67], s56 offen sc1
  s_mov_b32 s31, 35
  s_branch L_p2_cevt_ret
L_p2_cev5:
L_p2_cc_77:
  s_waitcnt vmcnt(0)
  v_cmp_ne_u32 vcc, 1, v159
  s_nop 4
  s_cbranch_vccz L_p2_cc_77_ok
  s_sleep 1
  buffer_load_dword v159, v157, s[64:67], s56 offen sc1
  s_branch L_p2_cc_77
L_p2_cc_77_ok:
  s_mov_b32 s31, -1
  s_branch L_p2_cevt_ret
L_p2_cev6:
  s_lshr_b32 s56, s21, 1
  s_lshl_b32 s56, s56, 11
  s_and_b32 s57, s21, 1
  s_lshl_b32 s57, s57, 8
  s_add_u32 s56, s56, s57
  s_add_u32 s56, s56, 50332672
  buffer_load_dword v159, v158, s[64:67], s56 offen sc1
  s_mov_b32 s31, 9
  s_branch L_p2_cevt_ret
L_p2_cev7:
L_p2_cc_78:
  s_waitcnt vmcnt(0)
  v_cmp_ne_u32 vcc, 1, v159
  s_nop 4
  s_cbranch_vccz L_p2_cc_78_ok
  s_sleep 1
  buffer_load_dword v159, v158, s[64:67], s56 offen sc1
  s_branch L_p2_cc_78
L_p2_cc_78_ok:
  s_lshr_b32 s56, s21, 1
  s_lshl_b32 s56, s56, 11
  s_and_b32 s57, s21, 1
  s_lshl_b32 s57, s57, 8
  s_add_u32 s56, s56, s57
  s_add_u32 s56, s56, 50333184
  buffer_load_dword v159, v158, s[64:67], s56 offen sc1
  s_mov_b32 s31, 11
  s_branch L_p2_cevt_ret
L_p2_cev8:
L_p2_cc_79:
  s_waitcnt vmcnt(0)
  v_cmp_ne_u32 vcc, 1, v159
  s_nop 4
  s_cbranch_vccz L_p2_cc_79_ok
  s_sleep 1
  buffer_load_dword v159, v158, s[64:67], s56 offen sc1
  s_branch L_p2_cc_79
L_p2_cc_79_ok:
  s_mov_b32 s31, -1
  s_branch L_p2_cevt_ret
L_p2_prod:
  v_mov_b32 v120, v96
  v_mov_b32 v121, v97
  v_mov_b32 v122, v98
  v_mov_b32 v123, v99
  v_mov_b32 v124, v100
  v_mov_b32 v125, v101
  v_mov_b32 v126, v102
  v_mov_b32 v127, v103
  v_mov_b32 v128, v104
  v_mov_b32 v129, v105
  v_mov_b32 v130, v106
  v_mov_b32 v131, v107
  v_mov_b32 v132, v108
  v_mov_b32 v133, v109
  v_mov_b32 v134, v110
  v_mov_b32 v135, v111
  v_mov_b32 v56, v88
  v_mov_b32 v57, v89
  v_mov_b32 v58, v90
  v_mov_b32 v59, v91
  v_mov_b32 v60, v92
  v_mov_b32 v61, v93
  v_mov_b32 v62, v94
  v_mov_b32 v63, v95
  v_mov_b32 v4, v9
  v_lshrrev_b32 v3, 4, v4
  v_lshrrev_b32 v5, 4, v3
  v_and_b32 v6, 15, v3
  v_lshlrev_b32 v12, 2, v3
  v_mov_b32 v13, 0
  v_mov_b32 v14, 1
  s_and_b32 s50, s2, 7
  s_lshr_b32 s51, s2, 3
  s_and_b32 s20, s50, 1
  s_lshr_b32 s21, s50, 1
  s_lshl_b32 s21, s21, 2
  s_and_b32 s50, s51, 3
  s_add_u32 s21, s21, s50
  s_lshr_b32 s22, s51, 2
  s_lshl_b32 s23, s21, 3
  s_add_u32 s23, s23, s22
  s_cmp_eq_u32 s20, 1
  s_cselect_b32 s60, 34, 38
  s_barrier
  s_mov_b32 s12, s100
  s_and_b32 s13, s101, 0xffff
  s_mov_b32 s14, 7340032
  s_mov_b32 s15, 0x00020000
  v_lshlrev_b32 v22, 3, v3
  v_add_u32 v22, 149760, v22
  s_lshl_b32 s50, s21, 13
  s_lshl_b32 s55, s4, 11
  s_add_u32 s50, s50, s55
  s_add_u32 s50, s50, 0
  v_add_u32 v8, s50, v4
  s_lshl_b32 s51, s4, 1
  v_lshlrev_b32 v9, 3, v5
  v_add_u32 v9, s51, v9
  v_lshlrev_b32 v9, 11, v9
  v_lshl_add_u32 v9, v6, 4, v9
  s_lshl_b32 s50, s22, 8
  v_add_u32 v9, s50, v9
  v_lshrrev_b32 v10, 1, v5
  v_mul_u32_u24 v10, 196608, v10
  v_add_u32 v10, v10, v9
  v_mov_b32 v11, v9
  s_lshl_b32 s34, s4, 11
  s_mul_i32 s35, s4, 2112
  s_add_u32 s35, s35, 8192
  s_lshl_b32 s58, s6, 17
  s_lshl_b32 s55, s7, 14
  s_add_u32 s58, s58, s55
  s_lshl_b32 s55, s4, 12
  s_add_u32 s58, s58, s55
  s_add_u32 s58, s58, 23068672
  s_cmp_eq_u32 s20, 1
  s_cselect_b32 s26, 0, 262144
  s_cselect_b32 s27, 0, 131072
  s_cselect_b32 s30, 1000, 0
  s_add_u32 s26, s26, 8388608
  s_add_u32 s31, s30, 32
  s_mov_b32 s28, 393216
  s_mov_b32 s29, 229376
  s_mov_b32 s33, 2048
  v_mfma_f32_16x16x32_bf16 v[64:67], v[56:59], v[120:123], 0
  v_mfma_f32_16x16x32_bf16 v[68:71], v[60:63], v[120:123], 0
  s_nop 7
  v_max3_f32 v96, v64, v65, v66
  v_min3_f32 v97, v64, v65, v66
  v_max3_f32 v96, v96, v67, v68
  v_min3_f32 v97, v97, v67, v68
  v_max3_f32 v96, v96, v69, v70
  v_min3_f32 v97, v97, v69, v70
  v_max_f32 v96, v96, v71
  v_min_f32 v97, v97, v71
  v_mov_b32 v98, v96
  v_mov_b32 v99, v97
  s_nop 1
  v_permlane16_swap_b32 v96, v98
  v_permlane16_swap_b32 v97, v99
  v_max_f32 v96, v96, v98
  v_min_f32 v97, v97, v99
  v_mov_b32 v98, v96
  v_mov_b32 v99, v97
  s_nop 1
  v_permlane32_swap_b32 v96, v98
  v_permlane32_swap_b32 v97, v99
  v_max_f32 v96, v96, v98
  v_min_f32 v97, v97, v99
  v_mul_f32 v96, s72, v96
  v_mul_f32 v97, s73, v97
  v_fma_f32 v100, v64, s73, v96
  v_fma_f32 v108, v64, s72, v97
  v_fma_f32 v101, v65, s73, v96
  v_fma_f32 v109, v65, s72, v97
  v_fma_f32 v102, v66, s73, v96
  v_fma_f32 v110, v66, s72, v97
  v_fma_f32 v103, v67, s73, v96
  v_fma_f32 v111, v67, s72, v97
  v_fma_f32 v104, v68, s73, v96
  v_fma_f32 v112, v68, s72, v97
  v_fma_f32 v105, v69, s73, v96
  v_fma_f32 v113, v69, s72, v97
  v_fma_f32 v106, v70, s73, v96
  v_fma_f32 v114, v70, s72, v97
  v_fma_f32 v107, v71, s73, v96
  v_fma_f32 v115, v71, s72, v97
  v_exp_f32 v100, v100
  v_exp_f32 v108, v108
  v_exp_f32 v101, v101
  v_exp_f32 v109, v109
  v_exp_f32 v102, v102
  v_exp_f32 v110, v110
  v_exp_f32 v103, v103
  v_exp_f32 v111, v111
  v_exp_f32 v104, v104
  v_exp_f32 v112, v112
  v_exp_f32 v105, v105
  v_exp_f32 v113, v113
  v_exp_f32 v106, v106
  v_exp_f32 v114, v114
  v_exp_f32 v107, v107
  v_exp_f32 v115, v115
  v_add_f32 v116, v100, v101
  v_add_f32 v117, v108, v109
  v_add_f32 v116, v116, v102
  v_add_f32 v117, v117, v110
  v_add_f32 v116, v116, v103
  v_add_f32 v117, v117, v111
  v_add_f32 v116, v116, v104
  v_add_f32 v117, v117, v112
  v_add_f32 v116, v116, v105
  v_add_f32 v117, v117, v113
  v_add_f32 v116, v116, v106
  v_add_f32 v117, v117, v114
  v_add_f32 v116, v116, v107
  v_add_f32 v117, v117, v115
  v_mov_b32 v98, v116
  v_mov_b32 v99, v117
  s_nop 1
  v_permlane16_swap_b32 v116, v98
  v_permlane16_swap_b32 v117, v99
  v_add_f32 v116, v116, v98
  v_add_f32 v117, v117, v99
  v_mov_b32 v98, v116
  v_mov_b32 v99, v117
  s_nop 1
  v_permlane32_swap_b32 v116, v98
  v_permlane32_swap_b32 v117, v99
  v_add_f32 v116, v116, v98
  v_add_f32 v117, v117, v99
  v_rcp_f32 v116, v116
  v_rcp_f32 v117, v117
  s_nop 0
  v_mul_f32 v100, v100, v116
  v_mul_f32 v108, v108, v117
  v_mul_f32 v101, v101, v116
  v_mul_f32 v109, v109, v117
  v_mul_f32 v102, v102, v116
  v_mul_f32 v110, v110, v117
  v_mul_f32 v103, v103, v116
  v_mul_f32 v111, v111, v117
  v_mul_f32 v104, v104, v116
  v_mul_f32 v112, v112, v117
  v_mul_f32 v105, v105, v116
  v_mul_f32 v113, v113, v117
  v_mul_f32 v106, v106, v116
  v_mul_f32 v114, v114, v117
  v_mul_f32 v107, v107, v116
  v_mul_f32 v115, v115, v117
  v_cvt_pk_bf16_f32 v136, v100, v101
  v_cvt_pk_bf16_f32 v140, v108, v109
  v_cvt_pk_bf16_f32 v137, v102, v103
  v_cvt_pk_bf16_f32 v141, v110, v111
  v_cvt_pk_bf16_f32 v138, v104, v105
  v_cvt_pk_bf16_f32 v142, v112, v113
  v_cvt_pk_bf16_f32 v139, v106, v107
  v_cvt_pk_bf16_f32 v143, v114, v115
  s_lshl_b32 s50, s7, 11
  s_lshl_b32 s55, s3, 7
  s_add_u32 s50, s50, s55
  s_lshl_b32 s55, s6, 2
  s_add_u32 s50, s50, s55
  s_add_u32 s50, s50, 50332672
  s_lshl_b32 s51, s6, 8
  s_lshl_b32 s55, s7, 5
  s_add_u32 s51, s51, s55
  s_lshl_b32 s55, s3, 2
  s_add_u32 s51, s51, s55
  s_add_u32 s51, s51, 50348032
  s_waitcnt vmcnt(0)
  s_mov_b64 exec, 1
  buffer_store_dword v14, v13, s[64:67], s50 offen sc1
  buffer_store_dword v14, v13, s[64:67], s51 offen sc1
  s_mov_b64 exec, -1
  s_mov_b32 s32, 0
  s_add_u32 m0, s32, s35
  s_add_u32 s56, s27, s33
  buffer_load_dwordx4 v11, s[12:15], s27 offen sc1 lds
  s_add_u32 m0, m0, 1056
  s_add_u32 s27, s27, s29
  buffer_load_dwordx4 v11, s[12:15], s56 offen sc1 lds
  s_add_u32 s32, s32, 16640
  s_cmp_eq_u32 s32, 149760
  s_cselect_b32 s32, 0, s32
  s_add_u32 m0, s32, s35
  s_add_u32 s56, s27, s33
  buffer_load_dwordx4 v11, s[12:15], s27 offen sc1 lds
  s_add_u32 m0, m0, 1056
  s_add_u32 s27, s27, s29
  buffer_load_dwordx4 v11, s[12:15], s56 offen sc1 lds
  s_add_u32 s32, s32, 16640
  s_cmp_eq_u32 s32, 149760
  s_cselect_b32 s32, 0, s32
  s_add_u32 m0, s32, s35
  s_add_u32 s56, s27, s33
  buffer_load_dwordx4 v11, s[12:15], s27 offen sc1 lds
  s_add_u32 m0, m0, 1056
  s_add_u32 s27, s27, s29
  buffer_load_dwordx4 v11, s[12:15], s56 offen sc1 lds
  s_add_u32 s32, s32, 16640
  s_cmp_eq_u32 s32, 149760
  s_cselect_b32 s32, 0, s32
  s_add_u32 m0, s32, s35
  s_add_u32 s56, s27, s33
  buffer_load_dwordx4 v11, s[12:15], s27 offen sc1 lds
  s_add_u32 m0, m0, 1056
  s_add_u32 s27, s27, s29
  buffer_load_dwordx4 v11, s[12:15], s56 offen sc1 lds
  s_add_u32 s32, s32, 16640
  s_cmp_eq_u32 s32, 149760
  s_cselect_b32 s32, 0, s32
  s_add_u32 m0, s32, s35
  s_add_u32 s56, s27, s33
  buffer_load_dwordx4 v11, s[12:15], s27 offen sc1 lds
  s_add_u32 m0, m0, 1056
  s_add_u32 s27, s27, s29
  buffer_load_dwordx4 v11, s[12:15], s56 offen sc1 lds
  s_add_u32 s32, s32, 16640
  s_cmp_eq_u32 s32, 149760
  s_cselect_b32 s32, 0, s32
  s_add_u32 m0, s32, s35
  s_add_u32 s56, s27, s33
  buffer_load_dwordx4 v11, s[12:15], s27 offen sc1 lds
  s_add_u32 m0, m0, 1056
  s_add_u32 s27, s27, s29
  buffer_load_dwordx4 v11, s[12:15], s56 offen sc1 lds
  s_add_u32 s32, s32, 16640
  s_cmp_eq_u32 s32, 149760
  s_cselect_b32 s32, 0, s32
  s_add_u32 m0, s32, s35
  s_add_u32 s56, s27, s33
  buffer_load_dwordx4 v11, s[12:15], s27 offen sc1 lds
  s_add_u32 m0, m0, 1056
  s_add_u32 s27, s27, s29
  buffer_load_dwordx4 v11, s[12:15], s56 offen sc1 lds
  s_add_u32 s32, s32, 16640
  s_cmp_eq_u32 s32, 149760
  s_cselect_b32 s32, 0, s32
  s_lshr_b32 s50, s21, 1
  s_lshl_b32 s50, s50, 11
  s_and_b32 s51, s21, 1
  s_lshl_b32 s51, s51, 8
  s_add_u32 s50, s50, s51
  s_add_u32 s50, s50, 50331648
  s_cmp_eq_u32 s20, 1
  s_cselect_b32 s51, 0, 512
  s_add_u32 s50, s50, s51
  buffer_load_dword v15, v12, s[64:67], s50 offen sc1
  v_mfma_f32_16x16x32_bf16 v[64:67], v[56:59], v[124:127], 0
  v_mfma_f32_16x16x32_bf16 v[68:71], v[60:63], v[124:127], 0
  s_nop 7
  v_max3_f32 v96, v64, v65, v66
  v_min3_f32 v97, v64, v65, v66
  v_max3_f32 v96, v96, v67, v68
  v_min3_f32 v97, v97, v67, v68
  v_max3_f32 v96, v96, v69, v70
  v_min3_f32 v97, v97, v69, v70
  v_max_f32 v96, v96, v71
  v_min_f32 v97, v97, v71
  v_mov_b32 v98, v96
  v_mov_b32 v99, v97
  s_nop 1
  v_permlane16_swap_b32 v96, v98
  v_permlane16_swap_b32 v97, v99
  v_max_f32 v96, v96, v98
  v_min_f32 v97, v97, v99
  v_mov_b32 v98, v96
  v_mov_b32 v99, v97
  s_nop 1
  v_permlane32_swap_b32 v96, v98
  v_permlane32_swap_b32 v97, v99
  v_max_f32 v96, v96, v98
  v_min_f32 v97, v97, v99
  v_mul_f32 v96, s72, v96
  v_mul_f32 v97, s73, v97
  v_fma_f32 v100, v64, s73, v96
  v_fma_f32 v108, v64, s72, v97
  v_fma_f32 v101, v65, s73, v96
  v_fma_f32 v109, v65, s72, v97
  v_fma_f32 v102, v66, s73, v96
  v_fma_f32 v110, v66, s72, v97
  v_fma_f32 v103, v67, s73, v96
  v_fma_f32 v111, v67, s72, v97
  v_fma_f32 v104, v68, s73, v96
  v_fma_f32 v112, v68, s72, v97
  v_fma_f32 v105, v69, s73, v96
  v_fma_f32 v113, v69, s72, v97
  v_fma_f32 v106, v70, s73, v96
  v_fma_f32 v114, v70, s72, v97
  v_fma_f32 v107, v71, s73, v96
  v_fma_f32 v115, v71, s72, v97
  v_exp_f32 v100, v100
  v_exp_f32 v108, v108
  v_exp_f32 v101, v101
  v_exp_f32 v109, v109
  v_exp_f32 v102, v102
  v_exp_f32 v110, v110
  v_exp_f32 v103, v103
  v_exp_f32 v111, v111
  v_exp_f32 v104, v104
  v_exp_f32 v112, v112
  v_exp_f32 v105, v105
  v_exp_f32 v113, v113
  v_exp_f32 v106, v106
  v_exp_f32 v114, v114
  v_exp_f32 v107, v107
  v_exp_f32 v115, v115
  v_add_f32 v116, v100, v101
  v_add_f32 v117, v108, v109
  v_add_f32 v116, v116, v102
  v_add_f32 v117, v117, v110
  v_add_f32 v116, v116, v103
  v_add_f32 v117, v117, v111
  v_add_f32 v116, v116, v104
  v_add_f32 v117, v117, v112
  v_add_f32 v116, v116, v105
  v_add_f32 v117, v117, v113
  v_add_f32 v116, v116, v106
  v_add_f32 v117, v117, v114
  v_add_f32 v116, v116, v107
  v_add_f32 v117, v117, v115
  v_mov_b32 v98, v116
  v_mov_b32 v99, v117
  s_nop 1
  v_permlane16_swap_b32 v116, v98
  v_permlane16_swap_b32 v117, v99
  v_add_f32 v116, v116, v98
  v_add_f32 v117, v117, v99
  v_mov_b32 v98, v116
  v_mov_b32 v99, v117
  s_nop 1
  v_permlane32_swap_b32 v116, v98
  v_permlane32_swap_b32 v117, v99
  v_add_f32 v116, v116, v98
  v_add_f32 v117, v117, v99
  v_rcp_f32 v116, v116
  v_rcp_f32 v117, v117
  s_nop 0
  v_mul_f32 v100, v100, v116
  v_mul_f32 v108, v108, v117
  v_mul_f32 v101, v101, v116
  v_mul_f32 v109, v109, v117
  v_mul_f32 v102, v102, v116
  v_mul_f32 v110, v110, v117
  v_mul_f32 v103, v103, v116
  v_mul_f32 v111, v111, v117
  v_mul_f32 v104, v104, v116
  v_mul_f32 v112, v112, v117
  v_mul_f32 v105, v105, v116
  v_mul_f32 v113, v113, v117
  v_mul_f32 v106, v106, v116
  v_mul_f32 v114, v114, v117
  v_mul_f32 v107, v107, v116
  v_mul_f32 v115, v115, v117
  v_cvt_pk_bf16_f32 v144, v100, v101
  v_cvt_pk_bf16_f32 v148, v108, v109
  v_cvt_pk_bf16_f32 v145, v102, v103
  v_cvt_pk_bf16_f32 v149, v110, v111
  v_cvt_pk_bf16_f32 v146, v104, v105
  v_cvt_pk_bf16_f32 v150, v112, v113
  v_cvt_pk_bf16_f32 v147, v106, v107
  v_cvt_pk_bf16_f32 v151, v114, v115
L_p2_poll0:
  s_waitcnt vmcnt(0)
  v_cmp_ne_u32 vcc, 1, v15
  s_nop 4
  s_cbranch_vccz L_p2_poll0_ok
  s_sleep 1
  buffer_load_dword v15, v12, s[64:67], s50 offen sc1
  s_branch L_p2_poll0
L_p2_poll0_ok:
  s_mov_b32 s32, 0
  s_add_u32 m0, s32, s34
  s_add_u32 s56, s27, s33
  buffer_load_dwordx4 v8, s[64:67], s26 offen sc1 lds
  buffer_load_dwordx4 v8, s[64:67], s26 offen offset:1024 sc1 lds
  s_add_u32 s26, s26, s28
  s_add_u32 s32, s32, 16640
  s_cmp_eq_u32 s32, 149760
  s_cselect_b32 s32, 0, s32
  s_add_u32 m0, s32, s34
  s_add_u32 s56, s27, s33
  buffer_load_dwordx4 v8, s[64:67], s26 offen sc1 lds
  buffer_load_dwordx4 v8, s[64:67], s26 offen offset:1024 sc1 lds
  s_add_u32 s26, s26, s28
  s_add_u32 s32, s32, 16640
  s_cmp_eq_u32 s32, 149760
  s_cselect_b32 s32, 0, s32
  s_add_u32 m0, s32, s34
  s_add_u32 s56, s27, s33
  buffer_load_dwordx4 v8, s[64:67], s26 offen sc1 lds
  buffer_load_dwordx4 v8, s[64:67], s26 offen offset:1024 sc1 lds
  s_add_u32 s26, s26, s28
  s_add_u32 s32, s32, 16640
  s_cmp_eq_u32 s32, 149760
  s_cselect_b32 s32, 0, s32
  s_add_u32 m0, s32, s34
  s_add_u32 s56, s27, s33
  buffer_load_dwordx4 v8, s[64:67], s26 offen sc1 lds
  buffer_load_dwordx4 v8, s[64:67], s26 offen offset:1024 sc1 lds
  s_add_u32 s26, s26, s28
  s_add_u32 s32, s32, 16640
  s_cmp_eq_u32 s32, 149760
  s_cselect_b32 s32, 0, s32
  s_add_u32 m0, s32, s34
  s_add_u32 s56, s27, s33
  buffer_load_dwordx4 v8, s[64:67], s26 offen sc1 lds
  buffer_load_dwordx4 v8, s[64:67], s26 offen offset:1024 sc1 lds
  s_add_u32 s26, s26, s28
  s_add_u32 s32, s32, 16640
  s_cmp_eq_u32 s32, 149760
  s_cselect_b32 s32, 0, s32
  s_add_u32 m0, s32, s34
  s_add_u32 s56, s27, s33
  buffer_load_dwordx4 v8, s[64:67], s26 offen sc1 lds
  buffer_load_dwordx4 v8, s[64:67], s26 offen offset:1024 sc1 lds
  s_add_u32 s26, s26, s28
  s_add_u32 s32, s32, 16640
  s_cmp_eq_u32 s32, 149760
  s_cselect_b32 s32, 0, s32
  s_add_u32 m0, s32, s34
  s_add_u32 s56, s27, s33
  buffer_load_dwordx4 v8, s[64:67], s26 offen sc1 lds
  buffer_load_dwordx4 v8, s[64:67], s26 offen offset:1024 sc1 lds
  s_add_u32 s26, s26, s28
  s_add_u32 s32, s32, 16640
  s_cmp_eq_u32 s32, 149760
  s_cselect_b32 s32, 0, s32
  s_add_u32 s30, s30, 7
  v_mfma_f32_16x16x32_bf16 v[64:67], v[56:59], v[128:131], 0
  v_mfma_f32_16x16x32_bf16 v[68:71], v[60:63], v[128:131], 0
  s_nop 7
  v_max3_f32 v96, v64, v65, v66
  v_min3_f32 v97, v64, v65, v66
  v_max3_f32 v96, v96, v67, v68
  v_min3_f32 v97, v97, v67, v68
  v_max3_f32 v96, v96, v69, v70
  v_min3_f32 v97, v97, v69, v70
  v_max_f32 v96, v96, v71
  v_min_f32 v97, v97, v71
  v_mov_b32 v98, v96
  v_mov_b32 v99, v97
  s_nop 1
  v_permlane16_swap_b32 v96, v98
  v_permlane16_swap_b32 v97, v99
  v_max_f32 v96, v96, v98
  v_min_f32 v97, v97, v99
  v_mov_b32 v98, v96
  v_mov_b32 v99, v97
  s_nop 1
  v_permlane32_swap_b32 v96, v98
  v_permlane32_swap_b32 v97, v99
  v_max_f32 v96, v96, v98
  v_min_f32 v97, v97, v99
  v_mul_f32 v96, s72, v96
  v_mul_f32 v97, s73, v97
  v_fma_f32 v100, v64, s73, v96
  v_fma_f32 v108, v64, s72, v97
  v_fma_f32 v101, v65, s73, v96
  v_fma_f32 v109, v65, s72, v97
  v_fma_f32 v102, v66, s73, v96
  v_fma_f32 v110, v66, s72, v97
  v_fma_f32 v103, v67, s73, v96
  v_fma_f32 v111, v67, s72, v97
  v_fma_f32 v104, v68, s73, v96
  v_fma_f32 v112, v68, s72, v97
  v_fma_f32 v105, v69, s73, v96
  v_fma_f32 v113, v69, s72, v97
  v_fma_f32 v106, v70, s73, v96
  v_fma_f32 v114, v70, s72, v97
  v_fma_f32 v107, v71, s73, v96
  v_fma_f32 v115, v71, s72, v97
  v_exp_f32 v100, v100
  v_exp_f32 v108, v108
  v_exp_f32 v101, v101
  v_exp_f32 v109, v109
  v_exp_f32 v102, v102
  v_exp_f32 v110, v110
  v_exp_f32 v103, v103
  v_exp_f32 v111, v111
  v_exp_f32 v104, v104
  v_exp_f32 v112, v112
  v_exp_f32 v105, v105
  v_exp_f32 v113, v113
  v_exp_f32 v106, v106
  v_exp_f32 v114, v114
  v_exp_f32 v107, v107
  v_exp_f32 v115, v115
  v_add_f32 v116, v100, v101
  v_add_f32 v117, v108, v109
  v_add_f32 v116, v116, v102
  v_add_f32 v117, v117, v110
  v_add_f32 v116, v116, v103
  v_add_f32 v117, v117, v111
  v_add_f32 v116, v116, v104
  v_add_f32 v117, v117, v112
  v_add_f32 v116, v116, v105
  v_add_f32 v117, v117, v113
  v_add_f32 v116, v116, v106
  v_add_f32 v117, v117, v114
  v_add_f32 v116, v116, v107
  v_add_f32 v117, v117, v115
  v_mov_b32 v98, v116
  v_mov_b32 v99, v117
  s_nop 1
  v_permlane16_swap_b32 v116, v98
  v_permlane16_swap_b32 v117, v99
  v_add_f32 v116, v116, v98
  v_add_f32 v117, v117, v99
  v_mov_b32 v98, v116
  v_mov_b32 v99, v117
  s_nop 1
  v_permlane32_swap_b32 v116, v98
  v_permlane32_swap_b32 v117, v99
  v_add_f32 v116, v116, v98
  v_add_f32 v117, v117, v99
  v_rcp_f32 v116, v116
  v_rcp_f32 v117, v117
  s_nop 0
  v_mul_f32 v100, v100, v116
  v_mul_f32 v108, v108, v117
  v_mul_f32 v101, v101, v116
  v_mul_f32 v109, v109, v117
  v_mul_f32 v102, v102, v116
  v_mul_f32 v110, v110, v117
  v_mul_f32 v103, v103, v116
  v_mul_f32 v111, v111, v117
  v_mul_f32 v104, v104, v116
  v_mul_f32 v112, v112, v117
  v_mul_f32 v105, v105, v116
  v_mul_f32 v113, v113, v117
  v_mul_f32 v106, v106, v116
  v_mul_f32 v114, v114, v117
  v_mul_f32 v107, v107, v116
  v_mul_f32 v115, v115, v117
  v_cvt_pk_bf16_f32 v152, v100, v101
  v_cvt_pk_bf16_f32 v156, v108, v109
  v_cvt_pk_bf16_f32 v153, v102, v103
  v_cvt_pk_bf16_f32 v157, v110, v111
  v_cvt_pk_bf16_f32 v154, v104, v105
  v_cvt_pk_bf16_f32 v158, v112, v113
  v_cvt_pk_bf16_f32 v155, v106, v107
  v_cvt_pk_bf16_f32 v159, v114, v115
  s_waitcnt vmcnt(8)
  s_barrier
  s_add_u32 m0, s32, s34
  s_add_u32 s56, s27, s33
  buffer_load_dwordx4 v8, s[64:67], s26 offen sc1 lds
  buffer_load_dwordx4 v8, s[64:67], s26 offen offset:1024 sc1 lds
  s_add_u32 s26, s26, s28
  s_add_u32 m0, s32, s35
  s_nop 0
  buffer_load_dwordx4 v11, s[12:15], s27 offen sc1 lds
  s_add_u32 m0, m0, 1056
  s_add_u32 s27, s27, s29
  buffer_load_dwordx4 v11, s[12:15], s56 offen sc1 lds
  s_add_u32 s30, s30, 1
  s_add_u32 s32, s32, 16640
  s_cmp_eq_u32 s32, 149760
  s_cselect_b32 s32, 0, s32
  s_cmp_eq_u32 s30, s31
  s_cbranch_scc0 L_p2_ne_80
  s_call_b64 s[76:77], L_p2_evt
L_p2_ne_80:
  s_add_u32 m0, s32, s34
  s_add_u32 s56, s27, s33
  buffer_load_dwordx4 v8, s[64:67], s26 offen sc1 lds
  buffer_load_dwordx4 v8, s[64:67], s26 offen offset:1024 sc1 lds
  s_add_u32 s26, s26, s28
  s_add_u32 m0, s32, s35
  s_nop 0
  buffer_load_dwordx4 v11, s[12:15], s27 offen sc1 lds
  s_add_u32 m0, m0, 1056
  s_add_u32 s27, s27, s29
  buffer_load_dwordx4 v11, s[12:15], s56 offen sc1 lds
  s_add_u32 s30, s30, 1
  s_add_u32 s32, s32, 16640
  s_cmp_eq_u32 s32, 149760
  s_cselect_b32 s32, 0, s32
  s_waitcnt vmcnt(12)
  s_barrier
  s_add_u32 m0, s32, s34
  s_add_u32 s56, s27, s33
  buffer_load_dwordx4 v8, s[64:67], s26 offen sc1 lds
  buffer_load_dwordx4 v8, s[64:67], s26 offen offset:1024 sc1 lds
  s_add_u32 s26, s26, s28
  s_add_u32 m0, s32, s35
  s_nop 0
  buffer_load_dwordx4 v11, s[12:15], s27 offen sc1 lds
  s_add_u32 m0, m0, 1056
  s_add_u32 s27, s27, s29
  buffer_load_dwordx4 v11, s[12:15], s56 offen sc1 lds
  s_add_u32 s30, s30, 1
  s_add_u32 s32, s32, 16640
  s_cmp_eq_u32 s32, 149760
  s_cselect_b32 s32, 0, s32
  s_cmp_eq_u32 s30, s31
  s_cbranch_scc0 L_p2_ne_81
  s_call_b64 s[76:77], L_p2_evt
L_p2_ne_81:
  s_add_u32 m0, s32, s34
  s_add_u32 s56, s27, s33
  buffer_load_dwordx4 v8, s[64:67], s26 offen sc1 lds
  buffer_load_dwordx4 v8, s[64:67], s26 offen offset:1024 sc1 lds
  s_add_u32 s26, s26, s28
  s_add_u32 m0, s32, s35
  s_nop 0
  buffer_load_dwordx4 v11, s[12:15], s27 offen sc1 lds
  s_add_u32 m0, m0, 1056
  s_add_u32 s27, s27, s29
  buffer_load_dwordx4 v11, s[12:15], s56 offen sc1 lds
  s_add_u32 s30, s30, 1
  s_add_u32 s32, s32, 16640
  s_cmp_eq_u32 s32, 149760
  s_cselect_b32 s32, 0, s32
  v_mfma_f32_16x16x32_bf16 v[64:67], v[56:59], v[132:135], 0
  v_mfma_f32_16x16x32_bf16 v[68:71], v[60:63], v[132:135], 0
  s_nop 7
  v_max3_f32 v96, v64, v65, v66
  v_min3_f32 v97, v64, v65, v66
  v_max3_f32 v96, v96, v67, v68
  v_min3_f32 v97, v97, v67, v68
  v_max3_f32 v96, v96, v69, v70
  v_min3_f32 v97, v97, v69, v70
  v_max_f32 v96, v96, v71
  v_min_f32 v97, v97, v71
  v_mov_b32 v98, v96
  v_mov_b32 v99, v97
  s_nop 1
  v_permlane16_swap_b32 v96, v98
  v_permlane16_swap_b32 v97, v99
  v_max_f32 v96, v96, v98
  v_min_f32 v97, v97, v99
  v_mov_b32 v98, v96
  v_mov_b32 v99, v97
  s_nop 1
  v_permlane32_swap_b32 v96, v98
  v_permlane32_swap_b32 v97, v99
  v_max_f32 v96, v96, v98
  v_min_f32 v97, v97, v99
  v_mul_f32 v96, s72, v96
  v_mul_f32 v97, s73, v97
  v_fma_f32 v100, v64, s73, v96
  v_fma_f32 v108, v64, s72, v97
  v_fma_f32 v101, v65, s73, v96
  v_fma_f32 v109, v65, s72, v97
  v_fma_f32 v102, v66, s73, v96
  v_fma_f32 v110, v66, s72, v97
  v_fma_f32 v103, v67, s73, v96
  v_fma_f32 v111, v67, s72, v97
  v_fma_f32 v104, v68, s73, v96
  v_fma_f32 v112, v68, s72, v97
  v_fma_f32 v105, v69, s73, v96
  v_fma_f32 v113, v69, s72, v97
  v_fma_f32 v106, v70, s73, v96
  v_fma_f32 v114, v70, s72, v97
  v_fma_f32 v107, v71, s73, v96
  v_fma_f32 v115, v71, s72, v97
  v_exp_f32 v100, v100
  v_exp_f32 v108, v108
  v_exp_f32 v101, v101
  v_exp_f32 v109, v109
  v_exp_f32 v102, v102
  v_exp_f32 v110, v110
  v_exp_f32 v103, v103
  v_exp_f32 v111, v111
  v_exp_f32 v104, v104
  v_exp_f32 v112, v112
  v_exp_f32 v105, v105
  v_exp_f32 v113, v113
  v_exp_f32 v106, v106
  v_exp_f32 v114, v114
  s_waitcnt vmcnt(16)
  s_barrier
  s_add_u32 m0, s32, s34
  s_add_u32 s56, s27, s33
  buffer_load_dwordx4 v8, s[64:67], s26 offen sc1 lds
  buffer_load_dwordx4 v8, s[64:67], s26 offen offset:1024 sc1 lds
  s_add_u32 s26, s26, s28
  s_add_u32 m0, s32, s35
  s_nop 0
  buffer_load_dwordx4 v11, s[12:15], s27 offen sc1 lds
  s_add_u32 m0, m0, 1056
  s_add_u32 s27, s27, s29
  buffer_load_dwordx4 v11, s[12:15], s56 offen sc1 lds
  s_add_u32 s30, s30, 1
  s_add_u32 s32, s32, 16640
  s_cmp_eq_u32 s32, 149760
  s_cselect_b32 s32, 0, s32
  s_cmp_eq_u32 s30, s31
  s_cbranch_scc0 L_p2_ne_82
  s_call_b64 s[76:77], L_p2_evt
L_p2_ne_82:
  s_add_u32 m0, s32, s34
  s_add_u32 s56, s27, s33
  buffer_load_dwordx4 v8, s[64:67], s26 offen sc1 lds
  buffer_load_dwordx4 v8, s[64:67], s26 offen offset:1024 sc1 lds
  s_add_u32 s26, s26, s28
  s_add_u32 m0, s32, s35
  s_nop 0
  buffer_load_dwordx4 v11, s[12:15], s27 offen sc1 lds
  s_add_u32 m0, m0, 1056
  s_add_u32 s27, s27, s29
  buffer_load_dwordx4 v11, s[12:15], s56 offen sc1 lds
  s_add_u32 s30, s30, 1
  s_add_u32 s32, s32, 16640
  s_cmp_eq_u32 s32, 149760
  s_cselect_b32 s32, 0, s32
  s_waitcnt vmcnt(16)
  s_barrier
  s_add_u32 m0, s32, s34
  s_add_u32 s56, s27, s33
  buffer_load_dwordx4 v8, s[64:67], s26 offen sc1 lds
  buffer_load_dwordx4 v8, s[64:67], s26 offen offset:1024 sc1 lds
  s_add_u32 s26, s26, s28
  s_add_u32 m0, s32, s35
  s_nop 0
  buffer_load_dwordx4 v11, s[12:15], s27 offen sc1 lds
  s_add_u32 m0, m0, 1056
  s_add_u32 s27, s27, s29
  buffer_load_dwordx4 v11, s[12:15], s56 offen sc1 lds
  s_add_u32 s30, s30, 1
  s_add_u32 s32, s32, 16640
  s_cmp_eq_u32 s32, 149760
  s_cselect_b32 s32, 0, s32
  s_cmp_eq_u32 s30, s31
  s_cbranch_scc0 L_p2_ne_83
  s_call_b64 s[76:77], L_p2_evt
L_p2_ne_83:
  s_add_u32 m0, s32, s34
  s_add_u32 s56, s27, s33
  buffer_load_dwordx4 v8, s[64:67], s26 offen sc1 lds
  buffer_load_dwordx4 v8, s[64:67], s26 offen offset:1024 sc1 lds
  s_add_u32 s26, s26, s28
  s_add_u32 m0, s32, s35
  s_nop 0
  buffer_load_dwordx4 v11, s[12:15], s27 offen sc1 lds
  s_add_u32 m0, m0, 1056
  s_add_u32 s27, s27, s29
  buffer_load_dwordx4 v11, s[12:15], s56 offen sc1 lds
  s_add_u32 s30, s30, 1
  s_add_u32 s32, s32, 16640
  s_cmp_eq_u32 s32, 149760
  s_cselect_b32 s32, 0, s32
  s_waitcnt vmcnt(16)
  s_barrier
  s_add_u32 m0, s32, s34
  s_add_u32 s56, s27, s33
  buffer_load_dwordx4 v8, s[64:67], s26 offen sc1 lds
  buffer_load_dwordx4 v8, s[64:67], s26 offen offset:1024 sc1 lds
  s_add_u32 s26, s26, s28
  s_add_u32 m0, s32, s35
  s_nop 0
  buffer_load_dwordx4 v11, s[12:15], s27 offen sc1 lds
  s_add_u32 m0, m0, 1056
  s_add_u32 s27, s27, s29
  buffer_load_dwordx4 v11, s[12:15], s56 offen sc1 lds
  s_add_u32 s30, s30, 1
  s_add_u32 s32, s32, 16640
  s_cmp_eq_u32 s32, 149760
  s_cselect_b32 s32, 0, s32
  s_cmp_eq_u32 s30, s31
  s_cbranch_scc0 L_p2_ne_84
  s_call_b64 s[76:77], L_p2_evt
L_p2_ne_84:
  s_add_u32 m0, s32, s34
  s_add_u32 s56, s27, s33
  buffer_load_dwordx4 v8, s[64:67], s26 offen sc1 lds
  buffer_load_dwordx4 v8, s[64:67], s26 offen offset:1024 sc1 lds
  s_add_u32 s26, s26, s28
  s_add_u32 m0, s32, s35
  s_nop 0
  buffer_load_dwordx4 v11, s[12:15], s27 offen sc1 lds
  s_add_u32 m0, m0, 1056
  s_add_u32 s27, s27, s29
  buffer_load_dwordx4 v11, s[12:15], s56 offen sc1 lds
  s_add_u32 s30, s30, 1
  s_add_u32 s32, s32, 16640
  s_cmp_eq_u32 s32, 149760
  s_cselect_b32 s32, 0, s32
  v_exp_f32 v107, v107
  v_exp_f32 v115, v115
  v_add_f32 v116, v100, v101
  v_add_f32 v117, v108, v109
  v_add_f32 v116, v116, v102
  v_add_f32 v117, v117, v110
  v_add_f32 v116, v116, v103
  v_add_f32 v117, v117, v111
  v_add_f32 v116, v116, v104
  v_add_f32 v117, v117, v112
  v_add_f32 v116, v116, v105
  v_add_f32 v117, v117, v113
  v_add_f32 v116, v116, v106
  v_add_f32 v117, v117, v114
  v_add_f32 v116, v116, v107
  v_add_f32 v117, v117, v115
  v_mov_b32 v98, v116
  v_mov_b32 v99, v117
  s_nop 1
  v_permlane16_swap_b32 v116, v98
  v_permlane16_swap_b32 v117, v99
  v_add_f32 v116, v116, v98
  v_add_f32 v117, v117, v99
  v_mov_b32 v98, v116
  v_mov_b32 v99, v117
  s_nop 1
  v_permlane32_swap_b32 v116, v98
  v_permlane32_swap_b32 v117, v99
  v_add_f32 v116, v116, v98
  v_add_f32 v117, v117, v99
  v_rcp_f32 v116, v116
  v_rcp_f32 v117, v117
  s_nop 0
  v_mul_f32 v100, v100, v116
  v_mul_f32 v108, v108, v117
  v_mul_f32 v101, v101, v116
  v_mul_f32 v109, v109, v117
  v_mul_f32 v102, v102, v116
  v_mul_f32 v110, v110, v117
  v_mul_f32 v103, v103, v116
  v_mul_f32 v111, v111, v117
  v_mul_f32 v104, v104, v116
  v_mul_f32 v112, v112, v117
  v_mul_f32 v105, v105, v116
  v_mul_f32 v113, v113, v117
  v_mul_f32 v106, v106, v116
  v_mul_f32 v114, v114, v117
  v_mul_f32 v107, v107, v116
  v_mul_f32 v115, v115, v117
  v_cvt_pk_bf16_f32 v160, v100, v101
  v_cvt_pk_bf16_f32 v164, v108, v109
  v_cvt_pk_bf16_f32 v161, v102, v103
  v_cvt_pk_bf16_f32 v165, v110, v111
  v_cvt_pk_bf16_f32 v162, v104, v105
  v_cvt_pk_bf16_f32 v166, v112, v113
  v_cvt_pk_bf16_f32 v163, v106, v107
  v_cvt_pk_bf16_f32 v167, v114, v115
  s_waitcnt vmcnt(16)
  s_barrier
  s_add_u32 m0, s32, s34
  s_add_u32 s56, s27, s33
  buffer_load_dwordx4 v8, s[64:67], s26 offen sc1 lds
  buffer_load_dwordx4 v8, s[64:67], s26 offen offset:1024 sc1 lds
  s_add_u32 s26, s26, s28
  s_add_u32 m0, s32, s35
  s_nop 0
  buffer_load_dwordx4 v11, s[12:15], s27 offen sc1 lds
  s_add_u32 m0, m0, 1056
  s_add_u32 s27, s27, s29
  buffer_load_dwordx4 v11, s[12:15], s56 offen sc1 lds
  s_add_u32 s30, s30, 1
  s_add_u32 s32, s32, 16640
  s_cmp_eq_u32 s32, 149760
  s_cselect_b32 s32, 0, s32
  s_cmp_eq_u32 s30, s31
  s_cbranch_scc0 L_p2_ne_85
  s_call_b64 s[76:77], L_p2_evt
L_p2_ne_85:
  s_add_u32 m0, s32, s34
  s_add_u32 s56, s27, s33
  buffer_load_dwordx4 v8, s[64:67], s26 offen sc1 lds
  buffer_load_dwordx4 v8, s[64:67], s26 offen offset:1024 sc1 lds
  s_add_u32 s26, s26, s28
  s_add_u32 m0, s32, s35
  s_nop 0
  buffer_load_dwordx4 v11, s[12:15], s27 offen sc1 lds
  s_add_u32 m0, m0, 1056
  s_add_u32 s27, s27, s29
  buffer_load_dwordx4 v11, s[12:15], s56 offen sc1 lds
  s_add_u32 s30, s30, 1
  s_add_u32 s32, s32, 16640
  s_cmp_eq_u32 s32, 149760
  s_cselect_b32 s32, 0, s32
  s_waitcnt vmcnt(16)
  s_barrier
  s_add_u32 m0, s32, s34
  s_add_u32 s56, s27, s33
  buffer_load_dwordx4 v8, s[64:67], s26 offen sc1 lds
  buffer_load_dwordx4 v8, s[64:67], s26 offen offset:1024 sc1 lds
  s_add_u32 s26, s26, s28
  s_add_u32 m0, s32, s35
  s_nop 0
  buffer_load_dwordx4 v11, s[12:15], s27 offen sc1 lds
  s_add_u32 m0, m0, 1056
  s_add_u32 s27, s27, s29
  buffer_load_dwordx4 v11, s[12:15], s56 offen sc1 lds
  s_add_u32 s30, s30, 1
  s_add_u32 s32, s32, 16640
  s_cmp_eq_u32 s32, 149760
  s_cselect_b32 s32, 0, s32
  s_cmp_eq_u32 s30, s31
  s_cbranch_scc0 L_p2_ne_86
  s_call_b64 s[76:77], L_p2_evt
L_p2_ne_86:
  s_add_u32 m0, s32, s34
  s_add_u32 s56, s27, s33
  buffer_load_dwordx4 v8, s[64:67], s26 offen sc1 lds
  buffer_load_dwordx4 v8, s[64:67], s26 offen offset:1024 sc1 lds
  s_add_u32 s26, s26, s28
  s_add_u32 m0, s32, s35
  s_nop 0
  buffer_load_dwordx4 v11, s[12:15], s27 offen sc1 lds
  s_add_u32 m0, m0, 1056
  s_add_u32 s27, s27, s29
  buffer_load_dwordx4 v11, s[12:15], s56 offen sc1 lds
  s_add_u32 s30, s30, 1
  s_add_u32 s32, s32, 16640
  s_cmp_eq_u32 s32, 149760
  s_cselect_b32 s32, 0, s32
  s_waitcnt vmcnt(16)
  s_barrier
  s_add_u32 m0, s32, s34
  s_add_u32 s56, s27, s33
  buffer_load_dwordx4 v8, s[64:67], s26 offen sc1 lds
  buffer_load_dwordx4 v8, s[64:67], s26 offen offset:1024 sc1 lds
  s_add_u32 s26, s26, s28
  s_add_u32 m0, s32, s35
  s_nop 0
  buffer_load_dwordx4 v11, s[12:15], s27 offen sc1 lds
  s_add_u32 m0, m0, 1056
  s_add_u32 s27, s27, s29
  buffer_load_dwordx4 v11, s[12:15], s56 offen sc1 lds
  s_add_u32 s30, s30, 1
  s_add_u32 s32, s32, 16640
  s_cmp_eq_u32 s32, 149760
  s_cselect_b32 s32, 0, s32
  s_cmp_eq_u32 s30, s31
  s_cbranch_scc0 L_p2_ne_87
  s_call_b64 s[76:77], L_p2_evt
L_p2_ne_87:
  s_add_u32 m0, s32, s34
  s_add_u32 s56, s27, s33
  buffer_load_dwordx4 v8, s[64:67], s26 offen sc1 lds
  buffer_load_dwordx4 v8, s[64:67], s26 offen offset:1024 sc1 lds
  s_add_u32 s26, s26, s28
  s_add_u32 m0, s32, s35
  s_nop 0
  buffer_load_dwordx4 v11, s[12:15], s27 offen sc1 lds
  s_add_u32 m0, m0, 1056
  s_add_u32 s27, s27, s29
  buffer_load_dwordx4 v11, s[12:15], s56 offen sc1 lds
  s_add_u32 s30, s30, 1
  s_add_u32 s32, s32, 16640
  s_cmp_eq_u32 s32, 149760
  s_cselect_b32 s32, 0, s32
  ds_read_b64 v[32:33], v22 offset:0
  ds_read_b64 v[34:35], v22 offset:1024
  ds_read_b64 v[36:37], v22 offset:2048
  ds_read_b64 v[38:39], v22 offset:3072
  ds_read_b64 v[40:41], v22 offset:512
  ds_read_b64 v[42:43], v22 offset:1536
  ds_read_b64 v[44:45], v22 offset:2560
  ds_read_b64 v[46:47], v22 offset:3584
  ds_read_b64 v[48:49], v22 offset:4096
  ds_read_b64 v[50:51], v22 offset:4608
  ds_read_b64 v[52:53], v22 offset:5120
  ds_read_b64 v[54:55], v22 offset:5632
  s_waitcnt lgkmcnt(0)
  v_mfma_f32_16x16x32_bf16 v[88:91], v[48:51], v[136:139], 0
  v_mfma_f32_16x16x32_bf16 v[80:83], v[32:35], v[136:139], 0
  v_mfma_f32_16x16x32_bf16 v[84:87], v[40:43], v[136:139], 0
  v_mfma_f32_16x16x32_bf16 v[88:91], v[52:55], v[140:143], v[88:91]
  v_mfma_f32_16x16x32_bf16 v[80:83], v[36:39], v[140:143], v[80:83]
  v_mfma_f32_16x16x32_bf16 v[84:87], v[44:47], v[140:143], v[84:87]
  s_nop 7
  v_add_f32 v88, 0x358637bd, v88
  v_rcp_f32 v88, v88
  s_nop 0
  v_mul_f32 v80, v80, v88
  v_mul_f32 v81, v81, v88
  v_mul_f32 v82, v82, v88
  v_mul_f32 v83, v83, v88
  v_mul_f32 v84, v84, v88
  v_mul_f32 v85, v85, v88
  v_mul_f32 v86, v86, v88
  v_mul_f32 v87, v87, v88
  v_cvt_pk_bf16_f32 v24, v80, v81
  v_cvt_pk_bf16_f32 v25, v82, v83
  v_cvt_pk_bf16_f32 v26, v84, v85
  v_cvt_pk_bf16_f32 v27, v86, v87
  buffer_store_dwordx4 v[24:27], v4, s[64:67], s58 offen offset:0 sc1
  v_mfma_f32_16x16x32_bf16 v[88:91], v[48:51], v[144:147], 0
  v_mfma_f32_16x16x32_bf16 v[80:83], v[32:35], v[144:147], 0
  v_mfma_f32_16x16x32_bf16 v[84:87], v[40:43], v[144:147], 0
  v_mfma_f32_16x16x32_bf16 v[88:91], v[52:55], v[148:151], v[88:91]
  v_mfma_f32_16x16x32_bf16 v[80:83], v[36:39], v[148:151], v[80:83]
  v_mfma_f32_16x16x32_bf16 v[84:87], v[44:47], v[148:151], v[84:87]
  s_nop 7
  v_add_f32 v88, 0x358637bd, v88
  v_rcp_f32 v88, v88
  s_nop 0
  v_mul_f32 v80, v80, v88
  v_mul_f32 v81, v81, v88
  v_mul_f32 v82, v82, v88
  v_mul_f32 v83, v83, v88
  v_mul_f32 v84, v84, v88
  v_mul_f32 v85, v85, v88
  v_mul_f32 v86, v86, v88
  v_mul_f32 v87, v87, v88
  v_cvt_pk_bf16_f32 v28, v80, v81
  v_cvt_pk_bf16_f32 v29, v82, v83
  v_cvt_pk_bf16_f32 v30, v84, v85
  v_cvt_pk_bf16_f32 v31, v86, v87
  buffer_store_dwordx4 v[28:31], v4, s[64:67], s58 offen offset:1024 sc1
  s_waitcnt vmcnt(16)
  s_barrier
  s_add_u32 m0, s32, s34
  s_add_u32 s56, s27, s33
  buffer_load_dwordx4 v8, s[64:67], s26 offen sc1 lds
  buffer_load_dwordx4 v8, s[64:67], s26 offen offset:1024 sc1 lds
  s_add_u32 s26, s26, s28
  s_add_u32 m0, s32, s35
  s_nop 0
  buffer_load_dwordx4 v11, s[12:15], s27 offen sc1 lds
  s_add_u32 m0, m0, 1056
  s_add_u32 s27, s27, s29
  buffer_load_dwordx4 v11, s[12:15], s56 offen sc1 lds
  s_add_u32 s30, s30, 1
  s_add_u32 s32, s32, 16640
  s_cmp_eq_u32 s32, 149760
  s_cselect_b32 s32, 0, s32
  s_cmp_eq_u32 s30, s31
  s_cbranch_scc0 L_p2_ne_88
  s_call_b64 s[76:77], L_p2_evt
L_p2_ne_88:
  s_add_u32 m0, s32, s34
  s_add_u32 s56, s27, s33
  buffer_load_dwordx4 v8, s[64:67], s26 offen sc1 lds
  buffer_load_dwordx4 v8, s[64:67], s26 offen offset:1024 sc1 lds
  s_add_u32 s26, s26, s28
  s_add_u32 m0, s32, s35
  s_nop 0
  buffer_load_dwordx4 v11, s[12:15], s27 offen sc1 lds
  s_add_u32 m0, m0, 1056
  s_add_u32 s27, s27, s29
  buffer_load_dwordx4 v11, s[12:15], s56 offen sc1 lds
  s_add_u32 s30, s30, 1
  s_add_u32 s32, s32, 16640
  s_cmp_eq_u32 s32, 149760
  s_cselect_b32 s32, 0, s32
  v_mfma_f32_16x16x32_bf16 v[88:91], v[48:51], v[152:155], 0
  v_mfma_f32_16x16x32_bf16 v[80:83], v[32:35], v[152:155], 0
  v_mfma_f32_16x16x32_bf16 v[84:87], v[40:43], v[152:155], 0
  v_mfma_f32_16x16x32_bf16 v[88:91], v[52:55], v[156:159], v[88:91]
  v_mfma_f32_16x16x32_bf16 v[80:83], v[36:39], v[156:159], v[80:83]
  v_mfma_f32_16x16x32_bf16 v[84:87], v[44:47], v[156:159], v[84:87]
  s_nop 7
  v_add_f32 v88, 0x358637bd, v88
  v_rcp_f32 v88, v88
  s_nop 0
  v_mul_f32 v80, v80, v88
  v_mul_f32 v81, v81, v88
  v_mul_f32 v82, v82, v88
  v_mul_f32 v83, v83, v88
  v_mul_f32 v84, v84, v88
  v_mul_f32 v85, v85, v88
  v_mul_f32 v86, v86, v88
  v_mul_f32 v87, v87, v88
  v_cvt_pk_bf16_f32 v24, v80, v81
  v_cvt_pk_bf16_f32 v25, v82, v83
  v_cvt_pk_bf16_f32 v26, v84, v85
  v_cvt_pk_bf16_f32 v27, v86, v87
  buffer_store_dwordx4 v[24:27], v4, s[64:67], s58 offen offset:2048 sc1
  v_mfma_f32_16x16x32_bf16 v[88:91], v[48:51], v[160:163], 0
  v_mfma_f32_16x16x32_bf16 v[80:83], v[32:35], v[160:163], 0
  v_mfma_f32_16x16x32_bf16 v[84:87], v[40:43], v[160:163], 0
  v_mfma_f32_16x16x32_bf16 v[88:91], v[52:55], v[164:167], v[88:91]
  v_mfma_f32_16x16x32_bf16 v[80:83], v[36:39], v[164:167], v[80:83]
  v_mfma_f32_16x16x32_bf16 v[84:87], v[44:47], v[164:167], v[84:87]
  s_nop 7
  v_add_f32 v88, 0x358637bd, v88
  v_rcp_f32 v88, v88
  s_nop 0
  v_mul_f32 v80, v80, v88
  v_mul_f32 v81, v81, v88
  v_mul_f32 v82, v82, v88
  v_mul_f32 v83, v83, v88
  v_mul_f32 v84, v84, v88
  v_mul_f32 v85, v85, v88
  v_mul_f32 v86, v86, v88
  v_mul_f32 v87, v87, v88
  v_cvt_pk_bf16_f32 v28, v80, v81
  v_cvt_pk_bf16_f32 v29, v82, v83
  v_cvt_pk_bf16_f32 v30, v84, v85
  v_cvt_pk_bf16_f32 v31, v86, v87
  buffer_store_dwordx4 v[28:31], v4, s[64:67], s58 offen offset:3072 sc1
  s_waitcnt vmcnt(16)
  s_barrier
  s_lshl_b32 s56, s7, 9
  s_lshl_b32 s55, s4, 7
  s_add_u32 s56, s56, s55
  s_lshl_b32 s55, s6, 2
  s_add_u32 s56, s56, s55
  s_add_u32 s56, s56, 50356224
  s_waitcnt vmcnt(0)
  s_mov_b64 exec, 1
  buffer_store_dword v14, v13, s[64:67], s56 offen sc1
  s_mov_b64 exec, -1
  s_add_u32 m0, s32, s34
  s_add_u32 s56, s27, s33
  buffer_load_dwordx4 v8, s[64:67], s26 offen sc1 lds
  buffer_load_dwordx4 v8, s[64:67], s26 offen offset:1024 sc1 lds
  s_add_u32 s26, s26, s28
  s_add_u32 m0, s32, s35
  s_nop 0
  buffer_load_dwordx4 v11, s[12:15], s27 offen sc1 lds
  s_add_u32 m0, m0, 1056
  s_add_u32 s27, s27, s29
  buffer_load_dwordx4 v11, s[12:15], s56 offen sc1 lds
  s_add_u32 s30, s30, 1
  s_add_u32 s32, s32, 16640
  s_cmp_eq_u32 s32, 149760
  s_cselect_b32 s32, 0, s32
  s_cmp_eq_u32 s30, s31
  s_cbranch_scc0 L_p2_ne_89
  s_call_b64 s[76:77], L_p2_evt
L_p2_ne_89:
  s_add_u32 m0, s32, s34
  s_add_u32 s56, s27, s33
  buffer_load_dwordx4 v8, s[64:67], s26 offen sc1 lds
  buffer_load_dwordx4 v8, s[64:67], s26 offen offset:1024 sc1 lds
  s_add_u32 s26, s26, s28
  s_add_u32 m0, s32, s35
  s_nop 0
  buffer_load_dwordx4 v11, s[12:15], s27 offen sc1 lds
  s_add_u32 m0, m0, 1056
  s_add_u32 s27, s27, s29
  buffer_load_dwordx4 v11, s[12:15], s56 offen sc1 lds
  s_add_u32 s30, s30, 1
  s_add_u32 s32, s32, 16640
  s_cmp_eq_u32 s32, 149760
  s_cselect_b32 s32, 0, s32
  s_waitcnt vmcnt(16)
  s_barrier
  s_sub_u32 s60, s60, 10
L_p2_ploop:
  s_add_u32 m0, s32, s34
  s_add_u32 s56, s27, s33
  buffer_load_dwordx4 v8, s[64:67], s26 offen sc1 lds
  buffer_load_dwordx4 v8, s[64:67], s26 offen offset:1024 sc1 lds
  s_add_u32 s26, s26, s28
  s_add_u32 m0, s32, s35
  s_nop 0
  buffer_load_dwordx4 v11, s[12:15], s27 offen sc1 lds
  s_add_u32 m0, m0, 1056
  s_add_u32 s27, s27, s29
  buffer_load_dwordx4 v11, s[12:15], s56 offen sc1 lds
  s_add_u32 s30, s30, 1
  s_add_u32 s32, s32, 16640
  s_cmp_eq_u32 s32, 149760
  s_cselect_b32 s32, 0, s32
  s_cmp_eq_u32 s30, s31
  s_cbranch_scc0 L_p2_ne_90
  s_call_b64 s[76:77], L_p2_evt
L_p2_ne_90:
  s_add_u32 m0, s32, s34
  s_add_u32 s56, s27, s33
  buffer_load_dwordx4 v8, s[64:67], s26 offen sc1 lds
  buffer_load_dwordx4 v8, s[64:67], s26 offen offset:1024 sc1 lds
  s_add_u32 s26, s26, s28
  s_add_u32 m0, s32, s35
  s_nop 0
  buffer_load_dwordx4 v11, s[12:15], s27 offen sc1 lds
  s_add_u32 m0, m0, 1056
  s_add_u32 s27, s27, s29
  buffer_load_dwordx4 v11, s[12:15], s56 offen sc1 lds
  s_add_u32 s30, s30, 1
  s_add_u32 s32, s32, 16640
  s_cmp_eq_u32 s32, 149760
  s_cselect_b32 s32, 0, s32
  s_sub_u32 s60, s60, 1
  s_cmp_lg_u32 s60, 0
  s_waitcnt vmcnt(16)
  s_barrier
  s_cbranch_scc1 L_p2_ploop
  s_cmp_eq_u32 s20, 1
  s_cbranch_scc1 L_p2_end
  s_waitcnt vmcnt(0)
  s_barrier
  s_branch L_p2_end
L_p2_evt:
  s_cmp_eq_u32 s30, 44
  s_cbranch_scc1 L_p2_ev1
  s_cmp_eq_u32 s30, 76
  s_cbranch_scc1 L_p2_ev2
  s_cmp_eq_u32 s30, 80
  s_cbranch_scc1 L_p2_ev3
  s_cmp_eq_u32 s30, 82
  s_cbranch_scc1 L_p2_ev4
  s_cmp_eq_u32 s30, 1032
  s_cbranch_scc1 L_p2_ev5
  s_cmp_eq_u32 s30, 1064
  s_cbranch_scc1 L_p2_ev6
  s_cmp_eq_u32 s30, 1068
  s_cbranch_scc1 L_p2_ev7
L_p2_ev0:
  s_mov_b32 s26, 21495808
  s_mov_b32 s28, 131072
  s_mov_b32 s27, 2031616
  s_mov_b32 s29, 458752
  v_mov_b32 v11, v10
  s_mov_b32 s31, 44
  s_setpc_b64 s[76:77]
L_p2_ev1:
  s_mov_b32 s26, 23068672
  s_mov_b32 s28, 131072
  s_mov_b32 s27, 0
  s_mov_b32 s29, 65536
  v_mov_b32 v11, v9
  s_mov_b32 s12, s42
  s_and_b32 s13, s43, 0xffff
  s_mov_b32 s14, 2097152
  s_mov_b32 s31, 76
  s_setpc_b64 s[76:77]
L_p2_ev2:
  s_mov_b32 s26, 0x40000000
  s_mov_b32 s28, 0
  s_mov_b32 s12, s36
  s_and_b32 s13, s37, 0xffff
  s_mov_b32 s14, 4194304
  s_lshl_b32 s27, s21, 18
  s_lshl_b32 s55, s22, 8
  s_add_u32 s27, s27, s55
  s_lshl_b32 s55, s4, 14
  s_add_u32 s27, s27, s55
  s_add_u32 s27, s27, 0
  s_mov_b32 s29, 65536
  s_mov_b32 s33, 8192
  v_lshlrev_b32 v11, 11, v5
  v_lshl_add_u32 v11, v6, 4, v11
  s_mov_b32 s31, 80
  s_setpc_b64 s[76:77]
L_p2_ev3:
  s_mov_b32 s12, s64
  s_mov_b32 s13, s65
  s_mov_b32 s14, s66
  s_lshl_b32 s26, s23, 15
  s_add_u32 s26, s26, 33554432
  s_add_u32 s27, s26, 8192
  s_mov_b32 s28, 16384
  s_mov_b32 s29, 16384
  s_mov_b32 s33, 1024
  v_add_u32 v8, s34, v4
  v_mov_b32 v11, v8
  s_mov_b32 s31, 82
  s_setpc_b64 s[76:77]
L_p2_ev4:
  s_mov_b32 s26, 1073741824
  s_mov_b32 s28, 0
  s_mov_b32 s27, 1073741824
  s_mov_b32 s29, 0
  s_mov_b32 s31, -1
  s_setpc_b64 s[76:77]
L_p2_ev5:
  s_mov_b32 s26, 8519680
  s_mov_b32 s28, 393216
  s_mov_b32 s27, 65536
  s_mov_b32 s29, 229376
  s_mov_b32 s31, 1064
  s_setpc_b64 s[76:77]
L_p2_ev6:
  s_mov_b32 s26, 20971520
  s_mov_b32 s28, 131072
  s_mov_b32 s27, 196608
  s_mov_b32 s29, 458752
  v_mov_b32 v11, v10
  s_mov_b32 s31, 1068
  s_setpc_b64 s[76:77]
L_p2_ev7:
  s_mov_b32 s26, 1073741824
  s_mov_b32 s28, 0
  s_mov_b32 s27, 1073741824
  s_mov_b32 s29, 0
  s_mov_b32 s31, -1
  s_setpc_b64 s[76:77]
L_p2_end:
L_done:
  s_endpgm
.section .rodata,"a"
.p2align 6
.amdhsa_kernel fused_kernel
  .amdhsa_next_free_vgpr 256
  .amdhsa_next_free_sgpr 102
  .amdhsa_accum_offset 256
  .amdhsa_group_segment_fixed_size 0
  .amdhsa_kernarg_size 88
  .amdhsa_user_sgpr_count 2
  .amdhsa_user_sgpr_kernarg_segment_ptr 1
  .amdhsa_system_sgpr_workgroup_id_x 1
.end_amdhsa_kernel
```
